```python
import torch

def _softmax(x, axis=-1):
    return torch.softmax(x, dim=axis)
def _gelu(x):
    return torch.nn.functional.gelu(x, approximate="tanh")
def _silu(x):
    return torch.nn.functional.silu(x)
def _sigmoid(x):
    return torch.sigmoid(x)
def _layernorm(x, axis=-1, eps=1e-5):
    m = x.mean(dim=axis, keepdim=True)
    v = x.var(dim=axis, keepdim=True, unbiased=False)
    return (x - m) / torch.sqrt(v + eps)
def _scatter_add(tgt, idx, src, axis=0):
    return tgt.clone().index_add_(axis, idx, src)
def _segment_sum(src, seg, n):
    out = torch.zeros((n,) + src.shape[1:], dtype=src.dtype)
    return out.index_add_(0, seg, src)
def _pad(x, pw):
    flat = tuple(v for pair in reversed(pw) for v in pair)
    return torch.nn.functional.pad(x, flat)

kernel_name = 'concat_heads__mha_block_cached__gqa_block_cached__near_ridge'

def setup_inputs():

    _w = (lambda a: (lambda t: t.to(torch.bfloat16) if t.is_floating_point() else t)(torch.as_tensor(a)))
    def _A_setup():
        B, Sq, D = 16, 112, 640
        H, Sk, Dh = 32, 512, 192
        return {
            "x": _w((lambda *s: torch.randn(*s, dtype=torch.bfloat16) * 0.8)(B, Sq, D)),
            "k_cache": _w((lambda *s: torch.randn(*s, dtype=torch.bfloat16) * 0.8)(B, H, Sk, Dh)),
            "v_cache": _w((lambda *s: torch.randn(*s, dtype=torch.bfloat16) * 0.05)(B, H, Sk, Dh)),
            "wq": _w((lambda *s: torch.randn(*s, dtype=torch.bfloat16) * 0.8)(D, H * Dh) * (D ** -0.5)),
            "wo": _w((lambda *s: torch.randn(*s, dtype=torch.bfloat16) * 0.05)(H * Dh, D) * ((H * Dh) ** -0.5)),
        }
    _A_in = _A_setup()

    def _B_setup():
        B, Sq, D = 16, 112, 640
        Hq, Hkv, Sk, Dh = 32, 32, 512, 192
        assert Hq % Hkv == 0, (Hq, Hkv)
        return {
            "x": _w((lambda *s: torch.randn(*s, dtype=torch.bfloat16) * 0.8)(B, Sq, D)),
            "k_cache": _w((lambda *s: torch.randn(*s, dtype=torch.bfloat16) * 0.8)(B, Hkv, Sk, Dh)),
            "v_cache": _w((lambda *s: torch.randn(*s, dtype=torch.bfloat16) * 0.05)(B, Hkv, Sk, Dh)),
            "wq": _w((lambda *s: torch.randn(*s, dtype=torch.bfloat16) * 0.8)(D, Hq * Dh) * (D ** -0.5)),
            "wo": _w((lambda *s: torch.randn(*s, dtype=torch.bfloat16) * 0.05)(Hq * Dh, D) * ((Hq * Dh) ** -0.5)),
        }
    _B_in = _B_setup()

    return {
        "A_x": _A_in["x"],
        "A_k_cache": _A_in["k_cache"],
        "A_v_cache": _A_in["v_cache"],
        "A_wq": _A_in["wq"],
        "A_wo": _A_in["wo"],
        "B_x": _B_in["x"],
        "B_k_cache": _B_in["k_cache"],
        "B_v_cache": _B_in["v_cache"],
        "B_wq": _B_in["wq"],
        "B_wo": _B_in["wo"],
    }

def reference(A_x, A_k_cache, A_v_cache, A_wq, A_wo, B_x, B_k_cache, B_v_cache, B_wq, B_wo):
    def _A_ref(x, k_cache, v_cache, wq, wo):
        B, Sq, D = x.shape
        H, Dh = 32, 192
        q = (lambda x, *d: x.permute(*d))((x @ wq).reshape(B, Sq, H, Dh), 0, 2, 1, 3)
        scores = torch.einsum("bhqd,bhkd->bhqk", q, k_cache) * (Dh ** -0.5)
        p = _softmax(scores, axis=-1)
        o = torch.einsum("bhqk,bhkd->bhqd", p, v_cache)
        return (lambda x, *d: x.permute(*d))(o, 0, 2, 1, 3).reshape(B, Sq, H * Dh) @ wo

    def _B_ref(x, k_cache, v_cache, wq, wo):
        B, Sq, D = x.shape
        Hq, Dh = 32, 192
        Hkv = k_cache.shape[1]
        rep = Hq // Hkv
        q = (lambda x, *d: x.permute(*d))((x @ wq).reshape(B, Sq, Hq, Dh), 0, 2, 1, 3)
        k = (lambda x, n, axis: torch.repeat_interleave(x, n, dim=axis))(k_cache, rep, axis=1)
        v = (lambda x, n, axis: torch.repeat_interleave(x, n, dim=axis))(v_cache, rep, axis=1)
        scores = torch.einsum("bhqd,bhkd->bhqk", q, k) * (Dh ** -0.5)
        p = _softmax(scores, axis=-1)
        o = torch.einsum("bhqk,bhkd->bhqd", p, v)
        return (lambda x, *d: x.permute(*d))(o, 0, 2, 1, 3).reshape(B, Sq, Hq * Dh) @ wo

    a = _A_ref(A_x, A_k_cache, A_v_cache, A_wq, A_wo)
    b = _B_ref(B_x, B_k_cache, B_v_cache, B_wq, B_wo)
    return torch.concatenate([a, b], axis=-1)
```

```asm
; @launch grid=(256,1,1) block=(256,1,1) lds=163840
.amdgcn_target "amdgcn-amd-amdhsa--gfx950"
.text
.globl concat_heads__mha_block_cached__gqa_block_cached__near_ridge_kernel
.p2align 8
.type concat_heads__mha_block_cached__gqa_block_cached__near_ridge_kernel,@function
concat_heads__mha_block_cached__gqa_block_cached__near_ridge_kernel:
s_cmp_lt_u32 s2, 256
s_cbranch_scc1 L_go
s_endpgm
L_go:
s_and_b32 s44, s2, 7
s_lshr_b32 s45, s44, 2
s_mul_i32 s46, s45, 40
s_add_u32 s48, s0, s46
s_addc_u32 s49, s1, 0
s_load_dwordx4 s[52:55], s[48:49], 0
s_load_dwordx4 s[56:59], s[48:49], 16
s_load_dwordx2 s[50:51], s[48:49], 32
s_load_dwordx2 s[46:47], s[0:1], 96
v_lshrrev_b32_e32 v1, 6, v0
v_and_b32_e32 v0, 63, v0
v_readfirstlane_b32 s3, v1
s_lshr_b32 s48, s2, 3
s_and_b32 s49, s48, 15
s_lshr_b32 s95, s48, 4
s_and_b32 s44, s44, 3
s_lshl_b32 s44, s44, 1
s_add_u32 s44, s44, s95
s_cmp_lg_u32 s3, 1
s_cbranch_scc1 L_ncp
s_getpc_b64 s[4:5]
L_pc0:
s_mul_i32 s6, s48, (L_codeend-L_pc0+4095)/4096*128
v_min_u32_e32 v1, (L_codeend-L_pc0+4095)/4096-1, v0
v_lshlrev_b32_e32 v1, 7, v1
v_add_u32_e32 v1, s6, v1
v_min_u32_e32 v1, L_codeend-L_pc0-4, v1
global_load_dword v254, v1, s[4:5]
L_ncp:
s_cmp_eq_u32 s3, 3
s_cbranch_scc1 L_c1
L_c0:
v_lshrrev_b32_e32 v27, 3, v0
v_and_b32_e32 v28, 7, v0
v_lshrrev_b32_e32 v29, 1, v27
v_xor_b32_e32 v28, v28, v29
s_lshl_b32 s48, s3, 5
v_add_u32_e32 v27, s48, v27
v_mul_u32_u24_e32 v27, 1280, v27
v_lshl_add_u32 v1, v28, 4, v27
v_xor_b32_e32 v28, 4, v28
v_lshl_add_u32 v27, v28, 4, v27
v_add_u32_e32 v2, 9216, v27
v_add_u32_e32 v3, 18432, v1
v_add_u32_e32 v255, 18432, v2
s_lshl_b32 s93, s3, 12
v_mul_u32_u24_e32 v30, 1280, v0
s_waitcnt lgkmcnt(0)
s_mul_i32 s48, s49, 143360
s_add_u32 s4, s52, s48
s_addc_u32 s5, s53, 0
s_mov_b32 s6, 143360
s_mov_b32 s7, 0x20000
s_cmp_eq_u32 s95, 0
s_cbranch_scc1 L_sp0
s_lshl_b32 s48, s3, 7
s_add_u32 s36, s48, 81920
buffer_load_dword v254, v30, s[4:7], s48 offen offset:256
buffer_load_dword v254, v30, s[4:7], s36 offen offset:256
buffer_load_dword v254, v30, s[4:7], s48 offen offset:768
buffer_load_dword v254, v30, s[4:7], s36 offen offset:768
L_sp0:
s_add_u32 m0, s93, 148224
s_mov_b32 s37, 0
buffer_load_dwordx4 v1, s[4:7], s37 offen lds
buffer_load_dwordx4 v2, s[4:7], s37 offen offset:1024 lds
buffer_load_dwordx4 v3, s[4:7], s37 offen offset:2048 lds
buffer_load_dwordx4 v255, s[4:7], s37 offen offset:3072 lds
v_and_b32_e32 v144, 15, v0
v_lshrrev_b32_e32 v145, 4, v0
v_lshrrev_b32_e32 v146, 2, v144
v_and_b32_e32 v147, 3, v144
v_mul_u32_u24_e32 v28, 3088, v145
v_and_b32_e32 v29, 1, v145
v_lshl_add_u32 v28, v29, 3, v28
v_mul_u32_u24_e32 v29, 384, v146
v_add_u32_e32 v28, v28, v29
v_lshl_add_u32 v28, v147, 4, v28
v_lshrrev_b32_e32 v29, 1, v146
v_lshlrev_b32_e32 v29, 6, v29
v_xor_b32_e32 v30, 64, v29
v_add_u32_e32 v253, v28, v29
v_add_u32_e32 v31, v28, v30
v_lshrrev_b32_e32 v28, 1, v144
v_xor_b32_e32 v28, v28, v145
v_lshlrev_b32_e32 v28, 4, v28
v_mul_u32_u24_e32 v29, 384, v144
v_add_u32_e32 v4, v28, v29
v_xor_b32_e32 v5, 64, v4
v_add_u32_e32 v6, 49408, v4
v_add_u32_e32 v7, 49408, v5
v_lshl_add_u32 v28, v144, 7, v28
s_add_u32 s48, s93, 61760
v_xor_b32_e32 v29, 64, v28
v_add_u32_e32 v24, s48, v28
v_add_u32_e32 v25, s48, v29
v_lshl_add_u32 v28, v145, 2, v146
v_bfe_u32 v29, v28, 1, 2
v_lshlrev_b32_e32 v29, 5, v29
v_lshl_add_u32 v29, v147, 3, v29
v_mul_u32_u24_e32 v30, 384, v28
v_add_u32_e32 v8, v29, v30
v_lshlrev_b32_e32 v30, 7, v28
v_add_u32_e32 v30, 98816, v30
v_add_u32_e32 v20, v29, v30
v_xor_b32_e32 v9, 32, v8
v_xor_b32_e32 v21, 32, v20
v_xor_b32_e32 v10, 64, v8
v_xor_b32_e32 v22, 64, v20
v_xor_b32_e32 v11, 96, v8
v_xor_b32_e32 v23, 96, v20
v_add_u32_e32 v12, 49408, v8
v_add_u32_e32 v13, 49408, v9
v_add_u32_e32 v14, 49408, v10
v_add_u32_e32 v15, 49408, v11
s_mul_i32 s48, s3, 40960
v_lshlrev_b32_e32 v28, 4, v0
v_add_u32_e32 v26, s48, v28
v_mov_b32_e32 v246, 0
v_mov_b32_e32 v247, 0
v_mov_b32_e32 v248, 0
v_mov_b32_e32 v249, 0
v_and_b32_e32 v28, 1, v144
v_lshlrev_b32_e32 v28, 4, v28
v_mov_b32_e32 v29, 0x3f80
v_lshlrev_b32_e32 v29, v28, v29
v_cmp_eq_u32_e32 vcc, v146, v145
s_nop 1
v_cndmask_b32_e32 v29, 0, v29, vcc
v_cmp_gt_u32_e32 vcc, 2, v147
s_nop 1
v_cndmask_b32_e32 v244, 0, v29, vcc
v_cndmask_b32_e32 v245, v29, v246, vcc
v_mov_b32_e32 v250, v244
v_mov_b32_e32 v251, v245
v_mov_b32_e32 v0, v31
s_lshl_b32 s48, s49, 3
s_add_u32 s48, s48, s44
s_mul_i32 s48, s48, 786432
s_add_u32 s8, s54, s48
s_addc_u32 s9, s55, 0
s_mov_b32 s10, 786432
s_mov_b32 s11, 0x20000
s_add_u32 s12, s56, s48
s_addc_u32 s13, s57, 0
s_mov_b32 s14, 786432
s_mov_b32 s15, 0x20000
s_lshl_b32 s48, s45, 4
s_add_u32 s98, s48, s49
s_lshl_b32 s48, s98, 3
s_add_u32 s48, s48, s44
s_mov_b32 s99, s44
s_mul_i32 s48, s48, 143360
s_add_u32 s24, s46, s48
s_addc_u32 s25, s47, 0
s_mov_b32 s26, 143360
s_mov_b32 s27, 0x20000
s_mul_i32 s48, s98, 1146880
s_add_u32 s64, s46, s48
s_addc_u32 s65, s47, 0
s_mov_b32 s66, 1146880
s_mov_b32 s67, 0x20000
s_mul_i32 s48, s98, 3072
s_add_u32 s48, s48, 50331648
s_add_u32 s68, s46, s48
s_addc_u32 s69, s47, 0
s_mov_b32 s70, 3072
s_mov_b32 s71, 0x20000
s_mov_b32 s40, 0x3dd53b95
s_mov_b32 s41, 0x3dd53b95
s_mov_b32 s42, 0x4f800000
s_mov_b32 s28, 0
s_mov_b32 s31, 0
s_mov_b32 s30, 0
v_mov_b32_e32 v160, 0
v_mov_b32_e32 v161, 0
v_mov_b32_e32 v162, 0
v_mov_b32_e32 v163, 0
s_nop 1
v_mfma_f32_32x32x16_bf16 a[0:15], v[160:163], v[160:163], 0
v_mfma_f32_32x32x16_bf16 a[16:31], v[160:163], v[160:163], 0
v_mfma_f32_32x32x16_bf16 a[32:47], v[160:163], v[160:163], 0
v_mfma_f32_32x32x16_bf16 a[48:63], v[160:163], v[160:163], 0
v_mfma_f32_32x32x16_bf16 a[64:79], v[160:163], v[160:163], 0
v_mfma_f32_32x32x16_bf16 a[80:95], v[160:163], v[160:163], 0
v_mfma_f32_32x32x16_bf16 a[96:111], v[160:163], v[160:163], 0
v_mfma_f32_32x32x16_bf16 a[112:127], v[160:163], v[160:163], 0
v_mfma_f32_32x32x16_bf16 a[128:143], v[160:163], v[160:163], 0
v_mfma_f32_32x32x16_bf16 a[144:159], v[160:163], v[160:163], 0
s_branch L_item0
L_c1:
v_lshrrev_b32_e32 v27, 3, v0
v_and_b32_e32 v28, 7, v0
v_lshrrev_b32_e32 v29, 1, v27
v_xor_b32_e32 v28, v28, v29
s_lshl_b32 s48, s3, 5
v_add_u32_e32 v27, s48, v27
v_mul_u32_u24_e32 v27, 1280, v27
v_lshl_add_u32 v1, v28, 4, v27
v_xor_b32_e32 v28, 4, v28
v_lshl_add_u32 v27, v28, 4, v27
v_add_u32_e32 v2, 9216, v27
s_lshl_b32 s93, s3, 12
v_add_u32_e32 v27, 0, v0
v_mul_u32_u24_e32 v176, 2731, v27
v_lshrrev_b32_e32 v176, 16, v176
v_mul_u32_u24_e32 v28, 24, v176
v_sub_u32_e32 v179, v27, v28
v_and_b32_e32 v27, 2, v176
v_lshlrev_b32_e32 v27, 1, v27
v_xor_b32_e32 v27, v27, v179
v_mul_u32_u24_e32 v28, 12288, v176
v_lshl_add_u32 v27, v27, 4, v28
v_subrev_u32_e32 v53, 0, v27
v_add_u32_e32 v27, 64, v0
v_mul_u32_u24_e32 v177, 2731, v27
v_lshrrev_b32_e32 v177, 16, v177
v_mul_u32_u24_e32 v28, 24, v177
v_sub_u32_e32 v180, v27, v28
v_and_b32_e32 v27, 2, v177
v_lshlrev_b32_e32 v27, 1, v27
v_xor_b32_e32 v27, v27, v180
v_mul_u32_u24_e32 v28, 12288, v177
v_lshl_add_u32 v27, v27, 4, v28
v_subrev_u32_e32 v54, 1024, v27
v_add_u32_e32 v27, 128, v0
v_mul_u32_u24_e32 v178, 2731, v27
v_lshrrev_b32_e32 v178, 16, v178
v_mul_u32_u24_e32 v28, 24, v178
v_sub_u32_e32 v181, v27, v28
v_and_b32_e32 v27, 2, v178
v_lshlrev_b32_e32 v27, 1, v27
v_xor_b32_e32 v27, v27, v181
v_mul_u32_u24_e32 v28, 12288, v178
v_lshl_add_u32 v27, v27, 4, v28
v_subrev_u32_e32 v55, 2048, v27
s_mov_b32 s34, 0
v_mul_u32_u24_e32 v30, 1280, v0
v_add_u32_e32 v27, 0, v0
v_min_u32_e32 v27, 119, v27
v_mul_u32_u24_e32 v28, 21846, v27
v_lshrrev_b32_e32 v28, 16, v28
v_mul_u32_u24_e32 v29, 3, v28
v_sub_u32_e32 v29, v27, v29
s_mul_i32 s48, s49, 40
v_add_u32_e32 v28, s48, v28
v_mul_u32_u24_e32 v28, 12288, v28
v_lshl_add_u32 v79, v29, 7, v28
v_add_u32_e32 v27, 64, v0
v_min_u32_e32 v27, 119, v27
v_mul_u32_u24_e32 v28, 21846, v27
v_lshrrev_b32_e32 v28, 16, v28
v_mul_u32_u24_e32 v29, 3, v28
v_sub_u32_e32 v29, v27, v29
s_mul_i32 s48, s49, 40
v_add_u32_e32 v28, s48, v28
v_mul_u32_u24_e32 v28, 12288, v28
v_lshl_add_u32 v84, v29, 7, v28
s_waitcnt lgkmcnt(0)
s_mul_i32 s48, s49, 143360
s_add_u32 s4, s52, s48
s_addc_u32 s5, s53, 0
s_mov_b32 s6, 143360
s_mov_b32 s7, 0x20000
s_mul_i32 s48, s44, 1536
s_add_u32 s16, s58, s48
s_addc_u32 s17, s59, 0
s_sub_u32 s18, 7864320, s48
s_mov_b32 s19, 0x20000
s_cmp_eq_u32 s95, 0
s_cbranch_scc1 L_sp1
s_sub_u32 s20, s16, 1536
s_subb_u32 s21, s17, 0
s_mov_b32 s22, s18
s_mov_b32 s23, 0x20000
buffer_load_dword v254, v79, s[20:23], 0 offen offset:0
buffer_load_dword v254, v84, s[20:23], 0 offen offset:0
buffer_load_dword v254, v79, s[16:19], 0 offen offset:0
buffer_load_dword v254, v84, s[16:19], 0 offen offset:0
s_lshl_b32 s48, s3, 7
s_add_u32 s36, s48, 81920
buffer_load_dword v254, v30, s[4:7], s48 offen offset:256
buffer_load_dword v254, v30, s[4:7], s36 offen offset:256
buffer_load_dword v254, v30, s[4:7], s48 offen offset:768
buffer_load_dword v254, v30, s[4:7], s36 offen offset:768
L_sp1:
s_mov_b32 m0, 98816
s_add_u32 s36, s34, 0
buffer_load_dwordx4 v53, s[16:19], s36 offen lds
buffer_load_dwordx4 v54, s[16:19], s36 offen offset:1024 lds
buffer_load_dwordx4 v55, s[16:19], s36 offen offset:2048 lds
s_addk_i32 m0, 3096
s_add_u32 s36, s34, 98304
buffer_load_dwordx4 v53, s[16:19], s36 offen lds
buffer_load_dwordx4 v54, s[16:19], s36 offen offset:1024 lds
buffer_load_dwordx4 v55, s[16:19], s36 offen offset:2048 lds
s_addk_i32 m0, 3080
s_add_u32 s36, s34, 196608
buffer_load_dwordx4 v53, s[16:19], s36 offen lds
buffer_load_dwordx4 v54, s[16:19], s36 offen offset:1024 lds
buffer_load_dwordx4 v55, s[16:19], s36 offen offset:2048 lds
s_addk_i32 m0, 3096
s_add_u32 s36, s34, 294912
buffer_load_dwordx4 v53, s[16:19], s36 offen lds
buffer_load_dwordx4 v54, s[16:19], s36 offen offset:1024 lds
buffer_load_dwordx4 v55, s[16:19], s36 offen offset:2048 lds
s_add_u32 m0, s93, 148224
s_mov_b32 s37, 0
buffer_load_dwordx4 v1, s[4:7], s37 offen lds
buffer_load_dwordx4 v2, s[4:7], s37 offen offset:1024 lds
s_mov_b32 m0, 111168
s_add_u32 s36, s34, 393216
buffer_load_dwordx4 v53, s[16:19], s36 offen lds
buffer_load_dwordx4 v54, s[16:19], s36 offen offset:1024 lds
buffer_load_dwordx4 v55, s[16:19], s36 offen offset:2048 lds
s_addk_i32 m0, 3096
s_add_u32 s36, s34, 491520
buffer_load_dwordx4 v53, s[16:19], s36 offen lds
buffer_load_dwordx4 v54, s[16:19], s36 offen offset:1024 lds
buffer_load_dwordx4 v55, s[16:19], s36 offen offset:2048 lds
s_addk_i32 m0, 3080
s_add_u32 s36, s34, 589824
buffer_load_dwordx4 v53, s[16:19], s36 offen lds
buffer_load_dwordx4 v54, s[16:19], s36 offen offset:1024 lds
buffer_load_dwordx4 v55, s[16:19], s36 offen offset:2048 lds
s_addk_i32 m0, 3096
s_add_u32 s36, s34, 688128
buffer_load_dwordx4 v53, s[16:19], s36 offen lds
buffer_load_dwordx4 v54, s[16:19], s36 offen offset:1024 lds
buffer_load_dwordx4 v55, s[16:19], s36 offen offset:2048 lds
s_addk_i32 m0, 3080
s_add_u32 s36, s34, 786432
buffer_load_dwordx4 v53, s[16:19], s36 offen lds
buffer_load_dwordx4 v54, s[16:19], s36 offen offset:1024 lds
buffer_load_dwordx4 v55, s[16:19], s36 offen offset:2048 lds
s_addk_i32 m0, 3096
s_add_u32 s36, s34, 884736
buffer_load_dwordx4 v53, s[16:19], s36 offen lds
buffer_load_dwordx4 v54, s[16:19], s36 offen offset:1024 lds
buffer_load_dwordx4 v55, s[16:19], s36 offen offset:2048 lds
s_addk_i32 m0, 3080
s_add_u32 s36, s34, 983040
buffer_load_dwordx4 v53, s[16:19], s36 offen lds
buffer_load_dwordx4 v54, s[16:19], s36 offen offset:1024 lds
buffer_load_dwordx4 v55, s[16:19], s36 offen offset:2048 lds
s_addk_i32 m0, 3096
s_add_u32 s36, s34, 1081344
buffer_load_dwordx4 v53, s[16:19], s36 offen lds
buffer_load_dwordx4 v54, s[16:19], s36 offen offset:1024 lds
buffer_load_dwordx4 v55, s[16:19], s36 offen offset:2048 lds
v_mul_u32_u24_e32 v28, 384, v176
v_lshrrev_b32_e32 v27, 1, v176
v_xor_b32_e32 v27, v27, v179
v_lshl_add_u32 v27, v27, 4, v28
v_xor_b32_e32 v29, 64, v27
v_subrev_u32_e32 v36, 0, v27
v_subrev_u32_e32 v39, 0, v29
v_and_b32_e32 v27, 6, v176
v_xor_b32_e32 v27, v27, v179
v_lshl_add_u32 v27, v27, 4, v28
v_subrev_u32_e32 v46, 0, v27
v_mul_u32_u24_e32 v28, 384, v177
v_lshrrev_b32_e32 v27, 1, v177
v_xor_b32_e32 v27, v27, v180
v_lshl_add_u32 v27, v27, 4, v28
v_xor_b32_e32 v29, 64, v27
v_subrev_u32_e32 v37, 1024, v27
v_subrev_u32_e32 v44, 1024, v29
v_and_b32_e32 v27, 6, v177
v_xor_b32_e32 v27, v27, v180
v_lshl_add_u32 v27, v27, 4, v28
v_subrev_u32_e32 v47, 1024, v27
v_mul_u32_u24_e32 v28, 384, v178
v_lshrrev_b32_e32 v27, 1, v178
v_xor_b32_e32 v27, v27, v181
v_lshl_add_u32 v27, v27, 4, v28
v_xor_b32_e32 v29, 64, v27
v_subrev_u32_e32 v38, 2048, v27
v_subrev_u32_e32 v45, 2048, v29
v_and_b32_e32 v27, 6, v178
v_xor_b32_e32 v27, v27, v181
v_lshl_add_u32 v27, v27, 4, v28
v_subrev_u32_e32 v52, 2048, v27
v_lshrrev_b32_e32 v29, 3, v0
v_and_b32_e32 v30, 7, v0
v_and_b32_e32 v27, 6, v29
v_xor_b32_e32 v27, v27, v30
v_mul_u32_u24_e32 v28, 1280, v29
v_lshl_add_u32 v63, v27, 4, v28
v_add_u32_e32 v68, 9216, v63
v_add_u32_e32 v69, 18432, v63
v_add_u32_e32 v70, 27648, v63
v_lshlrev_b32_e32 v85, 7, v0
s_mul_i32 s43, s49, 15360
s_mov_b32 s101, 384
s_mov_b32 s32, -4096
s_mov_b32 s33, -4096
s_mov_b32 s35, 0x40000000
v_and_b32_e32 v144, 15, v0
v_lshrrev_b32_e32 v145, 4, v0
v_lshrrev_b32_e32 v146, 2, v144
v_and_b32_e32 v147, 3, v144
v_mul_u32_u24_e32 v28, 3088, v145
v_and_b32_e32 v29, 1, v145
v_lshl_add_u32 v28, v29, 3, v28
v_mul_u32_u24_e32 v29, 384, v146
v_add_u32_e32 v28, v28, v29
v_lshl_add_u32 v28, v147, 4, v28
v_lshrrev_b32_e32 v29, 1, v146
v_lshlrev_b32_e32 v29, 6, v29
v_xor_b32_e32 v30, 64, v29
v_add_u32_e32 v18, v28, v29
v_add_u32_e32 v19, v28, v30
v_add_u32_e32 v16, 98816, v18
v_add_u32_e32 v17, 98816, v19
v_lshrrev_b32_e32 v28, 1, v144
v_xor_b32_e32 v28, v28, v145
v_lshlrev_b32_e32 v28, 4, v28
v_mul_u32_u24_e32 v29, 384, v144
v_add_u32_e32 v4, v28, v29
v_xor_b32_e32 v5, 64, v4
v_add_u32_e32 v6, 49408, v4
v_add_u32_e32 v7, 49408, v5
v_lshl_add_u32 v28, v144, 7, v28
s_add_u32 s48, s93, 61760
v_xor_b32_e32 v29, 64, v28
v_add_u32_e32 v24, s48, v28
v_add_u32_e32 v25, s48, v29
v_lshl_add_u32 v28, v145, 2, v146
v_bfe_u32 v29, v28, 1, 2
v_lshlrev_b32_e32 v29, 5, v29
v_lshl_add_u32 v29, v147, 3, v29
v_mul_u32_u24_e32 v30, 384, v28
v_add_u32_e32 v8, v29, v30
v_lshlrev_b32_e32 v30, 7, v28
v_add_u32_e32 v30, 98816, v30
v_add_u32_e32 v20, v29, v30
v_xor_b32_e32 v9, 32, v8
v_xor_b32_e32 v21, 32, v20
v_xor_b32_e32 v10, 64, v8
v_xor_b32_e32 v22, 64, v20
v_xor_b32_e32 v11, 96, v8
v_xor_b32_e32 v23, 96, v20
v_add_u32_e32 v12, 49408, v8
v_add_u32_e32 v13, 49408, v9
v_add_u32_e32 v14, 49408, v10
v_add_u32_e32 v15, 49408, v11
s_mul_i32 s48, s3, 40960
v_lshlrev_b32_e32 v28, 4, v0
v_add_u32_e32 v26, s48, v28
v_mov_b32_e32 v246, 0
v_mov_b32_e32 v247, 0
v_mov_b32_e32 v248, 0
v_mov_b32_e32 v249, 0
v_and_b32_e32 v28, 1, v144
v_lshlrev_b32_e32 v28, 4, v28
v_mov_b32_e32 v29, 0x3f80
v_lshlrev_b32_e32 v29, v28, v29
v_cmp_eq_u32_e32 vcc, v146, v145
s_nop 1
v_cndmask_b32_e32 v29, 0, v29, vcc
v_cmp_gt_u32_e32 vcc, 2, v147
s_nop 1
v_cndmask_b32_e32 v244, 0, v29, vcc
v_cndmask_b32_e32 v245, v29, v246, vcc
v_mov_b32_e32 v250, v244
v_mov_b32_e32 v251, v245
s_lshl_b32 s48, s49, 3
s_add_u32 s48, s48, s44
s_mul_i32 s48, s48, 786432
s_add_u32 s8, s54, s48
s_addc_u32 s9, s55, 0
s_mov_b32 s10, 786432
s_mov_b32 s11, 0x20000
s_add_u32 s12, s56, s48
s_addc_u32 s13, s57, 0
s_mov_b32 s14, 786432
s_mov_b32 s15, 0x20000
s_mul_i32 s48, s44, 983040
s_add_u32 s20, s50, s48
s_addc_u32 s21, s51, 0
s_sub_u32 s22, 7864320, s48
s_mov_b32 s23, 0x20000
s_lshl_b32 s48, s45, 4
s_add_u32 s98, s48, s49
s_lshl_b32 s48, s98, 3
s_add_u32 s48, s48, s44
s_mov_b32 s99, s44
s_mul_i32 s48, s48, 143360
s_add_u32 s24, s46, s48
s_addc_u32 s25, s47, 0
s_mov_b32 s26, 143360
s_mov_b32 s27, 0x20000
s_mul_i32 s48, s98, 1146880
s_add_u32 s64, s46, s48
s_addc_u32 s65, s47, 0
s_mov_b32 s66, 1146880
s_mov_b32 s67, 0x20000
s_mul_i32 s48, s98, 3072
s_add_u32 s48, s48, 50331648
s_add_u32 s68, s46, s48
s_addc_u32 s69, s47, 0
s_mov_b32 s70, 3072
s_mov_b32 s71, 0x20000
v_min_u32_e32 v86, 7, v0
v_lshlrev_b32_e32 v86, 7, v86
v_lshlrev_b32_e32 v76, 4, v0
buffer_load_dword v92, v86, s[68:71], 0 offen offset:0 sc1
buffer_load_dword v93, v86, s[68:71], 0 offen offset:1024 sc1
buffer_load_dword v94, v86, s[68:71], 0 offen offset:2048 sc1
s_getpc_b64 s[72:73]
L_pc2:
s_sub_u32 s72, s72, L_pc2-L_pc0
s_subb_u32 s73, s73, 0
s_lshr_b32 s48, s2, 3
s_mul_i32 s48, s48, (L_codeend-L_pc0+4095)/4096*128
v_min_u32_e32 v71, (L_codeend-L_pc0+4095)/4096-1, v0
v_lshlrev_b32_e32 v71, 7, v71
v_add_u32_e32 v71, s48, v71
v_min_u32_e32 v71, L_codeend-L_pc0-4, v71
s_mov_b32 s40, 0x3dd53b95
s_mov_b32 s41, 0x3dd53b95
s_mov_b32 s42, 0x4f800000
s_mov_b32 s28, 0
s_mov_b32 s31, 0
s_mov_b32 s30, 0
v_mov_b32_e32 v160, 0
v_mov_b32_e32 v161, 0
v_mov_b32_e32 v162, 0
v_mov_b32_e32 v163, 0
s_nop 1
v_mfma_f32_32x32x16_bf16 a[0:15], v[160:163], v[160:163], 0
v_mfma_f32_32x32x16_bf16 a[16:31], v[160:163], v[160:163], 0
v_mfma_f32_32x32x16_bf16 a[32:47], v[160:163], v[160:163], 0
v_mfma_f32_32x32x16_bf16 a[48:63], v[160:163], v[160:163], 0
v_mfma_f32_32x32x16_bf16 a[64:79], v[160:163], v[160:163], 0
v_mfma_f32_32x32x16_bf16 a[80:95], v[160:163], v[160:163], 0
v_mfma_f32_32x32x16_bf16 a[96:111], v[160:163], v[160:163], 0
v_mfma_f32_32x32x16_bf16 a[112:127], v[160:163], v[160:163], 0
v_mfma_f32_32x32x16_bf16 a[128:143], v[160:163], v[160:163], 0
v_mfma_f32_32x32x16_bf16 a[144:159], v[160:163], v[160:163], 0
s_branch L_item1
.p2align 7
L_item0:
s_mov_b32 s29, 3
s_mov_b32 s90, 0xba98cba9
s_mov_b32 s91, 0xa98c
s_add_u32 s92, s93, 61760
s_mov_b32 s38, 98816
v_add_u32_e32 v16, s38, v253
v_add_u32_e32 v17, s38, v0
s_mov_b32 s38, 111168
v_add_u32_e32 v18, s38, v253
v_add_u32_e32 v19, s38, v0
s_barrier
s_waitcnt vmcnt(0)
v_add_u32_e32 v27, 86464, v24
v_add_u32_e32 v29, 86464, v25
ds_read_b128 v[144:147], v27 offset:0
ds_read_b128 v[148:151], v27 offset:2048
ds_read_b128 v[152:155], v29 offset:0
ds_read_b128 v[156:159], v29 offset:2048
ds_read_b64_tr_b16 a[208:209], v16 offset:0
ds_read_b64_tr_b16 a[210:211], v16 offset:1536
ds_read_b64_tr_b16 a[212:213], v16 offset:8
ds_read_b64_tr_b16 a[214:215], v16 offset:1544
ds_read_b64_tr_b16 a[216:217], v17 offset:0
ds_read_b64_tr_b16 a[218:219], v17 offset:1536
ds_read_b64_tr_b16 a[220:221], v17 offset:8
ds_read_b64_tr_b16 a[222:223], v17 offset:1544
ds_read_b64_tr_b16 a[224:225], v16 offset:128
ds_read_b64_tr_b16 a[226:227], v16 offset:1664
ds_read_b64_tr_b16 a[228:229], v16 offset:136
ds_read_b64_tr_b16 a[230:231], v16 offset:1672
ds_read_b64_tr_b16 a[232:233], v17 offset:128
ds_read_b64_tr_b16 a[234:235], v17 offset:1664
ds_read_b64_tr_b16 a[236:237], v17 offset:136
ds_read_b64_tr_b16 a[238:239], v17 offset:1672
ds_read_b64_tr_b16 a[240:241], v16 offset:256
ds_read_b64_tr_b16 a[242:243], v16 offset:1792
v_cvt_pk_bf16_f32 v192, v32, v33
v_cvt_pk_bf16_f32 v193, v34, v35
v_pk_mul_f32 v[56:57], v[56:57], v[28:29] op_sel_hi:[1,0]
v_pk_mul_f32 v[58:59], v[58:59], v[28:29] op_sel_hi:[1,0]
v_pk_mul_f32 v[60:61], v[60:61], v[30:31] op_sel_hi:[1,0]
v_pk_mul_f32 v[62:63], v[62:63], v[30:31] op_sel_hi:[1,0]
v_pk_mul_f32 v[64:65], v[64:65], v[28:29] op_sel_hi:[1,0]
v_pk_mul_f32 v[66:67], v[66:67], v[28:29] op_sel_hi:[1,0]
v_pk_mul_f32 v[68:69], v[68:69], v[30:31] op_sel_hi:[1,0]
v_pk_mul_f32 v[70:71], v[70:71], v[30:31] op_sel_hi:[1,0]
v_pk_mul_f32 v[72:73], v[72:73], v[28:29] op_sel_hi:[1,0]
v_pk_mul_f32 v[74:75], v[74:75], v[28:29] op_sel_hi:[1,0]
v_pk_mul_f32 v[76:77], v[76:77], v[30:31] op_sel_hi:[1,0]
v_pk_mul_f32 v[78:79], v[78:79], v[30:31] op_sel_hi:[1,0]
v_pk_mul_f32 v[80:81], v[80:81], v[28:29] op_sel_hi:[1,0]
v_pk_mul_f32 v[82:83], v[82:83], v[28:29] op_sel_hi:[1,0]
v_pk_mul_f32 v[84:85], v[84:85], v[30:31] op_sel_hi:[1,0]
v_pk_mul_f32 v[86:87], v[86:87], v[30:31] op_sel_hi:[1,0]
v_pk_mul_f32 v[88:89], v[88:89], v[28:29] op_sel_hi:[1,0]
v_pk_mul_f32 v[90:91], v[90:91], v[28:29] op_sel_hi:[1,0]
v_pk_mul_f32 v[92:93], v[92:93], v[30:31] op_sel_hi:[1,0]
v_pk_mul_f32 v[94:95], v[94:95], v[30:31] op_sel_hi:[1,0]
v_pk_mul_f32 v[96:97], v[96:97], v[28:29] op_sel_hi:[1,0]
v_pk_mul_f32 v[98:99], v[98:99], v[28:29] op_sel_hi:[1,0]
v_pk_mul_f32 v[100:101], v[100:101], v[30:31] op_sel_hi:[1,0]
v_pk_mul_f32 v[102:103], v[102:103], v[30:31] op_sel_hi:[1,0]
v_pk_mul_f32 v[104:105], v[104:105], v[28:29] op_sel_hi:[1,0]
v_pk_mul_f32 v[106:107], v[106:107], v[28:29] op_sel_hi:[1,0]
v_pk_mul_f32 v[108:109], v[108:109], v[30:31] op_sel_hi:[1,0]
v_pk_mul_f32 v[110:111], v[110:111], v[30:31] op_sel_hi:[1,0]
v_pk_mul_f32 v[112:113], v[112:113], v[28:29] op_sel_hi:[1,0]
v_pk_mul_f32 v[114:115], v[114:115], v[28:29] op_sel_hi:[1,0]
v_pk_mul_f32 v[116:117], v[116:117], v[30:31] op_sel_hi:[1,0]
v_pk_mul_f32 v[118:119], v[118:119], v[30:31] op_sel_hi:[1,0]
v_pk_mul_f32 v[120:121], v[120:121], v[28:29] op_sel_hi:[1,0]
v_pk_mul_f32 v[122:123], v[122:123], v[28:29] op_sel_hi:[1,0]
v_pk_mul_f32 v[124:125], v[124:125], v[30:31] op_sel_hi:[1,0]
v_pk_mul_f32 v[126:127], v[126:127], v[30:31] op_sel_hi:[1,0]
s_waitcnt lgkmcnt(12)
v_mfma_f32_16x16x32_bf16 v[32:35], a[208:211], v[144:147], 0
v_cvt_pk_bf16_f32 v196, v36, v37
v_cvt_pk_bf16_f32 v197, v38, v39
v_mfma_f32_16x16x32_bf16 v[36:39], a[208:211], v[148:151], 0
ds_read_b64_tr_b16 a[244:245], v16 offset:264
ds_read_b64_tr_b16 a[246:247], v16 offset:1800
v_cvt_pk_bf16_f32 v194, v40, v41
v_cvt_pk_bf16_f32 v195, v42, v43
v_mfma_f32_16x16x32_bf16 v[40:43], a[212:215], v[144:147], 0
v_cvt_pk_bf16_f32 v198, v44, v45
v_cvt_pk_bf16_f32 v199, v46, v47
v_mfma_f32_16x16x32_bf16 v[44:47], a[212:215], v[148:151], 0
ds_read_b64_tr_b16 a[248:249], v17 offset:256
ds_read_b64_tr_b16 a[250:251], v17 offset:1792
v_cvt_pk_bf16_f32 v200, v48, v49
v_cvt_pk_bf16_f32 v201, v50, v51
v_mfma_f32_16x16x32_bf16 v[48:51], a[216:219], v[144:147], 0
v_cvt_pk_bf16_f32 v204, v52, v53
v_cvt_pk_bf16_f32 v205, v54, v55
v_mfma_f32_16x16x32_bf16 v[52:55], a[216:219], v[148:151], 0
s_waitcnt lgkmcnt(10)
ds_read_b64_tr_b16 a[252:253], v17 offset:264
ds_read_b64_tr_b16 a[254:255], v17 offset:1800
v_cvt_pk_bf16_f32 v202, v56, v57
v_cvt_pk_bf16_f32 v203, v58, v59
v_mfma_f32_16x16x32_bf16 v[56:59], a[220:223], v[144:147], 0
s_add_u32 m0, s92, 14336
s_add_u32 s37, s37, 128
buffer_load_dwordx4 v1, s[4:7], s37 offen lds
v_cvt_pk_bf16_f32 v206, v60, v61
v_cvt_pk_bf16_f32 v207, v62, v63
v_mfma_f32_16x16x32_bf16 v[60:63], a[220:223], v[148:151], 0
s_barrier
ds_read_b64_tr_b16 a[208:209], v18 offset:0
ds_read_b64_tr_b16 a[210:211], v18 offset:1536
v_cvt_pk_bf16_f32 v208, v64, v65
v_cvt_pk_bf16_f32 v209, v66, v67
v_mfma_f32_16x16x32_bf16 v[64:67], a[224:227], v[144:147], 0
buffer_load_dwordx4 v2, s[4:7], s37 offen offset:1024 lds
v_cvt_pk_bf16_f32 v212, v68, v69
v_cvt_pk_bf16_f32 v213, v70, v71
v_mfma_f32_16x16x32_bf16 v[68:71], a[224:227], v[148:151], 0
ds_read_b64_tr_b16 a[212:213], v18 offset:8
ds_read_b64_tr_b16 a[214:215], v18 offset:1544
v_cvt_pk_bf16_f32 v210, v72, v73
v_cvt_pk_bf16_f32 v211, v74, v75
v_mfma_f32_16x16x32_bf16 v[72:75], a[228:231], v[144:147], 0
s_mov_b32 s38, 123520
v_cvt_pk_bf16_f32 v214, v76, v77
v_cvt_pk_bf16_f32 v215, v78, v79
v_mfma_f32_16x16x32_bf16 v[76:79], a[228:231], v[148:151], 0
s_waitcnt lgkmcnt(10)
ds_read_b64_tr_b16 a[216:217], v19 offset:0
ds_read_b64_tr_b16 a[218:219], v19 offset:1536
buffer_load_dwordx4 v3, s[4:7], s37 offen offset:2048 lds
v_cvt_pk_bf16_f32 v216, v80, v81
v_cvt_pk_bf16_f32 v217, v82, v83
v_mfma_f32_16x16x32_bf16 v[80:83], a[232:235], v[144:147], 0
v_cvt_pk_bf16_f32 v220, v84, v85
v_cvt_pk_bf16_f32 v221, v86, v87
v_mfma_f32_16x16x32_bf16 v[84:87], a[232:235], v[148:151], 0
ds_read_b64_tr_b16 a[220:221], v19 offset:8
ds_read_b64_tr_b16 a[222:223], v19 offset:1544
v_cvt_pk_bf16_f32 v218, v88, v89
v_cvt_pk_bf16_f32 v219, v90, v91
v_mfma_f32_16x16x32_bf16 v[88:91], a[236:239], v[144:147], 0
buffer_load_dwordx4 v255, s[4:7], s37 offen offset:3072 lds
v_cvt_pk_bf16_f32 v222, v92, v93
v_cvt_pk_bf16_f32 v223, v94, v95
v_mfma_f32_16x16x32_bf16 v[92:95], a[236:239], v[148:151], 0
ds_read_b64_tr_b16 a[224:225], v18 offset:128
ds_read_b64_tr_b16 a[226:227], v18 offset:1664
v_cvt_pk_bf16_f32 v224, v96, v97
v_cvt_pk_bf16_f32 v225, v98, v99
v_mfma_f32_16x16x32_bf16 v[96:99], a[240:243], v[144:147], 0
v_cvt_pk_bf16_f32 v228, v100, v101
v_cvt_pk_bf16_f32 v229, v102, v103
v_mfma_f32_16x16x32_bf16 v[100:103], a[240:243], v[148:151], 0
s_waitcnt lgkmcnt(10)
ds_read_b64_tr_b16 a[228:229], v18 offset:136
ds_read_b64_tr_b16 a[230:231], v18 offset:1672
v_cvt_pk_bf16_f32 v226, v104, v105
v_cvt_pk_bf16_f32 v227, v106, v107
v_mfma_f32_16x16x32_bf16 v[104:107], a[244:247], v[144:147], 0
v_cvt_pk_bf16_f32 v230, v108, v109
v_cvt_pk_bf16_f32 v231, v110, v111
v_mfma_f32_16x16x32_bf16 v[108:111], a[244:247], v[148:151], 0
ds_read_b64_tr_b16 a[232:233], v19 offset:128
ds_read_b64_tr_b16 a[234:235], v19 offset:1664
v_cvt_pk_bf16_f32 v232, v112, v113
v_cvt_pk_bf16_f32 v233, v114, v115
v_mfma_f32_16x16x32_bf16 v[112:115], a[248:251], v[144:147], 0
v_cvt_pk_bf16_f32 v236, v116, v117
v_cvt_pk_bf16_f32 v237, v118, v119
v_mfma_f32_16x16x32_bf16 v[116:119], a[248:251], v[148:151], 0
ds_read_b64_tr_b16 a[236:237], v19 offset:136
ds_read_b64_tr_b16 a[238:239], v19 offset:1672
v_cvt_pk_bf16_f32 v234, v120, v121
v_cvt_pk_bf16_f32 v235, v122, v123
v_mfma_f32_16x16x32_bf16 v[120:123], a[252:255], v[144:147], 0
v_cvt_pk_bf16_f32 v238, v124, v125
v_cvt_pk_bf16_f32 v239, v126, v127
v_mfma_f32_16x16x32_bf16 v[124:127], a[252:255], v[148:151], 0
s_waitcnt lgkmcnt(10)
ds_read_b64_tr_b16 a[240:241], v18 offset:256
ds_read_b64_tr_b16 a[242:243], v18 offset:1792
v_add_u32_e32 v16, s38, v253
v_add_u32_e32 v17, s38, v0
v_mfma_f32_16x16x32_bf16 v[32:35], a[208:211], v[152:155], v[32:35]
s_add_u32 m0, s92, 0
s_add_u32 s37, s37, 128
ds_read_b64_tr_b16 a[244:245], v18 offset:264
v_mfma_f32_16x16x32_bf16 v[36:39], a[208:211], v[156:159], v[36:39]
ds_read_b64_tr_b16 a[246:247], v18 offset:1800
ds_read_b64_tr_b16 a[248:249], v19 offset:256
v_mfma_f32_16x16x32_bf16 v[40:43], a[212:215], v[152:155], v[40:43]
buffer_load_dwordx4 v1, s[4:7], s37 offen lds
v_mfma_f32_16x16x32_bf16 v[44:47], a[212:215], v[156:159], v[44:47]
ds_read_b64_tr_b16 a[250:251], v19 offset:1792
ds_read_b64_tr_b16 a[252:253], v19 offset:264
v_mfma_f32_16x16x32_bf16 v[48:51], a[216:219], v[152:155], v[48:51]
buffer_load_dwordx4 v2, s[4:7], s37 offen offset:1024 lds
v_mfma_f32_16x16x32_bf16 v[52:55], a[216:219], v[156:159], v[52:55]
s_waitcnt lgkmcnt(11)
ds_read_b64_tr_b16 a[254:255], v19 offset:1800
v_accvgpr_write_b32 a160, v192
v_mfma_f32_16x16x32_bf16 v[56:59], a[220:223], v[152:155], v[56:59]
buffer_load_dwordx4 v3, s[4:7], s37 offen offset:2048 lds
buffer_load_dwordx4 v255, s[4:7], s37 offen offset:3072 lds
v_mfma_f32_16x16x32_bf16 v[60:63], a[220:223], v[156:159], v[60:63]
s_barrier
ds_read_b64_tr_b16 a[208:209], v16 offset:0
ds_read_b64_tr_b16 a[210:211], v16 offset:1536
v_mfma_f32_16x16x32_bf16 v[64:67], a[224:227], v[152:155], v[64:67]
s_waitcnt vmcnt(4)
s_mov_b32 s38, 135872
ds_read_b64_tr_b16 a[212:213], v16 offset:8
v_mfma_f32_16x16x32_bf16 v[68:71], a[224:227], v[156:159], v[68:71]
ds_read_b64_tr_b16 a[214:215], v16 offset:1544
v_add_u32_e32 v18, s38, v253
v_mfma_f32_16x16x32_bf16 v[72:75], a[228:231], v[152:155], v[72:75]
ds_read_b64_tr_b16 a[216:217], v17 offset:0
v_add_u32_e32 v19, s38, v0
v_mfma_f32_16x16x32_bf16 v[76:79], a[228:231], v[156:159], v[76:79]
s_waitcnt lgkmcnt(11)
ds_read_b64_tr_b16 a[218:219], v17 offset:1536
ds_read_b128 v[160:163], v24 offset:14336
v_mfma_f32_16x16x32_bf16 v[80:83], a[232:235], v[152:155], v[80:83]
ds_read_b64_tr_b16 a[220:221], v17 offset:8
v_accvgpr_write_b32 a161, v193
v_mfma_f32_16x16x32_bf16 v[84:87], a[232:235], v[156:159], v[84:87]
ds_read_b64_tr_b16 a[222:223], v17 offset:1544
ds_read_b128 v[164:167], v24 offset:16384
v_mfma_f32_16x16x32_bf16 v[88:91], a[236:239], v[152:155], v[88:91]
ds_read_b64_tr_b16 a[224:225], v16 offset:128
v_accvgpr_write_b32 a164, v196
v_mfma_f32_16x16x32_bf16 v[92:95], a[236:239], v[156:159], v[92:95]
ds_read_b64_tr_b16 a[226:227], v16 offset:1664
ds_read_b128 v[168:171], v25 offset:14336
v_mfma_f32_16x16x32_bf16 v[96:99], a[240:243], v[152:155], v[96:99]
ds_read_b64_tr_b16 a[228:229], v16 offset:136
v_accvgpr_write_b32 a165, v197
v_mfma_f32_16x16x32_bf16 v[100:103], a[240:243], v[156:159], v[100:103]
s_waitcnt lgkmcnt(14)
ds_read_b64_tr_b16 a[230:231], v16 offset:1672
ds_read_b128 v[172:175], v25 offset:16384
v_mfma_f32_16x16x32_bf16 v[104:107], a[244:247], v[152:155], v[104:107]
ds_read_b64_tr_b16 a[232:233], v17 offset:128
v_accvgpr_write_b32 a162, v194
v_mfma_f32_16x16x32_bf16 v[108:111], a[244:247], v[156:159], v[108:111]
ds_read_b64_tr_b16 a[234:235], v17 offset:1664
v_accvgpr_write_b32 a163, v195
v_mfma_f32_16x16x32_bf16 v[112:115], a[248:251], v[152:155], v[112:115]
ds_read_b64_tr_b16 a[236:237], v17 offset:136
v_accvgpr_write_b32 a166, v198
v_mfma_f32_16x16x32_bf16 v[116:119], a[248:251], v[156:159], v[116:119]
ds_read_b64_tr_b16 a[238:239], v17 offset:1672
v_accvgpr_write_b32 a167, v199
v_mfma_f32_16x16x32_bf16 v[120:123], a[252:255], v[152:155], v[120:123]
ds_read_b64_tr_b16 a[240:241], v16 offset:256
v_accvgpr_write_b32 a168, v200
v_mfma_f32_16x16x32_bf16 v[124:127], a[252:255], v[156:159], v[124:127]
s_waitcnt lgkmcnt(5)
ds_read_b64_tr_b16 a[242:243], v16 offset:1792
v_accvgpr_write_b32 a169, v201
v_mfma_f32_16x16x32_bf16 v[32:35], a[208:211], v[160:163], v[32:35]
ds_read_b64_tr_b16 a[244:245], v16 offset:264
v_accvgpr_write_b32 a172, v204
v_mfma_f32_16x16x32_bf16 v[36:39], a[208:211], v[164:167], v[36:39]
ds_read_b64_tr_b16 a[246:247], v16 offset:1800
v_accvgpr_write_b32 a173, v205
v_mfma_f32_16x16x32_bf16 v[40:43], a[212:215], v[160:163], v[40:43]
ds_read_b64_tr_b16 a[248:249], v17 offset:256
v_accvgpr_write_b32 a170, v202
v_mfma_f32_16x16x32_bf16 v[44:47], a[212:215], v[164:167], v[44:47]
ds_read_b64_tr_b16 a[250:251], v17 offset:1792
v_accvgpr_write_b32 a171, v203
v_mfma_f32_16x16x32_bf16 v[48:51], a[216:219], v[160:163], v[48:51]
ds_read_b64_tr_b16 a[252:253], v17 offset:264
v_accvgpr_write_b32 a174, v206
v_mfma_f32_16x16x32_bf16 v[52:55], a[216:219], v[164:167], v[52:55]
s_waitcnt lgkmcnt(12)
ds_read_b64_tr_b16 a[254:255], v17 offset:1800
v_accvgpr_write_b32 a175, v207
v_mfma_f32_16x16x32_bf16 v[56:59], a[220:223], v[160:163], v[56:59]
s_barrier
v_accvgpr_write_b32 a176, v208
v_accvgpr_write_b32 a177, v209
v_mfma_f32_16x16x32_bf16 v[60:63], a[220:223], v[164:167], v[60:63]
ds_read_b64_tr_b16 a[208:209], v18 offset:0
ds_read_b64_tr_b16 a[210:211], v18 offset:1536
v_mfma_f32_16x16x32_bf16 v[64:67], a[224:227], v[160:163], v[64:67]
s_mov_b32 s38, 148224
ds_read_b64_tr_b16 a[212:213], v18 offset:8
ds_read_b64_tr_b16 a[214:215], v18 offset:1544
v_mfma_f32_16x16x32_bf16 v[68:71], a[224:227], v[164:167], v[68:71]
s_add_u32 m0, s92, 14336
s_add_u32 s37, s37, 128
ds_read_b64_tr_b16 a[216:217], v19 offset:0
v_mfma_f32_16x16x32_bf16 v[72:75], a[228:231], v[160:163], v[72:75]
ds_read_b64_tr_b16 a[218:219], v19 offset:1536
v_add_u32_e32 v16, s38, v253
v_mfma_f32_16x16x32_bf16 v[76:79], a[228:231], v[164:167], v[76:79]
s_waitcnt lgkmcnt(12)
ds_read_b64_tr_b16 a[220:221], v19 offset:8
ds_read_b64_tr_b16 a[222:223], v19 offset:1544
v_mfma_f32_16x16x32_bf16 v[80:83], a[232:235], v[160:163], v[80:83]
buffer_load_dwordx4 v1, s[4:7], s37 offen lds
v_mfma_f32_16x16x32_bf16 v[84:87], a[232:235], v[164:167], v[84:87]
ds_read_b64_tr_b16 a[224:225], v18 offset:128
v_add_u32_e32 v17, s38, v0
v_mfma_f32_16x16x32_bf16 v[88:91], a[236:239], v[160:163], v[88:91]
ds_read_b64_tr_b16 a[226:227], v18 offset:1664
ds_read_b64_tr_b16 a[228:229], v18 offset:136
v_mfma_f32_16x16x32_bf16 v[92:95], a[236:239], v[164:167], v[92:95]
buffer_load_dwordx4 v2, s[4:7], s37 offen offset:1024 lds
v_mfma_f32_16x16x32_bf16 v[96:99], a[240:243], v[160:163], v[96:99]
ds_read_b64_tr_b16 a[230:231], v18 offset:1672
v_accvgpr_write_b32 a180, v212
v_mfma_f32_16x16x32_bf16 v[100:103], a[240:243], v[164:167], v[100:103]
s_waitcnt lgkmcnt(12)
ds_read_b64_tr_b16 a[232:233], v19 offset:128
ds_read_b64_tr_b16 a[234:235], v19 offset:1664
v_mfma_f32_16x16x32_bf16 v[104:107], a[244:247], v[160:163], v[104:107]
buffer_load_dwordx4 v3, s[4:7], s37 offen offset:2048 lds
v_mfma_f32_16x16x32_bf16 v[108:111], a[244:247], v[164:167], v[108:111]
ds_read_b64_tr_b16 a[236:237], v19 offset:136
v_accvgpr_write_b32 a181, v213
v_mfma_f32_16x16x32_bf16 v[112:115], a[248:251], v[160:163], v[112:115]
ds_read_b64_tr_b16 a[238:239], v19 offset:1672
ds_read_b64_tr_b16 a[240:241], v18 offset:256
v_mfma_f32_16x16x32_bf16 v[116:119], a[248:251], v[164:167], v[116:119]
buffer_load_dwordx4 v255, s[4:7], s37 offen offset:3072 lds
v_mfma_f32_16x16x32_bf16 v[120:123], a[252:255], v[160:163], v[120:123]
ds_read_b64_tr_b16 a[242:243], v18 offset:1792
v_accvgpr_write_b32 a178, v210
v_mfma_f32_16x16x32_bf16 v[124:127], a[252:255], v[164:167], v[124:127]
s_waitcnt lgkmcnt(12)
ds_read_b64_tr_b16 a[244:245], v18 offset:264
v_accvgpr_write_b32 a179, v211
v_mfma_f32_16x16x32_bf16 v[32:35], a[208:211], v[168:171], v[32:35]
ds_read_b64_tr_b16 a[246:247], v18 offset:1800
v_accvgpr_write_b32 a182, v214
v_mfma_f32_16x16x32_bf16 v[36:39], a[208:211], v[172:175], v[36:39]
ds_read_b64_tr_b16 a[248:249], v19 offset:256
v_accvgpr_write_b32 a183, v215
v_mfma_f32_16x16x32_bf16 v[40:43], a[212:215], v[168:171], v[40:43]
ds_read_b64_tr_b16 a[250:251], v19 offset:1792
v_accvgpr_write_b32 a184, v216
v_mfma_f32_16x16x32_bf16 v[44:47], a[212:215], v[172:175], v[44:47]
ds_read_b64_tr_b16 a[252:253], v19 offset:264
v_accvgpr_write_b32 a185, v217
v_mfma_f32_16x16x32_bf16 v[48:51], a[216:219], v[168:171], v[48:51]
ds_read_b64_tr_b16 a[254:255], v19 offset:1800
v_accvgpr_write_b32 a188, v220
v_mfma_f32_16x16x32_bf16 v[52:55], a[216:219], v[172:175], v[52:55]
s_barrier
s_waitcnt lgkmcnt(12)
v_accvgpr_write_b32 a189, v221
v_mfma_f32_16x16x32_bf16 v[56:59], a[220:223], v[168:171], v[56:59]
ds_read_b64_tr_b16 a[208:209], v16 offset:0
v_accvgpr_write_b32 a186, v218
v_mfma_f32_16x16x32_bf16 v[60:63], a[220:223], v[172:175], v[60:63]
ds_read_b64_tr_b16 a[210:211], v16 offset:1536
v_accvgpr_write_b32 a187, v219
v_mfma_f32_16x16x32_bf16 v[64:67], a[224:227], v[168:171], v[64:67]
s_waitcnt vmcnt(4)
s_mov_b32 s38, 98816
ds_read_b64_tr_b16 a[212:213], v16 offset:8
v_mfma_f32_16x16x32_bf16 v[68:71], a[224:227], v[172:175], v[68:71]
ds_read_b64_tr_b16 a[214:215], v16 offset:1544
v_accvgpr_write_b32 a190, v222
v_mfma_f32_16x16x32_bf16 v[72:75], a[228:231], v[168:171], v[72:75]
ds_read_b64_tr_b16 a[216:217], v17 offset:0
v_accvgpr_write_b32 a191, v223
v_mfma_f32_16x16x32_bf16 v[76:79], a[228:231], v[172:175], v[76:79]
s_waitcnt lgkmcnt(11)
ds_read_b64_tr_b16 a[218:219], v17 offset:1536
ds_read_b128 v[144:147], v24 offset:0
v_mfma_f32_16x16x32_bf16 v[80:83], a[232:235], v[168:171], v[80:83]
ds_read_b64_tr_b16 a[220:221], v17 offset:8
v_accvgpr_write_b32 a192, v224
v_mfma_f32_16x16x32_bf16 v[84:87], a[232:235], v[172:175], v[84:87]
ds_read_b64_tr_b16 a[222:223], v17 offset:1544
ds_read_b128 v[148:151], v24 offset:2048
v_mfma_f32_16x16x32_bf16 v[88:91], a[236:239], v[168:171], v[88:91]
ds_read_b64_tr_b16 a[224:225], v16 offset:128
v_accvgpr_write_b32 a193, v225
v_mfma_f32_16x16x32_bf16 v[92:95], a[236:239], v[172:175], v[92:95]
ds_read_b64_tr_b16 a[226:227], v16 offset:1664
ds_read_b128 v[152:155], v25 offset:0
v_mfma_f32_16x16x32_bf16 v[96:99], a[240:243], v[168:171], v[96:99]
ds_read_b64_tr_b16 a[228:229], v16 offset:136
v_accvgpr_write_b32 a196, v228
v_mfma_f32_16x16x32_bf16 v[100:103], a[240:243], v[172:175], v[100:103]
s_waitcnt lgkmcnt(14)
ds_read_b64_tr_b16 a[230:231], v16 offset:1672
ds_read_b128 v[156:159], v25 offset:2048
v_mfma_f32_16x16x32_bf16 v[104:107], a[244:247], v[168:171], v[104:107]
ds_read_b64_tr_b16 a[232:233], v17 offset:128
v_accvgpr_write_b32 a197, v229
v_mfma_f32_16x16x32_bf16 v[108:111], a[244:247], v[172:175], v[108:111]
ds_read_b64_tr_b16 a[234:235], v17 offset:1664
v_accvgpr_write_b32 a194, v226
v_mfma_f32_16x16x32_bf16 v[112:115], a[248:251], v[168:171], v[112:115]
ds_read_b64_tr_b16 a[236:237], v17 offset:136
v_accvgpr_write_b32 a195, v227
v_mfma_f32_16x16x32_bf16 v[116:119], a[248:251], v[172:175], v[116:119]
ds_read_b64_tr_b16 a[238:239], v17 offset:1672
v_accvgpr_write_b32 a198, v230
v_mfma_f32_16x16x32_bf16 v[120:123], a[252:255], v[168:171], v[120:123]
v_accvgpr_write_b32 a199, v231
v_accvgpr_write_b32 a200, v232
v_accvgpr_write_b32 a201, v233
v_accvgpr_write_b32 a204, v236
v_accvgpr_write_b32 a205, v237
v_accvgpr_write_b32 a202, v234
v_accvgpr_write_b32 a203, v235
v_accvgpr_write_b32 a206, v238
v_accvgpr_write_b32 a207, v239
v_mfma_f32_16x16x32_bf16 v[124:127], a[252:255], v[172:175], v[124:127]
ds_read_b64_tr_b16 a[240:241], v16 offset:256
ds_read_b64_tr_b16 a[242:243], v16 offset:1792
v_add_u32_e32 v18, s38, v253
v_add_u32_e32 v19, s38, v0
L_q0:
s_waitcnt lgkmcnt(6)
v_mfma_f32_16x16x32_bf16 v[32:35], a[208:211], v[144:147], v[32:35]
ds_read_b64_tr_b16 a[244:245], v16 offset:264
v_mfma_f32_16x16x32_bf16 v[36:39], a[208:211], v[148:151], v[36:39]
ds_read_b64_tr_b16 a[246:247], v16 offset:1800
v_mfma_f32_16x16x32_bf16 v[40:43], a[212:215], v[144:147], v[40:43]
ds_read_b64_tr_b16 a[248:249], v17 offset:256
v_mfma_f32_16x16x32_bf16 v[44:47], a[212:215], v[148:151], v[44:47]
ds_read_b64_tr_b16 a[250:251], v17 offset:1792
v_mfma_f32_16x16x32_bf16 v[48:51], a[216:219], v[144:147], v[48:51]
ds_read_b64_tr_b16 a[252:253], v17 offset:264
v_mfma_f32_16x16x32_bf16 v[52:55], a[216:219], v[148:151], v[52:55]
s_waitcnt lgkmcnt(12)
ds_read_b64_tr_b16 a[254:255], v17 offset:1800
v_mfma_f32_16x16x32_bf16 v[56:59], a[220:223], v[144:147], v[56:59]
s_barrier
v_mfma_f32_16x16x32_bf16 v[60:63], a[220:223], v[148:151], v[60:63]
ds_read_b64_tr_b16 a[208:209], v18 offset:0
ds_read_b64_tr_b16 a[210:211], v18 offset:1536
v_mfma_f32_16x16x32_bf16 v[64:67], a[224:227], v[144:147], v[64:67]
s_and_b32 s38, s90, 15
s_lshr_b64 s[90:91], s[90:91], 4
s_mulk_i32 s38, 12352
v_mfma_f32_16x16x32_bf16 v[68:71], a[224:227], v[148:151], v[68:71]
ds_read_b64_tr_b16 a[212:213], v18 offset:8
ds_read_b64_tr_b16 a[214:215], v18 offset:1544
v_mfma_f32_16x16x32_bf16 v[72:75], a[228:231], v[144:147], v[72:75]
s_add_u32 m0, s92, 0
s_add_u32 s37, s37, 128
ds_read_b64_tr_b16 a[216:217], v19 offset:0
v_mfma_f32_16x16x32_bf16 v[76:79], a[228:231], v[148:151], v[76:79]
s_waitcnt lgkmcnt(11)
ds_read_b64_tr_b16 a[218:219], v19 offset:1536
ds_read_b64_tr_b16 a[220:221], v19 offset:8
v_mfma_f32_16x16x32_bf16 v[80:83], a[232:235], v[144:147], v[80:83]
buffer_load_dwordx4 v1, s[4:7], s37 offen lds
v_mfma_f32_16x16x32_bf16 v[84:87], a[232:235], v[148:151], v[84:87]
ds_read_b64_tr_b16 a[222:223], v19 offset:1544
v_add_u32_e32 v16, s38, v253
v_mfma_f32_16x16x32_bf16 v[88:91], a[236:239], v[144:147], v[88:91]
ds_read_b64_tr_b16 a[224:225], v18 offset:128
ds_read_b64_tr_b16 a[226:227], v18 offset:1664
v_mfma_f32_16x16x32_bf16 v[92:95], a[236:239], v[148:151], v[92:95]
buffer_load_dwordx4 v2, s[4:7], s37 offen offset:1024 lds
v_mfma_f32_16x16x32_bf16 v[96:99], a[240:243], v[144:147], v[96:99]
ds_read_b64_tr_b16 a[228:229], v18 offset:136
v_add_u32_e32 v17, s38, v0
v_mfma_f32_16x16x32_bf16 v[100:103], a[240:243], v[148:151], v[100:103]
s_waitcnt lgkmcnt(11)
ds_read_b64_tr_b16 a[230:231], v18 offset:1672
ds_read_b64_tr_b16 a[232:233], v19 offset:128
v_mfma_f32_16x16x32_bf16 v[104:107], a[244:247], v[144:147], v[104:107]
buffer_load_dwordx4 v3, s[4:7], s37 offen offset:2048 lds
v_mfma_f32_16x16x32_bf16 v[108:111], a[244:247], v[148:151], v[108:111]
ds_read_b64_tr_b16 a[234:235], v19 offset:1664
v_mfma_f32_16x16x32_bf16 v[112:115], a[248:251], v[144:147], v[112:115]
ds_read_b64_tr_b16 a[236:237], v19 offset:136
ds_read_b64_tr_b16 a[238:239], v19 offset:1672
v_mfma_f32_16x16x32_bf16 v[116:119], a[248:251], v[148:151], v[116:119]
buffer_load_dwordx4 v255, s[4:7], s37 offen offset:3072 lds
v_mfma_f32_16x16x32_bf16 v[120:123], a[252:255], v[144:147], v[120:123]
ds_read_b64_tr_b16 a[240:241], v18 offset:256
v_mfma_f32_16x16x32_bf16 v[124:127], a[252:255], v[148:151], v[124:127]
s_waitcnt lgkmcnt(11)
ds_read_b64_tr_b16 a[242:243], v18 offset:1792
v_mfma_f32_16x16x32_bf16 v[32:35], a[208:211], v[152:155], v[32:35]
ds_read_b64_tr_b16 a[244:245], v18 offset:264
v_mfma_f32_16x16x32_bf16 v[36:39], a[208:211], v[156:159], v[36:39]
ds_read_b64_tr_b16 a[246:247], v18 offset:1800
v_mfma_f32_16x16x32_bf16 v[40:43], a[212:215], v[152:155], v[40:43]
ds_read_b64_tr_b16 a[248:249], v19 offset:256
v_mfma_f32_16x16x32_bf16 v[44:47], a[212:215], v[156:159], v[44:47]
ds_read_b64_tr_b16 a[250:251], v19 offset:1792
v_mfma_f32_16x16x32_bf16 v[48:51], a[216:219], v[152:155], v[48:51]
ds_read_b64_tr_b16 a[252:253], v19 offset:264
v_mfma_f32_16x16x32_bf16 v[52:55], a[216:219], v[156:159], v[52:55]
s_waitcnt lgkmcnt(11)
ds_read_b64_tr_b16 a[254:255], v19 offset:1800
v_mfma_f32_16x16x32_bf16 v[56:59], a[220:223], v[152:155], v[56:59]
s_barrier
v_mfma_f32_16x16x32_bf16 v[60:63], a[220:223], v[156:159], v[60:63]
ds_read_b64_tr_b16 a[208:209], v16 offset:0
ds_read_b64_tr_b16 a[210:211], v16 offset:1536
v_mfma_f32_16x16x32_bf16 v[64:67], a[224:227], v[152:155], v[64:67]
s_waitcnt vmcnt(4)
s_and_b32 s38, s90, 15
s_lshr_b64 s[90:91], s[90:91], 4
v_mfma_f32_16x16x32_bf16 v[68:71], a[224:227], v[156:159], v[68:71]
s_mulk_i32 s38, 12352
ds_read_b64_tr_b16 a[212:213], v16 offset:8
ds_read_b64_tr_b16 a[214:215], v16 offset:1544
v_mfma_f32_16x16x32_bf16 v[72:75], a[228:231], v[152:155], v[72:75]
ds_read_b64_tr_b16 a[216:217], v17 offset:0
v_add_u32_e32 v18, s38, v253
v_mfma_f32_16x16x32_bf16 v[76:79], a[228:231], v[156:159], v[76:79]
s_waitcnt lgkmcnt(11)
ds_read_b64_tr_b16 a[218:219], v17 offset:1536
ds_read_b128 v[160:163], v24 offset:14336
v_mfma_f32_16x16x32_bf16 v[80:83], a[232:235], v[152:155], v[80:83]
ds_read_b64_tr_b16 a[220:221], v17 offset:8
v_add_u32_e32 v19, s38, v0
v_mfma_f32_16x16x32_bf16 v[84:87], a[232:235], v[156:159], v[84:87]
ds_read_b64_tr_b16 a[222:223], v17 offset:1544
ds_read_b128 v[164:167], v24 offset:16384
v_mfma_f32_16x16x32_bf16 v[88:91], a[236:239], v[152:155], v[88:91]
ds_read_b64_tr_b16 a[224:225], v16 offset:128
v_mfma_f32_16x16x32_bf16 v[92:95], a[236:239], v[156:159], v[92:95]
ds_read_b64_tr_b16 a[226:227], v16 offset:1664
ds_read_b128 v[168:171], v25 offset:14336
v_mfma_f32_16x16x32_bf16 v[96:99], a[240:243], v[152:155], v[96:99]
ds_read_b64_tr_b16 a[228:229], v16 offset:136
v_mfma_f32_16x16x32_bf16 v[100:103], a[240:243], v[156:159], v[100:103]
s_waitcnt lgkmcnt(14)
ds_read_b64_tr_b16 a[230:231], v16 offset:1672
ds_read_b128 v[172:175], v25 offset:16384
v_mfma_f32_16x16x32_bf16 v[104:107], a[244:247], v[152:155], v[104:107]
ds_read_b64_tr_b16 a[232:233], v17 offset:128
v_mfma_f32_16x16x32_bf16 v[108:111], a[244:247], v[156:159], v[108:111]
ds_read_b64_tr_b16 a[234:235], v17 offset:1664
v_mfma_f32_16x16x32_bf16 v[112:115], a[248:251], v[152:155], v[112:115]
ds_read_b64_tr_b16 a[236:237], v17 offset:136
v_mfma_f32_16x16x32_bf16 v[116:119], a[248:251], v[156:159], v[116:119]
ds_read_b64_tr_b16 a[238:239], v17 offset:1672
v_mfma_f32_16x16x32_bf16 v[120:123], a[252:255], v[152:155], v[120:123]
ds_read_b64_tr_b16 a[240:241], v16 offset:256
v_mfma_f32_16x16x32_bf16 v[124:127], a[252:255], v[156:159], v[124:127]
s_waitcnt lgkmcnt(5)
ds_read_b64_tr_b16 a[242:243], v16 offset:1792
v_mfma_f32_16x16x32_bf16 v[32:35], a[208:211], v[160:163], v[32:35]
ds_read_b64_tr_b16 a[244:245], v16 offset:264
v_mfma_f32_16x16x32_bf16 v[36:39], a[208:211], v[164:167], v[36:39]
ds_read_b64_tr_b16 a[246:247], v16 offset:1800
v_mfma_f32_16x16x32_bf16 v[40:43], a[212:215], v[160:163], v[40:43]
ds_read_b64_tr_b16 a[248:249], v17 offset:256
v_mfma_f32_16x16x32_bf16 v[44:47], a[212:215], v[164:167], v[44:47]
ds_read_b64_tr_b16 a[250:251], v17 offset:1792
v_mfma_f32_16x16x32_bf16 v[48:51], a[216:219], v[160:163], v[48:51]
ds_read_b64_tr_b16 a[252:253], v17 offset:264
v_mfma_f32_16x16x32_bf16 v[52:55], a[216:219], v[164:167], v[52:55]
s_waitcnt lgkmcnt(12)
ds_read_b64_tr_b16 a[254:255], v17 offset:1800
v_mfma_f32_16x16x32_bf16 v[56:59], a[220:223], v[160:163], v[56:59]
s_barrier
v_mfma_f32_16x16x32_bf16 v[60:63], a[220:223], v[164:167], v[60:63]
ds_read_b64_tr_b16 a[208:209], v18 offset:0
ds_read_b64_tr_b16 a[210:211], v18 offset:1536
v_mfma_f32_16x16x32_bf16 v[64:67], a[224:227], v[160:163], v[64:67]
s_and_b32 s38, s90, 15
s_lshr_b64 s[90:91], s[90:91], 4
s_mulk_i32 s38, 12352
v_mfma_f32_16x16x32_bf16 v[68:71], a[224:227], v[164:167], v[68:71]
ds_read_b64_tr_b16 a[212:213], v18 offset:8
ds_read_b64_tr_b16 a[214:215], v18 offset:1544
v_mfma_f32_16x16x32_bf16 v[72:75], a[228:231], v[160:163], v[72:75]
s_add_u32 m0, s92, 14336
s_add_u32 s37, s37, 128
ds_read_b64_tr_b16 a[216:217], v19 offset:0
v_mfma_f32_16x16x32_bf16 v[76:79], a[228:231], v[164:167], v[76:79]
s_waitcnt lgkmcnt(11)
ds_read_b64_tr_b16 a[218:219], v19 offset:1536
ds_read_b64_tr_b16 a[220:221], v19 offset:8
v_mfma_f32_16x16x32_bf16 v[80:83], a[232:235], v[160:163], v[80:83]
buffer_load_dwordx4 v1, s[4:7], s37 offen lds
v_mfma_f32_16x16x32_bf16 v[84:87], a[232:235], v[164:167], v[84:87]
ds_read_b64_tr_b16 a[222:223], v19 offset:1544
v_add_u32_e32 v16, s38, v253
v_mfma_f32_16x16x32_bf16 v[88:91], a[236:239], v[160:163], v[88:91]
ds_read_b64_tr_b16 a[224:225], v18 offset:128
ds_read_b64_tr_b16 a[226:227], v18 offset:1664
v_mfma_f32_16x16x32_bf16 v[92:95], a[236:239], v[164:167], v[92:95]
buffer_load_dwordx4 v2, s[4:7], s37 offen offset:1024 lds
v_mfma_f32_16x16x32_bf16 v[96:99], a[240:243], v[160:163], v[96:99]
ds_read_b64_tr_b16 a[228:229], v18 offset:136
v_add_u32_e32 v17, s38, v0
v_mfma_f32_16x16x32_bf16 v[100:103], a[240:243], v[164:167], v[100:103]
s_waitcnt lgkmcnt(11)
ds_read_b64_tr_b16 a[230:231], v18 offset:1672
ds_read_b64_tr_b16 a[232:233], v19 offset:128
v_mfma_f32_16x16x32_bf16 v[104:107], a[244:247], v[160:163], v[104:107]
buffer_load_dwordx4 v3, s[4:7], s37 offen offset:2048 lds
v_mfma_f32_16x16x32_bf16 v[108:111], a[244:247], v[164:167], v[108:111]
ds_read_b64_tr_b16 a[234:235], v19 offset:1664
v_mfma_f32_16x16x32_bf16 v[112:115], a[248:251], v[160:163], v[112:115]
ds_read_b64_tr_b16 a[236:237], v19 offset:136
ds_read_b64_tr_b16 a[238:239], v19 offset:1672
v_mfma_f32_16x16x32_bf16 v[116:119], a[248:251], v[164:167], v[116:119]
buffer_load_dwordx4 v255, s[4:7], s37 offen offset:3072 lds
v_mfma_f32_16x16x32_bf16 v[120:123], a[252:255], v[160:163], v[120:123]
ds_read_b64_tr_b16 a[240:241], v18 offset:256
v_mfma_f32_16x16x32_bf16 v[124:127], a[252:255], v[164:167], v[124:127]
s_waitcnt lgkmcnt(11)
ds_read_b64_tr_b16 a[242:243], v18 offset:1792
v_mfma_f32_16x16x32_bf16 v[32:35], a[208:211], v[168:171], v[32:35]
ds_read_b64_tr_b16 a[244:245], v18 offset:264
v_mfma_f32_16x16x32_bf16 v[36:39], a[208:211], v[172:175], v[36:39]
ds_read_b64_tr_b16 a[246:247], v18 offset:1800
v_mfma_f32_16x16x32_bf16 v[40:43], a[212:215], v[168:171], v[40:43]
ds_read_b64_tr_b16 a[248:249], v19 offset:256
v_mfma_f32_16x16x32_bf16 v[44:47], a[212:215], v[172:175], v[44:47]
ds_read_b64_tr_b16 a[250:251], v19 offset:1792
v_mfma_f32_16x16x32_bf16 v[48:51], a[216:219], v[168:171], v[48:51]
ds_read_b64_tr_b16 a[252:253], v19 offset:264
v_mfma_f32_16x16x32_bf16 v[52:55], a[216:219], v[172:175], v[52:55]
s_waitcnt lgkmcnt(11)
ds_read_b64_tr_b16 a[254:255], v19 offset:1800
v_mfma_f32_16x16x32_bf16 v[56:59], a[220:223], v[168:171], v[56:59]
s_barrier
v_mfma_f32_16x16x32_bf16 v[60:63], a[220:223], v[172:175], v[60:63]
ds_read_b64_tr_b16 a[208:209], v16 offset:0
ds_read_b64_tr_b16 a[210:211], v16 offset:1536
v_mfma_f32_16x16x32_bf16 v[64:67], a[224:227], v[168:171], v[64:67]
s_waitcnt vmcnt(4)
s_and_b32 s38, s90, 15
s_lshr_b64 s[90:91], s[90:91], 4
v_mfma_f32_16x16x32_bf16 v[68:71], a[224:227], v[172:175], v[68:71]
s_mulk_i32 s38, 12352
ds_read_b64_tr_b16 a[212:213], v16 offset:8
ds_read_b64_tr_b16 a[214:215], v16 offset:1544
v_mfma_f32_16x16x32_bf16 v[72:75], a[228:231], v[168:171], v[72:75]
ds_read_b64_tr_b16 a[216:217], v17 offset:0
v_add_u32_e32 v18, s38, v253
v_mfma_f32_16x16x32_bf16 v[76:79], a[228:231], v[172:175], v[76:79]
s_waitcnt lgkmcnt(11)
ds_read_b64_tr_b16 a[218:219], v17 offset:1536
ds_read_b128 v[144:147], v24 offset:0
v_mfma_f32_16x16x32_bf16 v[80:83], a[232:235], v[168:171], v[80:83]
ds_read_b64_tr_b16 a[220:221], v17 offset:8
v_add_u32_e32 v19, s38, v0
v_mfma_f32_16x16x32_bf16 v[84:87], a[232:235], v[172:175], v[84:87]
ds_read_b64_tr_b16 a[222:223], v17 offset:1544
ds_read_b128 v[148:151], v24 offset:2048
v_mfma_f32_16x16x32_bf16 v[88:91], a[236:239], v[168:171], v[88:91]
ds_read_b64_tr_b16 a[224:225], v16 offset:128
v_mfma_f32_16x16x32_bf16 v[92:95], a[236:239], v[172:175], v[92:95]
ds_read_b64_tr_b16 a[226:227], v16 offset:1664
ds_read_b128 v[152:155], v25 offset:0
v_mfma_f32_16x16x32_bf16 v[96:99], a[240:243], v[168:171], v[96:99]
ds_read_b64_tr_b16 a[228:229], v16 offset:136
v_mfma_f32_16x16x32_bf16 v[100:103], a[240:243], v[172:175], v[100:103]
s_waitcnt lgkmcnt(14)
ds_read_b64_tr_b16 a[230:231], v16 offset:1672
ds_read_b128 v[156:159], v25 offset:2048
v_mfma_f32_16x16x32_bf16 v[104:107], a[244:247], v[168:171], v[104:107]
ds_read_b64_tr_b16 a[232:233], v17 offset:128
v_mfma_f32_16x16x32_bf16 v[108:111], a[244:247], v[172:175], v[108:111]
ds_read_b64_tr_b16 a[234:235], v17 offset:1664
v_mfma_f32_16x16x32_bf16 v[112:115], a[248:251], v[168:171], v[112:115]
ds_read_b64_tr_b16 a[236:237], v17 offset:136
v_mfma_f32_16x16x32_bf16 v[116:119], a[248:251], v[172:175], v[116:119]
ds_read_b64_tr_b16 a[238:239], v17 offset:1672
v_mfma_f32_16x16x32_bf16 v[120:123], a[252:255], v[168:171], v[120:123]
ds_read_b64_tr_b16 a[240:241], v16 offset:256
v_mfma_f32_16x16x32_bf16 v[124:127], a[252:255], v[172:175], v[124:127]
ds_read_b64_tr_b16 a[242:243], v16 offset:1792
s_sub_u32 s29, s29, 1
s_cmp_lg_u32 s29, 0
s_cbranch_scc1 L_q0
s_waitcnt lgkmcnt(6)
v_mfma_f32_16x16x32_bf16 v[32:35], a[208:211], v[144:147], v[32:35]
ds_read_b64_tr_b16 a[244:245], v16 offset:264
v_mfma_f32_16x16x32_bf16 v[36:39], a[208:211], v[148:151], v[36:39]
ds_read_b64_tr_b16 a[246:247], v16 offset:1800
v_mfma_f32_16x16x32_bf16 v[40:43], a[212:215], v[144:147], v[40:43]
ds_read_b64_tr_b16 a[248:249], v17 offset:256
v_mfma_f32_16x16x32_bf16 v[44:47], a[212:215], v[148:151], v[44:47]
ds_read_b64_tr_b16 a[250:251], v17 offset:1792
v_mfma_f32_16x16x32_bf16 v[48:51], a[216:219], v[144:147], v[48:51]
ds_read_b64_tr_b16 a[252:253], v17 offset:264
v_mfma_f32_16x16x32_bf16 v[52:55], a[216:219], v[148:151], v[52:55]
s_waitcnt lgkmcnt(12)
ds_read_b64_tr_b16 a[254:255], v17 offset:1800
v_mfma_f32_16x16x32_bf16 v[56:59], a[220:223], v[144:147], v[56:59]
s_barrier
v_mfma_f32_16x16x32_bf16 v[60:63], a[220:223], v[148:151], v[60:63]
ds_read_b64_tr_b16 a[208:209], v18 offset:0
ds_read_b64_tr_b16 a[210:211], v18 offset:1536
v_mfma_f32_16x16x32_bf16 v[64:67], a[224:227], v[144:147], v[64:67]
s_mov_b32 s38, 135872
ds_read_b64_tr_b16 a[212:213], v18 offset:8
v_add_u32_e32 v16, s38, v253
v_mfma_f32_16x16x32_bf16 v[68:71], a[224:227], v[148:151], v[68:71]
ds_read_b64_tr_b16 a[214:215], v18 offset:1544
v_add_u32_e32 v17, s38, v0
v_mfma_f32_16x16x32_bf16 v[72:75], a[228:231], v[144:147], v[72:75]
ds_read_b64_tr_b16 a[216:217], v19 offset:0
v_mfma_f32_16x16x32_bf16 v[76:79], a[228:231], v[148:151], v[76:79]
s_waitcnt lgkmcnt(11)
ds_read_b64_tr_b16 a[218:219], v19 offset:1536
v_mfma_f32_16x16x32_bf16 v[80:83], a[232:235], v[144:147], v[80:83]
ds_read_b64_tr_b16 a[220:221], v19 offset:8
v_mfma_f32_16x16x32_bf16 v[84:87], a[232:235], v[148:151], v[84:87]
ds_read_b64_tr_b16 a[222:223], v19 offset:1544
v_mfma_f32_16x16x32_bf16 v[88:91], a[236:239], v[144:147], v[88:91]
ds_read_b64_tr_b16 a[224:225], v18 offset:128
v_mfma_f32_16x16x32_bf16 v[92:95], a[236:239], v[148:151], v[92:95]
ds_read_b64_tr_b16 a[226:227], v18 offset:1664
v_mfma_f32_16x16x32_bf16 v[96:99], a[240:243], v[144:147], v[96:99]
ds_read_b64_tr_b16 a[228:229], v18 offset:136
v_mfma_f32_16x16x32_bf16 v[100:103], a[240:243], v[148:151], v[100:103]
s_waitcnt lgkmcnt(11)
ds_read_b64_tr_b16 a[230:231], v18 offset:1672
v_mfma_f32_16x16x32_bf16 v[104:107], a[244:247], v[144:147], v[104:107]
ds_read_b64_tr_b16 a[232:233], v19 offset:128
v_mfma_f32_16x16x32_bf16 v[108:111], a[244:247], v[148:151], v[108:111]
ds_read_b64_tr_b16 a[234:235], v19 offset:1664
v_mfma_f32_16x16x32_bf16 v[112:115], a[248:251], v[144:147], v[112:115]
ds_read_b64_tr_b16 a[236:237], v19 offset:136
v_mfma_f32_16x16x32_bf16 v[116:119], a[248:251], v[148:151], v[116:119]
ds_read_b64_tr_b16 a[238:239], v19 offset:1672
v_mfma_f32_16x16x32_bf16 v[120:123], a[252:255], v[144:147], v[120:123]
ds_read_b64_tr_b16 a[240:241], v18 offset:256
v_mfma_f32_16x16x32_bf16 v[124:127], a[252:255], v[148:151], v[124:127]
s_waitcnt lgkmcnt(11)
ds_read_b64_tr_b16 a[242:243], v18 offset:1792
v_mfma_f32_16x16x32_bf16 v[32:35], a[208:211], v[152:155], v[32:35]
ds_read_b64_tr_b16 a[244:245], v18 offset:264
v_mfma_f32_16x16x32_bf16 v[36:39], a[208:211], v[156:159], v[36:39]
ds_read_b64_tr_b16 a[246:247], v18 offset:1800
v_mfma_f32_16x16x32_bf16 v[40:43], a[212:215], v[152:155], v[40:43]
ds_read_b64_tr_b16 a[248:249], v19 offset:256
v_mfma_f32_16x16x32_bf16 v[44:47], a[212:215], v[156:159], v[44:47]
ds_read_b64_tr_b16 a[250:251], v19 offset:1792
v_mfma_f32_16x16x32_bf16 v[48:51], a[216:219], v[152:155], v[48:51]
ds_read_b64_tr_b16 a[252:253], v19 offset:264
v_mfma_f32_16x16x32_bf16 v[52:55], a[216:219], v[156:159], v[52:55]
s_waitcnt lgkmcnt(11)
ds_read_b64_tr_b16 a[254:255], v19 offset:1800
v_mfma_f32_16x16x32_bf16 v[56:59], a[220:223], v[152:155], v[56:59]
s_barrier
v_mfma_f32_16x16x32_bf16 v[60:63], a[220:223], v[156:159], v[60:63]
ds_read_b64_tr_b16 a[208:209], v16 offset:0
ds_read_b64_tr_b16 a[210:211], v16 offset:1536
v_mfma_f32_16x16x32_bf16 v[64:67], a[224:227], v[152:155], v[64:67]
s_waitcnt vmcnt(0)
s_mov_b32 s38, 148224
ds_read_b64_tr_b16 a[212:213], v16 offset:8
v_mfma_f32_16x16x32_bf16 v[68:71], a[224:227], v[156:159], v[68:71]
ds_read_b64_tr_b16 a[214:215], v16 offset:1544
v_add_u32_e32 v18, s38, v253
v_mfma_f32_16x16x32_bf16 v[72:75], a[228:231], v[152:155], v[72:75]
ds_read_b64_tr_b16 a[216:217], v17 offset:0
v_add_u32_e32 v19, s38, v0
v_mfma_f32_16x16x32_bf16 v[76:79], a[228:231], v[156:159], v[76:79]
s_waitcnt lgkmcnt(11)
ds_read_b64_tr_b16 a[218:219], v17 offset:1536
ds_read_b128 v[160:163], v24 offset:14336
v_mfma_f32_16x16x32_bf16 v[80:83], a[232:235], v[152:155], v[80:83]
ds_read_b64_tr_b16 a[220:221], v17 offset:8
v_mfma_f32_16x16x32_bf16 v[84:87], a[232:235], v[156:159], v[84:87]
ds_read_b64_tr_b16 a[222:223], v17 offset:1544
ds_read_b128 v[164:167], v24 offset:16384
v_mfma_f32_16x16x32_bf16 v[88:91], a[236:239], v[152:155], v[88:91]
ds_read_b64_tr_b16 a[224:225], v16 offset:128
v_mfma_f32_16x16x32_bf16 v[92:95], a[236:239], v[156:159], v[92:95]
ds_read_b64_tr_b16 a[226:227], v16 offset:1664
ds_read_b128 v[168:171], v25 offset:14336
v_mfma_f32_16x16x32_bf16 v[96:99], a[240:243], v[152:155], v[96:99]
ds_read_b64_tr_b16 a[228:229], v16 offset:136
v_mfma_f32_16x16x32_bf16 v[100:103], a[240:243], v[156:159], v[100:103]
s_waitcnt lgkmcnt(14)
ds_read_b64_tr_b16 a[230:231], v16 offset:1672
ds_read_b128 v[172:175], v25 offset:16384
v_mfma_f32_16x16x32_bf16 v[104:107], a[244:247], v[152:155], v[104:107]
ds_read_b64_tr_b16 a[232:233], v17 offset:128
v_mfma_f32_16x16x32_bf16 v[108:111], a[244:247], v[156:159], v[108:111]
ds_read_b64_tr_b16 a[234:235], v17 offset:1664
v_mfma_f32_16x16x32_bf16 v[112:115], a[248:251], v[152:155], v[112:115]
ds_read_b64_tr_b16 a[236:237], v17 offset:136
v_mfma_f32_16x16x32_bf16 v[116:119], a[248:251], v[156:159], v[116:119]
ds_read_b64_tr_b16 a[238:239], v17 offset:1672
v_mfma_f32_16x16x32_bf16 v[120:123], a[252:255], v[152:155], v[120:123]
ds_read_b64_tr_b16 a[240:241], v16 offset:256
v_mfma_f32_16x16x32_bf16 v[124:127], a[252:255], v[156:159], v[124:127]
s_waitcnt lgkmcnt(5)
ds_read_b64_tr_b16 a[242:243], v16 offset:1792
v_mfma_f32_16x16x32_bf16 v[32:35], a[208:211], v[160:163], v[32:35]
ds_read_b64_tr_b16 a[244:245], v16 offset:264
v_mfma_f32_16x16x32_bf16 v[36:39], a[208:211], v[164:167], v[36:39]
ds_read_b64_tr_b16 a[246:247], v16 offset:1800
v_mfma_f32_16x16x32_bf16 v[40:43], a[212:215], v[160:163], v[40:43]
ds_read_b64_tr_b16 a[248:249], v17 offset:256
v_mfma_f32_16x16x32_bf16 v[44:47], a[212:215], v[164:167], v[44:47]
ds_read_b64_tr_b16 a[250:251], v17 offset:1792
v_mfma_f32_16x16x32_bf16 v[48:51], a[216:219], v[160:163], v[48:51]
ds_read_b64_tr_b16 a[252:253], v17 offset:264
v_mfma_f32_16x16x32_bf16 v[52:55], a[216:219], v[164:167], v[52:55]
s_waitcnt lgkmcnt(12)
ds_read_b64_tr_b16 a[254:255], v17 offset:1800
v_mfma_f32_16x16x32_bf16 v[56:59], a[220:223], v[160:163], v[56:59]
s_barrier
v_mfma_f32_16x16x32_bf16 v[60:63], a[220:223], v[164:167], v[60:63]
ds_read_b64_tr_b16 a[208:209], v18 offset:0
ds_read_b64_tr_b16 a[210:211], v18 offset:1536
v_mfma_f32_16x16x32_bf16 v[64:67], a[224:227], v[160:163], v[64:67]
ds_read_b64_tr_b16 a[212:213], v18 offset:8
v_mfma_f32_16x16x32_bf16 v[68:71], a[224:227], v[164:167], v[68:71]
ds_read_b64_tr_b16 a[214:215], v18 offset:1544
v_mfma_f32_16x16x32_bf16 v[72:75], a[228:231], v[160:163], v[72:75]
ds_read_b64_tr_b16 a[216:217], v19 offset:0
v_mfma_f32_16x16x32_bf16 v[76:79], a[228:231], v[164:167], v[76:79]
s_waitcnt lgkmcnt(11)
ds_read_b64_tr_b16 a[218:219], v19 offset:1536
v_mfma_f32_16x16x32_bf16 v[80:83], a[232:235], v[160:163], v[80:83]
ds_read_b64_tr_b16 a[220:221], v19 offset:8
v_mfma_f32_16x16x32_bf16 v[84:87], a[232:235], v[164:167], v[84:87]
ds_read_b64_tr_b16 a[222:223], v19 offset:1544
v_mfma_f32_16x16x32_bf16 v[88:91], a[236:239], v[160:163], v[88:91]
ds_read_b64_tr_b16 a[224:225], v18 offset:128
v_mfma_f32_16x16x32_bf16 v[92:95], a[236:239], v[164:167], v[92:95]
ds_read_b64_tr_b16 a[226:227], v18 offset:1664
v_mfma_f32_16x16x32_bf16 v[96:99], a[240:243], v[160:163], v[96:99]
ds_read_b64_tr_b16 a[228:229], v18 offset:136
v_mfma_f32_16x16x32_bf16 v[100:103], a[240:243], v[164:167], v[100:103]
s_waitcnt lgkmcnt(11)
ds_read_b64_tr_b16 a[230:231], v18 offset:1672
v_mfma_f32_16x16x32_bf16 v[104:107], a[244:247], v[160:163], v[104:107]
ds_read_b64_tr_b16 a[232:233], v19 offset:128
v_mfma_f32_16x16x32_bf16 v[108:111], a[244:247], v[164:167], v[108:111]
ds_read_b64_tr_b16 a[234:235], v19 offset:1664
v_mfma_f32_16x16x32_bf16 v[112:115], a[248:251], v[160:163], v[112:115]
ds_read_b64_tr_b16 a[236:237], v19 offset:136
v_mfma_f32_16x16x32_bf16 v[116:119], a[248:251], v[164:167], v[116:119]
ds_read_b64_tr_b16 a[238:239], v19 offset:1672
v_mfma_f32_16x16x32_bf16 v[120:123], a[252:255], v[160:163], v[120:123]
ds_read_b64_tr_b16 a[240:241], v18 offset:256
v_mfma_f32_16x16x32_bf16 v[124:127], a[252:255], v[164:167], v[124:127]
s_waitcnt lgkmcnt(11)
ds_read_b64_tr_b16 a[242:243], v18 offset:1792
v_mfma_f32_16x16x32_bf16 v[32:35], a[208:211], v[168:171], v[32:35]
ds_read_b64_tr_b16 a[244:245], v18 offset:264
v_mfma_f32_16x16x32_bf16 v[36:39], a[208:211], v[172:175], v[36:39]
ds_read_b64_tr_b16 a[246:247], v18 offset:1800
v_mfma_f32_16x16x32_bf16 v[40:43], a[212:215], v[168:171], v[40:43]
ds_read_b64_tr_b16 a[248:249], v19 offset:256
v_mfma_f32_16x16x32_bf16 v[44:47], a[212:215], v[172:175], v[44:47]
ds_read_b64_tr_b16 a[250:251], v19 offset:1792
v_mfma_f32_16x16x32_bf16 v[48:51], a[216:219], v[168:171], v[48:51]
ds_read_b64_tr_b16 a[252:253], v19 offset:264
v_mul_f32_e32 v32, s40, v32
v_mfma_f32_16x16x32_bf16 v[52:55], a[216:219], v[172:175], v[52:55]
s_waitcnt lgkmcnt(11)
ds_read_b64_tr_b16 a[254:255], v19 offset:1800
v_mul_f32_e32 v33, s40, v33
v_mfma_f32_16x16x32_bf16 v[56:59], a[220:223], v[168:171], v[56:59]
s_barrier
v_cvt_pk_bf16_f32 v192, v32, v33
v_mul_f32_e32 v34, s40, v34
v_mfma_f32_16x16x32_bf16 v[60:63], a[220:223], v[172:175], v[60:63]
ds_read_b128 a[208:211], v4 offset:0
v_mul_f32_e32 v35, s40, v35
v_mfma_f32_16x16x32_bf16 v[64:67], a[224:227], v[168:171], v[64:67]
ds_read_b128 a[212:215], v5 offset:0
v_cvt_pk_bf16_f32 v193, v34, v35
v_mfma_f32_16x16x32_bf16 v[68:71], a[224:227], v[172:175], v[68:71]
ds_read_b128 a[216:219], v4 offset:128
v_mul_f32_e32 v40, s40, v40
v_mfma_f32_16x16x32_bf16 v[72:75], a[228:231], v[168:171], v[72:75]
ds_read_b128 a[220:223], v5 offset:128
v_mul_f32_e32 v41, s40, v41
v_mfma_f32_16x16x32_bf16 v[76:79], a[228:231], v[172:175], v[76:79]
s_waitcnt lgkmcnt(10)
v_cvt_pk_bf16_f32 v194, v40, v41
v_mul_f32_e32 v42, s40, v42
v_mfma_f32_16x16x32_bf16 v[80:83], a[232:235], v[168:171], v[80:83]
ds_read_b128 a[224:227], v4 offset:256
v_mul_f32_e32 v43, s40, v43
v_mfma_f32_16x16x32_bf16 v[84:87], a[232:235], v[172:175], v[84:87]
v_cvt_pk_bf16_f32 v195, v42, v43
v_mul_f32_e32 v36, s40, v36
v_mfma_f32_16x16x32_bf16 v[88:91], a[236:239], v[168:171], v[88:91]
ds_read_b128 a[228:231], v5 offset:256
v_mul_f32_e32 v37, s40, v37
v_mfma_f32_16x16x32_bf16 v[92:95], a[236:239], v[172:175], v[92:95]
v_cvt_pk_bf16_f32 v196, v36, v37
v_mul_f32_e32 v38, s40, v38
v_mfma_f32_16x16x32_bf16 v[96:99], a[240:243], v[168:171], v[96:99]
ds_read_b128 a[232:235], v4 offset:6144
v_mul_f32_e32 v39, s40, v39
v_mfma_f32_16x16x32_bf16 v[100:103], a[240:243], v[172:175], v[100:103]
s_waitcnt lgkmcnt(7)
v_cvt_pk_bf16_f32 v197, v38, v39
v_mul_f32_e32 v44, s40, v44
v_mfma_f32_16x16x32_bf16 v[104:107], a[244:247], v[168:171], v[104:107]
ds_read_b128 a[236:239], v5 offset:6144
v_mul_f32_e32 v45, s40, v45
v_mfma_f32_16x16x32_bf16 v[108:111], a[244:247], v[172:175], v[108:111]
v_cvt_pk_bf16_f32 v198, v44, v45
v_mul_f32_e32 v46, s40, v46
v_mfma_f32_16x16x32_bf16 v[112:115], a[248:251], v[168:171], v[112:115]
ds_read_b128 a[240:243], v4 offset:6272
v_mul_f32_e32 v47, s40, v47
v_mfma_f32_16x16x32_bf16 v[116:119], a[248:251], v[172:175], v[116:119]
v_cvt_pk_bf16_f32 v199, v46, v47
v_mul_f32_e32 v48, s40, v48
v_mfma_f32_16x16x32_bf16 v[120:123], a[252:255], v[168:171], v[120:123]
v_mul_f32_e32 v49, s40, v49
v_cvt_pk_bf16_f32 v200, v48, v49
v_mfma_f32_16x16x32_bf16 v[124:127], a[252:255], v[172:175], v[124:127]
s_waitcnt lgkmcnt(6)
v_mul_f32_e32 v50, s40, v50
v_mul_f32_e32 v51, s40, v51
v_mfma_f32_16x16x32_bf16 v[176:179], a[208:211], v[192:195], 0
v_cvt_pk_bf16_f32 v201, v50, v51
v_mul_f32_e32 v56, s40, v56
v_mul_f32_e32 v57, s40, v57
v_cvt_pk_bf16_f32 v202, v56, v57
v_mul_f32_e32 v58, s40, v58
v_mul_f32_e32 v59, s40, v59
v_cvt_pk_bf16_f32 v203, v58, v59
v_mfma_f32_16x16x32_bf16 v[180:183], a[208:211], v[196:199], 0
ds_read_b128 a[244:247], v5 offset:6272
v_mul_f32_e32 v52, s40, v52
v_mul_f32_e32 v53, s40, v53
v_cvt_pk_bf16_f32 v204, v52, v53
v_mul_f32_e32 v54, s40, v54
v_mul_f32_e32 v55, s40, v55
v_cvt_pk_bf16_f32 v205, v54, v55
v_mul_f32_e32 v60, s40, v60
v_mul_f32_e32 v61, s40, v61
v_cvt_pk_bf16_f32 v206, v60, v61
v_mul_f32_e32 v62, s40, v62
v_mul_f32_e32 v63, s40, v63
v_cvt_pk_bf16_f32 v207, v62, v63
v_mfma_f32_16x16x32_bf16 v[176:179], a[212:215], v[200:203], v[176:179]
v_mul_f32_e32 v64, s40, v64
v_mul_f32_e32 v65, s40, v65
v_cvt_pk_bf16_f32 v208, v64, v65
v_mul_f32_e32 v66, s40, v66
v_mul_f32_e32 v67, s40, v67
v_cvt_pk_bf16_f32 v209, v66, v67
v_mul_f32_e32 v72, s40, v72
v_mul_f32_e32 v73, s40, v73
v_cvt_pk_bf16_f32 v210, v72, v73
v_mul_f32_e32 v74, s40, v74
v_mul_f32_e32 v75, s40, v75
v_cvt_pk_bf16_f32 v211, v74, v75
v_mfma_f32_16x16x32_bf16 v[180:183], a[212:215], v[204:207], v[180:183]
ds_read_b128 a[248:251], v4 offset:6400
v_mul_f32_e32 v68, s40, v68
v_mul_f32_e32 v69, s40, v69
v_cvt_pk_bf16_f32 v212, v68, v69
v_mul_f32_e32 v70, s40, v70
v_mul_f32_e32 v71, s40, v71
v_cvt_pk_bf16_f32 v213, v70, v71
v_mul_f32_e32 v76, s40, v76
v_mul_f32_e32 v77, s40, v77
v_cvt_pk_bf16_f32 v214, v76, v77
v_mul_f32_e32 v78, s40, v78
v_mul_f32_e32 v79, s40, v79
v_cvt_pk_bf16_f32 v215, v78, v79
v_mfma_f32_16x16x32_bf16 v[176:179], a[216:219], v[208:211], v[176:179]
v_mul_f32_e32 v80, s40, v80
v_mul_f32_e32 v81, s40, v81
v_cvt_pk_bf16_f32 v216, v80, v81
v_mul_f32_e32 v82, s40, v82
v_mul_f32_e32 v83, s40, v83
v_cvt_pk_bf16_f32 v217, v82, v83
v_mul_f32_e32 v88, s40, v88
v_mul_f32_e32 v89, s40, v89
v_cvt_pk_bf16_f32 v218, v88, v89
v_mul_f32_e32 v90, s40, v90
v_mul_f32_e32 v91, s40, v91
v_cvt_pk_bf16_f32 v219, v90, v91
v_mfma_f32_16x16x32_bf16 v[180:183], a[216:219], v[212:215], v[180:183]
s_waitcnt lgkmcnt(5)
ds_read_b128 a[252:255], v5 offset:6400
v_mul_f32_e32 v84, s40, v84
v_mul_f32_e32 v85, s40, v85
v_cvt_pk_bf16_f32 v220, v84, v85
v_mul_f32_e32 v86, s40, v86
v_mul_f32_e32 v87, s40, v87
v_cvt_pk_bf16_f32 v221, v86, v87
v_mul_f32_e32 v92, s40, v92
v_mul_f32_e32 v93, s40, v93
v_cvt_pk_bf16_f32 v222, v92, v93
v_mul_f32_e32 v94, s40, v94
v_mul_f32_e32 v95, s40, v95
v_cvt_pk_bf16_f32 v223, v94, v95
v_mfma_f32_16x16x32_bf16 v[176:179], a[220:223], v[216:219], v[176:179]
v_mul_f32_e32 v96, s40, v96
v_mul_f32_e32 v97, s40, v97
v_cvt_pk_bf16_f32 v224, v96, v97
v_mul_f32_e32 v98, s40, v98
v_mul_f32_e32 v99, s40, v99
v_cvt_pk_bf16_f32 v225, v98, v99
v_mul_f32_e32 v104, s40, v104
v_mul_f32_e32 v105, s40, v105
v_cvt_pk_bf16_f32 v226, v104, v105
v_mul_f32_e32 v106, s40, v106
v_mul_f32_e32 v107, s40, v107
v_cvt_pk_bf16_f32 v227, v106, v107
v_mfma_f32_16x16x32_bf16 v[180:183], a[220:223], v[220:223], v[180:183]
s_barrier
ds_read_b128 a[208:211], v4 offset:24704
v_mul_f32_e32 v100, s40, v100
v_mul_f32_e32 v101, s40, v101
v_cvt_pk_bf16_f32 v228, v100, v101
v_mul_f32_e32 v102, s40, v102
v_mul_f32_e32 v103, s40, v103
v_cvt_pk_bf16_f32 v229, v102, v103
v_mul_f32_e32 v108, s40, v108
v_mul_f32_e32 v109, s40, v109
v_cvt_pk_bf16_f32 v230, v108, v109
v_mul_f32_e32 v110, s40, v110
v_mul_f32_e32 v111, s40, v111
v_cvt_pk_bf16_f32 v231, v110, v111
v_mfma_f32_16x16x32_bf16 v[176:179], a[224:227], v[224:227], v[176:179]
v_mul_f32_e32 v112, s40, v112
v_mul_f32_e32 v113, s40, v113
v_cvt_pk_bf16_f32 v232, v112, v113
v_mul_f32_e32 v114, s40, v114
v_mul_f32_e32 v115, s40, v115
v_cvt_pk_bf16_f32 v233, v114, v115
v_mul_f32_e32 v120, s40, v120
v_mul_f32_e32 v121, s40, v121
v_cvt_pk_bf16_f32 v234, v120, v121
v_mul_f32_e32 v122, s40, v122
v_mul_f32_e32 v123, s40, v123
v_cvt_pk_bf16_f32 v235, v122, v123
v_mfma_f32_16x16x32_bf16 v[180:183], a[224:227], v[228:231], v[180:183]
ds_read_b128 a[212:215], v5 offset:24704
v_mul_f32_e32 v116, s40, v116
v_mul_f32_e32 v117, s40, v117
v_cvt_pk_bf16_f32 v236, v116, v117
v_mul_f32_e32 v118, s40, v118
v_mul_f32_e32 v119, s40, v119
v_cvt_pk_bf16_f32 v237, v118, v119
v_mul_f32_e32 v124, s40, v124
v_mul_f32_e32 v125, s40, v125
v_cvt_pk_bf16_f32 v238, v124, v125
v_mul_f32_e32 v126, s40, v126
v_mul_f32_e32 v127, s40, v127
v_cvt_pk_bf16_f32 v239, v126, v127
v_mfma_f32_16x16x32_bf16 v[176:179], a[228:231], v[232:235], v[176:179]
ds_read_b128 a[216:219], v4 offset:24832
v_mfma_f32_16x16x32_bf16 v[180:183], a[228:231], v[236:239], v[180:183]
s_waitcnt lgkmcnt(6)
ds_read_b128 a[220:223], v5 offset:24832
v_mfma_f32_16x16x32_bf16 v[184:187], a[232:235], v[192:195], 0
ds_read_b128 a[224:227], v4 offset:24960
v_mfma_f32_16x16x32_bf16 v[188:191], a[232:235], v[196:199], 0
v_mfma_f32_16x16x32_bf16 v[184:187], a[236:239], v[200:203], v[184:187]
ds_read_b128 a[228:231], v5 offset:24960
v_max3_f32 v28, v176, v177, v178
v_mfma_f32_16x16x32_bf16 v[188:191], a[236:239], v[204:207], v[188:191]
v_max_f32_e32 v28, v28, v179
v_mov_b32_e32 v27, v28
v_mfma_f32_16x16x32_bf16 v[184:187], a[240:243], v[208:211], v[184:187]
ds_read_b128 a[232:235], v4 offset:30848
v_max3_f32 v30, v180, v181, v182
v_mfma_f32_16x16x32_bf16 v[188:191], a[240:243], v[212:215], v[188:191]
s_waitcnt lgkmcnt(7)
v_permlane32_swap_b32 v28, v27
v_mfma_f32_16x16x32_bf16 v[184:187], a[244:247], v[216:219], v[184:187]
v_max_f32_e32 v28, v28, v27
v_mov_b32_e32 v27, v28
v_mfma_f32_16x16x32_bf16 v[188:191], a[244:247], v[220:223], v[188:191]
v_max_f32_e32 v30, v30, v183
v_mov_b32_e32 v29, v30
v_mfma_f32_16x16x32_bf16 v[184:187], a[248:251], v[224:227], v[184:187]
v_permlane16_swap_b32 v28, v27
v_max_f32_e32 v28, v28, v27
v_permlane32_swap_b32 v30, v29
v_max_f32_e32 v30, v30, v29
v_mov_b32_e32 v29, v30
s_nop 1
v_permlane16_swap_b32 v30, v29
v_max_f32_e32 v30, v30, v29
v_mfma_f32_16x16x32_bf16 v[188:191], a[248:251], v[228:231], v[188:191]
ds_read_b128 a[236:239], v5 offset:30848
v_sub_f32_e32 v136, 0, v28
v_mfma_f32_16x16x32_bf16 v[184:187], a[252:255], v[232:235], v[184:187]
v_sub_f32_e32 v137, 0, v28
v_sub_f32_e32 v138, 0, v28
v_sub_f32_e32 v139, 0, v28
v_mfma_f32_16x16x32_bf16 v[188:191], a[252:255], v[236:239], v[188:191]
s_waitcnt lgkmcnt(5)
ds_read_b128 a[240:243], v4 offset:30976
v_sub_f32_e32 v140, 0, v30
v_sub_f32_e32 v141, 0, v30
v_sub_f32_e32 v142, 0, v30
v_sub_f32_e32 v143, 0, v30
v_mfma_f32_16x16x32_bf16 v[144:147], a[208:211], v[192:195], v[136:139]
ds_read_b128 a[244:247], v5 offset:30976
v_sub_f32_e32 v176, v176, v28
v_mfma_f32_16x16x32_bf16 v[148:151], a[208:211], v[196:199], v[140:143]
v_exp_f32_e32 v176, v176
v_mfma_f32_16x16x32_bf16 v[144:147], a[212:215], v[200:203], v[144:147]
ds_read_b128 a[248:251], v4 offset:31104
v_sub_f32_e32 v180, v180, v30
v_mfma_f32_16x16x32_bf16 v[148:151], a[212:215], v[204:207], v[148:151]
v_exp_f32_e32 v180, v180
v_mfma_f32_16x16x32_bf16 v[144:147], a[216:219], v[208:211], v[144:147]
ds_read_b128 a[252:255], v5 offset:31104
v_sub_f32_e32 v177, v177, v28
v_mfma_f32_16x16x32_bf16 v[148:151], a[216:219], v[212:215], v[148:151]
s_barrier
s_waitcnt lgkmcnt(6)
v_sub_f32_e32 v181, v181, v30
v_mfma_f32_16x16x32_bf16 v[144:147], a[220:223], v[216:219], v[144:147]
v_exp_f32_e32 v177, v177
v_mfma_f32_16x16x32_bf16 v[148:151], a[220:223], v[220:223], v[148:151]
ds_read_b64_tr_b16 a[208:209], v8 offset:12352
ds_read_b64_tr_b16 a[210:211], v8 offset:18496
v_mfma_f32_16x16x32_bf16 v[144:147], a[224:227], v[224:227], v[144:147]
v_exp_f32_e32 v181, v181
v_mfma_f32_16x16x32_bf16 v[148:151], a[224:227], v[228:231], v[148:151]
ds_read_b64_tr_b16 a[212:213], v9 offset:12352
ds_read_b64_tr_b16 a[214:215], v9 offset:18496
v_mfma_f32_16x16x32_bf16 v[144:147], a[228:231], v[232:235], v[144:147]
ds_read_b64_tr_b16 a[216:217], v10 offset:12352
v_sub_f32_e32 v178, v178, v28
v_mfma_f32_16x16x32_bf16 v[148:151], a[228:231], v[236:239], v[148:151]
s_waitcnt lgkmcnt(8)
ds_read_b64_tr_b16 a[218:219], v10 offset:18496
v_exp_f32_e32 v178, v178
v_sub_f32_e32 v182, v182, v30
v_exp_f32_e32 v182, v182
v_mfma_f32_16x16x32_bf16 v[152:155], a[232:235], v[192:195], v[136:139]
v_exp_f32_e32 v144, v144
v_mfma_f32_16x16x32_bf16 v[156:159], a[232:235], v[196:199], v[140:143]
ds_read_b64_tr_b16 a[220:221], v11 offset:12352
ds_read_b64_tr_b16 a[222:223], v11 offset:18496
v_sub_f32_e32 v179, v179, v28
v_exp_f32_e32 v179, v179
v_sub_f32_e32 v183, v183, v30
v_exp_f32_e32 v183, v183
v_mfma_f32_16x16x32_bf16 v[152:155], a[236:239], v[200:203], v[152:155]
v_exp_f32_e32 v145, v145
v_mfma_f32_16x16x32_bf16 v[156:159], a[236:239], v[204:207], v[156:159]
ds_read_b64_tr_b16 a[224:225], v8 offset:12480
ds_read_b64_tr_b16 a[226:227], v8 offset:18624
v_sub_f32_e32 v184, v184, v28
v_exp_f32_e32 v184, v184
v_sub_f32_e32 v188, v188, v30
v_exp_f32_e32 v188, v188
v_mfma_f32_16x16x32_bf16 v[152:155], a[240:243], v[208:211], v[152:155]
v_exp_f32_e32 v146, v146
v_mfma_f32_16x16x32_bf16 v[156:159], a[240:243], v[212:215], v[156:159]
s_waitcnt lgkmcnt(10)
ds_read_b64_tr_b16 a[228:229], v9 offset:12480
ds_read_b64_tr_b16 a[230:231], v9 offset:18624
v_sub_f32_e32 v185, v185, v28
v_exp_f32_e32 v185, v185
v_sub_f32_e32 v189, v189, v30
v_exp_f32_e32 v189, v189
v_mfma_f32_16x16x32_bf16 v[152:155], a[244:247], v[216:219], v[152:155]
v_exp_f32_e32 v147, v147
v_mfma_f32_16x16x32_bf16 v[156:159], a[244:247], v[220:223], v[156:159]
ds_read_b64_tr_b16 a[232:233], v10 offset:12480
ds_read_b64_tr_b16 a[234:235], v10 offset:18624
v_sub_f32_e32 v186, v186, v28
v_exp_f32_e32 v186, v186
v_sub_f32_e32 v190, v190, v30
v_exp_f32_e32 v190, v190
v_mfma_f32_16x16x32_bf16 v[152:155], a[248:251], v[224:227], v[152:155]
v_exp_f32_e32 v148, v148
v_mfma_f32_16x16x32_bf16 v[156:159], a[248:251], v[228:231], v[156:159]
ds_read_b64_tr_b16 a[236:237], v11 offset:12480
ds_read_b64_tr_b16 a[238:239], v11 offset:18624
v_sub_f32_e32 v187, v187, v28
v_exp_f32_e32 v187, v187
v_sub_f32_e32 v191, v191, v30
v_exp_f32_e32 v191, v191
v_mfma_f32_16x16x32_bf16 v[152:155], a[252:255], v[232:235], v[152:155]
v_cvt_pk_bf16_f32 v160, v176, v177
v_cvt_pk_bf16_f32 v161, v178, v179
v_cvt_pk_bf16_f32 v162, v184, v185
v_cvt_pk_bf16_f32 v163, v186, v187
v_cvt_pk_bf16_f32 v164, v180, v181
v_cvt_pk_bf16_f32 v165, v182, v183
v_cvt_pk_bf16_f32 v166, v188, v189
v_cvt_pk_bf16_f32 v167, v190, v191
v_mfma_f32_16x16x32_bf16 v[156:159], a[252:255], v[236:239], v[156:159]
s_waitcnt lgkmcnt(10)
ds_read_b64_tr_b16 a[240:241], v8 offset:12608
ds_read_b64_tr_b16 a[242:243], v8 offset:18752
v_mfma_f32_16x16x32_bf16 v[32:35], a[208:211], v[160:163], 0
v_exp_f32_e32 v149, v149
v_mfma_f32_16x16x32_bf16 v[36:39], a[208:211], v[164:167], 0
ds_read_b64_tr_b16 a[244:245], v9 offset:12608
ds_read_b64_tr_b16 a[246:247], v9 offset:18752
v_mfma_f32_16x16x32_bf16 v[40:43], a[212:215], v[160:163], 0
v_exp_f32_e32 v150, v150
v_mfma_f32_16x16x32_bf16 v[44:47], a[212:215], v[164:167], 0
ds_read_b64_tr_b16 a[248:249], v10 offset:12608
ds_read_b64_tr_b16 a[250:251], v10 offset:18752
v_mfma_f32_16x16x32_bf16 v[48:51], a[216:219], v[160:163], 0
v_exp_f32_e32 v151, v151
v_mfma_f32_16x16x32_bf16 v[52:55], a[216:219], v[164:167], 0
s_waitcnt lgkmcnt(10)
ds_read_b64_tr_b16 a[252:253], v11 offset:12608
ds_read_b64_tr_b16 a[254:255], v11 offset:18752
v_mfma_f32_16x16x32_bf16 v[56:59], a[220:223], v[160:163], 0
s_barrier
v_exp_f32_e32 v152, v152
v_mfma_f32_16x16x32_bf16 v[60:63], a[220:223], v[164:167], 0
ds_read_b128 a[208:211], v6 offset:0
ds_read_b128 a[212:215], v7 offset:0
v_mfma_f32_16x16x32_bf16 v[64:67], a[224:227], v[160:163], 0
v_exp_f32_e32 v153, v153
v_mfma_f32_16x16x32_bf16 v[68:71], a[224:227], v[164:167], 0
v_exp_f32_e32 v154, v154
v_mfma_f32_16x16x32_bf16 v[72:75], a[228:231], v[160:163], 0
v_exp_f32_e32 v155, v155
v_mfma_f32_16x16x32_bf16 v[76:79], a[228:231], v[164:167], 0
s_waitcnt lgkmcnt(8)
ds_read_b128 a[216:219], v6 offset:128
v_add_f32_e32 v128, v176, v184
v_mfma_f32_16x16x32_bf16 v[80:83], a[232:235], v[160:163], 0
v_add_f32_e32 v129, v177, v185
v_add_f32_e32 v130, v178, v186
v_add_f32_e32 v131, v179, v187
v_add_f32_e32 v132, v180, v188
v_add_f32_e32 v133, v181, v189
v_add_f32_e32 v134, v182, v190
v_add_f32_e32 v135, v183, v191
v_mfma_f32_16x16x32_bf16 v[84:87], a[232:235], v[164:167], 0
ds_read_b128 a[220:223], v7 offset:128
ds_read_b128 a[224:227], v6 offset:256
v_mfma_f32_16x16x32_bf16 v[88:91], a[236:239], v[160:163], 0
v_exp_f32_e32 v156, v156
v_mfma_f32_16x16x32_bf16 v[92:95], a[236:239], v[164:167], 0
v_exp_f32_e32 v157, v157
v_mfma_f32_16x16x32_bf16 v[96:99], a[240:243], v[160:163], 0
ds_read_b128 a[228:231], v7 offset:256
v_add_f32_e32 v128, v128, v144
v_mfma_f32_16x16x32_bf16 v[100:103], a[240:243], v[164:167], 0
s_waitcnt lgkmcnt(6)
ds_read_b128 a[232:235], v6 offset:6144
v_add_f32_e32 v129, v129, v145
v_mfma_f32_16x16x32_bf16 v[104:107], a[244:247], v[160:163], 0
ds_read_b128 a[236:239], v7 offset:6144
v_add_f32_e32 v130, v130, v146
v_mfma_f32_16x16x32_bf16 v[108:111], a[244:247], v[164:167], 0
v_add_f32_e32 v131, v131, v147
v_add_f32_e32 v132, v132, v148
v_mfma_f32_16x16x32_bf16 v[112:115], a[248:251], v[160:163], 0
ds_read_b128 a[240:243], v6 offset:6272
v_add_f32_e32 v133, v133, v149
v_mfma_f32_16x16x32_bf16 v[116:119], a[248:251], v[164:167], 0
v_add_f32_e32 v134, v134, v150
v_add_f32_e32 v135, v135, v151
v_mfma_f32_16x16x32_bf16 v[120:123], a[252:255], v[160:163], 0
v_cvt_pk_bf16_f32 v168, v144, v145
v_cvt_pk_bf16_f32 v169, v146, v147
v_mfma_f32_16x16x32_bf16 v[124:127], a[252:255], v[164:167], 0
v_cvt_pk_bf16_f32 v172, v148, v149
v_cvt_pk_bf16_f32 v173, v150, v151
v_cvt_pk_bf16_f32 v170, v152, v153
v_cvt_pk_bf16_f32 v171, v154, v155
v_cvt_pk_bf16_f32 v174, v156, v157
s_mov_b32 s30, 0
L_a0:
s_waitcnt lgkmcnt(6)
v_mfma_f32_16x16x32_bf16 v[144:147], a[208:211], v[192:195], v[136:139]
v_exp_f32_e32 v158, v158
v_mfma_f32_16x16x32_bf16 v[148:151], a[208:211], v[196:199], v[140:143]
ds_read_b128 a[244:247], v7 offset:6272
ds_read_b128 a[248:251], v6 offset:6400
v_mfma_f32_16x16x32_bf16 v[144:147], a[212:215], v[200:203], v[144:147]
v_exp_f32_e32 v159, v159
v_mfma_f32_16x16x32_bf16 v[148:151], a[212:215], v[204:207], v[148:151]
ds_read_b128 a[252:255], v7 offset:6400
v_cvt_pk_bf16_f32 v175, v158, v159
v_mfma_f32_16x16x32_bf16 v[144:147], a[216:219], v[208:211], v[144:147]
s_barrier
v_add_f32_e32 v128, v128, v152
v_add_f32_e32 v129, v129, v153
v_mfma_f32_16x16x32_bf16 v[148:151], a[216:219], v[212:215], v[148:151]
s_waitcnt lgkmcnt(6)
ds_read_b64_tr_b16 a[208:209], v8 offset:37056
v_add_f32_e32 v130, v130, v154
v_mfma_f32_16x16x32_bf16 v[144:147], a[220:223], v[216:219], v[144:147]
ds_read_b64_tr_b16 a[210:211], v8 offset:43200
v_add_f32_e32 v131, v131, v155
v_mfma_f32_16x16x32_bf16 v[148:151], a[220:223], v[220:223], v[148:151]
ds_read_b64_tr_b16 a[212:213], v9 offset:37056
v_add_f32_e32 v132, v132, v156
v_mfma_f32_16x16x32_bf16 v[144:147], a[224:227], v[224:227], v[144:147]
ds_read_b64_tr_b16 a[214:215], v9 offset:43200
v_add_f32_e32 v133, v133, v157
v_mfma_f32_16x16x32_bf16 v[148:151], a[224:227], v[228:231], v[148:151]
ds_read_b64_tr_b16 a[216:217], v10 offset:37056
v_add_f32_e32 v134, v134, v158
v_mfma_f32_16x16x32_bf16 v[144:147], a[228:231], v[232:235], v[144:147]
ds_read_b64_tr_b16 a[218:219], v10 offset:43200
v_add_f32_e32 v135, v135, v159
v_mfma_f32_16x16x32_bf16 v[148:151], a[228:231], v[236:239], v[148:151]
s_waitcnt lgkmcnt(9)
ds_read_b64_tr_b16 a[220:221], v11 offset:37056
ds_read_b64_tr_b16 a[222:223], v11 offset:43200
v_mfma_f32_16x16x32_bf16 v[152:155], a[232:235], v[192:195], v[136:139]
ds_read_b64_tr_b16 a[224:225], v8 offset:37184
ds_read_b64_tr_b16 a[226:227], v8 offset:43328
v_mfma_f32_16x16x32_bf16 v[156:159], a[232:235], v[196:199], v[140:143]
v_exp_f32_e32 v144, v144
v_mfma_f32_16x16x32_bf16 v[152:155], a[236:239], v[200:203], v[152:155]
v_exp_f32_e32 v145, v145
v_mfma_f32_16x16x32_bf16 v[156:159], a[236:239], v[204:207], v[156:159]
v_exp_f32_e32 v146, v146
v_mfma_f32_16x16x32_bf16 v[152:155], a[240:243], v[208:211], v[152:155]
v_exp_f32_e32 v147, v147
v_mfma_f32_16x16x32_bf16 v[156:159], a[240:243], v[212:215], v[156:159]
s_waitcnt lgkmcnt(10)
ds_read_b64_tr_b16 a[228:229], v9 offset:37184
ds_read_b64_tr_b16 a[230:231], v9 offset:43328
v_mfma_f32_16x16x32_bf16 v[152:155], a[244:247], v[216:219], v[152:155]
v_exp_f32_e32 v148, v148
v_mfma_f32_16x16x32_bf16 v[156:159], a[244:247], v[220:223], v[156:159]
ds_read_b64_tr_b16 a[232:233], v10 offset:37184
ds_read_b64_tr_b16 a[234:235], v10 offset:43328
v_mfma_f32_16x16x32_bf16 v[152:155], a[248:251], v[224:227], v[152:155]
v_exp_f32_e32 v149, v149
v_mfma_f32_16x16x32_bf16 v[156:159], a[248:251], v[228:231], v[156:159]
ds_read_b64_tr_b16 a[236:237], v11 offset:37184
ds_read_b64_tr_b16 a[238:239], v11 offset:43328
v_mfma_f32_16x16x32_bf16 v[152:155], a[252:255], v[232:235], v[152:155]
v_exp_f32_e32 v150, v150
v_mfma_f32_16x16x32_bf16 v[156:159], a[252:255], v[236:239], v[156:159]
s_waitcnt lgkmcnt(10)
ds_read_b64_tr_b16 a[240:241], v8 offset:37312
ds_read_b64_tr_b16 a[242:243], v8 offset:43456
v_mfma_f32_16x16x32_bf16 v[32:35], a[208:211], v[168:171], v[32:35]
v_exp_f32_e32 v151, v151
v_mfma_f32_16x16x32_bf16 v[36:39], a[208:211], v[172:175], v[36:39]
ds_read_b64_tr_b16 a[244:245], v9 offset:37312
ds_read_b64_tr_b16 a[246:247], v9 offset:43456
v_mfma_f32_16x16x32_bf16 v[40:43], a[212:215], v[168:171], v[40:43]
v_exp_f32_e32 v152, v152
v_mfma_f32_16x16x32_bf16 v[44:47], a[212:215], v[172:175], v[44:47]
ds_read_b64_tr_b16 a[248:249], v10 offset:37312
ds_read_b64_tr_b16 a[250:251], v10 offset:43456
v_mfma_f32_16x16x32_bf16 v[48:51], a[216:219], v[168:171], v[48:51]
v_exp_f32_e32 v153, v153
v_mfma_f32_16x16x32_bf16 v[52:55], a[216:219], v[172:175], v[52:55]
s_waitcnt lgkmcnt(10)
ds_read_b64_tr_b16 a[252:253], v11 offset:37312
ds_read_b64_tr_b16 a[254:255], v11 offset:43456
v_mfma_f32_16x16x32_bf16 v[56:59], a[220:223], v[168:171], v[56:59]
s_barrier
v_exp_f32_e32 v154, v154
v_mfma_f32_16x16x32_bf16 v[60:63], a[220:223], v[172:175], v[60:63]
ds_read_b128 a[208:211], v6 offset:24704
ds_read_b128 a[212:215], v7 offset:24704
v_mfma_f32_16x16x32_bf16 v[64:67], a[224:227], v[168:171], v[64:67]
v_exp_f32_e32 v155, v155
v_mfma_f32_16x16x32_bf16 v[68:71], a[224:227], v[172:175], v[68:71]
v_exp_f32_e32 v156, v156
v_mfma_f32_16x16x32_bf16 v[72:75], a[228:231], v[168:171], v[72:75]
v_exp_f32_e32 v157, v157
v_mfma_f32_16x16x32_bf16 v[76:79], a[228:231], v[172:175], v[76:79]
s_waitcnt lgkmcnt(8)
ds_read_b128 a[216:219], v6 offset:24832
v_add_f32_e32 v128, v128, v144
v_mfma_f32_16x16x32_bf16 v[80:83], a[232:235], v[168:171], v[80:83]
ds_read_b128 a[220:223], v7 offset:24832
v_add_f32_e32 v129, v129, v145
v_mfma_f32_16x16x32_bf16 v[84:87], a[232:235], v[172:175], v[84:87]
ds_read_b128 a[224:227], v6 offset:24960
v_add_f32_e32 v130, v130, v146
v_mfma_f32_16x16x32_bf16 v[88:91], a[236:239], v[168:171], v[88:91]
ds_read_b128 a[228:231], v7 offset:24960
v_add_f32_e32 v131, v131, v147
v_mfma_f32_16x16x32_bf16 v[92:95], a[236:239], v[172:175], v[92:95]
v_add_f32_e32 v132, v132, v148
v_add_f32_e32 v133, v133, v149
v_mfma_f32_16x16x32_bf16 v[96:99], a[240:243], v[168:171], v[96:99]
ds_read_b128 a[232:235], v6 offset:30848
v_add_f32_e32 v134, v134, v150
v_mfma_f32_16x16x32_bf16 v[100:103], a[240:243], v[172:175], v[100:103]
s_waitcnt lgkmcnt(7)
v_add_f32_e32 v135, v135, v151
v_cvt_pk_bf16_f32 v160, v144, v145
v_mfma_f32_16x16x32_bf16 v[104:107], a[244:247], v[168:171], v[104:107]
ds_read_b128 a[236:239], v7 offset:30848
v_cvt_pk_bf16_f32 v161, v146, v147
v_mfma_f32_16x16x32_bf16 v[108:111], a[244:247], v[172:175], v[108:111]
v_cvt_pk_bf16_f32 v164, v148, v149
v_cvt_pk_bf16_f32 v165, v150, v151
v_mfma_f32_16x16x32_bf16 v[112:115], a[248:251], v[168:171], v[112:115]
ds_read_b128 a[240:243], v6 offset:30976
v_cvt_pk_bf16_f32 v162, v152, v153
v_mfma_f32_16x16x32_bf16 v[116:119], a[248:251], v[172:175], v[116:119]
v_cvt_pk_bf16_f32 v163, v154, v155
v_cvt_pk_bf16_f32 v166, v156, v157
v_mfma_f32_16x16x32_bf16 v[120:123], a[252:255], v[168:171], v[120:123]
ds_read_b128 a[244:247], v7 offset:30976
v_mfma_f32_16x16x32_bf16 v[124:127], a[252:255], v[172:175], v[124:127]
s_waitcnt lgkmcnt(7)
v_mfma_f32_16x16x32_bf16 v[144:147], a[208:211], v[192:195], v[136:139]
v_exp_f32_e32 v158, v158
v_mfma_f32_16x16x32_bf16 v[148:151], a[208:211], v[196:199], v[140:143]
v_exp_f32_e32 v159, v159
v_mfma_f32_16x16x32_bf16 v[144:147], a[212:215], v[200:203], v[144:147]
ds_read_b128 a[248:251], v6 offset:31104
v_cvt_pk_bf16_f32 v167, v158, v159
v_mfma_f32_16x16x32_bf16 v[148:151], a[212:215], v[204:207], v[148:151]
ds_read_b128 a[252:255], v7 offset:31104
v_add_f32_e32 v128, v128, v152
v_mfma_f32_16x16x32_bf16 v[144:147], a[216:219], v[208:211], v[144:147]
s_barrier
v_add_f32_e32 v129, v129, v153
v_add_f32_e32 v130, v130, v154
v_mfma_f32_16x16x32_bf16 v[148:151], a[216:219], v[212:215], v[148:151]
s_waitcnt lgkmcnt(6)
ds_read_b64_tr_b16 a[208:209], v12 offset:12352
v_add_f32_e32 v131, v131, v155
v_mfma_f32_16x16x32_bf16 v[144:147], a[220:223], v[216:219], v[144:147]
ds_read_b64_tr_b16 a[210:211], v12 offset:18496
v_add_f32_e32 v132, v132, v156
v_mfma_f32_16x16x32_bf16 v[148:151], a[220:223], v[220:223], v[148:151]
ds_read_b64_tr_b16 a[212:213], v13 offset:12352
v_add_f32_e32 v133, v133, v157
v_mfma_f32_16x16x32_bf16 v[144:147], a[224:227], v[224:227], v[144:147]
ds_read_b64_tr_b16 a[214:215], v13 offset:18496
v_add_f32_e32 v134, v134, v158
v_mfma_f32_16x16x32_bf16 v[148:151], a[224:227], v[228:231], v[148:151]
ds_read_b64_tr_b16 a[216:217], v14 offset:12352
v_add_f32_e32 v135, v135, v159
v_mfma_f32_16x16x32_bf16 v[144:147], a[228:231], v[232:235], v[144:147]
ds_read_b64_tr_b16 a[218:219], v14 offset:18496
v_mfma_f32_16x16x32_bf16 v[148:151], a[228:231], v[236:239], v[148:151]
s_waitcnt lgkmcnt(9)
ds_read_b64_tr_b16 a[220:221], v15 offset:12352
ds_read_b64_tr_b16 a[222:223], v15 offset:18496
v_mfma_f32_16x16x32_bf16 v[152:155], a[232:235], v[192:195], v[136:139]
ds_read_b64_tr_b16 a[224:225], v12 offset:12480
ds_read_b64_tr_b16 a[226:227], v12 offset:18624
v_mfma_f32_16x16x32_bf16 v[156:159], a[232:235], v[196:199], v[140:143]
v_exp_f32_e32 v144, v144
v_mfma_f32_16x16x32_bf16 v[152:155], a[236:239], v[200:203], v[152:155]
v_exp_f32_e32 v145, v145
v_mfma_f32_16x16x32_bf16 v[156:159], a[236:239], v[204:207], v[156:159]
v_exp_f32_e32 v146, v146
v_mfma_f32_16x16x32_bf16 v[152:155], a[240:243], v[208:211], v[152:155]
v_exp_f32_e32 v147, v147
v_mfma_f32_16x16x32_bf16 v[156:159], a[240:243], v[212:215], v[156:159]
s_waitcnt lgkmcnt(10)
ds_read_b64_tr_b16 a[228:229], v13 offset:12480
ds_read_b64_tr_b16 a[230:231], v13 offset:18624
v_mfma_f32_16x16x32_bf16 v[152:155], a[244:247], v[216:219], v[152:155]
v_exp_f32_e32 v148, v148
v_mfma_f32_16x16x32_bf16 v[156:159], a[244:247], v[220:223], v[156:159]
ds_read_b64_tr_b16 a[232:233], v14 offset:12480
ds_read_b64_tr_b16 a[234:235], v14 offset:18624
v_mfma_f32_16x16x32_bf16 v[152:155], a[248:251], v[224:227], v[152:155]
v_exp_f32_e32 v149, v149
v_mfma_f32_16x16x32_bf16 v[156:159], a[248:251], v[228:231], v[156:159]
ds_read_b64_tr_b16 a[236:237], v15 offset:12480
ds_read_b64_tr_b16 a[238:239], v15 offset:18624
v_mfma_f32_16x16x32_bf16 v[152:155], a[252:255], v[232:235], v[152:155]
v_exp_f32_e32 v150, v150
v_mfma_f32_16x16x32_bf16 v[156:159], a[252:255], v[236:239], v[156:159]
s_waitcnt lgkmcnt(10)
ds_read_b64_tr_b16 a[240:241], v12 offset:12608
ds_read_b64_tr_b16 a[242:243], v12 offset:18752
v_mfma_f32_16x16x32_bf16 v[32:35], a[208:211], v[160:163], v[32:35]
v_exp_f32_e32 v151, v151
v_mfma_f32_16x16x32_bf16 v[36:39], a[208:211], v[164:167], v[36:39]
ds_read_b64_tr_b16 a[244:245], v13 offset:12608
ds_read_b64_tr_b16 a[246:247], v13 offset:18752
v_mfma_f32_16x16x32_bf16 v[40:43], a[212:215], v[160:163], v[40:43]
v_exp_f32_e32 v152, v152
v_mfma_f32_16x16x32_bf16 v[44:47], a[212:215], v[164:167], v[44:47]
ds_read_b64_tr_b16 a[248:249], v14 offset:12608
ds_read_b64_tr_b16 a[250:251], v14 offset:18752
v_mfma_f32_16x16x32_bf16 v[48:51], a[216:219], v[160:163], v[48:51]
v_exp_f32_e32 v153, v153
v_mfma_f32_16x16x32_bf16 v[52:55], a[216:219], v[164:167], v[52:55]
s_waitcnt lgkmcnt(10)
ds_read_b64_tr_b16 a[252:253], v15 offset:12608
ds_read_b64_tr_b16 a[254:255], v15 offset:18752
v_mfma_f32_16x16x32_bf16 v[56:59], a[220:223], v[160:163], v[56:59]
s_barrier
v_exp_f32_e32 v154, v154
v_mfma_f32_16x16x32_bf16 v[60:63], a[220:223], v[164:167], v[60:63]
ds_read_b128 a[208:211], v4 offset:0
ds_read_b128 a[212:215], v5 offset:0
v_mfma_f32_16x16x32_bf16 v[64:67], a[224:227], v[160:163], v[64:67]
v_exp_f32_e32 v155, v155
v_mfma_f32_16x16x32_bf16 v[68:71], a[224:227], v[164:167], v[68:71]
v_exp_f32_e32 v156, v156
v_mfma_f32_16x16x32_bf16 v[72:75], a[228:231], v[160:163], v[72:75]
v_exp_f32_e32 v157, v157
v_mfma_f32_16x16x32_bf16 v[76:79], a[228:231], v[164:167], v[76:79]
s_waitcnt lgkmcnt(8)
ds_read_b128 a[216:219], v4 offset:128
v_add_f32_e32 v128, v128, v144
v_mfma_f32_16x16x32_bf16 v[80:83], a[232:235], v[160:163], v[80:83]
ds_read_b128 a[220:223], v5 offset:128
v_add_f32_e32 v129, v129, v145
v_mfma_f32_16x16x32_bf16 v[84:87], a[232:235], v[164:167], v[84:87]
ds_read_b128 a[224:227], v4 offset:256
v_add_f32_e32 v130, v130, v146
v_mfma_f32_16x16x32_bf16 v[88:91], a[236:239], v[160:163], v[88:91]
ds_read_b128 a[228:231], v5 offset:256
v_add_f32_e32 v131, v131, v147
v_mfma_f32_16x16x32_bf16 v[92:95], a[236:239], v[164:167], v[92:95]
v_add_f32_e32 v132, v132, v148
v_add_f32_e32 v133, v133, v149
v_mfma_f32_16x16x32_bf16 v[96:99], a[240:243], v[160:163], v[96:99]
ds_read_b128 a[232:235], v4 offset:6144
v_add_f32_e32 v134, v134, v150
v_mfma_f32_16x16x32_bf16 v[100:103], a[240:243], v[164:167], v[100:103]
s_waitcnt lgkmcnt(7)
v_add_f32_e32 v135, v135, v151
v_cvt_pk_bf16_f32 v168, v144, v145
v_mfma_f32_16x16x32_bf16 v[104:107], a[244:247], v[160:163], v[104:107]
ds_read_b128 a[236:239], v5 offset:6144
v_cvt_pk_bf16_f32 v169, v146, v147
v_mfma_f32_16x16x32_bf16 v[108:111], a[244:247], v[164:167], v[108:111]
v_cvt_pk_bf16_f32 v172, v148, v149
v_cvt_pk_bf16_f32 v173, v150, v151
v_mfma_f32_16x16x32_bf16 v[112:115], a[248:251], v[160:163], v[112:115]
ds_read_b128 a[240:243], v4 offset:6272
v_cvt_pk_bf16_f32 v170, v152, v153
v_mfma_f32_16x16x32_bf16 v[116:119], a[248:251], v[164:167], v[116:119]
v_cvt_pk_bf16_f32 v171, v154, v155
v_cvt_pk_bf16_f32 v174, v156, v157
v_mfma_f32_16x16x32_bf16 v[120:123], a[252:255], v[160:163], v[120:123]
ds_read_b128 a[244:247], v5 offset:6272
v_mfma_f32_16x16x32_bf16 v[124:127], a[252:255], v[164:167], v[124:127]
s_waitcnt lgkmcnt(7)
v_mfma_f32_16x16x32_bf16 v[144:147], a[208:211], v[192:195], v[136:139]
v_exp_f32_e32 v158, v158
v_mfma_f32_16x16x32_bf16 v[148:151], a[208:211], v[196:199], v[140:143]
v_exp_f32_e32 v159, v159
v_mfma_f32_16x16x32_bf16 v[144:147], a[212:215], v[200:203], v[144:147]
ds_read_b128 a[248:251], v4 offset:6400
v_cvt_pk_bf16_f32 v175, v158, v159
v_mfma_f32_16x16x32_bf16 v[148:151], a[212:215], v[204:207], v[148:151]
ds_read_b128 a[252:255], v5 offset:6400
v_add_f32_e32 v128, v128, v152
v_mfma_f32_16x16x32_bf16 v[144:147], a[216:219], v[208:211], v[144:147]
s_barrier
v_add_f32_e32 v129, v129, v153
v_add_f32_e32 v130, v130, v154
v_mfma_f32_16x16x32_bf16 v[148:151], a[216:219], v[212:215], v[148:151]
s_waitcnt lgkmcnt(6)
ds_read_b64_tr_b16 a[208:209], v12 offset:37056
v_add_f32_e32 v131, v131, v155
v_mfma_f32_16x16x32_bf16 v[144:147], a[220:223], v[216:219], v[144:147]
ds_read_b64_tr_b16 a[210:211], v12 offset:43200
v_add_f32_e32 v132, v132, v156
v_mfma_f32_16x16x32_bf16 v[148:151], a[220:223], v[220:223], v[148:151]
ds_read_b64_tr_b16 a[212:213], v13 offset:37056
v_add_f32_e32 v133, v133, v157
v_mfma_f32_16x16x32_bf16 v[144:147], a[224:227], v[224:227], v[144:147]
ds_read_b64_tr_b16 a[214:215], v13 offset:43200
v_add_f32_e32 v134, v134, v158
v_mfma_f32_16x16x32_bf16 v[148:151], a[224:227], v[228:231], v[148:151]
ds_read_b64_tr_b16 a[216:217], v14 offset:37056
v_add_f32_e32 v135, v135, v159
v_mfma_f32_16x16x32_bf16 v[144:147], a[228:231], v[232:235], v[144:147]
ds_read_b64_tr_b16 a[218:219], v14 offset:43200
v_mfma_f32_16x16x32_bf16 v[148:151], a[228:231], v[236:239], v[148:151]
s_waitcnt lgkmcnt(9)
ds_read_b64_tr_b16 a[220:221], v15 offset:37056
ds_read_b64_tr_b16 a[222:223], v15 offset:43200
v_mfma_f32_16x16x32_bf16 v[152:155], a[232:235], v[192:195], v[136:139]
ds_read_b64_tr_b16 a[224:225], v12 offset:37184
ds_read_b64_tr_b16 a[226:227], v12 offset:43328
v_mfma_f32_16x16x32_bf16 v[156:159], a[232:235], v[196:199], v[140:143]
v_exp_f32_e32 v144, v144
v_mfma_f32_16x16x32_bf16 v[152:155], a[236:239], v[200:203], v[152:155]
v_exp_f32_e32 v145, v145
v_mfma_f32_16x16x32_bf16 v[156:159], a[236:239], v[204:207], v[156:159]
v_exp_f32_e32 v146, v146
v_mfma_f32_16x16x32_bf16 v[152:155], a[240:243], v[208:211], v[152:155]
v_exp_f32_e32 v147, v147
v_mfma_f32_16x16x32_bf16 v[156:159], a[240:243], v[212:215], v[156:159]
s_waitcnt lgkmcnt(10)
ds_read_b64_tr_b16 a[228:229], v13 offset:37184
ds_read_b64_tr_b16 a[230:231], v13 offset:43328
v_mfma_f32_16x16x32_bf16 v[152:155], a[244:247], v[216:219], v[152:155]
v_exp_f32_e32 v148, v148
v_mfma_f32_16x16x32_bf16 v[156:159], a[244:247], v[220:223], v[156:159]
ds_read_b64_tr_b16 a[232:233], v14 offset:37184
ds_read_b64_tr_b16 a[234:235], v14 offset:43328
v_mfma_f32_16x16x32_bf16 v[152:155], a[248:251], v[224:227], v[152:155]
v_exp_f32_e32 v149, v149
v_mfma_f32_16x16x32_bf16 v[156:159], a[248:251], v[228:231], v[156:159]
ds_read_b64_tr_b16 a[236:237], v15 offset:37184
ds_read_b64_tr_b16 a[238:239], v15 offset:43328
v_mfma_f32_16x16x32_bf16 v[152:155], a[252:255], v[232:235], v[152:155]
v_exp_f32_e32 v150, v150
v_mfma_f32_16x16x32_bf16 v[156:159], a[252:255], v[236:239], v[156:159]
s_waitcnt lgkmcnt(10)
ds_read_b64_tr_b16 a[240:241], v12 offset:37312
ds_read_b64_tr_b16 a[242:243], v12 offset:43456
v_mfma_f32_16x16x32_bf16 v[32:35], a[208:211], v[168:171], v[32:35]
v_exp_f32_e32 v151, v151
v_mfma_f32_16x16x32_bf16 v[36:39], a[208:211], v[172:175], v[36:39]
ds_read_b64_tr_b16 a[244:245], v13 offset:37312
ds_read_b64_tr_b16 a[246:247], v13 offset:43456
v_mfma_f32_16x16x32_bf16 v[40:43], a[212:215], v[168:171], v[40:43]
v_exp_f32_e32 v152, v152
v_mfma_f32_16x16x32_bf16 v[44:47], a[212:215], v[172:175], v[44:47]
ds_read_b64_tr_b16 a[248:249], v14 offset:37312
ds_read_b64_tr_b16 a[250:251], v14 offset:43456
v_mfma_f32_16x16x32_bf16 v[48:51], a[216:219], v[168:171], v[48:51]
v_exp_f32_e32 v153, v153
v_mfma_f32_16x16x32_bf16 v[52:55], a[216:219], v[172:175], v[52:55]
s_waitcnt lgkmcnt(10)
ds_read_b64_tr_b16 a[252:253], v15 offset:37312
ds_read_b64_tr_b16 a[254:255], v15 offset:43456
v_mfma_f32_16x16x32_bf16 v[56:59], a[220:223], v[168:171], v[56:59]
s_barrier
v_exp_f32_e32 v154, v154
v_mfma_f32_16x16x32_bf16 v[60:63], a[220:223], v[172:175], v[60:63]
ds_read_b128 a[208:211], v4 offset:24704
ds_read_b128 a[212:215], v5 offset:24704
v_mfma_f32_16x16x32_bf16 v[64:67], a[224:227], v[168:171], v[64:67]
v_exp_f32_e32 v155, v155
v_mfma_f32_16x16x32_bf16 v[68:71], a[224:227], v[172:175], v[68:71]
v_exp_f32_e32 v156, v156
v_mfma_f32_16x16x32_bf16 v[72:75], a[228:231], v[168:171], v[72:75]
v_exp_f32_e32 v157, v157
v_mfma_f32_16x16x32_bf16 v[76:79], a[228:231], v[172:175], v[76:79]
s_waitcnt lgkmcnt(8)
ds_read_b128 a[216:219], v4 offset:24832
v_add_f32_e32 v128, v128, v144
v_mfma_f32_16x16x32_bf16 v[80:83], a[232:235], v[168:171], v[80:83]
ds_read_b128 a[220:223], v5 offset:24832
v_add_f32_e32 v129, v129, v145
v_mfma_f32_16x16x32_bf16 v[84:87], a[232:235], v[172:175], v[84:87]
ds_read_b128 a[224:227], v4 offset:24960
v_add_f32_e32 v130, v130, v146
v_mfma_f32_16x16x32_bf16 v[88:91], a[236:239], v[168:171], v[88:91]
ds_read_b128 a[228:231], v5 offset:24960
v_add_f32_e32 v131, v131, v147
v_mfma_f32_16x16x32_bf16 v[92:95], a[236:239], v[172:175], v[92:95]
v_add_f32_e32 v132, v132, v148
v_add_f32_e32 v133, v133, v149
v_mfma_f32_16x16x32_bf16 v[96:99], a[240:243], v[168:171], v[96:99]
ds_read_b128 a[232:235], v4 offset:30848
v_add_f32_e32 v134, v134, v150
v_mfma_f32_16x16x32_bf16 v[100:103], a[240:243], v[172:175], v[100:103]
s_waitcnt lgkmcnt(7)
v_add_f32_e32 v135, v135, v151
v_cvt_pk_bf16_f32 v160, v144, v145
v_mfma_f32_16x16x32_bf16 v[104:107], a[244:247], v[168:171], v[104:107]
ds_read_b128 a[236:239], v5 offset:30848
v_cvt_pk_bf16_f32 v161, v146, v147
v_mfma_f32_16x16x32_bf16 v[108:111], a[244:247], v[172:175], v[108:111]
v_cvt_pk_bf16_f32 v164, v148, v149
v_cvt_pk_bf16_f32 v165, v150, v151
v_mfma_f32_16x16x32_bf16 v[112:115], a[248:251], v[168:171], v[112:115]
ds_read_b128 a[240:243], v4 offset:30976
v_cvt_pk_bf16_f32 v162, v152, v153
v_mfma_f32_16x16x32_bf16 v[116:119], a[248:251], v[172:175], v[116:119]
v_cvt_pk_bf16_f32 v163, v154, v155
v_cvt_pk_bf16_f32 v166, v156, v157
v_mfma_f32_16x16x32_bf16 v[120:123], a[252:255], v[168:171], v[120:123]
ds_read_b128 a[244:247], v5 offset:30976
v_mfma_f32_16x16x32_bf16 v[124:127], a[252:255], v[172:175], v[124:127]
s_waitcnt lgkmcnt(7)
v_mfma_f32_16x16x32_bf16 v[144:147], a[208:211], v[192:195], v[136:139]
v_exp_f32_e32 v158, v158
v_mfma_f32_16x16x32_bf16 v[148:151], a[208:211], v[196:199], v[140:143]
v_exp_f32_e32 v159, v159
v_mfma_f32_16x16x32_bf16 v[144:147], a[212:215], v[200:203], v[144:147]
ds_read_b128 a[248:251], v4 offset:31104
v_cvt_pk_bf16_f32 v167, v158, v159
v_mfma_f32_16x16x32_bf16 v[148:151], a[212:215], v[204:207], v[148:151]
ds_read_b128 a[252:255], v5 offset:31104
v_add_f32_e32 v128, v128, v152
v_mfma_f32_16x16x32_bf16 v[144:147], a[216:219], v[208:211], v[144:147]
s_barrier
v_add_f32_e32 v129, v129, v153
v_add_f32_e32 v130, v130, v154
v_mfma_f32_16x16x32_bf16 v[148:151], a[216:219], v[212:215], v[148:151]
s_waitcnt lgkmcnt(6)
ds_read_b64_tr_b16 a[208:209], v8 offset:12352
v_add_f32_e32 v131, v131, v155
v_mfma_f32_16x16x32_bf16 v[144:147], a[220:223], v[216:219], v[144:147]
ds_read_b64_tr_b16 a[210:211], v8 offset:18496
v_add_f32_e32 v132, v132, v156
v_mfma_f32_16x16x32_bf16 v[148:151], a[220:223], v[220:223], v[148:151]
ds_read_b64_tr_b16 a[212:213], v9 offset:12352
v_add_f32_e32 v133, v133, v157
v_mfma_f32_16x16x32_bf16 v[144:147], a[224:227], v[224:227], v[144:147]
ds_read_b64_tr_b16 a[214:215], v9 offset:18496
v_add_f32_e32 v134, v134, v158
v_mfma_f32_16x16x32_bf16 v[148:151], a[224:227], v[228:231], v[148:151]
ds_read_b64_tr_b16 a[216:217], v10 offset:12352
v_add_f32_e32 v135, v135, v159
v_mfma_f32_16x16x32_bf16 v[144:147], a[228:231], v[232:235], v[144:147]
ds_read_b64_tr_b16 a[218:219], v10 offset:18496
v_mfma_f32_16x16x32_bf16 v[148:151], a[228:231], v[236:239], v[148:151]
s_waitcnt lgkmcnt(9)
ds_read_b64_tr_b16 a[220:221], v11 offset:12352
ds_read_b64_tr_b16 a[222:223], v11 offset:18496
v_mfma_f32_16x16x32_bf16 v[152:155], a[232:235], v[192:195], v[136:139]
ds_read_b64_tr_b16 a[224:225], v8 offset:12480
ds_read_b64_tr_b16 a[226:227], v8 offset:18624
v_mfma_f32_16x16x32_bf16 v[156:159], a[232:235], v[196:199], v[140:143]
v_exp_f32_e32 v144, v144
v_mfma_f32_16x16x32_bf16 v[152:155], a[236:239], v[200:203], v[152:155]
v_exp_f32_e32 v145, v145
v_mfma_f32_16x16x32_bf16 v[156:159], a[236:239], v[204:207], v[156:159]
v_exp_f32_e32 v146, v146
v_mfma_f32_16x16x32_bf16 v[152:155], a[240:243], v[208:211], v[152:155]
v_exp_f32_e32 v147, v147
v_mfma_f32_16x16x32_bf16 v[156:159], a[240:243], v[212:215], v[156:159]
s_waitcnt lgkmcnt(10)
ds_read_b64_tr_b16 a[228:229], v9 offset:12480
ds_read_b64_tr_b16 a[230:231], v9 offset:18624
v_mfma_f32_16x16x32_bf16 v[152:155], a[244:247], v[216:219], v[152:155]
v_exp_f32_e32 v148, v148
v_mfma_f32_16x16x32_bf16 v[156:159], a[244:247], v[220:223], v[156:159]
ds_read_b64_tr_b16 a[232:233], v10 offset:12480
ds_read_b64_tr_b16 a[234:235], v10 offset:18624
v_mfma_f32_16x16x32_bf16 v[152:155], a[248:251], v[224:227], v[152:155]
v_exp_f32_e32 v149, v149
v_mfma_f32_16x16x32_bf16 v[156:159], a[248:251], v[228:231], v[156:159]
ds_read_b64_tr_b16 a[236:237], v11 offset:12480
ds_read_b64_tr_b16 a[238:239], v11 offset:18624
v_mfma_f32_16x16x32_bf16 v[152:155], a[252:255], v[232:235], v[152:155]
v_exp_f32_e32 v150, v150
v_mfma_f32_16x16x32_bf16 v[156:159], a[252:255], v[236:239], v[156:159]
s_waitcnt lgkmcnt(10)
ds_read_b64_tr_b16 a[240:241], v8 offset:12608
ds_read_b64_tr_b16 a[242:243], v8 offset:18752
v_mfma_f32_16x16x32_bf16 v[32:35], a[208:211], v[160:163], v[32:35]
v_exp_f32_e32 v151, v151
v_mfma_f32_16x16x32_bf16 v[36:39], a[208:211], v[164:167], v[36:39]
ds_read_b64_tr_b16 a[244:245], v9 offset:12608
ds_read_b64_tr_b16 a[246:247], v9 offset:18752
v_mfma_f32_16x16x32_bf16 v[40:43], a[212:215], v[160:163], v[40:43]
v_exp_f32_e32 v152, v152
v_mfma_f32_16x16x32_bf16 v[44:47], a[212:215], v[164:167], v[44:47]
ds_read_b64_tr_b16 a[248:249], v10 offset:12608
ds_read_b64_tr_b16 a[250:251], v10 offset:18752
v_mfma_f32_16x16x32_bf16 v[48:51], a[216:219], v[160:163], v[48:51]
v_exp_f32_e32 v153, v153
v_mfma_f32_16x16x32_bf16 v[52:55], a[216:219], v[164:167], v[52:55]
s_waitcnt lgkmcnt(10)
ds_read_b64_tr_b16 a[252:253], v11 offset:12608
ds_read_b64_tr_b16 a[254:255], v11 offset:18752
v_mfma_f32_16x16x32_bf16 v[56:59], a[220:223], v[160:163], v[56:59]
s_barrier
v_exp_f32_e32 v154, v154
v_mfma_f32_16x16x32_bf16 v[60:63], a[220:223], v[164:167], v[60:63]
ds_read_b128 a[208:211], v6 offset:0
ds_read_b128 a[212:215], v7 offset:0
v_mfma_f32_16x16x32_bf16 v[64:67], a[224:227], v[160:163], v[64:67]
v_exp_f32_e32 v155, v155
v_mfma_f32_16x16x32_bf16 v[68:71], a[224:227], v[164:167], v[68:71]
v_exp_f32_e32 v156, v156
v_mfma_f32_16x16x32_bf16 v[72:75], a[228:231], v[160:163], v[72:75]
v_exp_f32_e32 v157, v157
v_mfma_f32_16x16x32_bf16 v[76:79], a[228:231], v[164:167], v[76:79]
s_waitcnt lgkmcnt(8)
ds_read_b128 a[216:219], v6 offset:128
v_add_f32_e32 v128, v128, v144
v_mfma_f32_16x16x32_bf16 v[80:83], a[232:235], v[160:163], v[80:83]
ds_read_b128 a[220:223], v7 offset:128
v_add_f32_e32 v129, v129, v145
v_mfma_f32_16x16x32_bf16 v[84:87], a[232:235], v[164:167], v[84:87]
ds_read_b128 a[224:227], v6 offset:256
v_add_f32_e32 v130, v130, v146
v_mfma_f32_16x16x32_bf16 v[88:91], a[236:239], v[160:163], v[88:91]
ds_read_b128 a[228:231], v7 offset:256
v_add_f32_e32 v131, v131, v147
v_mfma_f32_16x16x32_bf16 v[92:95], a[236:239], v[164:167], v[92:95]
v_add_f32_e32 v132, v132, v148
v_add_f32_e32 v133, v133, v149
v_mfma_f32_16x16x32_bf16 v[96:99], a[240:243], v[160:163], v[96:99]
ds_read_b128 a[232:235], v6 offset:6144
v_add_f32_e32 v134, v134, v150
v_mfma_f32_16x16x32_bf16 v[100:103], a[240:243], v[164:167], v[100:103]
s_waitcnt lgkmcnt(7)
v_add_f32_e32 v135, v135, v151
v_cvt_pk_bf16_f32 v168, v144, v145
v_mfma_f32_16x16x32_bf16 v[104:107], a[244:247], v[160:163], v[104:107]
ds_read_b128 a[236:239], v7 offset:6144
v_cvt_pk_bf16_f32 v169, v146, v147
v_mfma_f32_16x16x32_bf16 v[108:111], a[244:247], v[164:167], v[108:111]
v_cvt_pk_bf16_f32 v172, v148, v149
v_cvt_pk_bf16_f32 v173, v150, v151
v_mfma_f32_16x16x32_bf16 v[112:115], a[248:251], v[160:163], v[112:115]
ds_read_b128 a[240:243], v6 offset:6272
v_cvt_pk_bf16_f32 v170, v152, v153
v_mfma_f32_16x16x32_bf16 v[116:119], a[248:251], v[164:167], v[116:119]
v_cvt_pk_bf16_f32 v171, v154, v155
v_cvt_pk_bf16_f32 v174, v156, v157
v_mfma_f32_16x16x32_bf16 v[120:123], a[252:255], v[160:163], v[120:123]
v_mfma_f32_16x16x32_bf16 v[124:127], a[252:255], v[164:167], v[124:127]
s_add_u32 s30, s30, 1
s_cmp_eq_u32 s28, 0
s_cbranch_scc1 L_cont0
s_cmp_eq_u32 s30, 1
s_cbranch_scc1 L_O0a
s_cmp_eq_u32 s30, 2
s_cbranch_scc1 L_O0b
s_cmp_eq_u32 s30, 3
s_cbranch_scc1 L_O0c
L_cont0:
s_cmp_lg_u32 s30, 3
s_cbranch_scc1 L_a0
L_tail0:
s_waitcnt lgkmcnt(6)
v_mfma_f32_16x16x32_bf16 v[144:147], a[208:211], v[192:195], v[136:139]
v_exp_f32_e32 v158, v158
v_mfma_f32_16x16x32_bf16 v[148:151], a[208:211], v[196:199], v[140:143]
ds_read_b128 a[244:247], v7 offset:6272
ds_read_b128 a[248:251], v6 offset:6400
v_mfma_f32_16x16x32_bf16 v[144:147], a[212:215], v[200:203], v[144:147]
v_exp_f32_e32 v159, v159
v_mfma_f32_16x16x32_bf16 v[148:151], a[212:215], v[204:207], v[148:151]
ds_read_b128 a[252:255], v7 offset:6400
v_cvt_pk_bf16_f32 v175, v158, v159
v_mfma_f32_16x16x32_bf16 v[144:147], a[216:219], v[208:211], v[144:147]
s_barrier
v_add_f32_e32 v128, v128, v152
v_add_f32_e32 v129, v129, v153
v_mfma_f32_16x16x32_bf16 v[148:151], a[216:219], v[212:215], v[148:151]
s_waitcnt lgkmcnt(6)
ds_read_b64_tr_b16 a[208:209], v8 offset:37056
v_add_f32_e32 v130, v130, v154
v_mfma_f32_16x16x32_bf16 v[144:147], a[220:223], v[216:219], v[144:147]
ds_read_b64_tr_b16 a[210:211], v8 offset:43200
v_add_f32_e32 v131, v131, v155
v_mfma_f32_16x16x32_bf16 v[148:151], a[220:223], v[220:223], v[148:151]
ds_read_b64_tr_b16 a[212:213], v9 offset:37056
v_add_f32_e32 v132, v132, v156
v_mfma_f32_16x16x32_bf16 v[144:147], a[224:227], v[224:227], v[144:147]
ds_read_b64_tr_b16 a[214:215], v9 offset:43200
v_add_f32_e32 v133, v133, v157
v_mfma_f32_16x16x32_bf16 v[148:151], a[224:227], v[228:231], v[148:151]
ds_read_b64_tr_b16 a[216:217], v10 offset:37056
v_add_f32_e32 v134, v134, v158
v_mfma_f32_16x16x32_bf16 v[144:147], a[228:231], v[232:235], v[144:147]
ds_read_b64_tr_b16 a[218:219], v10 offset:43200
v_add_f32_e32 v135, v135, v159
v_mfma_f32_16x16x32_bf16 v[148:151], a[228:231], v[236:239], v[148:151]
s_waitcnt lgkmcnt(9)
ds_read_b64_tr_b16 a[220:221], v11 offset:37056
ds_read_b64_tr_b16 a[222:223], v11 offset:43200
v_mfma_f32_16x16x32_bf16 v[152:155], a[232:235], v[192:195], v[136:139]
ds_read_b64_tr_b16 a[224:225], v8 offset:37184
ds_read_b64_tr_b16 a[226:227], v8 offset:43328
v_mfma_f32_16x16x32_bf16 v[156:159], a[232:235], v[196:199], v[140:143]
v_exp_f32_e32 v144, v144
v_mfma_f32_16x16x32_bf16 v[152:155], a[236:239], v[200:203], v[152:155]
v_exp_f32_e32 v145, v145
v_mfma_f32_16x16x32_bf16 v[156:159], a[236:239], v[204:207], v[156:159]
v_exp_f32_e32 v146, v146
v_mfma_f32_16x16x32_bf16 v[152:155], a[240:243], v[208:211], v[152:155]
v_exp_f32_e32 v147, v147
v_mfma_f32_16x16x32_bf16 v[156:159], a[240:243], v[212:215], v[156:159]
s_waitcnt lgkmcnt(10)
ds_read_b64_tr_b16 a[228:229], v9 offset:37184
ds_read_b64_tr_b16 a[230:231], v9 offset:43328
v_mfma_f32_16x16x32_bf16 v[152:155], a[244:247], v[216:219], v[152:155]
v_exp_f32_e32 v148, v148
v_mfma_f32_16x16x32_bf16 v[156:159], a[244:247], v[220:223], v[156:159]
ds_read_b64_tr_b16 a[232:233], v10 offset:37184
ds_read_b64_tr_b16 a[234:235], v10 offset:43328
v_mfma_f32_16x16x32_bf16 v[152:155], a[248:251], v[224:227], v[152:155]
v_exp_f32_e32 v149, v149
v_mfma_f32_16x16x32_bf16 v[156:159], a[248:251], v[228:231], v[156:159]
ds_read_b64_tr_b16 a[236:237], v11 offset:37184
ds_read_b64_tr_b16 a[238:239], v11 offset:43328
v_mfma_f32_16x16x32_bf16 v[152:155], a[252:255], v[232:235], v[152:155]
v_exp_f32_e32 v150, v150
v_mfma_f32_16x16x32_bf16 v[156:159], a[252:255], v[236:239], v[156:159]
s_waitcnt lgkmcnt(10)
ds_read_b64_tr_b16 a[240:241], v8 offset:37312
ds_read_b64_tr_b16 a[242:243], v8 offset:43456
v_mfma_f32_16x16x32_bf16 v[32:35], a[208:211], v[168:171], v[32:35]
v_exp_f32_e32 v151, v151
v_mfma_f32_16x16x32_bf16 v[36:39], a[208:211], v[172:175], v[36:39]
ds_read_b64_tr_b16 a[244:245], v9 offset:37312
ds_read_b64_tr_b16 a[246:247], v9 offset:43456
v_mfma_f32_16x16x32_bf16 v[40:43], a[212:215], v[168:171], v[40:43]
v_exp_f32_e32 v152, v152
v_mfma_f32_16x16x32_bf16 v[44:47], a[212:215], v[172:175], v[44:47]
ds_read_b64_tr_b16 a[248:249], v10 offset:37312
ds_read_b64_tr_b16 a[250:251], v10 offset:43456
v_mfma_f32_16x16x32_bf16 v[48:51], a[216:219], v[168:171], v[48:51]
v_exp_f32_e32 v153, v153
v_mfma_f32_16x16x32_bf16 v[52:55], a[216:219], v[172:175], v[52:55]
s_waitcnt lgkmcnt(10)
ds_read_b64_tr_b16 a[252:253], v11 offset:37312
ds_read_b64_tr_b16 a[254:255], v11 offset:43456
v_mfma_f32_16x16x32_bf16 v[56:59], a[220:223], v[168:171], v[56:59]
s_barrier
v_exp_f32_e32 v154, v154
v_mfma_f32_16x16x32_bf16 v[60:63], a[220:223], v[172:175], v[60:63]
ds_read_b128 a[208:211], v6 offset:24704
ds_read_b128 a[212:215], v7 offset:24704
v_mfma_f32_16x16x32_bf16 v[64:67], a[224:227], v[168:171], v[64:67]
v_exp_f32_e32 v155, v155
v_mfma_f32_16x16x32_bf16 v[68:71], a[224:227], v[172:175], v[68:71]
v_exp_f32_e32 v156, v156
v_mfma_f32_16x16x32_bf16 v[72:75], a[228:231], v[168:171], v[72:75]
v_exp_f32_e32 v157, v157
v_mfma_f32_16x16x32_bf16 v[76:79], a[228:231], v[172:175], v[76:79]
s_waitcnt lgkmcnt(8)
ds_read_b128 a[216:219], v6 offset:24832
v_add_f32_e32 v128, v128, v144
v_mfma_f32_16x16x32_bf16 v[80:83], a[232:235], v[168:171], v[80:83]
ds_read_b128 a[220:223], v7 offset:24832
v_add_f32_e32 v129, v129, v145
v_mfma_f32_16x16x32_bf16 v[84:87], a[232:235], v[172:175], v[84:87]
ds_read_b128 a[224:227], v6 offset:24960
v_add_f32_e32 v130, v130, v146
v_mfma_f32_16x16x32_bf16 v[88:91], a[236:239], v[168:171], v[88:91]
ds_read_b128 a[228:231], v7 offset:24960
v_add_f32_e32 v131, v131, v147
v_mfma_f32_16x16x32_bf16 v[92:95], a[236:239], v[172:175], v[92:95]
v_add_f32_e32 v132, v132, v148
v_add_f32_e32 v133, v133, v149
v_mfma_f32_16x16x32_bf16 v[96:99], a[240:243], v[168:171], v[96:99]
ds_read_b128 a[232:235], v6 offset:30848
v_add_f32_e32 v134, v134, v150
v_mfma_f32_16x16x32_bf16 v[100:103], a[240:243], v[172:175], v[100:103]
s_waitcnt lgkmcnt(7)
v_add_f32_e32 v135, v135, v151
v_cvt_pk_bf16_f32 v160, v144, v145
v_mfma_f32_16x16x32_bf16 v[104:107], a[244:247], v[168:171], v[104:107]
ds_read_b128 a[236:239], v7 offset:30848
v_cvt_pk_bf16_f32 v161, v146, v147
v_mfma_f32_16x16x32_bf16 v[108:111], a[244:247], v[172:175], v[108:111]
v_cvt_pk_bf16_f32 v164, v148, v149
v_cvt_pk_bf16_f32 v165, v150, v151
v_mfma_f32_16x16x32_bf16 v[112:115], a[248:251], v[168:171], v[112:115]
ds_read_b128 a[240:243], v6 offset:30976
v_cvt_pk_bf16_f32 v162, v152, v153
v_mfma_f32_16x16x32_bf16 v[116:119], a[248:251], v[172:175], v[116:119]
v_cvt_pk_bf16_f32 v163, v154, v155
v_cvt_pk_bf16_f32 v166, v156, v157
v_mfma_f32_16x16x32_bf16 v[120:123], a[252:255], v[168:171], v[120:123]
ds_read_b128 a[244:247], v7 offset:30976
v_mfma_f32_16x16x32_bf16 v[124:127], a[252:255], v[172:175], v[124:127]
s_waitcnt lgkmcnt(7)
v_mfma_f32_16x16x32_bf16 v[144:147], a[208:211], v[192:195], v[136:139]
v_exp_f32_e32 v158, v158
v_mfma_f32_16x16x32_bf16 v[148:151], a[208:211], v[196:199], v[140:143]
v_exp_f32_e32 v159, v159
v_mfma_f32_16x16x32_bf16 v[144:147], a[212:215], v[200:203], v[144:147]
ds_read_b128 a[248:251], v6 offset:31104
v_cvt_pk_bf16_f32 v167, v158, v159
v_mfma_f32_16x16x32_bf16 v[148:151], a[212:215], v[204:207], v[148:151]
ds_read_b128 a[252:255], v7 offset:31104
v_add_f32_e32 v128, v128, v152
v_mfma_f32_16x16x32_bf16 v[144:147], a[216:219], v[208:211], v[144:147]
s_barrier
v_add_f32_e32 v129, v129, v153
v_add_f32_e32 v130, v130, v154
v_mfma_f32_16x16x32_bf16 v[148:151], a[216:219], v[212:215], v[148:151]
s_waitcnt lgkmcnt(6)
ds_read_b64_tr_b16 a[208:209], v12 offset:12352
v_add_f32_e32 v131, v131, v155
v_mfma_f32_16x16x32_bf16 v[144:147], a[220:223], v[216:219], v[144:147]
ds_read_b64_tr_b16 a[210:211], v12 offset:18496
v_add_f32_e32 v132, v132, v156
v_mfma_f32_16x16x32_bf16 v[148:151], a[220:223], v[220:223], v[148:151]
ds_read_b64_tr_b16 a[212:213], v13 offset:12352
v_add_f32_e32 v133, v133, v157
v_mfma_f32_16x16x32_bf16 v[144:147], a[224:227], v[224:227], v[144:147]
ds_read_b64_tr_b16 a[214:215], v13 offset:18496
v_add_f32_e32 v134, v134, v158
v_mfma_f32_16x16x32_bf16 v[148:151], a[224:227], v[228:231], v[148:151]
s_cmp_eq_u32 s28, 3
s_cbranch_scc1 L_x0
s_add_u32 m0, s93, 148224
s_mov_b32 s37, 0
buffer_load_dwordx4 v1, s[4:7], s37 offen lds
buffer_load_dwordx4 v2, s[4:7], s37 offen offset:1024 lds
buffer_load_dwordx4 v3, s[4:7], s37 offen offset:2048 lds
buffer_load_dwordx4 v255, s[4:7], s37 offen offset:3072 lds
L_x0:
v_mfma_f32_16x16x32_bf16 v[144:147], a[228:231], v[232:235], v[144:147]
ds_read_b64_tr_b16 a[216:217], v14 offset:12352
v_add_f32_e32 v135, v135, v159
v_mfma_f32_16x16x32_bf16 v[148:151], a[228:231], v[236:239], v[148:151]
s_waitcnt lgkmcnt(8)
ds_read_b64_tr_b16 a[218:219], v14 offset:18496
ds_read_b64_tr_b16 a[220:221], v15 offset:12352
v_mfma_f32_16x16x32_bf16 v[152:155], a[232:235], v[192:195], v[136:139]
ds_read_b64_tr_b16 a[222:223], v15 offset:18496
ds_read_b64_tr_b16 a[224:225], v12 offset:12480
v_mfma_f32_16x16x32_bf16 v[156:159], a[232:235], v[196:199], v[140:143]
v_exp_f32_e32 v144, v144
v_mfma_f32_16x16x32_bf16 v[152:155], a[236:239], v[200:203], v[152:155]
v_exp_f32_e32 v145, v145
v_mfma_f32_16x16x32_bf16 v[156:159], a[236:239], v[204:207], v[156:159]
ds_read_b64_tr_b16 a[226:227], v12 offset:18624
ds_read_b64_tr_b16 a[228:229], v13 offset:12480
v_mfma_f32_16x16x32_bf16 v[152:155], a[240:243], v[208:211], v[152:155]
v_exp_f32_e32 v146, v146
v_mfma_f32_16x16x32_bf16 v[156:159], a[240:243], v[212:215], v[156:159]
s_waitcnt lgkmcnt(11)
ds_read_b64_tr_b16 a[230:231], v13 offset:18624
ds_read_b64_tr_b16 a[232:233], v14 offset:12480
v_mfma_f32_16x16x32_bf16 v[152:155], a[244:247], v[216:219], v[152:155]
v_exp_f32_e32 v147, v147
v_mfma_f32_16x16x32_bf16 v[156:159], a[244:247], v[220:223], v[156:159]
ds_read_b64_tr_b16 a[234:235], v14 offset:18624
ds_read_b64_tr_b16 a[236:237], v15 offset:12480
v_mfma_f32_16x16x32_bf16 v[152:155], a[248:251], v[224:227], v[152:155]
v_exp_f32_e32 v148, v148
v_mfma_f32_16x16x32_bf16 v[156:159], a[248:251], v[228:231], v[156:159]
ds_read_b64_tr_b16 a[238:239], v15 offset:18624
ds_read_b64_tr_b16 a[240:241], v12 offset:12608
v_mfma_f32_16x16x32_bf16 v[152:155], a[252:255], v[232:235], v[152:155]
v_exp_f32_e32 v149, v149
v_mfma_f32_16x16x32_bf16 v[156:159], a[252:255], v[236:239], v[156:159]
s_waitcnt lgkmcnt(11)
ds_read_b64_tr_b16 a[242:243], v12 offset:18752
ds_read_b64_tr_b16 a[244:245], v13 offset:12608
v_mfma_f32_16x16x32_bf16 v[32:35], a[208:211], v[160:163], v[32:35]
v_exp_f32_e32 v150, v150
v_mfma_f32_16x16x32_bf16 v[36:39], a[208:211], v[164:167], v[36:39]
ds_read_b64_tr_b16 a[246:247], v13 offset:18752
ds_read_b64_tr_b16 a[248:249], v14 offset:12608
v_mfma_f32_16x16x32_bf16 v[40:43], a[212:215], v[160:163], v[40:43]
v_exp_f32_e32 v151, v151
v_mfma_f32_16x16x32_bf16 v[44:47], a[212:215], v[164:167], v[44:47]
ds_read_b64_tr_b16 a[250:251], v14 offset:18752
ds_read_b64_tr_b16 a[252:253], v15 offset:12608
v_mfma_f32_16x16x32_bf16 v[48:51], a[216:219], v[160:163], v[48:51]
v_exp_f32_e32 v152, v152
v_mfma_f32_16x16x32_bf16 v[52:55], a[216:219], v[164:167], v[52:55]
s_waitcnt lgkmcnt(11)
ds_read_b64_tr_b16 a[254:255], v15 offset:18752
v_cvt_pk_bf16_f32 v168, v144, v145
v_mfma_f32_16x16x32_bf16 v[56:59], a[220:223], v[160:163], v[56:59]
s_barrier
v_exp_f32_e32 v153, v153
v_mfma_f32_16x16x32_bf16 v[60:63], a[220:223], v[164:167], v[60:63]
ds_read_b64_tr_b16 a[208:209], v12 offset:37056
ds_read_b64_tr_b16 a[210:211], v12 offset:43200
v_mfma_f32_16x16x32_bf16 v[64:67], a[224:227], v[160:163], v[64:67]
v_exp_f32_e32 v154, v154
v_mfma_f32_16x16x32_bf16 v[68:71], a[224:227], v[164:167], v[68:71]
ds_read_b64_tr_b16 a[212:213], v13 offset:37056
ds_read_b64_tr_b16 a[214:215], v13 offset:43200
v_mfma_f32_16x16x32_bf16 v[72:75], a[228:231], v[160:163], v[72:75]
v_exp_f32_e32 v155, v155
v_mfma_f32_16x16x32_bf16 v[76:79], a[228:231], v[164:167], v[76:79]
s_waitcnt lgkmcnt(10)
ds_read_b64_tr_b16 a[216:217], v14 offset:37056
ds_read_b64_tr_b16 a[218:219], v14 offset:43200
v_mfma_f32_16x16x32_bf16 v[80:83], a[232:235], v[160:163], v[80:83]
v_exp_f32_e32 v156, v156
v_mfma_f32_16x16x32_bf16 v[84:87], a[232:235], v[164:167], v[84:87]
ds_read_b64_tr_b16 a[220:221], v15 offset:37056
ds_read_b64_tr_b16 a[222:223], v15 offset:43200
v_mfma_f32_16x16x32_bf16 v[88:91], a[236:239], v[160:163], v[88:91]
v_exp_f32_e32 v157, v157
v_mfma_f32_16x16x32_bf16 v[92:95], a[236:239], v[164:167], v[92:95]
ds_read_b64_tr_b16 a[224:225], v12 offset:37184
ds_read_b64_tr_b16 a[226:227], v12 offset:43328
v_mfma_f32_16x16x32_bf16 v[96:99], a[240:243], v[160:163], v[96:99]
v_exp_f32_e32 v158, v158
v_mfma_f32_16x16x32_bf16 v[100:103], a[240:243], v[164:167], v[100:103]
s_waitcnt lgkmcnt(10)
ds_read_b64_tr_b16 a[228:229], v13 offset:37184
ds_read_b64_tr_b16 a[230:231], v13 offset:43328
v_mfma_f32_16x16x32_bf16 v[104:107], a[244:247], v[160:163], v[104:107]
v_exp_f32_e32 v159, v159
v_mfma_f32_16x16x32_bf16 v[108:111], a[244:247], v[164:167], v[108:111]
ds_read_b64_tr_b16 a[232:233], v14 offset:37184
ds_read_b64_tr_b16 a[234:235], v14 offset:43328
v_mfma_f32_16x16x32_bf16 v[112:115], a[248:251], v[160:163], v[112:115]
ds_read_b64_tr_b16 a[236:237], v15 offset:37184
v_cvt_pk_bf16_f32 v169, v146, v147
v_mfma_f32_16x16x32_bf16 v[116:119], a[248:251], v[164:167], v[116:119]
ds_read_b64_tr_b16 a[238:239], v15 offset:43328
v_cvt_pk_bf16_f32 v172, v148, v149
v_mfma_f32_16x16x32_bf16 v[120:123], a[252:255], v[160:163], v[120:123]
v_cvt_pk_bf16_f32 v173, v150, v151
v_cvt_pk_bf16_f32 v170, v152, v153
v_cvt_pk_bf16_f32 v171, v154, v155
v_cvt_pk_bf16_f32 v174, v156, v157
v_cvt_pk_bf16_f32 v175, v158, v159
v_mfma_f32_16x16x32_bf16 v[124:127], a[252:255], v[164:167], v[124:127]
s_waitcnt lgkmcnt(10)
ds_read_b64_tr_b16 a[240:241], v12 offset:37312
ds_read_b64_tr_b16 a[242:243], v12 offset:43456
v_add_f32_e32 v128, v128, v144
v_add_f32_e32 v129, v129, v145
v_add_f32_e32 v130, v130, v146
v_add_f32_e32 v131, v131, v147
v_add_f32_e32 v132, v132, v148
v_add_f32_e32 v133, v133, v149
v_add_f32_e32 v134, v134, v150
v_add_f32_e32 v135, v135, v151
v_add_f32_e32 v128, v128, v152
v_add_f32_e32 v129, v129, v153
v_add_f32_e32 v130, v130, v154
v_add_f32_e32 v131, v131, v155
v_add_f32_e32 v132, v132, v156
v_add_f32_e32 v133, v133, v157
v_add_f32_e32 v134, v134, v158
v_add_f32_e32 v135, v135, v159
v_mfma_f32_16x16x32_bf16 v[32:35], a[208:211], v[168:171], v[32:35]
ds_read_b64_tr_b16 a[244:245], v13 offset:37312
v_add_f32_e32 v128, v128, v129
v_mfma_f32_16x16x32_bf16 v[36:39], a[208:211], v[172:175], v[36:39]
ds_read_b64_tr_b16 a[246:247], v13 offset:43456
v_add_f32_e32 v130, v130, v131
v_mfma_f32_16x16x32_bf16 v[40:43], a[212:215], v[168:171], v[40:43]
ds_read_b64_tr_b16 a[248:249], v14 offset:37312
v_add_f32_e32 v128, v128, v130
v_mfma_f32_16x16x32_bf16 v[44:47], a[212:215], v[172:175], v[44:47]
ds_read_b64_tr_b16 a[250:251], v14 offset:43456
v_mov_b32_e32 v27, v128
v_mfma_f32_16x16x32_bf16 v[48:51], a[216:219], v[168:171], v[48:51]
ds_read_b64_tr_b16 a[252:253], v15 offset:37312
ds_read_b64_tr_b16 a[254:255], v15 offset:43456
v_mfma_f32_16x16x32_bf16 v[52:55], a[216:219], v[172:175], v[52:55]
s_waitcnt lgkmcnt(12)
v_permlane32_swap_b32 v128, v27
v_mfma_f32_16x16x32_bf16 v[56:59], a[220:223], v[168:171], v[56:59]
v_add_f32_e32 v128, v128, v27
v_mov_b32_e32 v27, v128
v_mfma_f32_16x16x32_bf16 v[60:63], a[220:223], v[172:175], v[60:63]
v_add_f32_e32 v132, v132, v133
v_add_f32_e32 v134, v134, v135
v_mfma_f32_16x16x32_bf16 v[64:67], a[224:227], v[168:171], v[64:67]
v_permlane16_swap_b32 v128, v27
v_mfma_f32_16x16x32_bf16 v[68:71], a[224:227], v[172:175], v[68:71]
v_add_f32_e32 v128, v128, v27
v_add_f32_e32 v132, v132, v134
v_mfma_f32_16x16x32_bf16 v[72:75], a[228:231], v[168:171], v[72:75]
v_rcp_f32_e32 v28, v128
v_mfma_f32_16x16x32_bf16 v[76:79], a[228:231], v[172:175], v[76:79]
s_waitcnt lgkmcnt(6)
v_mov_b32_e32 v29, v132
v_cmp_nge_f32_e64 vcc, s42, v128
v_mfma_f32_16x16x32_bf16 v[80:83], a[232:235], v[168:171], v[80:83]
v_permlane32_swap_b32 v132, v29
v_mfma_f32_16x16x32_bf16 v[84:87], a[232:235], v[172:175], v[84:87]
v_add_f32_e32 v132, v132, v29
v_mov_b32_e32 v29, v132
v_mfma_f32_16x16x32_bf16 v[88:91], a[236:239], v[168:171], v[88:91]
s_nop 0
v_permlane16_swap_b32 v132, v29
v_add_f32_e32 v132, v132, v29
v_rcp_f32_e32 v30, v132
v_mfma_f32_16x16x32_bf16 v[92:95], a[236:239], v[172:175], v[92:95]
v_cmp_nge_f32_e64 s[44:45], s42, v132
v_mul_f32_e32 v32, v28, v32
v_mfma_f32_16x16x32_bf16 v[96:99], a[240:243], v[168:171], v[96:99]
v_mul_f32_e32 v33, v28, v33
v_mul_f32_e32 v34, v28, v34
v_mfma_f32_16x16x32_bf16 v[100:103], a[240:243], v[172:175], v[100:103]
s_waitcnt lgkmcnt(0)
v_mul_f32_e32 v35, v28, v35
v_mul_f32_e32 v40, v28, v40
v_mfma_f32_16x16x32_bf16 v[104:107], a[244:247], v[168:171], v[104:107]
v_mul_f32_e32 v41, v28, v41
v_mul_f32_e32 v42, v28, v42
v_mfma_f32_16x16x32_bf16 v[108:111], a[244:247], v[172:175], v[108:111]
v_mul_f32_e32 v43, v28, v43
v_mul_f32_e32 v48, v28, v48
v_mfma_f32_16x16x32_bf16 v[112:115], a[248:251], v[168:171], v[112:115]
v_mul_f32_e32 v49, v28, v49
v_mul_f32_e32 v50, v28, v50
v_mfma_f32_16x16x32_bf16 v[116:119], a[248:251], v[172:175], v[116:119]
v_mul_f32_e32 v51, v28, v51
v_mul_f32_e32 v36, v30, v36
v_mfma_f32_16x16x32_bf16 v[120:123], a[252:255], v[168:171], v[120:123]
v_mul_f32_e32 v37, v30, v37
v_mul_f32_e32 v38, v30, v38
v_mfma_f32_16x16x32_bf16 v[124:127], a[252:255], v[172:175], v[124:127]
v_mul_f32_e32 v39, v30, v39
v_mul_f32_e32 v44, v30, v44
v_mul_f32_e32 v45, v30, v45
v_mul_f32_e32 v46, v30, v46
v_mul_f32_e32 v47, v30, v47
v_mul_f32_e32 v52, v30, v52
v_mul_f32_e32 v53, v30, v53
v_mul_f32_e32 v54, v30, v54
v_mul_f32_e32 v55, v30, v55
s_or_b64 vcc, vcc, s[44:45]
s_cbranch_vccnz L_slow0
L_back0:
s_add_u32 s28, s28, 1
s_cmp_lt_u32 s28, 4
s_cbranch_scc1 L_item0
s_branch L_fb0
L_O0a:
s_barrier
v_mfma_f32_16x16x32_bf16 v[144:147], v[244:247], a[0:3], 0
ds_read_b64_tr_b16 a[208:209], v20 offset:0
ds_read_b64_tr_b16 a[210:211], v20 offset:2048
v_mfma_f32_16x16x32_bf16 v[148:151], v[244:247], a[4:7], 0
ds_read_b64_tr_b16 a[212:213], v20 offset:4096
ds_read_b64_tr_b16 a[214:215], v20 offset:6144
v_mfma_f32_16x16x32_bf16 v[160:163], v[248:251], a[0:3], 0
ds_read_b64_tr_b16 a[216:217], v20 offset:8192
ds_read_b64_tr_b16 a[218:219], v20 offset:10240
v_mfma_f32_16x16x32_bf16 v[164:167], v[248:251], a[4:7], 0
ds_read_b64_tr_b16 a[220:221], v21 offset:0
ds_read_b64_tr_b16 a[222:223], v21 offset:2048
v_mfma_f32_16x16x32_bf16 v[176:179], v[244:247], a[8:11], 0
ds_read_b64_tr_b16 a[224:225], v21 offset:4096
ds_read_b64_tr_b16 a[226:227], v21 offset:6144
v_mfma_f32_16x16x32_bf16 v[180:183], v[244:247], a[12:15], 0
ds_read_b64_tr_b16 a[228:229], v21 offset:8192
ds_read_b64_tr_b16 a[230:231], v21 offset:10240
v_mfma_f32_16x16x32_bf16 v[184:187], v[248:251], a[8:11], 0
ds_read_b64_tr_b16 a[232:233], v22 offset:0
ds_read_b64_tr_b16 a[234:235], v22 offset:2048
v_mfma_f32_16x16x32_bf16 v[188:191], v[248:251], a[12:15], 0
s_waitcnt lgkmcnt(8)
ds_read_b64_tr_b16 a[236:237], v22 offset:4096
ds_read_b64_tr_b16 a[238:239], v22 offset:6144
v_mfma_f32_16x16x32_bf16 v[144:147], a[208:211], a[160:163], v[144:147]
ds_read_b64_tr_b16 a[240:241], v22 offset:8192
ds_read_b64_tr_b16 a[242:243], v22 offset:10240
v_mfma_f32_16x16x32_bf16 v[148:151], a[208:211], a[164:167], v[148:151]
ds_read_b64_tr_b16 a[244:245], v23 offset:0
ds_read_b64_tr_b16 a[246:247], v23 offset:2048
v_mfma_f32_16x16x32_bf16 v[144:147], a[212:215], a[168:171], v[144:147]
ds_read_b64_tr_b16 a[248:249], v23 offset:4096
v_mfma_f32_16x16x32_bf16 v[148:151], a[212:215], a[172:175], v[148:151]
ds_read_b64_tr_b16 a[250:251], v23 offset:6144
v_mfma_f32_16x16x32_bf16 v[144:147], a[216:219], a[176:179], v[144:147]
ds_read_b64_tr_b16 a[252:253], v23 offset:8192
v_mfma_f32_16x16x32_bf16 v[148:151], a[216:219], a[180:183], v[148:151]
s_waitcnt lgkmcnt(11)
ds_read_b64_tr_b16 a[254:255], v23 offset:10240
v_mfma_f32_16x16x32_bf16 v[160:163], a[220:223], a[160:163], v[160:163]
s_barrier
v_mfma_f32_16x16x32_bf16 v[164:167], a[220:223], a[164:167], v[164:167]
ds_read_b64_tr_b16 a[208:209], v20 offset:12352
ds_read_b64_tr_b16 a[210:211], v20 offset:14400
v_mfma_f32_16x16x32_bf16 v[160:163], a[224:227], a[168:171], v[160:163]
ds_read_b64_tr_b16 a[212:213], v20 offset:16448
v_mfma_f32_16x16x32_bf16 v[164:167], a[224:227], a[172:175], v[164:167]
ds_read_b64_tr_b16 a[214:215], v20 offset:18496
v_mfma_f32_16x16x32_bf16 v[160:163], a[228:231], a[176:179], v[160:163]
ds_read_b64_tr_b16 a[216:217], v20 offset:20544
v_mfma_f32_16x16x32_bf16 v[164:167], a[228:231], a[180:183], v[164:167]
s_waitcnt lgkmcnt(11)
ds_read_b64_tr_b16 a[218:219], v20 offset:22592
v_mfma_f32_16x16x32_bf16 v[176:179], a[232:235], a[160:163], v[176:179]
ds_read_b64_tr_b16 a[220:221], v21 offset:12352
v_mfma_f32_16x16x32_bf16 v[180:183], a[232:235], a[164:167], v[180:183]
ds_read_b64_tr_b16 a[222:223], v21 offset:14400
v_mfma_f32_16x16x32_bf16 v[176:179], a[236:239], a[168:171], v[176:179]
ds_read_b64_tr_b16 a[224:225], v21 offset:16448
v_mfma_f32_16x16x32_bf16 v[180:183], a[236:239], a[172:175], v[180:183]
ds_read_b64_tr_b16 a[226:227], v21 offset:18496
v_mfma_f32_16x16x32_bf16 v[176:179], a[240:243], a[176:179], v[176:179]
ds_read_b64_tr_b16 a[228:229], v21 offset:20544
v_mfma_f32_16x16x32_bf16 v[180:183], a[240:243], a[180:183], v[180:183]
s_waitcnt lgkmcnt(11)
ds_read_b64_tr_b16 a[230:231], v21 offset:22592
v_mfma_f32_16x16x32_bf16 v[184:187], a[244:247], a[160:163], v[184:187]
ds_read_b64_tr_b16 a[232:233], v22 offset:12352
v_mfma_f32_16x16x32_bf16 v[188:191], a[244:247], a[164:167], v[188:191]
ds_read_b64_tr_b16 a[234:235], v22 offset:14400
v_mfma_f32_16x16x32_bf16 v[184:187], a[248:251], a[168:171], v[184:187]
ds_read_b64_tr_b16 a[236:237], v22 offset:16448
v_mfma_f32_16x16x32_bf16 v[188:191], a[248:251], a[172:175], v[188:191]
ds_read_b64_tr_b16 a[238:239], v22 offset:18496
v_mfma_f32_16x16x32_bf16 v[184:187], a[252:255], a[176:179], v[184:187]
ds_read_b64_tr_b16 a[240:241], v22 offset:20544
v_mfma_f32_16x16x32_bf16 v[188:191], a[252:255], a[180:183], v[188:191]
s_waitcnt lgkmcnt(11)
ds_read_b64_tr_b16 a[242:243], v22 offset:22592
v_mfma_f32_16x16x32_bf16 v[144:147], a[208:211], a[184:187], v[144:147]
ds_read_b64_tr_b16 a[244:245], v23 offset:12352
v_mfma_f32_16x16x32_bf16 v[148:151], a[208:211], a[188:191], v[148:151]
ds_read_b64_tr_b16 a[246:247], v23 offset:14400
v_mfma_f32_16x16x32_bf16 v[144:147], a[212:215], a[192:195], v[144:147]
ds_read_b64_tr_b16 a[248:249], v23 offset:16448
v_mfma_f32_16x16x32_bf16 v[148:151], a[212:215], a[196:199], v[148:151]
ds_read_b64_tr_b16 a[250:251], v23 offset:18496
v_mfma_f32_16x16x32_bf16 v[144:147], a[216:219], a[200:203], v[144:147]
ds_read_b64_tr_b16 a[252:253], v23 offset:20544
v_mfma_f32_16x16x32_bf16 v[148:151], a[216:219], a[204:207], v[148:151]
s_waitcnt lgkmcnt(11)
ds_read_b64_tr_b16 a[254:255], v23 offset:22592
v_mfma_f32_16x16x32_bf16 v[160:163], a[220:223], a[184:187], v[160:163]
s_barrier
v_mfma_f32_16x16x32_bf16 v[164:167], a[220:223], a[188:191], v[164:167]
ds_read_b64_tr_b16 a[208:209], v20 offset:24704
ds_read_b64_tr_b16 a[210:211], v20 offset:26752
v_mfma_f32_16x16x32_bf16 v[160:163], a[224:227], a[192:195], v[160:163]
ds_read_b64_tr_b16 a[212:213], v20 offset:28800
v_cvt_pk_bf16_f32 v144, v144, v145
v_mfma_f32_16x16x32_bf16 v[164:167], a[224:227], a[196:199], v[164:167]
ds_read_b64_tr_b16 a[214:215], v20 offset:30848
v_accvgpr_write_b32 a0, v144
v_mfma_f32_16x16x32_bf16 v[160:163], a[228:231], a[200:203], v[160:163]
ds_read_b64_tr_b16 a[216:217], v20 offset:32896
v_cvt_pk_bf16_f32 v146, v146, v147
v_mfma_f32_16x16x32_bf16 v[164:167], a[228:231], a[204:207], v[164:167]
s_waitcnt lgkmcnt(11)
ds_read_b64_tr_b16 a[218:219], v20 offset:34944
v_accvgpr_write_b32 a1, v146
v_mfma_f32_16x16x32_bf16 v[176:179], a[232:235], a[184:187], v[176:179]
ds_read_b64_tr_b16 a[220:221], v21 offset:24704
v_cvt_pk_bf16_f32 v148, v148, v149
v_mfma_f32_16x16x32_bf16 v[180:183], a[232:235], a[188:191], v[180:183]
ds_read_b64_tr_b16 a[222:223], v21 offset:26752
v_accvgpr_write_b32 a4, v148
v_mfma_f32_16x16x32_bf16 v[176:179], a[236:239], a[192:195], v[176:179]
ds_read_b64_tr_b16 a[224:225], v21 offset:28800
v_cvt_pk_bf16_f32 v150, v150, v151
v_mfma_f32_16x16x32_bf16 v[180:183], a[236:239], a[196:199], v[180:183]
ds_read_b64_tr_b16 a[226:227], v21 offset:30848
v_accvgpr_write_b32 a5, v150
v_mfma_f32_16x16x32_bf16 v[176:179], a[240:243], a[200:203], v[176:179]
ds_read_b64_tr_b16 a[228:229], v21 offset:32896
v_cvt_pk_bf16_f32 v160, v160, v161
v_mfma_f32_16x16x32_bf16 v[180:183], a[240:243], a[204:207], v[180:183]
s_waitcnt lgkmcnt(11)
ds_read_b64_tr_b16 a[230:231], v21 offset:34944
v_accvgpr_write_b32 a2, v160
v_mfma_f32_16x16x32_bf16 v[184:187], a[244:247], a[184:187], v[184:187]
ds_read_b64_tr_b16 a[232:233], v22 offset:24704
v_cvt_pk_bf16_f32 v162, v162, v163
v_mfma_f32_16x16x32_bf16 v[188:191], a[244:247], a[188:191], v[188:191]
ds_read_b64_tr_b16 a[234:235], v22 offset:26752
v_accvgpr_write_b32 a3, v162
v_mfma_f32_16x16x32_bf16 v[184:187], a[248:251], a[192:195], v[184:187]
ds_read_b64_tr_b16 a[236:237], v22 offset:28800
v_cvt_pk_bf16_f32 v164, v164, v165
v_mfma_f32_16x16x32_bf16 v[188:191], a[248:251], a[196:199], v[188:191]
ds_read_b64_tr_b16 a[238:239], v22 offset:30848
v_accvgpr_write_b32 a6, v164
v_mfma_f32_16x16x32_bf16 v[184:187], a[252:255], a[200:203], v[184:187]
ds_read_b64_tr_b16 a[240:241], v22 offset:32896
v_cvt_pk_bf16_f32 v166, v166, v167
v_mfma_f32_16x16x32_bf16 v[188:191], a[252:255], a[204:207], v[188:191]
ds_read_b64_tr_b16 a[242:243], v22 offset:34944
v_accvgpr_write_b32 a7, v166
v_mfma_f32_16x16x32_bf16 v[144:147], v[244:247], a[16:19], 0
ds_read_b64_tr_b16 a[244:245], v23 offset:24704
v_cvt_pk_bf16_f32 v176, v176, v177
v_mfma_f32_16x16x32_bf16 v[148:151], v[244:247], a[20:23], 0
s_waitcnt lgkmcnt(13)
ds_read_b64_tr_b16 a[246:247], v23 offset:26752
v_accvgpr_write_b32 a8, v176
v_mfma_f32_16x16x32_bf16 v[144:147], a[208:211], a[160:163], v[144:147]
ds_read_b64_tr_b16 a[248:249], v23 offset:28800
v_cvt_pk_bf16_f32 v178, v178, v179
v_mfma_f32_16x16x32_bf16 v[148:151], a[208:211], a[164:167], v[148:151]
ds_read_b64_tr_b16 a[250:251], v23 offset:30848
v_accvgpr_write_b32 a9, v178
v_mfma_f32_16x16x32_bf16 v[144:147], a[212:215], a[168:171], v[144:147]
ds_read_b64_tr_b16 a[252:253], v23 offset:32896
v_cvt_pk_bf16_f32 v180, v180, v181
v_mfma_f32_16x16x32_bf16 v[148:151], a[212:215], a[172:175], v[148:151]
ds_read_b64_tr_b16 a[254:255], v23 offset:34944
v_accvgpr_write_b32 a12, v180
v_mfma_f32_16x16x32_bf16 v[144:147], a[216:219], a[176:179], v[144:147]
s_barrier
v_cvt_pk_bf16_f32 v182, v182, v183
v_accvgpr_write_b32 a13, v182
v_mfma_f32_16x16x32_bf16 v[148:151], a[216:219], a[180:183], v[148:151]
ds_read_b64_tr_b16 a[208:209], v20 offset:37056
v_cvt_pk_bf16_f32 v184, v184, v185
v_mfma_f32_16x16x32_bf16 v[160:163], v[248:251], a[16:19], 0
ds_read_b64_tr_b16 a[210:211], v20 offset:39104
v_accvgpr_write_b32 a10, v184
v_mfma_f32_16x16x32_bf16 v[164:167], v[248:251], a[20:23], 0
s_waitcnt lgkmcnt(14)
v_cvt_pk_bf16_f32 v186, v186, v187
v_accvgpr_write_b32 a11, v186
v_mfma_f32_16x16x32_bf16 v[160:163], a[220:223], a[160:163], v[160:163]
ds_read_b64_tr_b16 a[212:213], v20 offset:41152
v_cvt_pk_bf16_f32 v188, v188, v189
v_mfma_f32_16x16x32_bf16 v[164:167], a[220:223], a[164:167], v[164:167]
ds_read_b64_tr_b16 a[214:215], v20 offset:43200
v_accvgpr_write_b32 a14, v188
v_mfma_f32_16x16x32_bf16 v[160:163], a[224:227], a[168:171], v[160:163]
ds_read_b64_tr_b16 a[216:217], v20 offset:45248
v_cvt_pk_bf16_f32 v190, v190, v191
v_mfma_f32_16x16x32_bf16 v[164:167], a[224:227], a[172:175], v[164:167]
ds_read_b64_tr_b16 a[218:219], v20 offset:47296
v_accvgpr_write_b32 a15, v190
v_mfma_f32_16x16x32_bf16 v[160:163], a[228:231], a[176:179], v[160:163]
ds_read_b64_tr_b16 a[220:221], v21 offset:37056
v_mfma_f32_16x16x32_bf16 v[164:167], a[228:231], a[180:183], v[164:167]
ds_read_b64_tr_b16 a[222:223], v21 offset:39104
v_mfma_f32_16x16x32_bf16 v[176:179], v[244:247], a[24:27], 0
v_mfma_f32_16x16x32_bf16 v[180:183], v[244:247], a[28:31], 0
s_waitcnt lgkmcnt(14)
v_mfma_f32_16x16x32_bf16 v[176:179], a[232:235], a[160:163], v[176:179]
ds_read_b64_tr_b16 a[224:225], v21 offset:41152
v_mfma_f32_16x16x32_bf16 v[180:183], a[232:235], a[164:167], v[180:183]
ds_read_b64_tr_b16 a[226:227], v21 offset:43200
v_mfma_f32_16x16x32_bf16 v[176:179], a[236:239], a[168:171], v[176:179]
ds_read_b64_tr_b16 a[228:229], v21 offset:45248
v_mfma_f32_16x16x32_bf16 v[180:183], a[236:239], a[172:175], v[180:183]
ds_read_b64_tr_b16 a[230:231], v21 offset:47296
v_mfma_f32_16x16x32_bf16 v[176:179], a[240:243], a[176:179], v[176:179]
ds_read_b64_tr_b16 a[232:233], v22 offset:37056
v_mfma_f32_16x16x32_bf16 v[180:183], a[240:243], a[180:183], v[180:183]
ds_read_b64_tr_b16 a[234:235], v22 offset:39104
v_mfma_f32_16x16x32_bf16 v[184:187], v[248:251], a[24:27], 0
v_mfma_f32_16x16x32_bf16 v[188:191], v[248:251], a[28:31], 0
s_waitcnt lgkmcnt(14)
v_mfma_f32_16x16x32_bf16 v[184:187], a[244:247], a[160:163], v[184:187]
ds_read_b64_tr_b16 a[236:237], v22 offset:41152
v_mfma_f32_16x16x32_bf16 v[188:191], a[244:247], a[164:167], v[188:191]
ds_read_b64_tr_b16 a[238:239], v22 offset:43200
v_mfma_f32_16x16x32_bf16 v[184:187], a[248:251], a[168:171], v[184:187]
ds_read_b64_tr_b16 a[240:241], v22 offset:45248
v_mfma_f32_16x16x32_bf16 v[188:191], a[248:251], a[172:175], v[188:191]
ds_read_b64_tr_b16 a[242:243], v22 offset:47296
v_mfma_f32_16x16x32_bf16 v[184:187], a[252:255], a[176:179], v[184:187]
ds_read_b64_tr_b16 a[244:245], v23 offset:37056
v_mfma_f32_16x16x32_bf16 v[188:191], a[252:255], a[180:183], v[188:191]
s_waitcnt lgkmcnt(13)
ds_read_b64_tr_b16 a[246:247], v23 offset:39104
v_mfma_f32_16x16x32_bf16 v[144:147], a[208:211], a[184:187], v[144:147]
ds_read_b64_tr_b16 a[248:249], v23 offset:41152
v_mfma_f32_16x16x32_bf16 v[148:151], a[208:211], a[188:191], v[148:151]
ds_read_b64_tr_b16 a[250:251], v23 offset:43200
v_mfma_f32_16x16x32_bf16 v[144:147], a[212:215], a[192:195], v[144:147]
ds_read_b64_tr_b16 a[252:253], v23 offset:45248
v_mfma_f32_16x16x32_bf16 v[148:151], a[212:215], a[196:199], v[148:151]
ds_read_b64_tr_b16 a[254:255], v23 offset:47296
v_mfma_f32_16x16x32_bf16 v[144:147], a[216:219], a[200:203], v[144:147]
s_barrier
v_mfma_f32_16x16x32_bf16 v[148:151], a[216:219], a[204:207], v[148:151]
s_waitcnt lgkmcnt(12)
ds_read_b64_tr_b16 a[208:209], v20 offset:49408
v_mfma_f32_16x16x32_bf16 v[160:163], a[220:223], a[184:187], v[160:163]
ds_read_b64_tr_b16 a[210:211], v20 offset:51456
v_mfma_f32_16x16x32_bf16 v[164:167], a[220:223], a[188:191], v[164:167]
ds_read_b64_tr_b16 a[212:213], v20 offset:53504
v_cvt_pk_bf16_f32 v144, v144, v145
v_mfma_f32_16x16x32_bf16 v[160:163], a[224:227], a[192:195], v[160:163]
ds_read_b64_tr_b16 a[214:215], v20 offset:55552
v_accvgpr_write_b32 a16, v144
v_mfma_f32_16x16x32_bf16 v[164:167], a[224:227], a[196:199], v[164:167]
ds_read_b64_tr_b16 a[216:217], v20 offset:57600
v_cvt_pk_bf16_f32 v146, v146, v147
v_mfma_f32_16x16x32_bf16 v[160:163], a[228:231], a[200:203], v[160:163]
ds_read_b64_tr_b16 a[218:219], v20 offset:59648
v_accvgpr_write_b32 a17, v146
v_mfma_f32_16x16x32_bf16 v[164:167], a[228:231], a[204:207], v[164:167]
s_waitcnt lgkmcnt(12)
ds_read_b64_tr_b16 a[220:221], v21 offset:49408
v_cvt_pk_bf16_f32 v148, v148, v149
v_mfma_f32_16x16x32_bf16 v[176:179], a[232:235], a[184:187], v[176:179]
ds_read_b64_tr_b16 a[222:223], v21 offset:51456
v_accvgpr_write_b32 a20, v148
v_mfma_f32_16x16x32_bf16 v[180:183], a[232:235], a[188:191], v[180:183]
ds_read_b64_tr_b16 a[224:225], v21 offset:53504
v_cvt_pk_bf16_f32 v150, v150, v151
v_mfma_f32_16x16x32_bf16 v[176:179], a[236:239], a[192:195], v[176:179]
ds_read_b64_tr_b16 a[226:227], v21 offset:55552
v_accvgpr_write_b32 a21, v150
v_mfma_f32_16x16x32_bf16 v[180:183], a[236:239], a[196:199], v[180:183]
ds_read_b64_tr_b16 a[228:229], v21 offset:57600
v_cvt_pk_bf16_f32 v160, v160, v161
v_mfma_f32_16x16x32_bf16 v[176:179], a[240:243], a[200:203], v[176:179]
ds_read_b64_tr_b16 a[230:231], v21 offset:59648
v_accvgpr_write_b32 a18, v160
v_mfma_f32_16x16x32_bf16 v[180:183], a[240:243], a[204:207], v[180:183]
s_waitcnt lgkmcnt(12)
ds_read_b64_tr_b16 a[232:233], v22 offset:49408
v_cvt_pk_bf16_f32 v162, v162, v163
v_mfma_f32_16x16x32_bf16 v[184:187], a[244:247], a[184:187], v[184:187]
ds_read_b64_tr_b16 a[234:235], v22 offset:51456
v_accvgpr_write_b32 a19, v162
v_mfma_f32_16x16x32_bf16 v[188:191], a[244:247], a[188:191], v[188:191]
ds_read_b64_tr_b16 a[236:237], v22 offset:53504
v_cvt_pk_bf16_f32 v164, v164, v165
v_mfma_f32_16x16x32_bf16 v[184:187], a[248:251], a[192:195], v[184:187]
ds_read_b64_tr_b16 a[238:239], v22 offset:55552
v_accvgpr_write_b32 a22, v164
v_mfma_f32_16x16x32_bf16 v[188:191], a[248:251], a[196:199], v[188:191]
ds_read_b64_tr_b16 a[240:241], v22 offset:57600
v_cvt_pk_bf16_f32 v166, v166, v167
v_mfma_f32_16x16x32_bf16 v[184:187], a[252:255], a[200:203], v[184:187]
ds_read_b64_tr_b16 a[242:243], v22 offset:59648
v_accvgpr_write_b32 a23, v166
v_mfma_f32_16x16x32_bf16 v[188:191], a[252:255], a[204:207], v[188:191]
ds_read_b64_tr_b16 a[244:245], v23 offset:49408
v_cvt_pk_bf16_f32 v176, v176, v177
v_mfma_f32_16x16x32_bf16 v[144:147], v[244:247], a[32:35], 0
ds_read_b64_tr_b16 a[246:247], v23 offset:51456
v_accvgpr_write_b32 a24, v176
v_mfma_f32_16x16x32_bf16 v[148:151], v[244:247], a[36:39], 0
s_waitcnt lgkmcnt(14)
v_cvt_pk_bf16_f32 v178, v178, v179
v_accvgpr_write_b32 a25, v178
v_mfma_f32_16x16x32_bf16 v[144:147], a[208:211], a[160:163], v[144:147]
ds_read_b64_tr_b16 a[248:249], v23 offset:53504
v_cvt_pk_bf16_f32 v180, v180, v181
v_mfma_f32_16x16x32_bf16 v[148:151], a[208:211], a[164:167], v[148:151]
ds_read_b64_tr_b16 a[250:251], v23 offset:55552
v_accvgpr_write_b32 a28, v180
v_mfma_f32_16x16x32_bf16 v[144:147], a[212:215], a[168:171], v[144:147]
ds_read_b64_tr_b16 a[252:253], v23 offset:57600
v_cvt_pk_bf16_f32 v182, v182, v183
v_mfma_f32_16x16x32_bf16 v[148:151], a[212:215], a[172:175], v[148:151]
ds_read_b64_tr_b16 a[254:255], v23 offset:59648
v_accvgpr_write_b32 a29, v182
v_mfma_f32_16x16x32_bf16 v[144:147], a[216:219], a[176:179], v[144:147]
s_barrier
v_cvt_pk_bf16_f32 v184, v184, v185
v_accvgpr_write_b32 a26, v184
v_mfma_f32_16x16x32_bf16 v[148:151], a[216:219], a[180:183], v[148:151]
ds_read_b64_tr_b16 a[208:209], v20 offset:0
v_cvt_pk_bf16_f32 v186, v186, v187
v_mfma_f32_16x16x32_bf16 v[160:163], v[248:251], a[32:35], 0
ds_read_b64_tr_b16 a[210:211], v20 offset:2048
v_accvgpr_write_b32 a27, v186
v_mfma_f32_16x16x32_bf16 v[164:167], v[248:251], a[36:39], 0
s_waitcnt lgkmcnt(14)
v_cvt_pk_bf16_f32 v188, v188, v189
v_accvgpr_write_b32 a30, v188
v_mfma_f32_16x16x32_bf16 v[160:163], a[220:223], a[160:163], v[160:163]
ds_read_b64_tr_b16 a[212:213], v20 offset:4096
v_cvt_pk_bf16_f32 v190, v190, v191
v_mfma_f32_16x16x32_bf16 v[164:167], a[220:223], a[164:167], v[164:167]
ds_read_b64_tr_b16 a[214:215], v20 offset:6144
v_accvgpr_write_b32 a31, v190
v_mfma_f32_16x16x32_bf16 v[160:163], a[224:227], a[168:171], v[160:163]
ds_read_b64_tr_b16 a[216:217], v20 offset:8192
v_mfma_f32_16x16x32_bf16 v[164:167], a[224:227], a[172:175], v[164:167]
ds_read_b64_tr_b16 a[218:219], v20 offset:10240
v_mfma_f32_16x16x32_bf16 v[160:163], a[228:231], a[176:179], v[160:163]
ds_read_b64_tr_b16 a[220:221], v21 offset:0
v_mfma_f32_16x16x32_bf16 v[164:167], a[228:231], a[180:183], v[164:167]
ds_read_b64_tr_b16 a[222:223], v21 offset:2048
v_mfma_f32_16x16x32_bf16 v[176:179], v[244:247], a[40:43], 0
v_mfma_f32_16x16x32_bf16 v[180:183], v[244:247], a[44:47], 0
s_waitcnt lgkmcnt(14)
v_mfma_f32_16x16x32_bf16 v[176:179], a[232:235], a[160:163], v[176:179]
ds_read_b64_tr_b16 a[224:225], v21 offset:4096
v_mfma_f32_16x16x32_bf16 v[180:183], a[232:235], a[164:167], v[180:183]
ds_read_b64_tr_b16 a[226:227], v21 offset:6144
v_mfma_f32_16x16x32_bf16 v[176:179], a[236:239], a[168:171], v[176:179]
ds_read_b64_tr_b16 a[228:229], v21 offset:8192
v_mfma_f32_16x16x32_bf16 v[180:183], a[236:239], a[172:175], v[180:183]
ds_read_b64_tr_b16 a[230:231], v21 offset:10240
v_mfma_f32_16x16x32_bf16 v[176:179], a[240:243], a[176:179], v[176:179]
ds_read_b64_tr_b16 a[232:233], v22 offset:0
v_mfma_f32_16x16x32_bf16 v[180:183], a[240:243], a[180:183], v[180:183]
ds_read_b64_tr_b16 a[234:235], v22 offset:2048
v_mfma_f32_16x16x32_bf16 v[184:187], v[248:251], a[40:43], 0
v_mfma_f32_16x16x32_bf16 v[188:191], v[248:251], a[44:47], 0
s_waitcnt lgkmcnt(14)
v_mfma_f32_16x16x32_bf16 v[184:187], a[244:247], a[160:163], v[184:187]
ds_read_b64_tr_b16 a[236:237], v22 offset:4096
v_mfma_f32_16x16x32_bf16 v[188:191], a[244:247], a[164:167], v[188:191]
ds_read_b64_tr_b16 a[238:239], v22 offset:6144
v_mfma_f32_16x16x32_bf16 v[184:187], a[248:251], a[168:171], v[184:187]
ds_read_b64_tr_b16 a[240:241], v22 offset:8192
v_mfma_f32_16x16x32_bf16 v[188:191], a[248:251], a[172:175], v[188:191]
ds_read_b64_tr_b16 a[242:243], v22 offset:10240
v_mfma_f32_16x16x32_bf16 v[184:187], a[252:255], a[176:179], v[184:187]
ds_read_b64_tr_b16 a[244:245], v23 offset:0
v_mfma_f32_16x16x32_bf16 v[188:191], a[252:255], a[180:183], v[188:191]
s_waitcnt lgkmcnt(13)
ds_read_b64_tr_b16 a[246:247], v23 offset:2048
v_mfma_f32_16x16x32_bf16 v[144:147], a[208:211], a[184:187], v[144:147]
ds_read_b64_tr_b16 a[248:249], v23 offset:4096
v_mfma_f32_16x16x32_bf16 v[148:151], a[208:211], a[188:191], v[148:151]
ds_read_b64_tr_b16 a[250:251], v23 offset:6144
v_mfma_f32_16x16x32_bf16 v[144:147], a[212:215], a[192:195], v[144:147]
ds_read_b64_tr_b16 a[252:253], v23 offset:8192
v_mfma_f32_16x16x32_bf16 v[148:151], a[212:215], a[196:199], v[148:151]
ds_read_b64_tr_b16 a[254:255], v23 offset:10240
v_mfma_f32_16x16x32_bf16 v[144:147], a[216:219], a[200:203], v[144:147]
ds_read_b128 a[208:211], v6 offset:0
v_mfma_f32_16x16x32_bf16 v[148:151], a[216:219], a[204:207], v[148:151]
s_waitcnt lgkmcnt(13)
v_mfma_f32_16x16x32_bf16 v[160:163], a[220:223], a[184:187], v[160:163]
ds_read_b128 a[212:215], v7 offset:0
v_mfma_f32_16x16x32_bf16 v[164:167], a[220:223], a[188:191], v[164:167]
v_mfma_f32_16x16x32_bf16 v[160:163], a[224:227], a[192:195], v[160:163]
ds_read_b128 a[216:219], v6 offset:128
v_cvt_pk_bf16_f32 v144, v144, v145
v_mfma_f32_16x16x32_bf16 v[164:167], a[224:227], a[196:199], v[164:167]
v_accvgpr_write_b32 a32, v144
v_cvt_pk_bf16_f32 v146, v146, v147
v_mfma_f32_16x16x32_bf16 v[160:163], a[228:231], a[200:203], v[160:163]
ds_read_b128 a[220:223], v7 offset:128
v_accvgpr_write_b32 a33, v146
v_mfma_f32_16x16x32_bf16 v[164:167], a[228:231], a[204:207], v[164:167]
s_waitcnt lgkmcnt(10)
v_cvt_pk_bf16_f32 v148, v148, v149
v_accvgpr_write_b32 a36, v148
v_mfma_f32_16x16x32_bf16 v[176:179], a[232:235], a[184:187], v[176:179]
ds_read_b128 a[224:227], v6 offset:256
v_cvt_pk_bf16_f32 v150, v150, v151
v_mfma_f32_16x16x32_bf16 v[180:183], a[232:235], a[188:191], v[180:183]
v_accvgpr_write_b32 a37, v150
v_cvt_pk_bf16_f32 v160, v160, v161
v_mfma_f32_16x16x32_bf16 v[176:179], a[236:239], a[192:195], v[176:179]
ds_read_b128 a[228:231], v7 offset:256
v_accvgpr_write_b32 a34, v160
v_mfma_f32_16x16x32_bf16 v[180:183], a[236:239], a[196:199], v[180:183]
v_cvt_pk_bf16_f32 v162, v162, v163
v_accvgpr_write_b32 a35, v162
v_mfma_f32_16x16x32_bf16 v[176:179], a[240:243], a[200:203], v[176:179]
ds_read_b128 a[232:235], v6 offset:6144
v_cvt_pk_bf16_f32 v164, v164, v165
v_mfma_f32_16x16x32_bf16 v[180:183], a[240:243], a[204:207], v[180:183]
s_waitcnt lgkmcnt(7)
v_accvgpr_write_b32 a38, v164
v_cvt_pk_bf16_f32 v166, v166, v167
v_mfma_f32_16x16x32_bf16 v[184:187], a[244:247], a[184:187], v[184:187]
ds_read_b128 a[236:239], v7 offset:6144
v_accvgpr_write_b32 a39, v166
v_mfma_f32_16x16x32_bf16 v[188:191], a[244:247], a[188:191], v[188:191]
v_cvt_pk_bf16_f32 v176, v176, v177
v_accvgpr_write_b32 a40, v176
v_mfma_f32_16x16x32_bf16 v[184:187], a[248:251], a[192:195], v[184:187]
ds_read_b128 a[240:243], v6 offset:6272
v_cvt_pk_bf16_f32 v178, v178, v179
v_mfma_f32_16x16x32_bf16 v[188:191], a[248:251], a[196:199], v[188:191]
v_accvgpr_write_b32 a41, v178
v_cvt_pk_bf16_f32 v180, v180, v181
v_mfma_f32_16x16x32_bf16 v[184:187], a[252:255], a[200:203], v[184:187]
v_accvgpr_write_b32 a44, v180
v_cvt_pk_bf16_f32 v182, v182, v183
v_mfma_f32_16x16x32_bf16 v[188:191], a[252:255], a[204:207], v[188:191]
v_accvgpr_write_b32 a45, v182
s_nop 3
v_cvt_pk_bf16_f32 v184, v184, v185
v_accvgpr_write_b32 a42, v184
v_cvt_pk_bf16_f32 v186, v186, v187
v_accvgpr_write_b32 a43, v186
v_cvt_pk_bf16_f32 v188, v188, v189
v_accvgpr_write_b32 a46, v188
v_cvt_pk_bf16_f32 v190, v190, v191
v_accvgpr_write_b32 a47, v190
s_branch L_a0
L_O0b:
s_barrier
v_mfma_f32_16x16x32_bf16 v[144:147], v[244:247], a[48:51], 0
ds_read_b64_tr_b16 a[208:209], v20 offset:12352
ds_read_b64_tr_b16 a[210:211], v20 offset:14400
v_mfma_f32_16x16x32_bf16 v[148:151], v[244:247], a[52:55], 0
ds_read_b64_tr_b16 a[212:213], v20 offset:16448
ds_read_b64_tr_b16 a[214:215], v20 offset:18496
v_mfma_f32_16x16x32_bf16 v[160:163], v[248:251], a[48:51], 0
ds_read_b64_tr_b16 a[216:217], v20 offset:20544
ds_read_b64_tr_b16 a[218:219], v20 offset:22592
v_mfma_f32_16x16x32_bf16 v[164:167], v[248:251], a[52:55], 0
ds_read_b64_tr_b16 a[220:221], v21 offset:12352
ds_read_b64_tr_b16 a[222:223], v21 offset:14400
v_mfma_f32_16x16x32_bf16 v[176:179], v[244:247], a[56:59], 0
ds_read_b64_tr_b16 a[224:225], v21 offset:16448
ds_read_b64_tr_b16 a[226:227], v21 offset:18496
v_mfma_f32_16x16x32_bf16 v[180:183], v[244:247], a[60:63], 0
ds_read_b64_tr_b16 a[228:229], v21 offset:20544
ds_read_b64_tr_b16 a[230:231], v21 offset:22592
v_mfma_f32_16x16x32_bf16 v[184:187], v[248:251], a[56:59], 0
ds_read_b64_tr_b16 a[232:233], v22 offset:12352
ds_read_b64_tr_b16 a[234:235], v22 offset:14400
v_mfma_f32_16x16x32_bf16 v[188:191], v[248:251], a[60:63], 0
s_waitcnt lgkmcnt(8)
ds_read_b64_tr_b16 a[236:237], v22 offset:16448
ds_read_b64_tr_b16 a[238:239], v22 offset:18496
v_mfma_f32_16x16x32_bf16 v[144:147], a[208:211], a[160:163], v[144:147]
ds_read_b64_tr_b16 a[240:241], v22 offset:20544
ds_read_b64_tr_b16 a[242:243], v22 offset:22592
v_mfma_f32_16x16x32_bf16 v[148:151], a[208:211], a[164:167], v[148:151]
ds_read_b64_tr_b16 a[244:245], v23 offset:12352
ds_read_b64_tr_b16 a[246:247], v23 offset:14400
v_mfma_f32_16x16x32_bf16 v[144:147], a[212:215], a[168:171], v[144:147]
ds_read_b64_tr_b16 a[248:249], v23 offset:16448
v_mfma_f32_16x16x32_bf16 v[148:151], a[212:215], a[172:175], v[148:151]
ds_read_b64_tr_b16 a[250:251], v23 offset:18496
v_mfma_f32_16x16x32_bf16 v[144:147], a[216:219], a[176:179], v[144:147]
ds_read_b64_tr_b16 a[252:253], v23 offset:20544
v_mfma_f32_16x16x32_bf16 v[148:151], a[216:219], a[180:183], v[148:151]
s_waitcnt lgkmcnt(11)
ds_read_b64_tr_b16 a[254:255], v23 offset:22592
v_mfma_f32_16x16x32_bf16 v[160:163], a[220:223], a[160:163], v[160:163]
s_barrier
v_mfma_f32_16x16x32_bf16 v[164:167], a[220:223], a[164:167], v[164:167]
ds_read_b64_tr_b16 a[208:209], v20 offset:24704
ds_read_b64_tr_b16 a[210:211], v20 offset:26752
v_mfma_f32_16x16x32_bf16 v[160:163], a[224:227], a[168:171], v[160:163]
ds_read_b64_tr_b16 a[212:213], v20 offset:28800
v_mfma_f32_16x16x32_bf16 v[164:167], a[224:227], a[172:175], v[164:167]
ds_read_b64_tr_b16 a[214:215], v20 offset:30848
v_mfma_f32_16x16x32_bf16 v[160:163], a[228:231], a[176:179], v[160:163]
ds_read_b64_tr_b16 a[216:217], v20 offset:32896
v_mfma_f32_16x16x32_bf16 v[164:167], a[228:231], a[180:183], v[164:167]
s_waitcnt lgkmcnt(11)
ds_read_b64_tr_b16 a[218:219], v20 offset:34944
v_mfma_f32_16x16x32_bf16 v[176:179], a[232:235], a[160:163], v[176:179]
ds_read_b64_tr_b16 a[220:221], v21 offset:24704
v_mfma_f32_16x16x32_bf16 v[180:183], a[232:235], a[164:167], v[180:183]
ds_read_b64_tr_b16 a[222:223], v21 offset:26752
v_mfma_f32_16x16x32_bf16 v[176:179], a[236:239], a[168:171], v[176:179]
ds_read_b64_tr_b16 a[224:225], v21 offset:28800
v_mfma_f32_16x16x32_bf16 v[180:183], a[236:239], a[172:175], v[180:183]
ds_read_b64_tr_b16 a[226:227], v21 offset:30848
v_mfma_f32_16x16x32_bf16 v[176:179], a[240:243], a[176:179], v[176:179]
ds_read_b64_tr_b16 a[228:229], v21 offset:32896
v_mfma_f32_16x16x32_bf16 v[180:183], a[240:243], a[180:183], v[180:183]
s_waitcnt lgkmcnt(11)
ds_read_b64_tr_b16 a[230:231], v21 offset:34944
v_mfma_f32_16x16x32_bf16 v[184:187], a[244:247], a[160:163], v[184:187]
ds_read_b64_tr_b16 a[232:233], v22 offset:24704
v_mfma_f32_16x16x32_bf16 v[188:191], a[244:247], a[164:167], v[188:191]
ds_read_b64_tr_b16 a[234:235], v22 offset:26752
v_mfma_f32_16x16x32_bf16 v[184:187], a[248:251], a[168:171], v[184:187]
ds_read_b64_tr_b16 a[236:237], v22 offset:28800
v_mfma_f32_16x16x32_bf16 v[188:191], a[248:251], a[172:175], v[188:191]
ds_read_b64_tr_b16 a[238:239], v22 offset:30848
v_mfma_f32_16x16x32_bf16 v[184:187], a[252:255], a[176:179], v[184:187]
ds_read_b64_tr_b16 a[240:241], v22 offset:32896
v_mfma_f32_16x16x32_bf16 v[188:191], a[252:255], a[180:183], v[188:191]
s_waitcnt lgkmcnt(11)
ds_read_b64_tr_b16 a[242:243], v22 offset:34944
v_mfma_f32_16x16x32_bf16 v[144:147], a[208:211], a[184:187], v[144:147]
ds_read_b64_tr_b16 a[244:245], v23 offset:24704
v_mfma_f32_16x16x32_bf16 v[148:151], a[208:211], a[188:191], v[148:151]
ds_read_b64_tr_b16 a[246:247], v23 offset:26752
v_mfma_f32_16x16x32_bf16 v[144:147], a[212:215], a[192:195], v[144:147]
ds_read_b64_tr_b16 a[248:249], v23 offset:28800
v_mfma_f32_16x16x32_bf16 v[148:151], a[212:215], a[196:199], v[148:151]
ds_read_b64_tr_b16 a[250:251], v23 offset:30848
v_mfma_f32_16x16x32_bf16 v[144:147], a[216:219], a[200:203], v[144:147]
ds_read_b64_tr_b16 a[252:253], v23 offset:32896
v_mfma_f32_16x16x32_bf16 v[148:151], a[216:219], a[204:207], v[148:151]
s_waitcnt lgkmcnt(11)
ds_read_b64_tr_b16 a[254:255], v23 offset:34944
v_mfma_f32_16x16x32_bf16 v[160:163], a[220:223], a[184:187], v[160:163]
s_barrier
v_mfma_f32_16x16x32_bf16 v[164:167], a[220:223], a[188:191], v[164:167]
ds_read_b64_tr_b16 a[208:209], v20 offset:37056
ds_read_b64_tr_b16 a[210:211], v20 offset:39104
v_mfma_f32_16x16x32_bf16 v[160:163], a[224:227], a[192:195], v[160:163]
ds_read_b64_tr_b16 a[212:213], v20 offset:41152
v_cvt_pk_bf16_f32 v144, v144, v145
v_mfma_f32_16x16x32_bf16 v[164:167], a[224:227], a[196:199], v[164:167]
ds_read_b64_tr_b16 a[214:215], v20 offset:43200
v_accvgpr_write_b32 a48, v144
v_mfma_f32_16x16x32_bf16 v[160:163], a[228:231], a[200:203], v[160:163]
ds_read_b64_tr_b16 a[216:217], v20 offset:45248
v_cvt_pk_bf16_f32 v146, v146, v147
v_mfma_f32_16x16x32_bf16 v[164:167], a[228:231], a[204:207], v[164:167]
s_waitcnt lgkmcnt(11)
ds_read_b64_tr_b16 a[218:219], v20 offset:47296
v_accvgpr_write_b32 a49, v146
v_mfma_f32_16x16x32_bf16 v[176:179], a[232:235], a[184:187], v[176:179]
ds_read_b64_tr_b16 a[220:221], v21 offset:37056
v_cvt_pk_bf16_f32 v148, v148, v149
v_mfma_f32_16x16x32_bf16 v[180:183], a[232:235], a[188:191], v[180:183]
ds_read_b64_tr_b16 a[222:223], v21 offset:39104
v_accvgpr_write_b32 a52, v148
v_mfma_f32_16x16x32_bf16 v[176:179], a[236:239], a[192:195], v[176:179]
ds_read_b64_tr_b16 a[224:225], v21 offset:41152
v_cvt_pk_bf16_f32 v150, v150, v151
v_mfma_f32_16x16x32_bf16 v[180:183], a[236:239], a[196:199], v[180:183]
ds_read_b64_tr_b16 a[226:227], v21 offset:43200
v_accvgpr_write_b32 a53, v150
v_mfma_f32_16x16x32_bf16 v[176:179], a[240:243], a[200:203], v[176:179]
ds_read_b64_tr_b16 a[228:229], v21 offset:45248
v_cvt_pk_bf16_f32 v160, v160, v161
v_mfma_f32_16x16x32_bf16 v[180:183], a[240:243], a[204:207], v[180:183]
s_waitcnt lgkmcnt(11)
ds_read_b64_tr_b16 a[230:231], v21 offset:47296
v_accvgpr_write_b32 a50, v160
v_mfma_f32_16x16x32_bf16 v[184:187], a[244:247], a[184:187], v[184:187]
ds_read_b64_tr_b16 a[232:233], v22 offset:37056
v_cvt_pk_bf16_f32 v162, v162, v163
v_mfma_f32_16x16x32_bf16 v[188:191], a[244:247], a[188:191], v[188:191]
ds_read_b64_tr_b16 a[234:235], v22 offset:39104
v_accvgpr_write_b32 a51, v162
v_mfma_f32_16x16x32_bf16 v[184:187], a[248:251], a[192:195], v[184:187]
ds_read_b64_tr_b16 a[236:237], v22 offset:41152
v_cvt_pk_bf16_f32 v164, v164, v165
v_mfma_f32_16x16x32_bf16 v[188:191], a[248:251], a[196:199], v[188:191]
ds_read_b64_tr_b16 a[238:239], v22 offset:43200
v_accvgpr_write_b32 a54, v164
v_mfma_f32_16x16x32_bf16 v[184:187], a[252:255], a[200:203], v[184:187]
ds_read_b64_tr_b16 a[240:241], v22 offset:45248
v_cvt_pk_bf16_f32 v166, v166, v167
v_mfma_f32_16x16x32_bf16 v[188:191], a[252:255], a[204:207], v[188:191]
ds_read_b64_tr_b16 a[242:243], v22 offset:47296
v_accvgpr_write_b32 a55, v166
v_mfma_f32_16x16x32_bf16 v[144:147], v[244:247], a[64:67], 0
ds_read_b64_tr_b16 a[244:245], v23 offset:37056
v_cvt_pk_bf16_f32 v176, v176, v177
v_mfma_f32_16x16x32_bf16 v[148:151], v[244:247], a[68:71], 0
s_waitcnt lgkmcnt(13)
ds_read_b64_tr_b16 a[246:247], v23 offset:39104
v_accvgpr_write_b32 a56, v176
v_mfma_f32_16x16x32_bf16 v[144:147], a[208:211], a[160:163], v[144:147]
ds_read_b64_tr_b16 a[248:249], v23 offset:41152
v_cvt_pk_bf16_f32 v178, v178, v179
v_mfma_f32_16x16x32_bf16 v[148:151], a[208:211], a[164:167], v[148:151]
ds_read_b64_tr_b16 a[250:251], v23 offset:43200
v_accvgpr_write_b32 a57, v178
v_mfma_f32_16x16x32_bf16 v[144:147], a[212:215], a[168:171], v[144:147]
ds_read_b64_tr_b16 a[252:253], v23 offset:45248
v_cvt_pk_bf16_f32 v180, v180, v181
v_mfma_f32_16x16x32_bf16 v[148:151], a[212:215], a[172:175], v[148:151]
ds_read_b64_tr_b16 a[254:255], v23 offset:47296
v_accvgpr_write_b32 a60, v180
v_mfma_f32_16x16x32_bf16 v[144:147], a[216:219], a[176:179], v[144:147]
s_barrier
v_cvt_pk_bf16_f32 v182, v182, v183
v_accvgpr_write_b32 a61, v182
v_mfma_f32_16x16x32_bf16 v[148:151], a[216:219], a[180:183], v[148:151]
ds_read_b64_tr_b16 a[208:209], v20 offset:49408
v_cvt_pk_bf16_f32 v184, v184, v185
v_mfma_f32_16x16x32_bf16 v[160:163], v[248:251], a[64:67], 0
ds_read_b64_tr_b16 a[210:211], v20 offset:51456
v_accvgpr_write_b32 a58, v184
v_mfma_f32_16x16x32_bf16 v[164:167], v[248:251], a[68:71], 0
s_waitcnt lgkmcnt(14)
v_cvt_pk_bf16_f32 v186, v186, v187
v_accvgpr_write_b32 a59, v186
v_mfma_f32_16x16x32_bf16 v[160:163], a[220:223], a[160:163], v[160:163]
ds_read_b64_tr_b16 a[212:213], v20 offset:53504
v_cvt_pk_bf16_f32 v188, v188, v189
v_mfma_f32_16x16x32_bf16 v[164:167], a[220:223], a[164:167], v[164:167]
ds_read_b64_tr_b16 a[214:215], v20 offset:55552
v_accvgpr_write_b32 a62, v188
v_mfma_f32_16x16x32_bf16 v[160:163], a[224:227], a[168:171], v[160:163]
ds_read_b64_tr_b16 a[216:217], v20 offset:57600
v_cvt_pk_bf16_f32 v190, v190, v191
v_mfma_f32_16x16x32_bf16 v[164:167], a[224:227], a[172:175], v[164:167]
ds_read_b64_tr_b16 a[218:219], v20 offset:59648
v_accvgpr_write_b32 a63, v190
v_mfma_f32_16x16x32_bf16 v[160:163], a[228:231], a[176:179], v[160:163]
ds_read_b64_tr_b16 a[220:221], v21 offset:49408
v_mfma_f32_16x16x32_bf16 v[164:167], a[228:231], a[180:183], v[164:167]
ds_read_b64_tr_b16 a[222:223], v21 offset:51456
v_mfma_f32_16x16x32_bf16 v[176:179], v[244:247], a[72:75], 0
v_mfma_f32_16x16x32_bf16 v[180:183], v[244:247], a[76:79], 0
s_waitcnt lgkmcnt(14)
v_mfma_f32_16x16x32_bf16 v[176:179], a[232:235], a[160:163], v[176:179]
ds_read_b64_tr_b16 a[224:225], v21 offset:53504
v_mfma_f32_16x16x32_bf16 v[180:183], a[232:235], a[164:167], v[180:183]
ds_read_b64_tr_b16 a[226:227], v21 offset:55552
v_mfma_f32_16x16x32_bf16 v[176:179], a[236:239], a[168:171], v[176:179]
ds_read_b64_tr_b16 a[228:229], v21 offset:57600
v_mfma_f32_16x16x32_bf16 v[180:183], a[236:239], a[172:175], v[180:183]
ds_read_b64_tr_b16 a[230:231], v21 offset:59648
v_mfma_f32_16x16x32_bf16 v[176:179], a[240:243], a[176:179], v[176:179]
ds_read_b64_tr_b16 a[232:233], v22 offset:49408
v_mfma_f32_16x16x32_bf16 v[180:183], a[240:243], a[180:183], v[180:183]
ds_read_b64_tr_b16 a[234:235], v22 offset:51456
v_mfma_f32_16x16x32_bf16 v[184:187], v[248:251], a[72:75], 0
v_mfma_f32_16x16x32_bf16 v[188:191], v[248:251], a[76:79], 0
s_waitcnt lgkmcnt(14)
v_mfma_f32_16x16x32_bf16 v[184:187], a[244:247], a[160:163], v[184:187]
ds_read_b64_tr_b16 a[236:237], v22 offset:53504
v_mfma_f32_16x16x32_bf16 v[188:191], a[244:247], a[164:167], v[188:191]
ds_read_b64_tr_b16 a[238:239], v22 offset:55552
v_mfma_f32_16x16x32_bf16 v[184:187], a[248:251], a[168:171], v[184:187]
ds_read_b64_tr_b16 a[240:241], v22 offset:57600
v_mfma_f32_16x16x32_bf16 v[188:191], a[248:251], a[172:175], v[188:191]
ds_read_b64_tr_b16 a[242:243], v22 offset:59648
v_mfma_f32_16x16x32_bf16 v[184:187], a[252:255], a[176:179], v[184:187]
ds_read_b64_tr_b16 a[244:245], v23 offset:49408
v_mfma_f32_16x16x32_bf16 v[188:191], a[252:255], a[180:183], v[188:191]
s_waitcnt lgkmcnt(13)
ds_read_b64_tr_b16 a[246:247], v23 offset:51456
v_mfma_f32_16x16x32_bf16 v[144:147], a[208:211], a[184:187], v[144:147]
ds_read_b64_tr_b16 a[248:249], v23 offset:53504
v_mfma_f32_16x16x32_bf16 v[148:151], a[208:211], a[188:191], v[148:151]
ds_read_b64_tr_b16 a[250:251], v23 offset:55552
v_mfma_f32_16x16x32_bf16 v[144:147], a[212:215], a[192:195], v[144:147]
ds_read_b64_tr_b16 a[252:253], v23 offset:57600
v_mfma_f32_16x16x32_bf16 v[148:151], a[212:215], a[196:199], v[148:151]
ds_read_b64_tr_b16 a[254:255], v23 offset:59648
v_mfma_f32_16x16x32_bf16 v[144:147], a[216:219], a[200:203], v[144:147]
s_barrier
v_mfma_f32_16x16x32_bf16 v[148:151], a[216:219], a[204:207], v[148:151]
s_waitcnt lgkmcnt(12)
ds_read_b64_tr_b16 a[208:209], v20 offset:0
v_mfma_f32_16x16x32_bf16 v[160:163], a[220:223], a[184:187], v[160:163]
ds_read_b64_tr_b16 a[210:211], v20 offset:2048
v_mfma_f32_16x16x32_bf16 v[164:167], a[220:223], a[188:191], v[164:167]
ds_read_b64_tr_b16 a[212:213], v20 offset:4096
v_cvt_pk_bf16_f32 v144, v144, v145
v_mfma_f32_16x16x32_bf16 v[160:163], a[224:227], a[192:195], v[160:163]
ds_read_b64_tr_b16 a[214:215], v20 offset:6144
v_accvgpr_write_b32 a64, v144
v_mfma_f32_16x16x32_bf16 v[164:167], a[224:227], a[196:199], v[164:167]
ds_read_b64_tr_b16 a[216:217], v20 offset:8192
v_cvt_pk_bf16_f32 v146, v146, v147
v_mfma_f32_16x16x32_bf16 v[160:163], a[228:231], a[200:203], v[160:163]
ds_read_b64_tr_b16 a[218:219], v20 offset:10240
v_accvgpr_write_b32 a65, v146
v_mfma_f32_16x16x32_bf16 v[164:167], a[228:231], a[204:207], v[164:167]
s_waitcnt lgkmcnt(12)
ds_read_b64_tr_b16 a[220:221], v21 offset:0
v_cvt_pk_bf16_f32 v148, v148, v149
v_mfma_f32_16x16x32_bf16 v[176:179], a[232:235], a[184:187], v[176:179]
ds_read_b64_tr_b16 a[222:223], v21 offset:2048
v_accvgpr_write_b32 a68, v148
v_mfma_f32_16x16x32_bf16 v[180:183], a[232:235], a[188:191], v[180:183]
ds_read_b64_tr_b16 a[224:225], v21 offset:4096
v_cvt_pk_bf16_f32 v150, v150, v151
v_mfma_f32_16x16x32_bf16 v[176:179], a[236:239], a[192:195], v[176:179]
ds_read_b64_tr_b16 a[226:227], v21 offset:6144
v_accvgpr_write_b32 a69, v150
v_mfma_f32_16x16x32_bf16 v[180:183], a[236:239], a[196:199], v[180:183]
ds_read_b64_tr_b16 a[228:229], v21 offset:8192
v_cvt_pk_bf16_f32 v160, v160, v161
v_mfma_f32_16x16x32_bf16 v[176:179], a[240:243], a[200:203], v[176:179]
ds_read_b64_tr_b16 a[230:231], v21 offset:10240
v_accvgpr_write_b32 a66, v160
v_mfma_f32_16x16x32_bf16 v[180:183], a[240:243], a[204:207], v[180:183]
s_waitcnt lgkmcnt(12)
ds_read_b64_tr_b16 a[232:233], v22 offset:0
v_cvt_pk_bf16_f32 v162, v162, v163
v_mfma_f32_16x16x32_bf16 v[184:187], a[244:247], a[184:187], v[184:187]
ds_read_b64_tr_b16 a[234:235], v22 offset:2048
v_accvgpr_write_b32 a67, v162
v_mfma_f32_16x16x32_bf16 v[188:191], a[244:247], a[188:191], v[188:191]
ds_read_b64_tr_b16 a[236:237], v22 offset:4096
v_cvt_pk_bf16_f32 v164, v164, v165
v_mfma_f32_16x16x32_bf16 v[184:187], a[248:251], a[192:195], v[184:187]
ds_read_b64_tr_b16 a[238:239], v22 offset:6144
v_accvgpr_write_b32 a70, v164
v_mfma_f32_16x16x32_bf16 v[188:191], a[248:251], a[196:199], v[188:191]
ds_read_b64_tr_b16 a[240:241], v22 offset:8192
v_cvt_pk_bf16_f32 v166, v166, v167
v_mfma_f32_16x16x32_bf16 v[184:187], a[252:255], a[200:203], v[184:187]
ds_read_b64_tr_b16 a[242:243], v22 offset:10240
v_accvgpr_write_b32 a71, v166
v_mfma_f32_16x16x32_bf16 v[188:191], a[252:255], a[204:207], v[188:191]
ds_read_b64_tr_b16 a[244:245], v23 offset:0
v_cvt_pk_bf16_f32 v176, v176, v177
v_mfma_f32_16x16x32_bf16 v[144:147], v[244:247], a[80:83], 0
ds_read_b64_tr_b16 a[246:247], v23 offset:2048
v_accvgpr_write_b32 a72, v176
v_mfma_f32_16x16x32_bf16 v[148:151], v[244:247], a[84:87], 0
s_waitcnt lgkmcnt(14)
v_cvt_pk_bf16_f32 v178, v178, v179
v_accvgpr_write_b32 a73, v178
v_mfma_f32_16x16x32_bf16 v[144:147], a[208:211], a[160:163], v[144:147]
ds_read_b64_tr_b16 a[248:249], v23 offset:4096
v_cvt_pk_bf16_f32 v180, v180, v181
v_mfma_f32_16x16x32_bf16 v[148:151], a[208:211], a[164:167], v[148:151]
ds_read_b64_tr_b16 a[250:251], v23 offset:6144
v_accvgpr_write_b32 a76, v180
v_mfma_f32_16x16x32_bf16 v[144:147], a[212:215], a[168:171], v[144:147]
ds_read_b64_tr_b16 a[252:253], v23 offset:8192
v_cvt_pk_bf16_f32 v182, v182, v183
v_mfma_f32_16x16x32_bf16 v[148:151], a[212:215], a[172:175], v[148:151]
ds_read_b64_tr_b16 a[254:255], v23 offset:10240
v_accvgpr_write_b32 a77, v182
v_mfma_f32_16x16x32_bf16 v[144:147], a[216:219], a[176:179], v[144:147]
s_barrier
v_cvt_pk_bf16_f32 v184, v184, v185
v_accvgpr_write_b32 a74, v184
v_mfma_f32_16x16x32_bf16 v[148:151], a[216:219], a[180:183], v[148:151]
ds_read_b64_tr_b16 a[208:209], v20 offset:12352
v_cvt_pk_bf16_f32 v186, v186, v187
v_mfma_f32_16x16x32_bf16 v[160:163], v[248:251], a[80:83], 0
ds_read_b64_tr_b16 a[210:211], v20 offset:14400
v_accvgpr_write_b32 a75, v186
v_mfma_f32_16x16x32_bf16 v[164:167], v[248:251], a[84:87], 0
s_waitcnt lgkmcnt(14)
v_cvt_pk_bf16_f32 v188, v188, v189
v_accvgpr_write_b32 a78, v188
v_mfma_f32_16x16x32_bf16 v[160:163], a[220:223], a[160:163], v[160:163]
ds_read_b64_tr_b16 a[212:213], v20 offset:16448
v_cvt_pk_bf16_f32 v190, v190, v191
v_mfma_f32_16x16x32_bf16 v[164:167], a[220:223], a[164:167], v[164:167]
ds_read_b64_tr_b16 a[214:215], v20 offset:18496
v_accvgpr_write_b32 a79, v190
v_mfma_f32_16x16x32_bf16 v[160:163], a[224:227], a[168:171], v[160:163]
ds_read_b64_tr_b16 a[216:217], v20 offset:20544
v_mfma_f32_16x16x32_bf16 v[164:167], a[224:227], a[172:175], v[164:167]
ds_read_b64_tr_b16 a[218:219], v20 offset:22592
v_mfma_f32_16x16x32_bf16 v[160:163], a[228:231], a[176:179], v[160:163]
ds_read_b64_tr_b16 a[220:221], v21 offset:12352
v_mfma_f32_16x16x32_bf16 v[164:167], a[228:231], a[180:183], v[164:167]
ds_read_b64_tr_b16 a[222:223], v21 offset:14400
v_mfma_f32_16x16x32_bf16 v[176:179], v[244:247], a[88:91], 0
v_mfma_f32_16x16x32_bf16 v[180:183], v[244:247], a[92:95], 0
s_waitcnt lgkmcnt(14)
v_mfma_f32_16x16x32_bf16 v[176:179], a[232:235], a[160:163], v[176:179]
ds_read_b64_tr_b16 a[224:225], v21 offset:16448
v_mfma_f32_16x16x32_bf16 v[180:183], a[232:235], a[164:167], v[180:183]
ds_read_b64_tr_b16 a[226:227], v21 offset:18496
v_mfma_f32_16x16x32_bf16 v[176:179], a[236:239], a[168:171], v[176:179]
ds_read_b64_tr_b16 a[228:229], v21 offset:20544
v_mfma_f32_16x16x32_bf16 v[180:183], a[236:239], a[172:175], v[180:183]
ds_read_b64_tr_b16 a[230:231], v21 offset:22592
v_mfma_f32_16x16x32_bf16 v[176:179], a[240:243], a[176:179], v[176:179]
ds_read_b64_tr_b16 a[232:233], v22 offset:12352
v_mfma_f32_16x16x32_bf16 v[180:183], a[240:243], a[180:183], v[180:183]
ds_read_b64_tr_b16 a[234:235], v22 offset:14400
v_mfma_f32_16x16x32_bf16 v[184:187], v[248:251], a[88:91], 0
v_mfma_f32_16x16x32_bf16 v[188:191], v[248:251], a[92:95], 0
s_waitcnt lgkmcnt(14)
v_mfma_f32_16x16x32_bf16 v[184:187], a[244:247], a[160:163], v[184:187]
ds_read_b64_tr_b16 a[236:237], v22 offset:16448
v_mfma_f32_16x16x32_bf16 v[188:191], a[244:247], a[164:167], v[188:191]
ds_read_b64_tr_b16 a[238:239], v22 offset:18496
v_mfma_f32_16x16x32_bf16 v[184:187], a[248:251], a[168:171], v[184:187]
ds_read_b64_tr_b16 a[240:241], v22 offset:20544
v_mfma_f32_16x16x32_bf16 v[188:191], a[248:251], a[172:175], v[188:191]
ds_read_b64_tr_b16 a[242:243], v22 offset:22592
v_mfma_f32_16x16x32_bf16 v[184:187], a[252:255], a[176:179], v[184:187]
ds_read_b64_tr_b16 a[244:245], v23 offset:12352
v_mfma_f32_16x16x32_bf16 v[188:191], a[252:255], a[180:183], v[188:191]
s_waitcnt lgkmcnt(13)
ds_read_b64_tr_b16 a[246:247], v23 offset:14400
v_mfma_f32_16x16x32_bf16 v[144:147], a[208:211], a[184:187], v[144:147]
ds_read_b64_tr_b16 a[248:249], v23 offset:16448
v_mfma_f32_16x16x32_bf16 v[148:151], a[208:211], a[188:191], v[148:151]
ds_read_b64_tr_b16 a[250:251], v23 offset:18496
v_mfma_f32_16x16x32_bf16 v[144:147], a[212:215], a[192:195], v[144:147]
ds_read_b64_tr_b16 a[252:253], v23 offset:20544
v_mfma_f32_16x16x32_bf16 v[148:151], a[212:215], a[196:199], v[148:151]
ds_read_b64_tr_b16 a[254:255], v23 offset:22592
v_mfma_f32_16x16x32_bf16 v[144:147], a[216:219], a[200:203], v[144:147]
s_barrier
v_mfma_f32_16x16x32_bf16 v[148:151], a[216:219], a[204:207], v[148:151]
s_waitcnt lgkmcnt(12)
ds_read_b64_tr_b16 a[208:209], v20 offset:24704
v_mfma_f32_16x16x32_bf16 v[160:163], a[220:223], a[184:187], v[160:163]
ds_read_b64_tr_b16 a[210:211], v20 offset:26752
v_mfma_f32_16x16x32_bf16 v[164:167], a[220:223], a[188:191], v[164:167]
ds_read_b64_tr_b16 a[212:213], v20 offset:28800
v_cvt_pk_bf16_f32 v144, v144, v145
v_mfma_f32_16x16x32_bf16 v[160:163], a[224:227], a[192:195], v[160:163]
ds_read_b64_tr_b16 a[214:215], v20 offset:30848
v_accvgpr_write_b32 a80, v144
v_mfma_f32_16x16x32_bf16 v[164:167], a[224:227], a[196:199], v[164:167]
ds_read_b64_tr_b16 a[216:217], v20 offset:32896
v_cvt_pk_bf16_f32 v146, v146, v147
v_mfma_f32_16x16x32_bf16 v[160:163], a[228:231], a[200:203], v[160:163]
ds_read_b64_tr_b16 a[218:219], v20 offset:34944
v_accvgpr_write_b32 a81, v146
v_mfma_f32_16x16x32_bf16 v[164:167], a[228:231], a[204:207], v[164:167]
s_waitcnt lgkmcnt(12)
ds_read_b64_tr_b16 a[220:221], v21 offset:24704
v_cvt_pk_bf16_f32 v148, v148, v149
v_mfma_f32_16x16x32_bf16 v[176:179], a[232:235], a[184:187], v[176:179]
ds_read_b64_tr_b16 a[222:223], v21 offset:26752
v_accvgpr_write_b32 a84, v148
v_mfma_f32_16x16x32_bf16 v[180:183], a[232:235], a[188:191], v[180:183]
ds_read_b64_tr_b16 a[224:225], v21 offset:28800
v_cvt_pk_bf16_f32 v150, v150, v151
v_mfma_f32_16x16x32_bf16 v[176:179], a[236:239], a[192:195], v[176:179]
ds_read_b64_tr_b16 a[226:227], v21 offset:30848
v_accvgpr_write_b32 a85, v150
v_mfma_f32_16x16x32_bf16 v[180:183], a[236:239], a[196:199], v[180:183]
ds_read_b64_tr_b16 a[228:229], v21 offset:32896
v_cvt_pk_bf16_f32 v160, v160, v161
v_mfma_f32_16x16x32_bf16 v[176:179], a[240:243], a[200:203], v[176:179]
ds_read_b64_tr_b16 a[230:231], v21 offset:34944
v_accvgpr_write_b32 a82, v160
v_mfma_f32_16x16x32_bf16 v[180:183], a[240:243], a[204:207], v[180:183]
s_waitcnt lgkmcnt(12)
ds_read_b64_tr_b16 a[232:233], v22 offset:24704
v_cvt_pk_bf16_f32 v162, v162, v163
v_mfma_f32_16x16x32_bf16 v[184:187], a[244:247], a[184:187], v[184:187]
ds_read_b64_tr_b16 a[234:235], v22 offset:26752
v_accvgpr_write_b32 a83, v162
v_mfma_f32_16x16x32_bf16 v[188:191], a[244:247], a[188:191], v[188:191]
ds_read_b64_tr_b16 a[236:237], v22 offset:28800
v_cvt_pk_bf16_f32 v164, v164, v165
v_mfma_f32_16x16x32_bf16 v[184:187], a[248:251], a[192:195], v[184:187]
ds_read_b64_tr_b16 a[238:239], v22 offset:30848
v_accvgpr_write_b32 a86, v164
v_mfma_f32_16x16x32_bf16 v[188:191], a[248:251], a[196:199], v[188:191]
ds_read_b64_tr_b16 a[240:241], v22 offset:32896
v_cvt_pk_bf16_f32 v166, v166, v167
v_mfma_f32_16x16x32_bf16 v[184:187], a[252:255], a[200:203], v[184:187]
ds_read_b64_tr_b16 a[242:243], v22 offset:34944
v_accvgpr_write_b32 a87, v166
v_mfma_f32_16x16x32_bf16 v[188:191], a[252:255], a[204:207], v[188:191]
ds_read_b64_tr_b16 a[244:245], v23 offset:24704
v_cvt_pk_bf16_f32 v176, v176, v177
v_mfma_f32_16x16x32_bf16 v[144:147], v[244:247], a[96:99], 0
ds_read_b64_tr_b16 a[246:247], v23 offset:26752
v_accvgpr_write_b32 a88, v176
v_mfma_f32_16x16x32_bf16 v[148:151], v[244:247], a[100:103], 0
s_waitcnt lgkmcnt(14)
v_cvt_pk_bf16_f32 v178, v178, v179
v_accvgpr_write_b32 a89, v178
v_mfma_f32_16x16x32_bf16 v[144:147], a[208:211], a[160:163], v[144:147]
ds_read_b64_tr_b16 a[248:249], v23 offset:28800
v_cvt_pk_bf16_f32 v180, v180, v181
v_mfma_f32_16x16x32_bf16 v[148:151], a[208:211], a[164:167], v[148:151]
ds_read_b64_tr_b16 a[250:251], v23 offset:30848
v_accvgpr_write_b32 a92, v180
v_mfma_f32_16x16x32_bf16 v[144:147], a[212:215], a[168:171], v[144:147]
ds_read_b64_tr_b16 a[252:253], v23 offset:32896
v_cvt_pk_bf16_f32 v182, v182, v183
v_mfma_f32_16x16x32_bf16 v[148:151], a[212:215], a[172:175], v[148:151]
ds_read_b64_tr_b16 a[254:255], v23 offset:34944
v_accvgpr_write_b32 a93, v182
v_mfma_f32_16x16x32_bf16 v[144:147], a[216:219], a[176:179], v[144:147]
s_barrier
v_cvt_pk_bf16_f32 v184, v184, v185
v_accvgpr_write_b32 a90, v184
v_mfma_f32_16x16x32_bf16 v[148:151], a[216:219], a[180:183], v[148:151]
ds_read_b64_tr_b16 a[208:209], v20 offset:37056
v_cvt_pk_bf16_f32 v186, v186, v187
v_mfma_f32_16x16x32_bf16 v[160:163], v[248:251], a[96:99], 0
ds_read_b64_tr_b16 a[210:211], v20 offset:39104
v_accvgpr_write_b32 a91, v186
v_mfma_f32_16x16x32_bf16 v[164:167], v[248:251], a[100:103], 0
s_waitcnt lgkmcnt(14)
v_cvt_pk_bf16_f32 v188, v188, v189
v_accvgpr_write_b32 a94, v188
v_mfma_f32_16x16x32_bf16 v[160:163], a[220:223], a[160:163], v[160:163]
ds_read_b64_tr_b16 a[212:213], v20 offset:41152
v_cvt_pk_bf16_f32 v190, v190, v191
v_mfma_f32_16x16x32_bf16 v[164:167], a[220:223], a[164:167], v[164:167]
ds_read_b64_tr_b16 a[214:215], v20 offset:43200
v_accvgpr_write_b32 a95, v190
v_mfma_f32_16x16x32_bf16 v[160:163], a[224:227], a[168:171], v[160:163]
ds_read_b64_tr_b16 a[216:217], v20 offset:45248
v_mfma_f32_16x16x32_bf16 v[164:167], a[224:227], a[172:175], v[164:167]
ds_read_b64_tr_b16 a[218:219], v20 offset:47296
v_mfma_f32_16x16x32_bf16 v[160:163], a[228:231], a[176:179], v[160:163]
ds_read_b64_tr_b16 a[220:221], v21 offset:37056
v_mfma_f32_16x16x32_bf16 v[164:167], a[228:231], a[180:183], v[164:167]
ds_read_b64_tr_b16 a[222:223], v21 offset:39104
v_mfma_f32_16x16x32_bf16 v[176:179], v[244:247], a[104:107], 0
v_mfma_f32_16x16x32_bf16 v[180:183], v[244:247], a[108:111], 0
s_waitcnt lgkmcnt(14)
v_mfma_f32_16x16x32_bf16 v[176:179], a[232:235], a[160:163], v[176:179]
ds_read_b64_tr_b16 a[224:225], v21 offset:41152
v_mfma_f32_16x16x32_bf16 v[180:183], a[232:235], a[164:167], v[180:183]
ds_read_b64_tr_b16 a[226:227], v21 offset:43200
v_mfma_f32_16x16x32_bf16 v[176:179], a[236:239], a[168:171], v[176:179]
ds_read_b64_tr_b16 a[228:229], v21 offset:45248
v_mfma_f32_16x16x32_bf16 v[180:183], a[236:239], a[172:175], v[180:183]
ds_read_b64_tr_b16 a[230:231], v21 offset:47296
v_mfma_f32_16x16x32_bf16 v[176:179], a[240:243], a[176:179], v[176:179]
ds_read_b64_tr_b16 a[232:233], v22 offset:37056
v_mfma_f32_16x16x32_bf16 v[180:183], a[240:243], a[180:183], v[180:183]
ds_read_b64_tr_b16 a[234:235], v22 offset:39104
v_mfma_f32_16x16x32_bf16 v[184:187], v[248:251], a[104:107], 0
v_mfma_f32_16x16x32_bf16 v[188:191], v[248:251], a[108:111], 0
s_waitcnt lgkmcnt(14)
v_mfma_f32_16x16x32_bf16 v[184:187], a[244:247], a[160:163], v[184:187]
ds_read_b64_tr_b16 a[236:237], v22 offset:41152
v_mfma_f32_16x16x32_bf16 v[188:191], a[244:247], a[164:167], v[188:191]
ds_read_b64_tr_b16 a[238:239], v22 offset:43200
v_mfma_f32_16x16x32_bf16 v[184:187], a[248:251], a[168:171], v[184:187]
ds_read_b64_tr_b16 a[240:241], v22 offset:45248
v_mfma_f32_16x16x32_bf16 v[188:191], a[248:251], a[172:175], v[188:191]
ds_read_b64_tr_b16 a[242:243], v22 offset:47296
v_mfma_f32_16x16x32_bf16 v[184:187], a[252:255], a[176:179], v[184:187]
ds_read_b64_tr_b16 a[244:245], v23 offset:37056
v_mfma_f32_16x16x32_bf16 v[188:191], a[252:255], a[180:183], v[188:191]
s_waitcnt lgkmcnt(13)
ds_read_b64_tr_b16 a[246:247], v23 offset:39104
v_mfma_f32_16x16x32_bf16 v[144:147], a[208:211], a[184:187], v[144:147]
ds_read_b64_tr_b16 a[248:249], v23 offset:41152
v_mfma_f32_16x16x32_bf16 v[148:151], a[208:211], a[188:191], v[148:151]
ds_read_b64_tr_b16 a[250:251], v23 offset:43200
v_mfma_f32_16x16x32_bf16 v[144:147], a[212:215], a[192:195], v[144:147]
ds_read_b64_tr_b16 a[252:253], v23 offset:45248
v_mfma_f32_16x16x32_bf16 v[148:151], a[212:215], a[196:199], v[148:151]
ds_read_b64_tr_b16 a[254:255], v23 offset:47296
v_mfma_f32_16x16x32_bf16 v[144:147], a[216:219], a[200:203], v[144:147]
ds_read_b128 a[208:211], v6 offset:0
v_mfma_f32_16x16x32_bf16 v[148:151], a[216:219], a[204:207], v[148:151]
s_waitcnt lgkmcnt(13)
v_mfma_f32_16x16x32_bf16 v[160:163], a[220:223], a[184:187], v[160:163]
ds_read_b128 a[212:215], v7 offset:0
v_mfma_f32_16x16x32_bf16 v[164:167], a[220:223], a[188:191], v[164:167]
v_mfma_f32_16x16x32_bf16 v[160:163], a[224:227], a[192:195], v[160:163]
ds_read_b128 a[216:219], v6 offset:128
v_cvt_pk_bf16_f32 v144, v144, v145
v_mfma_f32_16x16x32_bf16 v[164:167], a[224:227], a[196:199], v[164:167]
v_accvgpr_write_b32 a96, v144
v_cvt_pk_bf16_f32 v146, v146, v147
v_mfma_f32_16x16x32_bf16 v[160:163], a[228:231], a[200:203], v[160:163]
ds_read_b128 a[220:223], v7 offset:128
v_accvgpr_write_b32 a97, v146
v_mfma_f32_16x16x32_bf16 v[164:167], a[228:231], a[204:207], v[164:167]
s_waitcnt lgkmcnt(10)
v_cvt_pk_bf16_f32 v148, v148, v149
v_accvgpr_write_b32 a100, v148
v_mfma_f32_16x16x32_bf16 v[176:179], a[232:235], a[184:187], v[176:179]
ds_read_b128 a[224:227], v6 offset:256
v_cvt_pk_bf16_f32 v150, v150, v151
v_mfma_f32_16x16x32_bf16 v[180:183], a[232:235], a[188:191], v[180:183]
v_accvgpr_write_b32 a101, v150
v_cvt_pk_bf16_f32 v160, v160, v161
v_mfma_f32_16x16x32_bf16 v[176:179], a[236:239], a[192:195], v[176:179]
ds_read_b128 a[228:231], v7 offset:256
v_accvgpr_write_b32 a98, v160
v_mfma_f32_16x16x32_bf16 v[180:183], a[236:239], a[196:199], v[180:183]
v_cvt_pk_bf16_f32 v162, v162, v163
v_accvgpr_write_b32 a99, v162
v_mfma_f32_16x16x32_bf16 v[176:179], a[240:243], a[200:203], v[176:179]
ds_read_b128 a[232:235], v6 offset:6144
v_cvt_pk_bf16_f32 v164, v164, v165
v_mfma_f32_16x16x32_bf16 v[180:183], a[240:243], a[204:207], v[180:183]
s_waitcnt lgkmcnt(7)
v_accvgpr_write_b32 a102, v164
v_cvt_pk_bf16_f32 v166, v166, v167
v_mfma_f32_16x16x32_bf16 v[184:187], a[244:247], a[184:187], v[184:187]
ds_read_b128 a[236:239], v7 offset:6144
v_accvgpr_write_b32 a103, v166
v_mfma_f32_16x16x32_bf16 v[188:191], a[244:247], a[188:191], v[188:191]
v_cvt_pk_bf16_f32 v176, v176, v177
v_accvgpr_write_b32 a104, v176
v_mfma_f32_16x16x32_bf16 v[184:187], a[248:251], a[192:195], v[184:187]
ds_read_b128 a[240:243], v6 offset:6272
v_cvt_pk_bf16_f32 v178, v178, v179
v_mfma_f32_16x16x32_bf16 v[188:191], a[248:251], a[196:199], v[188:191]
v_accvgpr_write_b32 a105, v178
v_cvt_pk_bf16_f32 v180, v180, v181
v_mfma_f32_16x16x32_bf16 v[184:187], a[252:255], a[200:203], v[184:187]
v_accvgpr_write_b32 a108, v180
v_cvt_pk_bf16_f32 v182, v182, v183
v_mfma_f32_16x16x32_bf16 v[188:191], a[252:255], a[204:207], v[188:191]
v_accvgpr_write_b32 a109, v182
s_nop 3
v_cvt_pk_bf16_f32 v184, v184, v185
v_accvgpr_write_b32 a106, v184
v_cvt_pk_bf16_f32 v186, v186, v187
v_accvgpr_write_b32 a107, v186
v_cvt_pk_bf16_f32 v188, v188, v189
v_accvgpr_write_b32 a110, v188
v_cvt_pk_bf16_f32 v190, v190, v191
v_accvgpr_write_b32 a111, v190
s_branch L_a0
L_O0c:
s_barrier
v_mfma_f32_16x16x32_bf16 v[144:147], v[244:247], a[112:115], 0
ds_read_b64_tr_b16 a[208:209], v20 offset:49408
ds_read_b64_tr_b16 a[210:211], v20 offset:51456
v_mfma_f32_16x16x32_bf16 v[148:151], v[244:247], a[116:119], 0
ds_read_b64_tr_b16 a[212:213], v20 offset:53504
ds_read_b64_tr_b16 a[214:215], v20 offset:55552
v_mfma_f32_16x16x32_bf16 v[160:163], v[248:251], a[112:115], 0
ds_read_b64_tr_b16 a[216:217], v20 offset:57600
ds_read_b64_tr_b16 a[218:219], v20 offset:59648
v_mfma_f32_16x16x32_bf16 v[164:167], v[248:251], a[116:119], 0
ds_read_b64_tr_b16 a[220:221], v21 offset:49408
ds_read_b64_tr_b16 a[222:223], v21 offset:51456
v_mfma_f32_16x16x32_bf16 v[176:179], v[244:247], a[120:123], 0
ds_read_b64_tr_b16 a[224:225], v21 offset:53504
ds_read_b64_tr_b16 a[226:227], v21 offset:55552
v_mfma_f32_16x16x32_bf16 v[180:183], v[244:247], a[124:127], 0
ds_read_b64_tr_b16 a[228:229], v21 offset:57600
ds_read_b64_tr_b16 a[230:231], v21 offset:59648
v_mfma_f32_16x16x32_bf16 v[184:187], v[248:251], a[120:123], 0
ds_read_b64_tr_b16 a[232:233], v22 offset:49408
ds_read_b64_tr_b16 a[234:235], v22 offset:51456
v_mfma_f32_16x16x32_bf16 v[188:191], v[248:251], a[124:127], 0
s_waitcnt lgkmcnt(8)
ds_read_b64_tr_b16 a[236:237], v22 offset:53504
ds_read_b64_tr_b16 a[238:239], v22 offset:55552
v_mfma_f32_16x16x32_bf16 v[144:147], a[208:211], a[160:163], v[144:147]
ds_read_b64_tr_b16 a[240:241], v22 offset:57600
ds_read_b64_tr_b16 a[242:243], v22 offset:59648
v_mfma_f32_16x16x32_bf16 v[148:151], a[208:211], a[164:167], v[148:151]
ds_read_b64_tr_b16 a[244:245], v23 offset:49408
ds_read_b64_tr_b16 a[246:247], v23 offset:51456
v_mfma_f32_16x16x32_bf16 v[144:147], a[212:215], a[168:171], v[144:147]
ds_read_b64_tr_b16 a[248:249], v23 offset:53504
v_mfma_f32_16x16x32_bf16 v[148:151], a[212:215], a[172:175], v[148:151]
ds_read_b64_tr_b16 a[250:251], v23 offset:55552
v_mfma_f32_16x16x32_bf16 v[144:147], a[216:219], a[176:179], v[144:147]
ds_read_b64_tr_b16 a[252:253], v23 offset:57600
v_mfma_f32_16x16x32_bf16 v[148:151], a[216:219], a[180:183], v[148:151]
s_waitcnt lgkmcnt(11)
ds_read_b64_tr_b16 a[254:255], v23 offset:59648
v_mfma_f32_16x16x32_bf16 v[160:163], a[220:223], a[160:163], v[160:163]
s_barrier
v_mfma_f32_16x16x32_bf16 v[164:167], a[220:223], a[164:167], v[164:167]
ds_read_b64_tr_b16 a[208:209], v20 offset:0
ds_read_b64_tr_b16 a[210:211], v20 offset:2048
v_mfma_f32_16x16x32_bf16 v[160:163], a[224:227], a[168:171], v[160:163]
ds_read_b64_tr_b16 a[212:213], v20 offset:4096
v_mfma_f32_16x16x32_bf16 v[164:167], a[224:227], a[172:175], v[164:167]
ds_read_b64_tr_b16 a[214:215], v20 offset:6144
v_mfma_f32_16x16x32_bf16 v[160:163], a[228:231], a[176:179], v[160:163]
ds_read_b64_tr_b16 a[216:217], v20 offset:8192
v_mfma_f32_16x16x32_bf16 v[164:167], a[228:231], a[180:183], v[164:167]
s_waitcnt lgkmcnt(11)
ds_read_b64_tr_b16 a[218:219], v20 offset:10240
v_mfma_f32_16x16x32_bf16 v[176:179], a[232:235], a[160:163], v[176:179]
ds_read_b64_tr_b16 a[220:221], v21 offset:0
v_mfma_f32_16x16x32_bf16 v[180:183], a[232:235], a[164:167], v[180:183]
ds_read_b64_tr_b16 a[222:223], v21 offset:2048
v_mfma_f32_16x16x32_bf16 v[176:179], a[236:239], a[168:171], v[176:179]
ds_read_b64_tr_b16 a[224:225], v21 offset:4096
v_mfma_f32_16x16x32_bf16 v[180:183], a[236:239], a[172:175], v[180:183]
ds_read_b64_tr_b16 a[226:227], v21 offset:6144
v_mfma_f32_16x16x32_bf16 v[176:179], a[240:243], a[176:179], v[176:179]
ds_read_b64_tr_b16 a[228:229], v21 offset:8192
v_mfma_f32_16x16x32_bf16 v[180:183], a[240:243], a[180:183], v[180:183]
s_waitcnt lgkmcnt(11)
ds_read_b64_tr_b16 a[230:231], v21 offset:10240
v_mfma_f32_16x16x32_bf16 v[184:187], a[244:247], a[160:163], v[184:187]
ds_read_b64_tr_b16 a[232:233], v22 offset:0
v_mfma_f32_16x16x32_bf16 v[188:191], a[244:247], a[164:167], v[188:191]
ds_read_b64_tr_b16 a[234:235], v22 offset:2048
v_mfma_f32_16x16x32_bf16 v[184:187], a[248:251], a[168:171], v[184:187]
ds_read_b64_tr_b16 a[236:237], v22 offset:4096
v_mfma_f32_16x16x32_bf16 v[188:191], a[248:251], a[172:175], v[188:191]
ds_read_b64_tr_b16 a[238:239], v22 offset:6144
v_mfma_f32_16x16x32_bf16 v[184:187], a[252:255], a[176:179], v[184:187]
ds_read_b64_tr_b16 a[240:241], v22 offset:8192
v_mfma_f32_16x16x32_bf16 v[188:191], a[252:255], a[180:183], v[188:191]
s_waitcnt lgkmcnt(11)
ds_read_b64_tr_b16 a[242:243], v22 offset:10240
v_mfma_f32_16x16x32_bf16 v[144:147], a[208:211], a[184:187], v[144:147]
ds_read_b64_tr_b16 a[244:245], v23 offset:0
v_mfma_f32_16x16x32_bf16 v[148:151], a[208:211], a[188:191], v[148:151]
ds_read_b64_tr_b16 a[246:247], v23 offset:2048
v_mfma_f32_16x16x32_bf16 v[144:147], a[212:215], a[192:195], v[144:147]
ds_read_b64_tr_b16 a[248:249], v23 offset:4096
v_mfma_f32_16x16x32_bf16 v[148:151], a[212:215], a[196:199], v[148:151]
ds_read_b64_tr_b16 a[250:251], v23 offset:6144
v_mfma_f32_16x16x32_bf16 v[144:147], a[216:219], a[200:203], v[144:147]
ds_read_b64_tr_b16 a[252:253], v23 offset:8192
v_mfma_f32_16x16x32_bf16 v[148:151], a[216:219], a[204:207], v[148:151]
s_waitcnt lgkmcnt(11)
ds_read_b64_tr_b16 a[254:255], v23 offset:10240
v_mfma_f32_16x16x32_bf16 v[160:163], a[220:223], a[184:187], v[160:163]
s_barrier
v_mfma_f32_16x16x32_bf16 v[164:167], a[220:223], a[188:191], v[164:167]
ds_read_b64_tr_b16 a[208:209], v20 offset:12352
ds_read_b64_tr_b16 a[210:211], v20 offset:14400
v_mfma_f32_16x16x32_bf16 v[160:163], a[224:227], a[192:195], v[160:163]
ds_read_b64_tr_b16 a[212:213], v20 offset:16448
v_cvt_pk_bf16_f32 v144, v144, v145
v_mfma_f32_16x16x32_bf16 v[164:167], a[224:227], a[196:199], v[164:167]
ds_read_b64_tr_b16 a[214:215], v20 offset:18496
v_accvgpr_write_b32 a112, v144
v_mfma_f32_16x16x32_bf16 v[160:163], a[228:231], a[200:203], v[160:163]
ds_read_b64_tr_b16 a[216:217], v20 offset:20544
v_cvt_pk_bf16_f32 v146, v146, v147
v_mfma_f32_16x16x32_bf16 v[164:167], a[228:231], a[204:207], v[164:167]
s_waitcnt lgkmcnt(11)
ds_read_b64_tr_b16 a[218:219], v20 offset:22592
v_accvgpr_write_b32 a113, v146
v_mfma_f32_16x16x32_bf16 v[176:179], a[232:235], a[184:187], v[176:179]
ds_read_b64_tr_b16 a[220:221], v21 offset:12352
v_cvt_pk_bf16_f32 v148, v148, v149
v_mfma_f32_16x16x32_bf16 v[180:183], a[232:235], a[188:191], v[180:183]
ds_read_b64_tr_b16 a[222:223], v21 offset:14400
v_accvgpr_write_b32 a116, v148
v_mfma_f32_16x16x32_bf16 v[176:179], a[236:239], a[192:195], v[176:179]
ds_read_b64_tr_b16 a[224:225], v21 offset:16448
v_cvt_pk_bf16_f32 v150, v150, v151
v_mfma_f32_16x16x32_bf16 v[180:183], a[236:239], a[196:199], v[180:183]
ds_read_b64_tr_b16 a[226:227], v21 offset:18496
v_accvgpr_write_b32 a117, v150
v_mfma_f32_16x16x32_bf16 v[176:179], a[240:243], a[200:203], v[176:179]
ds_read_b64_tr_b16 a[228:229], v21 offset:20544
v_cvt_pk_bf16_f32 v160, v160, v161
v_mfma_f32_16x16x32_bf16 v[180:183], a[240:243], a[204:207], v[180:183]
s_waitcnt lgkmcnt(11)
ds_read_b64_tr_b16 a[230:231], v21 offset:22592
v_accvgpr_write_b32 a114, v160
v_mfma_f32_16x16x32_bf16 v[184:187], a[244:247], a[184:187], v[184:187]
ds_read_b64_tr_b16 a[232:233], v22 offset:12352
v_cvt_pk_bf16_f32 v162, v162, v163
v_mfma_f32_16x16x32_bf16 v[188:191], a[244:247], a[188:191], v[188:191]
ds_read_b64_tr_b16 a[234:235], v22 offset:14400
v_accvgpr_write_b32 a115, v162
v_mfma_f32_16x16x32_bf16 v[184:187], a[248:251], a[192:195], v[184:187]
ds_read_b64_tr_b16 a[236:237], v22 offset:16448
v_cvt_pk_bf16_f32 v164, v164, v165
v_mfma_f32_16x16x32_bf16 v[188:191], a[248:251], a[196:199], v[188:191]
ds_read_b64_tr_b16 a[238:239], v22 offset:18496
v_accvgpr_write_b32 a118, v164
v_mfma_f32_16x16x32_bf16 v[184:187], a[252:255], a[200:203], v[184:187]
ds_read_b64_tr_b16 a[240:241], v22 offset:20544
v_cvt_pk_bf16_f32 v166, v166, v167
v_mfma_f32_16x16x32_bf16 v[188:191], a[252:255], a[204:207], v[188:191]
ds_read_b64_tr_b16 a[242:243], v22 offset:22592
v_accvgpr_write_b32 a119, v166
v_mfma_f32_16x16x32_bf16 v[144:147], v[244:247], a[128:131], 0
ds_read_b64_tr_b16 a[244:245], v23 offset:12352
v_cvt_pk_bf16_f32 v176, v176, v177
v_mfma_f32_16x16x32_bf16 v[148:151], v[244:247], a[132:135], 0
s_waitcnt lgkmcnt(13)
ds_read_b64_tr_b16 a[246:247], v23 offset:14400
v_accvgpr_write_b32 a120, v176
v_mfma_f32_16x16x32_bf16 v[144:147], a[208:211], a[160:163], v[144:147]
ds_read_b64_tr_b16 a[248:249], v23 offset:16448
v_cvt_pk_bf16_f32 v178, v178, v179
v_mfma_f32_16x16x32_bf16 v[148:151], a[208:211], a[164:167], v[148:151]
ds_read_b64_tr_b16 a[250:251], v23 offset:18496
v_accvgpr_write_b32 a121, v178
v_mfma_f32_16x16x32_bf16 v[144:147], a[212:215], a[168:171], v[144:147]
ds_read_b64_tr_b16 a[252:253], v23 offset:20544
v_cvt_pk_bf16_f32 v180, v180, v181
v_mfma_f32_16x16x32_bf16 v[148:151], a[212:215], a[172:175], v[148:151]
ds_read_b64_tr_b16 a[254:255], v23 offset:22592
v_accvgpr_write_b32 a124, v180
v_mfma_f32_16x16x32_bf16 v[144:147], a[216:219], a[176:179], v[144:147]
s_barrier
v_cvt_pk_bf16_f32 v182, v182, v183
v_accvgpr_write_b32 a125, v182
v_mfma_f32_16x16x32_bf16 v[148:151], a[216:219], a[180:183], v[148:151]
ds_read_b64_tr_b16 a[208:209], v20 offset:24704
v_cvt_pk_bf16_f32 v184, v184, v185
v_mfma_f32_16x16x32_bf16 v[160:163], v[248:251], a[128:131], 0
ds_read_b64_tr_b16 a[210:211], v20 offset:26752
v_accvgpr_write_b32 a122, v184
v_mfma_f32_16x16x32_bf16 v[164:167], v[248:251], a[132:135], 0
s_waitcnt lgkmcnt(14)
v_cvt_pk_bf16_f32 v186, v186, v187
v_accvgpr_write_b32 a123, v186
v_mfma_f32_16x16x32_bf16 v[160:163], a[220:223], a[160:163], v[160:163]
ds_read_b64_tr_b16 a[212:213], v20 offset:28800
v_cvt_pk_bf16_f32 v188, v188, v189
v_mfma_f32_16x16x32_bf16 v[164:167], a[220:223], a[164:167], v[164:167]
ds_read_b64_tr_b16 a[214:215], v20 offset:30848
v_accvgpr_write_b32 a126, v188
v_mfma_f32_16x16x32_bf16 v[160:163], a[224:227], a[168:171], v[160:163]
ds_read_b64_tr_b16 a[216:217], v20 offset:32896
v_cvt_pk_bf16_f32 v190, v190, v191
v_mfma_f32_16x16x32_bf16 v[164:167], a[224:227], a[172:175], v[164:167]
ds_read_b64_tr_b16 a[218:219], v20 offset:34944
v_accvgpr_write_b32 a127, v190
v_mfma_f32_16x16x32_bf16 v[160:163], a[228:231], a[176:179], v[160:163]
ds_read_b64_tr_b16 a[220:221], v21 offset:24704
v_mfma_f32_16x16x32_bf16 v[164:167], a[228:231], a[180:183], v[164:167]
ds_read_b64_tr_b16 a[222:223], v21 offset:26752
v_mfma_f32_16x16x32_bf16 v[176:179], v[244:247], a[136:139], 0
v_mfma_f32_16x16x32_bf16 v[180:183], v[244:247], a[140:143], 0
s_waitcnt lgkmcnt(14)
v_mfma_f32_16x16x32_bf16 v[176:179], a[232:235], a[160:163], v[176:179]
ds_read_b64_tr_b16 a[224:225], v21 offset:28800
v_mfma_f32_16x16x32_bf16 v[180:183], a[232:235], a[164:167], v[180:183]
ds_read_b64_tr_b16 a[226:227], v21 offset:30848
v_mfma_f32_16x16x32_bf16 v[176:179], a[236:239], a[168:171], v[176:179]
ds_read_b64_tr_b16 a[228:229], v21 offset:32896
v_mfma_f32_16x16x32_bf16 v[180:183], a[236:239], a[172:175], v[180:183]
ds_read_b64_tr_b16 a[230:231], v21 offset:34944
v_mfma_f32_16x16x32_bf16 v[176:179], a[240:243], a[176:179], v[176:179]
ds_read_b64_tr_b16 a[232:233], v22 offset:24704
v_mfma_f32_16x16x32_bf16 v[180:183], a[240:243], a[180:183], v[180:183]
ds_read_b64_tr_b16 a[234:235], v22 offset:26752
v_mfma_f32_16x16x32_bf16 v[184:187], v[248:251], a[136:139], 0
v_mfma_f32_16x16x32_bf16 v[188:191], v[248:251], a[140:143], 0
s_waitcnt lgkmcnt(14)
v_mfma_f32_16x16x32_bf16 v[184:187], a[244:247], a[160:163], v[184:187]
ds_read_b64_tr_b16 a[236:237], v22 offset:28800
v_mfma_f32_16x16x32_bf16 v[188:191], a[244:247], a[164:167], v[188:191]
ds_read_b64_tr_b16 a[238:239], v22 offset:30848
v_mfma_f32_16x16x32_bf16 v[184:187], a[248:251], a[168:171], v[184:187]
ds_read_b64_tr_b16 a[240:241], v22 offset:32896
v_mfma_f32_16x16x32_bf16 v[188:191], a[248:251], a[172:175], v[188:191]
ds_read_b64_tr_b16 a[242:243], v22 offset:34944
v_mfma_f32_16x16x32_bf16 v[184:187], a[252:255], a[176:179], v[184:187]
ds_read_b64_tr_b16 a[244:245], v23 offset:24704
v_mfma_f32_16x16x32_bf16 v[188:191], a[252:255], a[180:183], v[188:191]
s_waitcnt lgkmcnt(13)
ds_read_b64_tr_b16 a[246:247], v23 offset:26752
v_mfma_f32_16x16x32_bf16 v[144:147], a[208:211], a[184:187], v[144:147]
ds_read_b64_tr_b16 a[248:249], v23 offset:28800
v_mfma_f32_16x16x32_bf16 v[148:151], a[208:211], a[188:191], v[148:151]
ds_read_b64_tr_b16 a[250:251], v23 offset:30848
v_mfma_f32_16x16x32_bf16 v[144:147], a[212:215], a[192:195], v[144:147]
ds_read_b64_tr_b16 a[252:253], v23 offset:32896
v_mfma_f32_16x16x32_bf16 v[148:151], a[212:215], a[196:199], v[148:151]
ds_read_b64_tr_b16 a[254:255], v23 offset:34944
v_mfma_f32_16x16x32_bf16 v[144:147], a[216:219], a[200:203], v[144:147]
s_barrier
v_mfma_f32_16x16x32_bf16 v[148:151], a[216:219], a[204:207], v[148:151]
s_waitcnt lgkmcnt(12)
ds_read_b64_tr_b16 a[208:209], v20 offset:37056
v_mfma_f32_16x16x32_bf16 v[160:163], a[220:223], a[184:187], v[160:163]
ds_read_b64_tr_b16 a[210:211], v20 offset:39104
v_mfma_f32_16x16x32_bf16 v[164:167], a[220:223], a[188:191], v[164:167]
ds_read_b64_tr_b16 a[212:213], v20 offset:41152
v_cvt_pk_bf16_f32 v144, v144, v145
v_mfma_f32_16x16x32_bf16 v[160:163], a[224:227], a[192:195], v[160:163]
ds_read_b64_tr_b16 a[214:215], v20 offset:43200
v_accvgpr_write_b32 a128, v144
v_mfma_f32_16x16x32_bf16 v[164:167], a[224:227], a[196:199], v[164:167]
ds_read_b64_tr_b16 a[216:217], v20 offset:45248
v_cvt_pk_bf16_f32 v146, v146, v147
v_mfma_f32_16x16x32_bf16 v[160:163], a[228:231], a[200:203], v[160:163]
ds_read_b64_tr_b16 a[218:219], v20 offset:47296
v_accvgpr_write_b32 a129, v146
v_mfma_f32_16x16x32_bf16 v[164:167], a[228:231], a[204:207], v[164:167]
s_waitcnt lgkmcnt(12)
ds_read_b64_tr_b16 a[220:221], v21 offset:37056
v_cvt_pk_bf16_f32 v148, v148, v149
v_mfma_f32_16x16x32_bf16 v[176:179], a[232:235], a[184:187], v[176:179]
ds_read_b64_tr_b16 a[222:223], v21 offset:39104
v_accvgpr_write_b32 a132, v148
v_mfma_f32_16x16x32_bf16 v[180:183], a[232:235], a[188:191], v[180:183]
ds_read_b64_tr_b16 a[224:225], v21 offset:41152
v_cvt_pk_bf16_f32 v150, v150, v151
v_mfma_f32_16x16x32_bf16 v[176:179], a[236:239], a[192:195], v[176:179]
ds_read_b64_tr_b16 a[226:227], v21 offset:43200
v_accvgpr_write_b32 a133, v150
v_mfma_f32_16x16x32_bf16 v[180:183], a[236:239], a[196:199], v[180:183]
ds_read_b64_tr_b16 a[228:229], v21 offset:45248
v_cvt_pk_bf16_f32 v160, v160, v161
v_mfma_f32_16x16x32_bf16 v[176:179], a[240:243], a[200:203], v[176:179]
ds_read_b64_tr_b16 a[230:231], v21 offset:47296
v_accvgpr_write_b32 a130, v160
v_mfma_f32_16x16x32_bf16 v[180:183], a[240:243], a[204:207], v[180:183]
s_waitcnt lgkmcnt(12)
ds_read_b64_tr_b16 a[232:233], v22 offset:37056
v_cvt_pk_bf16_f32 v162, v162, v163
v_mfma_f32_16x16x32_bf16 v[184:187], a[244:247], a[184:187], v[184:187]
ds_read_b64_tr_b16 a[234:235], v22 offset:39104
v_accvgpr_write_b32 a131, v162
v_mfma_f32_16x16x32_bf16 v[188:191], a[244:247], a[188:191], v[188:191]
ds_read_b64_tr_b16 a[236:237], v22 offset:41152
v_cvt_pk_bf16_f32 v164, v164, v165
v_mfma_f32_16x16x32_bf16 v[184:187], a[248:251], a[192:195], v[184:187]
ds_read_b64_tr_b16 a[238:239], v22 offset:43200
v_accvgpr_write_b32 a134, v164
v_mfma_f32_16x16x32_bf16 v[188:191], a[248:251], a[196:199], v[188:191]
ds_read_b64_tr_b16 a[240:241], v22 offset:45248
v_cvt_pk_bf16_f32 v166, v166, v167
v_mfma_f32_16x16x32_bf16 v[184:187], a[252:255], a[200:203], v[184:187]
ds_read_b64_tr_b16 a[242:243], v22 offset:47296
v_accvgpr_write_b32 a135, v166
v_mfma_f32_16x16x32_bf16 v[188:191], a[252:255], a[204:207], v[188:191]
ds_read_b64_tr_b16 a[244:245], v23 offset:37056
v_cvt_pk_bf16_f32 v176, v176, v177
v_mfma_f32_16x16x32_bf16 v[144:147], v[244:247], a[144:147], 0
ds_read_b64_tr_b16 a[246:247], v23 offset:39104
v_accvgpr_write_b32 a136, v176
v_mfma_f32_16x16x32_bf16 v[148:151], v[244:247], a[148:151], 0
s_waitcnt lgkmcnt(14)
v_cvt_pk_bf16_f32 v178, v178, v179
v_accvgpr_write_b32 a137, v178
v_mfma_f32_16x16x32_bf16 v[144:147], a[208:211], a[160:163], v[144:147]
ds_read_b64_tr_b16 a[248:249], v23 offset:41152
v_cvt_pk_bf16_f32 v180, v180, v181
v_mfma_f32_16x16x32_bf16 v[148:151], a[208:211], a[164:167], v[148:151]
ds_read_b64_tr_b16 a[250:251], v23 offset:43200
v_accvgpr_write_b32 a140, v180
v_mfma_f32_16x16x32_bf16 v[144:147], a[212:215], a[168:171], v[144:147]
ds_read_b64_tr_b16 a[252:253], v23 offset:45248
v_cvt_pk_bf16_f32 v182, v182, v183
v_mfma_f32_16x16x32_bf16 v[148:151], a[212:215], a[172:175], v[148:151]
ds_read_b64_tr_b16 a[254:255], v23 offset:47296
v_accvgpr_write_b32 a141, v182
v_mfma_f32_16x16x32_bf16 v[144:147], a[216:219], a[176:179], v[144:147]
s_barrier
v_cvt_pk_bf16_f32 v184, v184, v185
v_accvgpr_write_b32 a138, v184
v_mfma_f32_16x16x32_bf16 v[148:151], a[216:219], a[180:183], v[148:151]
ds_read_b64_tr_b16 a[208:209], v20 offset:49408
v_cvt_pk_bf16_f32 v186, v186, v187
v_mfma_f32_16x16x32_bf16 v[160:163], v[248:251], a[144:147], 0
ds_read_b64_tr_b16 a[210:211], v20 offset:51456
v_accvgpr_write_b32 a139, v186
v_mfma_f32_16x16x32_bf16 v[164:167], v[248:251], a[148:151], 0
s_waitcnt lgkmcnt(14)
v_cvt_pk_bf16_f32 v188, v188, v189
v_accvgpr_write_b32 a142, v188
v_mfma_f32_16x16x32_bf16 v[160:163], a[220:223], a[160:163], v[160:163]
ds_read_b64_tr_b16 a[212:213], v20 offset:53504
v_cvt_pk_bf16_f32 v190, v190, v191
v_mfma_f32_16x16x32_bf16 v[164:167], a[220:223], a[164:167], v[164:167]
ds_read_b64_tr_b16 a[214:215], v20 offset:55552
v_accvgpr_write_b32 a143, v190
v_mfma_f32_16x16x32_bf16 v[160:163], a[224:227], a[168:171], v[160:163]
ds_read_b64_tr_b16 a[216:217], v20 offset:57600
v_mfma_f32_16x16x32_bf16 v[164:167], a[224:227], a[172:175], v[164:167]
ds_read_b64_tr_b16 a[218:219], v20 offset:59648
v_mfma_f32_16x16x32_bf16 v[160:163], a[228:231], a[176:179], v[160:163]
ds_read_b64_tr_b16 a[220:221], v21 offset:49408
v_mfma_f32_16x16x32_bf16 v[164:167], a[228:231], a[180:183], v[164:167]
ds_read_b64_tr_b16 a[222:223], v21 offset:51456
v_mfma_f32_16x16x32_bf16 v[176:179], v[244:247], a[152:155], 0
v_mfma_f32_16x16x32_bf16 v[180:183], v[244:247], a[156:159], 0
s_waitcnt lgkmcnt(14)
v_mfma_f32_16x16x32_bf16 v[176:179], a[232:235], a[160:163], v[176:179]
ds_read_b64_tr_b16 a[224:225], v21 offset:53504
v_mfma_f32_16x16x32_bf16 v[180:183], a[232:235], a[164:167], v[180:183]
ds_read_b64_tr_b16 a[226:227], v21 offset:55552
v_mfma_f32_16x16x32_bf16 v[176:179], a[236:239], a[168:171], v[176:179]
ds_read_b64_tr_b16 a[228:229], v21 offset:57600
v_mfma_f32_16x16x32_bf16 v[180:183], a[236:239], a[172:175], v[180:183]
ds_read_b64_tr_b16 a[230:231], v21 offset:59648
v_mfma_f32_16x16x32_bf16 v[176:179], a[240:243], a[176:179], v[176:179]
ds_read_b64_tr_b16 a[232:233], v22 offset:49408
v_mfma_f32_16x16x32_bf16 v[180:183], a[240:243], a[180:183], v[180:183]
ds_read_b64_tr_b16 a[234:235], v22 offset:51456
v_mfma_f32_16x16x32_bf16 v[184:187], v[248:251], a[152:155], 0
v_mfma_f32_16x16x32_bf16 v[188:191], v[248:251], a[156:159], 0
s_waitcnt lgkmcnt(14)
v_mfma_f32_16x16x32_bf16 v[184:187], a[244:247], a[160:163], v[184:187]
ds_read_b64_tr_b16 a[236:237], v22 offset:53504
v_mfma_f32_16x16x32_bf16 v[188:191], a[244:247], a[164:167], v[188:191]
ds_read_b64_tr_b16 a[238:239], v22 offset:55552
v_mfma_f32_16x16x32_bf16 v[184:187], a[248:251], a[168:171], v[184:187]
ds_read_b64_tr_b16 a[240:241], v22 offset:57600
v_mfma_f32_16x16x32_bf16 v[188:191], a[248:251], a[172:175], v[188:191]
ds_read_b64_tr_b16 a[242:243], v22 offset:59648
v_mfma_f32_16x16x32_bf16 v[184:187], a[252:255], a[176:179], v[184:187]
ds_read_b64_tr_b16 a[244:245], v23 offset:49408
v_mfma_f32_16x16x32_bf16 v[188:191], a[252:255], a[180:183], v[188:191]
s_waitcnt lgkmcnt(13)
ds_read_b64_tr_b16 a[246:247], v23 offset:51456
v_mfma_f32_16x16x32_bf16 v[144:147], a[208:211], a[184:187], v[144:147]
ds_read_b64_tr_b16 a[248:249], v23 offset:53504
v_mfma_f32_16x16x32_bf16 v[148:151], a[208:211], a[188:191], v[148:151]
ds_read_b64_tr_b16 a[250:251], v23 offset:55552
v_mfma_f32_16x16x32_bf16 v[144:147], a[212:215], a[192:195], v[144:147]
ds_read_b64_tr_b16 a[252:253], v23 offset:57600
v_mfma_f32_16x16x32_bf16 v[148:151], a[212:215], a[196:199], v[148:151]
ds_read_b64_tr_b16 a[254:255], v23 offset:59648
v_mfma_f32_16x16x32_bf16 v[144:147], a[216:219], a[200:203], v[144:147]
ds_read_b128 a[208:211], v6 offset:0
v_mfma_f32_16x16x32_bf16 v[148:151], a[216:219], a[204:207], v[148:151]
s_waitcnt lgkmcnt(13)
v_mfma_f32_16x16x32_bf16 v[160:163], a[220:223], a[184:187], v[160:163]
ds_read_b128 a[212:215], v7 offset:0
v_mfma_f32_16x16x32_bf16 v[164:167], a[220:223], a[188:191], v[164:167]
v_mfma_f32_16x16x32_bf16 v[160:163], a[224:227], a[192:195], v[160:163]
ds_read_b128 a[216:219], v6 offset:128
v_cvt_pk_bf16_f32 v144, v144, v145
v_mfma_f32_16x16x32_bf16 v[164:167], a[224:227], a[196:199], v[164:167]
v_accvgpr_write_b32 a144, v144
v_cvt_pk_bf16_f32 v146, v146, v147
v_mfma_f32_16x16x32_bf16 v[160:163], a[228:231], a[200:203], v[160:163]
ds_read_b128 a[220:223], v7 offset:128
v_accvgpr_write_b32 a145, v146
v_mfma_f32_16x16x32_bf16 v[164:167], a[228:231], a[204:207], v[164:167]
s_waitcnt lgkmcnt(10)
v_cvt_pk_bf16_f32 v148, v148, v149
v_accvgpr_write_b32 a148, v148
v_mfma_f32_16x16x32_bf16 v[176:179], a[232:235], a[184:187], v[176:179]
ds_read_b128 a[224:227], v6 offset:256
v_cvt_pk_bf16_f32 v150, v150, v151
v_mfma_f32_16x16x32_bf16 v[180:183], a[232:235], a[188:191], v[180:183]
v_accvgpr_write_b32 a149, v150
v_cvt_pk_bf16_f32 v160, v160, v161
v_mfma_f32_16x16x32_bf16 v[176:179], a[236:239], a[192:195], v[176:179]
ds_read_b128 a[228:231], v7 offset:256
v_accvgpr_write_b32 a146, v160
v_mfma_f32_16x16x32_bf16 v[180:183], a[236:239], a[196:199], v[180:183]
v_cvt_pk_bf16_f32 v162, v162, v163
v_accvgpr_write_b32 a147, v162
v_mfma_f32_16x16x32_bf16 v[176:179], a[240:243], a[200:203], v[176:179]
ds_read_b128 a[232:235], v6 offset:6144
v_cvt_pk_bf16_f32 v164, v164, v165
v_mfma_f32_16x16x32_bf16 v[180:183], a[240:243], a[204:207], v[180:183]
s_waitcnt lgkmcnt(7)
v_accvgpr_write_b32 a150, v164
v_cvt_pk_bf16_f32 v166, v166, v167
v_mfma_f32_16x16x32_bf16 v[184:187], a[244:247], a[184:187], v[184:187]
ds_read_b128 a[236:239], v7 offset:6144
v_accvgpr_write_b32 a151, v166
v_mfma_f32_16x16x32_bf16 v[188:191], a[244:247], a[188:191], v[188:191]
v_cvt_pk_bf16_f32 v176, v176, v177
v_accvgpr_write_b32 a152, v176
v_mfma_f32_16x16x32_bf16 v[184:187], a[248:251], a[192:195], v[184:187]
ds_read_b128 a[240:243], v6 offset:6272
v_cvt_pk_bf16_f32 v178, v178, v179
v_mfma_f32_16x16x32_bf16 v[188:191], a[248:251], a[196:199], v[188:191]
v_accvgpr_write_b32 a153, v178
v_cvt_pk_bf16_f32 v180, v180, v181
v_mfma_f32_16x16x32_bf16 v[184:187], a[252:255], a[200:203], v[184:187]
v_accvgpr_write_b32 a156, v180
v_cvt_pk_bf16_f32 v182, v182, v183
v_mfma_f32_16x16x32_bf16 v[188:191], a[252:255], a[204:207], v[188:191]
v_accvgpr_write_b32 a157, v182
s_nop 3
v_cvt_pk_bf16_f32 v184, v184, v185
v_accvgpr_write_b32 a154, v184
v_cvt_pk_bf16_f32 v186, v186, v187
v_accvgpr_write_b32 a155, v186
v_cvt_pk_bf16_f32 v188, v188, v189
v_accvgpr_write_b32 a158, v188
v_cvt_pk_bf16_f32 v190, v190, v191
v_accvgpr_write_b32 a159, v190
s_branch L_tail0
L_item1:
s_add_u32 s92, s93, 61760
s_waitcnt vmcnt(62)
s_cmp_lg_u32 s28, 0
s_cbranch_scc1 L_cw1_1
s_waitcnt vmcnt(29)
L_cw1_1:
s_barrier
s_waitcnt vmcnt(20)
v_add_u32_e32 v27, 86464, v24
v_add_u32_e32 v29, 86464, v25
ds_read_b128 v[144:147], v27 offset:0
ds_read_b128 v[152:155], v29 offset:0
ds_read_b64_tr_b16 a[208:209], v16 offset:0
ds_read_b64_tr_b16 a[210:211], v16 offset:1536
ds_read_b64_tr_b16 a[212:213], v16 offset:8
ds_read_b64_tr_b16 a[214:215], v16 offset:1544
ds_read_b64_tr_b16 a[216:217], v17 offset:0
ds_read_b64_tr_b16 a[218:219], v17 offset:1536
ds_read_b64_tr_b16 a[220:221], v17 offset:8
ds_read_b64_tr_b16 a[222:223], v17 offset:1544
ds_read_b64_tr_b16 a[224:225], v16 offset:128
ds_read_b64_tr_b16 a[226:227], v16 offset:1664
ds_read_b64_tr_b16 a[228:229], v16 offset:136
ds_read_b64_tr_b16 a[230:231], v16 offset:1672
ds_read_b64_tr_b16 a[232:233], v17 offset:128
ds_read_b64_tr_b16 a[234:235], v17 offset:1664
ds_read_b64_tr_b16 a[236:237], v17 offset:136
ds_read_b64_tr_b16 a[238:239], v17 offset:1672
ds_read_b64_tr_b16 a[240:241], v16 offset:256
ds_read_b64_tr_b16 a[242:243], v16 offset:1792
v_cvt_pk_bf16_f32 v192, v32, v33
v_cvt_pk_bf16_f32 v193, v34, v35
v_pk_mul_f32 v[56:57], v[56:57], v[28:29] op_sel_hi:[1,0]
v_pk_mul_f32 v[58:59], v[58:59], v[28:29] op_sel_hi:[1,0]
v_pk_mul_f32 v[64:65], v[64:65], v[28:29] op_sel_hi:[1,0]
v_pk_mul_f32 v[66:67], v[66:67], v[28:29] op_sel_hi:[1,0]
v_pk_mul_f32 v[72:73], v[72:73], v[28:29] op_sel_hi:[1,0]
v_pk_mul_f32 v[74:75], v[74:75], v[28:29] op_sel_hi:[1,0]
v_pk_mul_f32 v[80:81], v[80:81], v[28:29] op_sel_hi:[1,0]
v_pk_mul_f32 v[82:83], v[82:83], v[28:29] op_sel_hi:[1,0]
v_pk_mul_f32 v[88:89], v[88:89], v[28:29] op_sel_hi:[1,0]
v_pk_mul_f32 v[90:91], v[90:91], v[28:29] op_sel_hi:[1,0]
v_pk_mul_f32 v[96:97], v[96:97], v[28:29] op_sel_hi:[1,0]
v_pk_mul_f32 v[98:99], v[98:99], v[28:29] op_sel_hi:[1,0]
v_pk_mul_f32 v[104:105], v[104:105], v[28:29] op_sel_hi:[1,0]
v_pk_mul_f32 v[106:107], v[106:107], v[28:29] op_sel_hi:[1,0]
v_pk_mul_f32 v[112:113], v[112:113], v[28:29] op_sel_hi:[1,0]
v_pk_mul_f32 v[114:115], v[114:115], v[28:29] op_sel_hi:[1,0]
v_pk_mul_f32 v[120:121], v[120:121], v[28:29] op_sel_hi:[1,0]
v_pk_mul_f32 v[122:123], v[122:123], v[28:29] op_sel_hi:[1,0]
s_waitcnt lgkmcnt(12)
v_mfma_f32_16x16x32_bf16 v[32:35], a[208:211], v[144:147], 0
s_cmp_eq_u32 s28, 0
s_cbranch_scc1 L_xt0
L_xt0r:
ds_read_b64_tr_b16 a[244:245], v16 offset:264
ds_read_b64_tr_b16 a[246:247], v16 offset:1800
ds_read_b64_tr_b16 a[248:249], v17 offset:256
ds_read_b64_tr_b16 a[250:251], v17 offset:1792
v_cvt_pk_bf16_f32 v194, v40, v41
v_cvt_pk_bf16_f32 v195, v42, v43
v_cvt_pk_bf16_f32 v200, v48, v49
v_mfma_f32_16x16x32_bf16 v[40:43], a[212:215], v[144:147], 0
s_add_u32 m0, s92, 14336
s_add_u32 s37, s37, 128
buffer_load_dwordx4 v1, s[4:7], s37 offen lds
ds_read_b64_tr_b16 a[252:253], v17 offset:264
ds_read_b64_tr_b16 a[254:255], v17 offset:1800
v_cvt_pk_bf16_f32 v201, v50, v51
v_cvt_pk_bf16_f32 v202, v56, v57
v_cvt_pk_bf16_f32 v203, v58, v59
v_mfma_f32_16x16x32_bf16 v[48:51], a[216:219], v[144:147], 0
s_waitcnt lgkmcnt(12)
buffer_load_dwordx4 v2, s[4:7], s37 offen offset:1024 lds
v_cvt_pk_bf16_f32 v208, v64, v65
v_cvt_pk_bf16_f32 v209, v66, v67
v_cvt_pk_bf16_f32 v210, v72, v73
v_cvt_pk_bf16_f32 v211, v74, v75
v_cvt_pk_bf16_f32 v216, v80, v81
v_cvt_pk_bf16_f32 v217, v82, v83
v_mfma_f32_16x16x32_bf16 v[56:59], a[220:223], v[144:147], 0
s_waitcnt vmcnt(52)
s_cmp_lg_u32 s28, 0
s_cbranch_scc1 L_cw1_2
s_waitcnt vmcnt(29)
L_cw1_2:
s_barrier
s_cmp_eq_u32 s28, 0
s_cbranch_scc1 L_first1
L_first1r:
ds_read_b64_tr_b16 a[208:209], v16 offset:12352
ds_read_b64_tr_b16 a[210:211], v16 offset:13888
ds_read_b64_tr_b16 a[212:213], v16 offset:12360
ds_read_b64_tr_b16 a[214:215], v16 offset:13896
v_cvt_pk_bf16_f32 v218, v88, v89
v_mfma_f32_16x16x32_bf16 v[64:67], a[224:227], v[144:147], 0
s_mov_b32 m0, 148224
s_add_u32 s36, s34, 1572864
buffer_load_dwordx4 v53, s[16:19], s36 offen lds
ds_read_b64_tr_b16 a[216:217], v17 offset:12352
ds_read_b64_tr_b16 a[218:219], v17 offset:13888
v_cvt_pk_bf16_f32 v219, v90, v91
v_cvt_pk_bf16_f32 v224, v96, v97
v_cvt_pk_bf16_f32 v225, v98, v99
v_mfma_f32_16x16x32_bf16 v[72:75], a[228:231], v[144:147], 0
s_waitcnt lgkmcnt(12)
ds_read_b64_tr_b16 a[220:221], v17 offset:12360
ds_read_b64_tr_b16 a[222:223], v17 offset:13896
v_cvt_pk_bf16_f32 v226, v104, v105
v_cvt_pk_bf16_f32 v227, v106, v107
v_cvt_pk_bf16_f32 v232, v112, v113
v_cvt_pk_bf16_f32 v233, v114, v115
v_cvt_pk_bf16_f32 v234, v120, v121
v_cvt_pk_bf16_f32 v235, v122, v123
v_mfma_f32_16x16x32_bf16 v[80:83], a[232:235], v[144:147], 0
ds_read_b64_tr_b16 a[224:225], v16 offset:12480
ds_read_b64_tr_b16 a[226:227], v16 offset:14016
buffer_load_dwordx4 v54, s[16:19], s36 offen offset:1024 lds
buffer_load_dwordx4 v55, s[16:19], s36 offen offset:2048 lds
v_mfma_f32_16x16x32_bf16 v[88:91], a[236:239], v[144:147], 0
s_addk_i32 m0, 3096
s_add_u32 s36, s34, 1671168
buffer_load_dwordx4 v53, s[16:19], s36 offen lds
ds_read_b64_tr_b16 a[228:229], v16 offset:12488
ds_read_b64_tr_b16 a[230:231], v16 offset:14024
buffer_load_dwordx4 v54, s[16:19], s36 offen offset:1024 lds
v_mfma_f32_16x16x32_bf16 v[96:99], a[240:243], v[144:147], 0
s_waitcnt lgkmcnt(12)
ds_read_b64_tr_b16 a[232:233], v17 offset:12480
ds_read_b64_tr_b16 a[234:235], v17 offset:14016
buffer_load_dwordx4 v55, s[16:19], s36 offen offset:2048 lds
v_mfma_f32_16x16x32_bf16 v[104:107], a[244:247], v[144:147], 0
s_addk_i32 m0, 3080
s_add_u32 s36, s34, 1769472
buffer_load_dwordx4 v53, s[16:19], s36 offen lds
ds_read_b64_tr_b16 a[236:237], v17 offset:12488
ds_read_b64_tr_b16 a[238:239], v17 offset:14024
buffer_load_dwordx4 v54, s[16:19], s36 offen offset:1024 lds
v_mfma_f32_16x16x32_bf16 v[112:115], a[248:251], v[144:147], 0
ds_read_b64_tr_b16 a[240:241], v16 offset:12608
ds_read_b64_tr_b16 a[242:243], v16 offset:14144
buffer_load_dwordx4 v55, s[16:19], s36 offen offset:2048 lds
v_mfma_f32_16x16x32_bf16 v[120:123], a[252:255], v[144:147], 0
s_waitcnt lgkmcnt(12)
s_addk_i32 m0, 3096
s_add_u32 s36, s34, 1867776
buffer_load_dwordx4 v53, s[16:19], s36 offen lds
ds_read_b64_tr_b16 a[244:245], v16 offset:12616
ds_read_b64_tr_b16 a[246:247], v16 offset:14152
buffer_load_dwordx4 v54, s[16:19], s36 offen offset:1024 lds
v_mfma_f32_16x16x32_bf16 v[32:35], a[208:211], v[152:155], v[32:35]
ds_read_b64_tr_b16 a[248:249], v17 offset:12608
ds_read_b64_tr_b16 a[250:251], v17 offset:14144
buffer_load_dwordx4 v55, s[16:19], s36 offen offset:2048 lds
v_accvgpr_write_b32 a160, v192
v_accvgpr_write_b32 a161, v193
v_accvgpr_write_b32 a162, v194
v_accvgpr_write_b32 a163, v195
v_mfma_f32_16x16x32_bf16 v[40:43], a[212:215], v[152:155], v[40:43]
s_add_u32 m0, s92, 0
s_add_u32 s37, s37, 128
buffer_load_dwordx4 v1, s[4:7], s37 offen lds
ds_read_b64_tr_b16 a[252:253], v17 offset:12616
ds_read_b64_tr_b16 a[254:255], v17 offset:14152
v_accvgpr_write_b32 a168, v200
v_accvgpr_write_b32 a169, v201
v_accvgpr_write_b32 a170, v202
v_mfma_f32_16x16x32_bf16 v[48:51], a[216:219], v[152:155], v[48:51]
s_waitcnt lgkmcnt(12)
buffer_load_dwordx4 v2, s[4:7], s37 offen offset:1024 lds
v_accvgpr_write_b32 a171, v203
v_accvgpr_write_b32 a176, v208
v_accvgpr_write_b32 a177, v209
v_accvgpr_write_b32 a178, v210
v_accvgpr_write_b32 a179, v211
v_accvgpr_write_b32 a184, v216
v_mfma_f32_16x16x32_bf16 v[56:59], a[220:223], v[152:155], v[56:59]
s_waitcnt vmcnt(54)
s_cmp_lg_u32 s28, 0
s_cbranch_scc1 L_cw1_3
s_waitcnt vmcnt(47)
L_cw1_3:
s_barrier
s_mov_b32 m0, 98816
s_add_u32 s36, s34, 1966080
buffer_load_dwordx4 v53, s[16:19], s36 offen lds
ds_read_b64_tr_b16 a[208:209], v16 offset:24704
ds_read_b64_tr_b16 a[210:211], v16 offset:26240
ds_read_b64_tr_b16 a[212:213], v16 offset:24712
v_mfma_f32_16x16x32_bf16 v[64:67], a[224:227], v[152:155], v[64:67]
s_waitcnt vmcnt(15)
ds_read_b64_tr_b16 a[214:215], v16 offset:26248
ds_read_b64_tr_b16 a[216:217], v17 offset:24704
ds_read_b64_tr_b16 a[218:219], v17 offset:26240
ds_read_b128 v[160:163], v24 offset:14336
ds_read_b128 v[168:171], v25 offset:14336
buffer_load_dwordx4 v54, s[16:19], s36 offen offset:1024 lds
v_accvgpr_write_b32 a185, v217
v_mfma_f32_16x16x32_bf16 v[72:75], a[228:231], v[152:155], v[72:75]
s_waitcnt lgkmcnt(14)
ds_read_b64_tr_b16 a[220:221], v17 offset:24712
ds_read_b64_tr_b16 a[222:223], v17 offset:26248
buffer_load_dwordx4 v55, s[16:19], s36 offen offset:2048 lds
v_accvgpr_write_b32 a186, v218
v_accvgpr_write_b32 a187, v219
v_accvgpr_write_b32 a192, v224
v_accvgpr_write_b32 a193, v225
v_mfma_f32_16x16x32_bf16 v[80:83], a[232:235], v[152:155], v[80:83]
ds_read_b64_tr_b16 a[224:225], v16 offset:24832
ds_read_b64_tr_b16 a[226:227], v16 offset:26368
v_accvgpr_write_b32 a194, v226
v_accvgpr_write_b32 a195, v227
v_accvgpr_write_b32 a200, v232
v_accvgpr_write_b32 a201, v233
v_accvgpr_write_b32 a202, v234
v_accvgpr_write_b32 a203, v235
v_mfma_f32_16x16x32_bf16 v[88:91], a[236:239], v[152:155], v[88:91]
s_addk_i32 m0, 3096
s_add_u32 s36, s34, 2064384
buffer_load_dwordx4 v53, s[16:19], s36 offen lds
ds_read_b64_tr_b16 a[228:229], v16 offset:24840
ds_read_b64_tr_b16 a[230:231], v16 offset:26376
v_mfma_f32_16x16x32_bf16 v[96:99], a[240:243], v[152:155], v[96:99]
s_waitcnt lgkmcnt(14)
ds_read_b64_tr_b16 a[232:233], v17 offset:24832
ds_read_b64_tr_b16 a[234:235], v17 offset:26368
buffer_load_dwordx4 v54, s[16:19], s36 offen offset:1024 lds
v_mfma_f32_16x16x32_bf16 v[104:107], a[244:247], v[152:155], v[104:107]
ds_read_b64_tr_b16 a[236:237], v17 offset:24840
ds_read_b64_tr_b16 a[238:239], v17 offset:26376
buffer_load_dwordx4 v55, s[16:19], s36 offen offset:2048 lds
v_mfma_f32_16x16x32_bf16 v[112:115], a[248:251], v[152:155], v[112:115]
ds_read_b64_tr_b16 a[240:241], v16 offset:24960
ds_read_b64_tr_b16 a[242:243], v16 offset:26496
v_mfma_f32_16x16x32_bf16 v[120:123], a[252:255], v[152:155], v[120:123]
s_waitcnt lgkmcnt(12)
s_addk_i32 m0, 3080
s_add_u32 s36, s34, 2162688
buffer_load_dwordx4 v53, s[16:19], s36 offen lds
ds_read_b64_tr_b16 a[244:245], v16 offset:24968
ds_read_b64_tr_b16 a[246:247], v16 offset:26504
v_mfma_f32_16x16x32_bf16 v[32:35], a[208:211], v[160:163], v[32:35]
ds_read_b64_tr_b16 a[248:249], v17 offset:24960
ds_read_b64_tr_b16 a[250:251], v17 offset:26496
buffer_load_dwordx4 v54, s[16:19], s36 offen offset:1024 lds
v_mfma_f32_16x16x32_bf16 v[40:43], a[212:215], v[160:163], v[40:43]
ds_read_b64_tr_b16 a[252:253], v17 offset:24968
ds_read_b64_tr_b16 a[254:255], v17 offset:26504
buffer_load_dwordx4 v55, s[16:19], s36 offen offset:2048 lds
v_mfma_f32_16x16x32_bf16 v[48:51], a[216:219], v[160:163], v[48:51]
s_waitcnt lgkmcnt(12)
v_mfma_f32_16x16x32_bf16 v[56:59], a[220:223], v[160:163], v[56:59]
s_waitcnt vmcnt(51)
s_cmp_lg_u32 s28, 0
s_cbranch_scc1 L_cw1_4
s_waitcnt vmcnt(41)
L_cw1_4:
s_barrier
s_mov_b32 m0, 108088
s_add_u32 s36, s34, 2260992
buffer_load_dwordx4 v53, s[16:19], s36 offen lds
ds_read_b64_tr_b16 a[208:209], v16 offset:37056
ds_read_b64_tr_b16 a[210:211], v16 offset:38592
ds_read_b64_tr_b16 a[212:213], v16 offset:37064
v_mfma_f32_16x16x32_bf16 v[64:67], a[224:227], v[160:163], v[64:67]
ds_read_b64_tr_b16 a[214:215], v16 offset:38600
ds_read_b64_tr_b16 a[216:217], v17 offset:37056
ds_read_b64_tr_b16 a[218:219], v17 offset:38592
buffer_load_dwordx4 v54, s[16:19], s36 offen offset:1024 lds
v_mfma_f32_16x16x32_bf16 v[72:75], a[228:231], v[160:163], v[72:75]
s_waitcnt lgkmcnt(12)
ds_read_b64_tr_b16 a[220:221], v17 offset:37064
ds_read_b64_tr_b16 a[222:223], v17 offset:38600
buffer_load_dwordx4 v55, s[16:19], s36 offen offset:2048 lds
v_mfma_f32_16x16x32_bf16 v[80:83], a[232:235], v[160:163], v[80:83]
ds_read_b64_tr_b16 a[224:225], v16 offset:37184
ds_read_b64_tr_b16 a[226:227], v16 offset:38720
v_mfma_f32_16x16x32_bf16 v[88:91], a[236:239], v[160:163], v[88:91]
s_addk_i32 m0, 3080
s_add_u32 s36, s34, 2359296
buffer_load_dwordx4 v53, s[16:19], s36 offen lds
ds_read_b64_tr_b16 a[228:229], v16 offset:37192
ds_read_b64_tr_b16 a[230:231], v16 offset:38728
v_mfma_f32_16x16x32_bf16 v[96:99], a[240:243], v[160:163], v[96:99]
s_waitcnt lgkmcnt(12)
ds_read_b64_tr_b16 a[232:233], v17 offset:37184
ds_read_b64_tr_b16 a[234:235], v17 offset:38720
buffer_load_dwordx4 v54, s[16:19], s36 offen offset:1024 lds
v_mfma_f32_16x16x32_bf16 v[104:107], a[244:247], v[160:163], v[104:107]
ds_read_b64_tr_b16 a[236:237], v17 offset:37192
ds_read_b64_tr_b16 a[238:239], v17 offset:38728
buffer_load_dwordx4 v55, s[16:19], s36 offen offset:2048 lds
v_mfma_f32_16x16x32_bf16 v[112:115], a[248:251], v[160:163], v[112:115]
ds_read_b64_tr_b16 a[240:241], v16 offset:37312
ds_read_b64_tr_b16 a[242:243], v16 offset:38848
v_mfma_f32_16x16x32_bf16 v[120:123], a[252:255], v[160:163], v[120:123]
s_waitcnt lgkmcnt(12)
s_add_u32 m0, s92, 14336
s_add_u32 s37, s37, 128
buffer_load_dwordx4 v1, s[4:7], s37 offen lds
ds_read_b64_tr_b16 a[244:245], v16 offset:37320
ds_read_b64_tr_b16 a[246:247], v16 offset:38856
v_mfma_f32_16x16x32_bf16 v[32:35], a[208:211], v[168:171], v[32:35]
ds_read_b64_tr_b16 a[248:249], v17 offset:37312
ds_read_b64_tr_b16 a[250:251], v17 offset:38848
buffer_load_dwordx4 v2, s[4:7], s37 offen offset:1024 lds
v_mfma_f32_16x16x32_bf16 v[40:43], a[212:215], v[168:171], v[40:43]
ds_read_b64_tr_b16 a[252:253], v17 offset:37320
ds_read_b64_tr_b16 a[254:255], v17 offset:38856
v_mfma_f32_16x16x32_bf16 v[48:51], a[216:219], v[168:171], v[48:51]
s_waitcnt lgkmcnt(12)
v_mfma_f32_16x16x32_bf16 v[56:59], a[220:223], v[168:171], v[56:59]
s_waitcnt vmcnt(19)
s_barrier
s_mov_b32 m0, 114264
s_add_u32 s36, s34, 2457600
buffer_load_dwordx4 v53, s[16:19], s36 offen lds
ds_read_b64_tr_b16 a[208:209], v16 offset:49408
ds_read_b64_tr_b16 a[210:211], v16 offset:50944
ds_read_b64_tr_b16 a[212:213], v16 offset:49416
v_mfma_f32_16x16x32_bf16 v[64:67], a[224:227], v[168:171], v[64:67]
s_waitcnt vmcnt(18)
ds_read_b64_tr_b16 a[214:215], v16 offset:50952
ds_read_b64_tr_b16 a[216:217], v17 offset:49408
ds_read_b64_tr_b16 a[218:219], v17 offset:50944
ds_read_b128 v[144:147], v24 offset:0
ds_read_b128 v[152:155], v25 offset:0
buffer_load_dwordx4 v54, s[16:19], s36 offen offset:1024 lds
v_mfma_f32_16x16x32_bf16 v[72:75], a[228:231], v[168:171], v[72:75]
s_waitcnt lgkmcnt(14)
ds_read_b64_tr_b16 a[220:221], v17 offset:49416
ds_read_b64_tr_b16 a[222:223], v17 offset:50952
buffer_load_dwordx4 v55, s[16:19], s36 offen offset:2048 lds
v_mfma_f32_16x16x32_bf16 v[80:83], a[232:235], v[168:171], v[80:83]
s_addk_i32 m0, 3080
s_add_u32 s36, s34, 2555904
buffer_load_dwordx4 v53, s[16:19], s36 offen lds
ds_read_b64_tr_b16 a[224:225], v16 offset:49536
ds_read_b64_tr_b16 a[226:227], v16 offset:51072
buffer_load_dwordx4 v54, s[16:19], s36 offen offset:1024 lds
v_mfma_f32_16x16x32_bf16 v[88:91], a[236:239], v[168:171], v[88:91]
ds_read_b64_tr_b16 a[228:229], v16 offset:49544
ds_read_b64_tr_b16 a[230:231], v16 offset:51080
buffer_load_dwordx4 v55, s[16:19], s36 offen offset:2048 lds
v_mfma_f32_16x16x32_bf16 v[96:99], a[240:243], v[168:171], v[96:99]
s_waitcnt lgkmcnt(14)
s_addk_i32 m0, 3096
s_add_u32 s36, s34, 2654208
buffer_load_dwordx4 v53, s[16:19], s36 offen lds
ds_read_b64_tr_b16 a[232:233], v17 offset:49536
ds_read_b64_tr_b16 a[234:235], v17 offset:51072
buffer_load_dwordx4 v54, s[16:19], s36 offen offset:1024 lds
v_mfma_f32_16x16x32_bf16 v[104:107], a[244:247], v[168:171], v[104:107]
ds_read_b64_tr_b16 a[236:237], v17 offset:49544
ds_read_b64_tr_b16 a[238:239], v17 offset:51080
buffer_load_dwordx4 v55, s[16:19], s36 offen offset:2048 lds
v_mfma_f32_16x16x32_bf16 v[112:115], a[248:251], v[168:171], v[112:115]
s_addk_i32 m0, 3080
s_add_u32 s36, s34, 2752512
buffer_load_dwordx4 v53, s[16:19], s36 offen lds
ds_read_b64_tr_b16 a[240:241], v16 offset:49664
ds_read_b64_tr_b16 a[242:243], v16 offset:51200
buffer_load_dwordx4 v54, s[16:19], s36 offen offset:1024 lds
v_mfma_f32_16x16x32_bf16 v[120:123], a[252:255], v[168:171], v[120:123]
s_waitcnt lgkmcnt(12)
ds_read_b64_tr_b16 a[244:245], v16 offset:49672
ds_read_b64_tr_b16 a[246:247], v16 offset:51208
buffer_load_dwordx4 v55, s[16:19], s36 offen offset:2048 lds
v_mfma_f32_16x16x32_bf16 v[32:35], a[208:211], v[144:147], v[32:35]
s_addk_i32 m0, 3096
s_add_u32 s36, s34, 2850816
buffer_load_dwordx4 v53, s[16:19], s36 offen lds
ds_read_b64_tr_b16 a[248:249], v17 offset:49664
ds_read_b64_tr_b16 a[250:251], v17 offset:51200
buffer_load_dwordx4 v54, s[16:19], s36 offen offset:1024 lds
v_mfma_f32_16x16x32_bf16 v[40:43], a[212:215], v[144:147], v[40:43]
ds_read_b64_tr_b16 a[252:253], v17 offset:49672
ds_read_b64_tr_b16 a[254:255], v17 offset:51208
buffer_load_dwordx4 v55, s[16:19], s36 offen offset:2048 lds
v_mfma_f32_16x16x32_bf16 v[48:51], a[216:219], v[144:147], v[48:51]
s_waitcnt lgkmcnt(12)
s_addk_i32 m0, 3080
s_add_u32 s36, s34, 2949120
buffer_load_dwordx4 v53, s[16:19], s36 offen lds
buffer_load_dwordx4 v54, s[16:19], s36 offen offset:1024 lds
buffer_load_dwordx4 v55, s[16:19], s36 offen offset:2048 lds
v_mfma_f32_16x16x32_bf16 v[56:59], a[220:223], v[144:147], v[56:59]
s_waitcnt vmcnt(23)
s_barrier
s_addk_i32 m0, 3096
s_add_u32 s36, s34, 3047424
buffer_load_dwordx4 v53, s[16:19], s36 offen lds
ds_read_b64_tr_b16 a[208:209], v16 offset:0
ds_read_b64_tr_b16 a[210:211], v16 offset:1536
ds_read_b64_tr_b16 a[212:213], v16 offset:8
v_mfma_f32_16x16x32_bf16 v[64:67], a[224:227], v[144:147], v[64:67]
ds_read_b64_tr_b16 a[214:215], v16 offset:1544
ds_read_b64_tr_b16 a[216:217], v17 offset:0
ds_read_b64_tr_b16 a[218:219], v17 offset:1536
buffer_load_dwordx4 v54, s[16:19], s36 offen offset:1024 lds
v_mfma_f32_16x16x32_bf16 v[72:75], a[228:231], v[144:147], v[72:75]
s_waitcnt lgkmcnt(12)
ds_read_b64_tr_b16 a[220:221], v17 offset:8
ds_read_b64_tr_b16 a[222:223], v17 offset:1544
buffer_load_dwordx4 v55, s[16:19], s36 offen offset:2048 lds
v_mfma_f32_16x16x32_bf16 v[80:83], a[232:235], v[144:147], v[80:83]
ds_read_b64_tr_b16 a[224:225], v16 offset:128
ds_read_b64_tr_b16 a[226:227], v16 offset:1664
v_mfma_f32_16x16x32_bf16 v[88:91], a[236:239], v[144:147], v[88:91]
s_addk_i32 m0, 3080
s_add_u32 s36, s34, 3145728
buffer_load_dwordx4 v53, s[16:19], s36 offen lds
ds_read_b64_tr_b16 a[228:229], v16 offset:136
ds_read_b64_tr_b16 a[230:231], v16 offset:1672
v_mfma_f32_16x16x32_bf16 v[96:99], a[240:243], v[144:147], v[96:99]
s_waitcnt lgkmcnt(12)
ds_read_b64_tr_b16 a[232:233], v17 offset:128
ds_read_b64_tr_b16 a[234:235], v17 offset:1664
buffer_load_dwordx4 v54, s[16:19], s36 offen offset:1024 lds
v_mfma_f32_16x16x32_bf16 v[104:107], a[244:247], v[144:147], v[104:107]
ds_read_b64_tr_b16 a[236:237], v17 offset:136
ds_read_b64_tr_b16 a[238:239], v17 offset:1672
buffer_load_dwordx4 v55, s[16:19], s36 offen offset:2048 lds
v_mfma_f32_16x16x32_bf16 v[112:115], a[248:251], v[144:147], v[112:115]
ds_read_b64_tr_b16 a[240:241], v16 offset:256
ds_read_b64_tr_b16 a[242:243], v16 offset:1792
v_mfma_f32_16x16x32_bf16 v[120:123], a[252:255], v[144:147], v[120:123]
s_waitcnt lgkmcnt(12)
s_add_u32 m0, s92, 0
s_add_u32 s37, s37, 128
buffer_load_dwordx4 v1, s[4:7], s37 offen lds
ds_read_b64_tr_b16 a[244:245], v16 offset:264
ds_read_b64_tr_b16 a[246:247], v16 offset:1800
v_mfma_f32_16x16x32_bf16 v[32:35], a[208:211], v[152:155], v[32:35]
ds_read_b64_tr_b16 a[248:249], v17 offset:256
ds_read_b64_tr_b16 a[250:251], v17 offset:1792
buffer_load_dwordx4 v2, s[4:7], s37 offen offset:1024 lds
v_mfma_f32_16x16x32_bf16 v[40:43], a[212:215], v[152:155], v[40:43]
ds_read_b64_tr_b16 a[252:253], v17 offset:264
ds_read_b64_tr_b16 a[254:255], v17 offset:1800
v_mfma_f32_16x16x32_bf16 v[48:51], a[216:219], v[152:155], v[48:51]
s_waitcnt lgkmcnt(12)
v_mfma_f32_16x16x32_bf16 v[56:59], a[220:223], v[152:155], v[56:59]
s_waitcnt vmcnt(17)
s_barrier
s_mov_b32 m0, 138968
s_add_u32 s36, s34, 3244032
buffer_load_dwordx4 v53, s[16:19], s36 offen lds
ds_read_b64_tr_b16 a[208:209], v16 offset:12352
ds_read_b64_tr_b16 a[210:211], v16 offset:13888
ds_read_b64_tr_b16 a[212:213], v16 offset:12360
v_mfma_f32_16x16x32_bf16 v[64:67], a[224:227], v[152:155], v[64:67]
s_waitcnt vmcnt(27)
ds_read_b64_tr_b16 a[214:215], v16 offset:13896
ds_read_b64_tr_b16 a[216:217], v17 offset:12352
ds_read_b64_tr_b16 a[218:219], v17 offset:13888
ds_read_b128 v[160:163], v24 offset:14336
ds_read_b128 v[168:171], v25 offset:14336
buffer_load_dwordx4 v54, s[16:19], s36 offen offset:1024 lds
v_mfma_f32_16x16x32_bf16 v[72:75], a[228:231], v[152:155], v[72:75]
s_waitcnt lgkmcnt(14)
ds_read_b64_tr_b16 a[220:221], v17 offset:12360
ds_read_b64_tr_b16 a[222:223], v17 offset:13896
buffer_load_dwordx4 v55, s[16:19], s36 offen offset:2048 lds
v_mfma_f32_16x16x32_bf16 v[80:83], a[232:235], v[152:155], v[80:83]
s_addk_i32 m0, 3080
s_add_u32 s36, s34, 3342336
buffer_load_dwordx4 v53, s[16:19], s36 offen lds
ds_read_b64_tr_b16 a[224:225], v16 offset:12480
ds_read_b64_tr_b16 a[226:227], v16 offset:14016
buffer_load_dwordx4 v54, s[16:19], s36 offen offset:1024 lds
v_mfma_f32_16x16x32_bf16 v[88:91], a[236:239], v[152:155], v[88:91]
ds_read_b64_tr_b16 a[228:229], v16 offset:12488
ds_read_b64_tr_b16 a[230:231], v16 offset:14024
buffer_load_dwordx4 v55, s[16:19], s36 offen offset:2048 lds
v_mfma_f32_16x16x32_bf16 v[96:99], a[240:243], v[152:155], v[96:99]
s_waitcnt lgkmcnt(14)
s_addk_i32 m0, 3096
s_add_u32 s36, s34, 3440640
buffer_load_dwordx4 v53, s[16:19], s36 offen lds
ds_read_b64_tr_b16 a[232:233], v17 offset:12480
ds_read_b64_tr_b16 a[234:235], v17 offset:14016
buffer_load_dwordx4 v54, s[16:19], s36 offen offset:1024 lds
v_mfma_f32_16x16x32_bf16 v[104:107], a[244:247], v[152:155], v[104:107]
ds_read_b64_tr_b16 a[236:237], v17 offset:12488
ds_read_b64_tr_b16 a[238:239], v17 offset:14024
buffer_load_dwordx4 v55, s[16:19], s36 offen offset:2048 lds
v_mfma_f32_16x16x32_bf16 v[112:115], a[248:251], v[152:155], v[112:115]
s_addk_i32 m0, 3080
s_add_u32 s36, s34, 3538944
buffer_load_dwordx4 v53, s[16:19], s36 offen lds
ds_read_b64_tr_b16 a[240:241], v16 offset:12608
ds_read_b64_tr_b16 a[242:243], v16 offset:14144
v_mfma_f32_16x16x32_bf16 v[120:123], a[252:255], v[152:155], v[120:123]
s_waitcnt lgkmcnt(12)
ds_read_b64_tr_b16 a[244:245], v16 offset:12616
ds_read_b64_tr_b16 a[246:247], v16 offset:14152
buffer_load_dwordx4 v54, s[16:19], s36 offen offset:1024 lds
buffer_load_dwordx4 v55, s[16:19], s36 offen offset:2048 lds
v_mfma_f32_16x16x32_bf16 v[32:35], a[208:211], v[160:163], v[32:35]
s_addk_i32 m0, 3096
s_add_u32 s36, s34, 3637248
buffer_load_dwordx4 v53, s[16:19], s36 offen lds
ds_read_b64_tr_b16 a[248:249], v17 offset:12608
ds_read_b64_tr_b16 a[250:251], v17 offset:14144
v_mfma_f32_16x16x32_bf16 v[40:43], a[212:215], v[160:163], v[40:43]
ds_read_b64_tr_b16 a[252:253], v17 offset:12616
ds_read_b64_tr_b16 a[254:255], v17 offset:14152
buffer_load_dwordx4 v54, s[16:19], s36 offen offset:1024 lds
v_mfma_f32_16x16x32_bf16 v[48:51], a[216:219], v[160:163], v[48:51]
s_waitcnt lgkmcnt(12)
buffer_load_dwordx4 v55, s[16:19], s36 offen offset:2048 lds
v_mfma_f32_16x16x32_bf16 v[56:59], a[220:223], v[160:163], v[56:59]
s_waitcnt vmcnt(20)
s_barrier
s_addk_i32 m0, 3080
s_add_u32 s36, s34, 3735552
buffer_load_dwordx4 v53, s[16:19], s36 offen lds
ds_read_b64_tr_b16 a[208:209], v16 offset:24704
ds_read_b64_tr_b16 a[210:211], v16 offset:26240
ds_read_b64_tr_b16 a[212:213], v16 offset:24712
v_mfma_f32_16x16x32_bf16 v[64:67], a[224:227], v[160:163], v[64:67]
ds_read_b64_tr_b16 a[214:215], v16 offset:26248
ds_read_b64_tr_b16 a[216:217], v17 offset:24704
ds_read_b64_tr_b16 a[218:219], v17 offset:26240
buffer_load_dwordx4 v54, s[16:19], s36 offen offset:1024 lds
v_mfma_f32_16x16x32_bf16 v[72:75], a[228:231], v[160:163], v[72:75]
s_waitcnt lgkmcnt(12)
ds_read_b64_tr_b16 a[220:221], v17 offset:24712
ds_read_b64_tr_b16 a[222:223], v17 offset:26248
buffer_load_dwordx4 v55, s[16:19], s36 offen offset:2048 lds
v_mfma_f32_16x16x32_bf16 v[80:83], a[232:235], v[160:163], v[80:83]
ds_read_b64_tr_b16 a[224:225], v16 offset:24832
ds_read_b64_tr_b16 a[226:227], v16 offset:26368
v_mfma_f32_16x16x32_bf16 v[88:91], a[236:239], v[160:163], v[88:91]
s_addk_i32 m0, 3096
s_add_u32 s36, s34, 3833856
buffer_load_dwordx4 v53, s[16:19], s36 offen lds
ds_read_b64_tr_b16 a[228:229], v16 offset:24840
ds_read_b64_tr_b16 a[230:231], v16 offset:26376
v_mfma_f32_16x16x32_bf16 v[96:99], a[240:243], v[160:163], v[96:99]
s_waitcnt lgkmcnt(12)
ds_read_b64_tr_b16 a[232:233], v17 offset:24832
ds_read_b64_tr_b16 a[234:235], v17 offset:26368
buffer_load_dwordx4 v54, s[16:19], s36 offen offset:1024 lds
v_mfma_f32_16x16x32_bf16 v[104:107], a[244:247], v[160:163], v[104:107]
ds_read_b64_tr_b16 a[236:237], v17 offset:24840
ds_read_b64_tr_b16 a[238:239], v17 offset:26376
buffer_load_dwordx4 v55, s[16:19], s36 offen offset:2048 lds
v_mfma_f32_16x16x32_bf16 v[112:115], a[248:251], v[160:163], v[112:115]
ds_read_b64_tr_b16 a[240:241], v16 offset:24960
ds_read_b64_tr_b16 a[242:243], v16 offset:26496
v_mfma_f32_16x16x32_bf16 v[120:123], a[252:255], v[160:163], v[120:123]
s_waitcnt lgkmcnt(12)
s_cmp_eq_u32 s28, 0
s_cbranch_scc1 L_nfV1_2
s_mov_b32 m0, 45248
s_addk_i32 s33, 4096
buffer_load_dwordx4 v52, s[12:15], s33 offen nt lds
buffer_load_dwordx4 v46, s[12:15], s33 offen offset:1024 nt lds
buffer_load_dwordx4 v47, s[12:15], s33 offen offset:2048 nt lds
buffer_load_dwordx4 v52, s[12:15], s33 offen offset:3072 nt lds
L_nfV1_2:
v_mfma_f32_16x16x32_bf16 v[32:35], a[208:211], v[168:171], v[32:35]
s_add_u32 m0, s92, 14336
s_add_u32 s37, s37, 128
buffer_load_dwordx4 v1, s[4:7], s37 offen lds
ds_read_b64_tr_b16 a[244:245], v16 offset:24968
ds_read_b64_tr_b16 a[246:247], v16 offset:26504
ds_read_b64_tr_b16 a[248:249], v17 offset:24960
ds_read_b64_tr_b16 a[250:251], v17 offset:26496
v_mfma_f32_16x16x32_bf16 v[40:43], a[212:215], v[168:171], v[40:43]
ds_read_b64_tr_b16 a[252:253], v17 offset:24968
ds_read_b64_tr_b16 a[254:255], v17 offset:26504
buffer_load_dwordx4 v2, s[4:7], s37 offen offset:1024 lds
v_mfma_f32_16x16x32_bf16 v[48:51], a[216:219], v[168:171], v[48:51]
s_waitcnt lgkmcnt(12)
v_mfma_f32_16x16x32_bf16 v[56:59], a[220:223], v[168:171], v[56:59]
s_waitcnt vmcnt(14)
s_barrier
s_mov_b32 m0, 98816
s_add_u32 s36, s34, 3932160
buffer_load_dwordx4 v53, s[16:19], s36 offen lds
ds_read_b64_tr_b16 a[208:209], v16 offset:37056
ds_read_b64_tr_b16 a[210:211], v16 offset:38592
ds_read_b64_tr_b16 a[212:213], v16 offset:37064
v_mfma_f32_16x16x32_bf16 v[64:67], a[224:227], v[168:171], v[64:67]
s_waitcnt vmcnt(24)
ds_read_b64_tr_b16 a[214:215], v16 offset:38600
ds_read_b64_tr_b16 a[216:217], v17 offset:37056
ds_read_b64_tr_b16 a[218:219], v17 offset:38592
ds_read_b128 v[144:147], v24 offset:0
ds_read_b128 v[152:155], v25 offset:0
buffer_load_dwordx4 v54, s[16:19], s36 offen offset:1024 lds
v_mfma_f32_16x16x32_bf16 v[72:75], a[228:231], v[168:171], v[72:75]
s_waitcnt lgkmcnt(14)
ds_read_b64_tr_b16 a[220:221], v17 offset:37064
ds_read_b64_tr_b16 a[222:223], v17 offset:38600
buffer_load_dwordx4 v55, s[16:19], s36 offen offset:2048 lds
v_mfma_f32_16x16x32_bf16 v[80:83], a[232:235], v[168:171], v[80:83]
s_addk_i32 m0, 3096
s_add_u32 s36, s34, 4030464
buffer_load_dwordx4 v53, s[16:19], s36 offen lds
ds_read_b64_tr_b16 a[224:225], v16 offset:37184
ds_read_b64_tr_b16 a[226:227], v16 offset:38720
buffer_load_dwordx4 v54, s[16:19], s36 offen offset:1024 lds
v_mfma_f32_16x16x32_bf16 v[88:91], a[236:239], v[168:171], v[88:91]
ds_read_b64_tr_b16 a[228:229], v16 offset:37192
ds_read_b64_tr_b16 a[230:231], v16 offset:38728
buffer_load_dwordx4 v55, s[16:19], s36 offen offset:2048 lds
v_mfma_f32_16x16x32_bf16 v[96:99], a[240:243], v[168:171], v[96:99]
s_waitcnt lgkmcnt(14)
s_addk_i32 m0, 3080
s_add_u32 s36, s34, 4128768
buffer_load_dwordx4 v53, s[16:19], s36 offen lds
ds_read_b64_tr_b16 a[232:233], v17 offset:37184
ds_read_b64_tr_b16 a[234:235], v17 offset:38720
buffer_load_dwordx4 v54, s[16:19], s36 offen offset:1024 lds
v_mfma_f32_16x16x32_bf16 v[104:107], a[244:247], v[168:171], v[104:107]
ds_read_b64_tr_b16 a[236:237], v17 offset:37192
ds_read_b64_tr_b16 a[238:239], v17 offset:38728
buffer_load_dwordx4 v55, s[16:19], s36 offen offset:2048 lds
v_mfma_f32_16x16x32_bf16 v[112:115], a[248:251], v[168:171], v[112:115]
s_addk_i32 m0, 3096
s_add_u32 s36, s34, 4227072
buffer_load_dwordx4 v53, s[16:19], s36 offen lds
ds_read_b64_tr_b16 a[240:241], v16 offset:37312
ds_read_b64_tr_b16 a[242:243], v16 offset:38848
buffer_load_dwordx4 v54, s[16:19], s36 offen offset:1024 lds
v_mfma_f32_16x16x32_bf16 v[120:123], a[252:255], v[168:171], v[120:123]
s_waitcnt lgkmcnt(12)
ds_read_b64_tr_b16 a[244:245], v16 offset:37320
ds_read_b64_tr_b16 a[246:247], v16 offset:38856
buffer_load_dwordx4 v55, s[16:19], s36 offen offset:2048 lds
v_mfma_f32_16x16x32_bf16 v[32:35], a[208:211], v[144:147], v[32:35]
s_addk_i32 m0, 3080
s_add_u32 s36, s34, 4325376
buffer_load_dwordx4 v53, s[16:19], s36 offen lds
ds_read_b64_tr_b16 a[248:249], v17 offset:37312
ds_read_b64_tr_b16 a[250:251], v17 offset:38848
buffer_load_dwordx4 v54, s[16:19], s36 offen offset:1024 lds
v_mfma_f32_16x16x32_bf16 v[40:43], a[212:215], v[144:147], v[40:43]
ds_read_b64_tr_b16 a[252:253], v17 offset:37320
ds_read_b64_tr_b16 a[254:255], v17 offset:38856
buffer_load_dwordx4 v55, s[16:19], s36 offen offset:2048 lds
v_mfma_f32_16x16x32_bf16 v[48:51], a[216:219], v[144:147], v[48:51]
s_waitcnt lgkmcnt(12)
s_addk_i32 m0, 3096
s_add_u32 s36, s34, 4423680
buffer_load_dwordx4 v53, s[16:19], s36 offen lds
buffer_load_dwordx4 v54, s[16:19], s36 offen offset:1024 lds
buffer_load_dwordx4 v55, s[16:19], s36 offen offset:2048 lds
s_addk_i32 m0, 3080
s_add_u32 s36, s34, 4521984
buffer_load_dwordx4 v53, s[16:19], s36 offen lds
buffer_load_dwordx4 v54, s[16:19], s36 offen offset:1024 lds
buffer_load_dwordx4 v55, s[16:19], s36 offen offset:2048 lds
s_addk_i32 m0, 3096
s_add_u32 s36, s34, 4620288
buffer_load_dwordx4 v53, s[16:19], s36 offen lds
buffer_load_dwordx4 v54, s[16:19], s36 offen offset:1024 lds
buffer_load_dwordx4 v55, s[16:19], s36 offen offset:2048 lds
v_mfma_f32_16x16x32_bf16 v[56:59], a[220:223], v[144:147], v[56:59]
s_waitcnt vmcnt(26)
s_barrier
s_addk_i32 m0, 3080
s_add_u32 s36, s34, 4718592
buffer_load_dwordx4 v53, s[16:19], s36 offen lds
ds_read_b64_tr_b16 a[208:209], v16 offset:49408
ds_read_b64_tr_b16 a[210:211], v16 offset:50944
ds_read_b64_tr_b16 a[212:213], v16 offset:49416
v_mfma_f32_16x16x32_bf16 v[64:67], a[224:227], v[144:147], v[64:67]
ds_read_b64_tr_b16 a[214:215], v16 offset:50952
ds_read_b64_tr_b16 a[216:217], v17 offset:49408
ds_read_b64_tr_b16 a[218:219], v17 offset:50944
buffer_load_dwordx4 v54, s[16:19], s36 offen offset:1024 lds
buffer_load_dwordx4 v55, s[16:19], s36 offen offset:2048 lds
v_mfma_f32_16x16x32_bf16 v[72:75], a[228:231], v[144:147], v[72:75]
s_waitcnt lgkmcnt(12)
s_addk_i32 m0, 3096
s_add_u32 s36, s34, 4816896
buffer_load_dwordx4 v53, s[16:19], s36 offen lds
ds_read_b64_tr_b16 a[220:221], v17 offset:49416
ds_read_b64_tr_b16 a[222:223], v17 offset:50952
v_mfma_f32_16x16x32_bf16 v[80:83], a[232:235], v[144:147], v[80:83]
ds_read_b64_tr_b16 a[224:225], v16 offset:49536
ds_read_b64_tr_b16 a[226:227], v16 offset:51072
buffer_load_dwordx4 v54, s[16:19], s36 offen offset:1024 lds
v_mfma_f32_16x16x32_bf16 v[88:91], a[236:239], v[144:147], v[88:91]
ds_read_b64_tr_b16 a[228:229], v16 offset:49544
ds_read_b64_tr_b16 a[230:231], v16 offset:51080
buffer_load_dwordx4 v55, s[16:19], s36 offen offset:2048 lds
v_mfma_f32_16x16x32_bf16 v[96:99], a[240:243], v[144:147], v[96:99]
s_waitcnt lgkmcnt(12)
s_addk_i32 m0, 3080
s_add_u32 s36, s34, 4915200
buffer_load_dwordx4 v53, s[16:19], s36 offen lds
ds_read_b64_tr_b16 a[232:233], v17 offset:49536
ds_read_b64_tr_b16 a[234:235], v17 offset:51072
v_mfma_f32_16x16x32_bf16 v[104:107], a[244:247], v[144:147], v[104:107]
ds_read_b64_tr_b16 a[236:237], v17 offset:49544
ds_read_b64_tr_b16 a[238:239], v17 offset:51080
buffer_load_dwordx4 v54, s[16:19], s36 offen offset:1024 lds
buffer_load_dwordx4 v55, s[16:19], s36 offen offset:2048 lds
v_mfma_f32_16x16x32_bf16 v[112:115], a[248:251], v[144:147], v[112:115]
s_addk_i32 m0, 3096
s_add_u32 s36, s34, 5013504
buffer_load_dwordx4 v53, s[16:19], s36 offen lds
ds_read_b64_tr_b16 a[240:241], v16 offset:49664
ds_read_b64_tr_b16 a[242:243], v16 offset:51200
v_mfma_f32_16x16x32_bf16 v[120:123], a[252:255], v[144:147], v[120:123]
s_waitcnt lgkmcnt(12)
ds_read_b64_tr_b16 a[244:245], v16 offset:49672
ds_read_b64_tr_b16 a[246:247], v16 offset:51208
buffer_load_dwordx4 v54, s[16:19], s36 offen offset:1024 lds
v_mfma_f32_16x16x32_bf16 v[32:35], a[208:211], v[152:155], v[32:35]
ds_read_b64_tr_b16 a[248:249], v17 offset:49664
ds_read_b64_tr_b16 a[250:251], v17 offset:51200
buffer_load_dwordx4 v55, s[16:19], s36 offen offset:2048 lds
v_mfma_f32_16x16x32_bf16 v[40:43], a[212:215], v[152:155], v[40:43]
s_add_u32 m0, s92, 0
s_add_u32 s37, s37, 128
buffer_load_dwordx4 v1, s[4:7], s37 offen lds
ds_read_b64_tr_b16 a[252:253], v17 offset:49672
ds_read_b64_tr_b16 a[254:255], v17 offset:51208
v_mfma_f32_16x16x32_bf16 v[48:51], a[216:219], v[152:155], v[48:51]
s_waitcnt lgkmcnt(12)
buffer_load_dwordx4 v2, s[4:7], s37 offen offset:1024 lds
v_mfma_f32_16x16x32_bf16 v[56:59], a[220:223], v[152:155], v[56:59]
s_waitcnt vmcnt(26)
s_barrier
s_cmp_eq_u32 s28, 0
s_cbranch_scc1 L_first10
L_first10r:
ds_read_b64_tr_b16 a[208:209], v16 offset:0
ds_read_b64_tr_b16 a[210:211], v16 offset:1536
ds_read_b64_tr_b16 a[212:213], v16 offset:8
ds_read_b64_tr_b16 a[214:215], v16 offset:1544
v_mfma_f32_16x16x32_bf16 v[64:67], a[224:227], v[152:155], v[64:67]
s_waitcnt vmcnt(38)
s_mov_b32 m0, 135872
s_add_u32 s36, s34, 5111808
buffer_load_dwordx4 v53, s[16:19], s36 offen lds
ds_read_b64_tr_b16 a[216:217], v17 offset:0
ds_read_b64_tr_b16 a[218:219], v17 offset:1536
ds_read_b128 v[160:163], v24 offset:14336
ds_read_b128 v[168:171], v25 offset:14336
v_mfma_f32_16x16x32_bf16 v[72:75], a[228:231], v[152:155], v[72:75]
s_waitcnt lgkmcnt(14)
ds_read_b64_tr_b16 a[220:221], v17 offset:8
ds_read_b64_tr_b16 a[222:223], v17 offset:1544
buffer_load_dwordx4 v54, s[16:19], s36 offen offset:1024 lds
buffer_load_dwordx4 v55, s[16:19], s36 offen offset:2048 lds
v_mfma_f32_16x16x32_bf16 v[80:83], a[232:235], v[152:155], v[80:83]
s_addk_i32 m0, 3096
s_add_u32 s36, s34, 5210112
buffer_load_dwordx4 v53, s[16:19], s36 offen lds
ds_read_b64_tr_b16 a[224:225], v16 offset:128
ds_read_b64_tr_b16 a[226:227], v16 offset:1664
v_mfma_f32_16x16x32_bf16 v[88:91], a[236:239], v[152:155], v[88:91]
ds_read_b64_tr_b16 a[228:229], v16 offset:136
ds_read_b64_tr_b16 a[230:231], v16 offset:1672
buffer_load_dwordx4 v54, s[16:19], s36 offen offset:1024 lds
v_mfma_f32_16x16x32_bf16 v[96:99], a[240:243], v[152:155], v[96:99]
s_waitcnt lgkmcnt(14)
ds_read_b64_tr_b16 a[232:233], v17 offset:128
ds_read_b64_tr_b16 a[234:235], v17 offset:1664
buffer_load_dwordx4 v55, s[16:19], s36 offen offset:2048 lds
v_mfma_f32_16x16x32_bf16 v[104:107], a[244:247], v[152:155], v[104:107]
s_addk_i32 m0, 3080
s_add_u32 s36, s34, 5308416
buffer_load_dwordx4 v53, s[16:19], s36 offen lds
ds_read_b64_tr_b16 a[236:237], v17 offset:136
ds_read_b64_tr_b16 a[238:239], v17 offset:1672
v_mfma_f32_16x16x32_bf16 v[112:115], a[248:251], v[152:155], v[112:115]
ds_read_b64_tr_b16 a[240:241], v16 offset:256
ds_read_b64_tr_b16 a[242:243], v16 offset:1792
buffer_load_dwordx4 v54, s[16:19], s36 offen offset:1024 lds
v_mfma_f32_16x16x32_bf16 v[120:123], a[252:255], v[152:155], v[120:123]
s_waitcnt lgkmcnt(12)
ds_read_b64_tr_b16 a[244:245], v16 offset:264
ds_read_b64_tr_b16 a[246:247], v16 offset:1800
buffer_load_dwordx4 v55, s[16:19], s36 offen offset:2048 lds
v_mfma_f32_16x16x32_bf16 v[32:35], a[208:211], v[160:163], v[32:35]
s_addk_i32 m0, 3096
s_add_u32 s36, s34, 5406720
buffer_load_dwordx4 v53, s[16:19], s36 offen lds
ds_read_b64_tr_b16 a[248:249], v17 offset:256
ds_read_b64_tr_b16 a[250:251], v17 offset:1792
v_mfma_f32_16x16x32_bf16 v[40:43], a[212:215], v[160:163], v[40:43]
ds_read_b64_tr_b16 a[252:253], v17 offset:264
ds_read_b64_tr_b16 a[254:255], v17 offset:1800
buffer_load_dwordx4 v54, s[16:19], s36 offen offset:1024 lds
v_mfma_f32_16x16x32_bf16 v[48:51], a[216:219], v[160:163], v[48:51]
s_waitcnt lgkmcnt(12)
buffer_load_dwordx4 v55, s[16:19], s36 offen offset:2048 lds
v_mfma_f32_16x16x32_bf16 v[56:59], a[220:223], v[160:163], v[56:59]
s_waitcnt vmcnt(26)
s_barrier
s_addk_i32 m0, 3080
s_add_u32 s36, s34, 5505024
buffer_load_dwordx4 v53, s[16:19], s36 offen lds
ds_read_b64_tr_b16 a[208:209], v16 offset:12352
ds_read_b64_tr_b16 a[210:211], v16 offset:13888
ds_read_b64_tr_b16 a[212:213], v16 offset:12360
v_mfma_f32_16x16x32_bf16 v[64:67], a[224:227], v[160:163], v[64:67]
ds_read_b64_tr_b16 a[214:215], v16 offset:13896
ds_read_b64_tr_b16 a[216:217], v17 offset:12352
ds_read_b64_tr_b16 a[218:219], v17 offset:13888
buffer_load_dwordx4 v54, s[16:19], s36 offen offset:1024 lds
v_mfma_f32_16x16x32_bf16 v[72:75], a[228:231], v[160:163], v[72:75]
s_waitcnt lgkmcnt(12)
ds_read_b64_tr_b16 a[220:221], v17 offset:12360
ds_read_b64_tr_b16 a[222:223], v17 offset:13896
buffer_load_dwordx4 v55, s[16:19], s36 offen offset:2048 lds
v_mfma_f32_16x16x32_bf16 v[80:83], a[232:235], v[160:163], v[80:83]
ds_read_b64_tr_b16 a[224:225], v16 offset:12480
ds_read_b64_tr_b16 a[226:227], v16 offset:14016
v_mfma_f32_16x16x32_bf16 v[88:91], a[236:239], v[160:163], v[88:91]
s_addk_i32 m0, 3096
s_add_u32 s36, s34, 5603328
buffer_load_dwordx4 v53, s[16:19], s36 offen lds
ds_read_b64_tr_b16 a[228:229], v16 offset:12488
ds_read_b64_tr_b16 a[230:231], v16 offset:14024
v_mfma_f32_16x16x32_bf16 v[96:99], a[240:243], v[160:163], v[96:99]
s_waitcnt lgkmcnt(12)
ds_read_b64_tr_b16 a[232:233], v17 offset:12480
ds_read_b64_tr_b16 a[234:235], v17 offset:14016
buffer_load_dwordx4 v54, s[16:19], s36 offen offset:1024 lds
v_mfma_f32_16x16x32_bf16 v[104:107], a[244:247], v[160:163], v[104:107]
ds_read_b64_tr_b16 a[236:237], v17 offset:12488
ds_read_b64_tr_b16 a[238:239], v17 offset:14024
buffer_load_dwordx4 v55, s[16:19], s36 offen offset:2048 lds
v_mfma_f32_16x16x32_bf16 v[112:115], a[248:251], v[160:163], v[112:115]
ds_read_b64_tr_b16 a[240:241], v16 offset:12608
ds_read_b64_tr_b16 a[242:243], v16 offset:14144
v_mfma_f32_16x16x32_bf16 v[120:123], a[252:255], v[160:163], v[120:123]
s_waitcnt lgkmcnt(12)
s_add_u32 m0, s92, 14336
s_add_u32 s37, s37, 128
buffer_load_dwordx4 v1, s[4:7], s37 offen lds
ds_read_b64_tr_b16 a[244:245], v16 offset:12616
ds_read_b64_tr_b16 a[246:247], v16 offset:14152
v_mfma_f32_16x16x32_bf16 v[32:35], a[208:211], v[168:171], v[32:35]
ds_read_b64_tr_b16 a[248:249], v17 offset:12608
ds_read_b64_tr_b16 a[250:251], v17 offset:14144
buffer_load_dwordx4 v2, s[4:7], s37 offen offset:1024 lds
v_mfma_f32_16x16x32_bf16 v[40:43], a[212:215], v[168:171], v[40:43]
ds_read_b64_tr_b16 a[252:253], v17 offset:12616
ds_read_b64_tr_b16 a[254:255], v17 offset:14152
v_mfma_f32_16x16x32_bf16 v[48:51], a[216:219], v[168:171], v[48:51]
s_waitcnt lgkmcnt(12)
v_mfma_f32_16x16x32_bf16 v[56:59], a[220:223], v[168:171], v[56:59]
s_waitcnt vmcnt(22)
s_barrier
s_mov_b32 m0, 154400
s_add_u32 s36, s34, 5701632
buffer_load_dwordx4 v53, s[16:19], s36 offen lds
ds_read_b64_tr_b16 a[208:209], v16 offset:24704
ds_read_b64_tr_b16 a[210:211], v16 offset:26240
ds_read_b64_tr_b16 a[212:213], v16 offset:24712
v_mfma_f32_16x16x32_bf16 v[64:67], a[224:227], v[168:171], v[64:67]
s_waitcnt vmcnt(21)
ds_read_b64_tr_b16 a[214:215], v16 offset:26248
ds_read_b64_tr_b16 a[216:217], v17 offset:24704
ds_read_b64_tr_b16 a[218:219], v17 offset:26240
ds_read_b128 v[144:147], v24 offset:0
ds_read_b128 v[152:155], v25 offset:0
buffer_load_dwordx4 v54, s[16:19], s36 offen offset:1024 lds
v_mfma_f32_16x16x32_bf16 v[72:75], a[228:231], v[168:171], v[72:75]
s_waitcnt lgkmcnt(14)
ds_read_b64_tr_b16 a[220:221], v17 offset:24712
ds_read_b64_tr_b16 a[222:223], v17 offset:26248
buffer_load_dwordx4 v55, s[16:19], s36 offen offset:2048 lds
v_mfma_f32_16x16x32_bf16 v[80:83], a[232:235], v[168:171], v[80:83]
s_addk_i32 m0, 3096
s_add_u32 s36, s34, 5799936
buffer_load_dwordx4 v53, s[16:19], s36 offen lds
ds_read_b64_tr_b16 a[224:225], v16 offset:24832
ds_read_b64_tr_b16 a[226:227], v16 offset:26368
buffer_load_dwordx4 v54, s[16:19], s36 offen offset:1024 lds
v_mfma_f32_16x16x32_bf16 v[88:91], a[236:239], v[168:171], v[88:91]
ds_read_b64_tr_b16 a[228:229], v16 offset:24840
ds_read_b64_tr_b16 a[230:231], v16 offset:26376
buffer_load_dwordx4 v55, s[16:19], s36 offen offset:2048 lds
v_mfma_f32_16x16x32_bf16 v[96:99], a[240:243], v[168:171], v[96:99]
s_waitcnt lgkmcnt(14)
s_mov_b32 m0, 98816
s_add_u32 s36, s34, 5898240
buffer_load_dwordx4 v53, s[16:19], s36 offen lds
ds_read_b64_tr_b16 a[232:233], v17 offset:24832
ds_read_b64_tr_b16 a[234:235], v17 offset:26368
buffer_load_dwordx4 v54, s[16:19], s36 offen offset:1024 lds
v_mfma_f32_16x16x32_bf16 v[104:107], a[244:247], v[168:171], v[104:107]
ds_read_b64_tr_b16 a[236:237], v17 offset:24840
ds_read_b64_tr_b16 a[238:239], v17 offset:26376
buffer_load_dwordx4 v55, s[16:19], s36 offen offset:2048 lds
v_mfma_f32_16x16x32_bf16 v[112:115], a[248:251], v[168:171], v[112:115]
s_addk_i32 m0, 3096
s_add_u32 s36, s34, 5996544
buffer_load_dwordx4 v53, s[16:19], s36 offen lds
ds_read_b64_tr_b16 a[240:241], v16 offset:24960
ds_read_b64_tr_b16 a[242:243], v16 offset:26496
v_mfma_f32_16x16x32_bf16 v[120:123], a[252:255], v[168:171], v[120:123]
s_waitcnt lgkmcnt(12)
ds_read_b64_tr_b16 a[244:245], v16 offset:24968
ds_read_b64_tr_b16 a[246:247], v16 offset:26504
buffer_load_dwordx4 v54, s[16:19], s36 offen offset:1024 lds
buffer_load_dwordx4 v55, s[16:19], s36 offen offset:2048 lds
v_mfma_f32_16x16x32_bf16 v[32:35], a[208:211], v[144:147], v[32:35]
s_addk_i32 m0, 3080
s_add_u32 s36, s34, 6094848
buffer_load_dwordx4 v53, s[16:19], s36 offen lds
ds_read_b64_tr_b16 a[248:249], v17 offset:24960
ds_read_b64_tr_b16 a[250:251], v17 offset:26496
v_mfma_f32_16x16x32_bf16 v[40:43], a[212:215], v[144:147], v[40:43]
ds_read_b64_tr_b16 a[252:253], v17 offset:24968
ds_read_b64_tr_b16 a[254:255], v17 offset:26504
buffer_load_dwordx4 v54, s[16:19], s36 offen offset:1024 lds
v_mfma_f32_16x16x32_bf16 v[48:51], a[216:219], v[144:147], v[48:51]
s_waitcnt lgkmcnt(12)
buffer_load_dwordx4 v55, s[16:19], s36 offen offset:2048 lds
v_mfma_f32_16x16x32_bf16 v[56:59], a[220:223], v[144:147], v[56:59]
s_waitcnt vmcnt(23)
s_barrier
s_addk_i32 m0, 3096
s_add_u32 s36, s34, 6193152
buffer_load_dwordx4 v53, s[16:19], s36 offen lds
ds_read_b64_tr_b16 a[208:209], v16 offset:37056
ds_read_b64_tr_b16 a[210:211], v16 offset:38592
ds_read_b64_tr_b16 a[212:213], v16 offset:37064
v_mfma_f32_16x16x32_bf16 v[64:67], a[224:227], v[144:147], v[64:67]
ds_read_b64_tr_b16 a[214:215], v16 offset:38600
ds_read_b64_tr_b16 a[216:217], v17 offset:37056
ds_read_b64_tr_b16 a[218:219], v17 offset:38592
buffer_load_dwordx4 v54, s[16:19], s36 offen offset:1024 lds
v_mfma_f32_16x16x32_bf16 v[72:75], a[228:231], v[144:147], v[72:75]
s_waitcnt lgkmcnt(12)
ds_read_b64_tr_b16 a[220:221], v17 offset:37064
ds_read_b64_tr_b16 a[222:223], v17 offset:38600
buffer_load_dwordx4 v55, s[16:19], s36 offen offset:2048 lds
v_mfma_f32_16x16x32_bf16 v[80:83], a[232:235], v[144:147], v[80:83]
ds_read_b64_tr_b16 a[224:225], v16 offset:37184
ds_read_b64_tr_b16 a[226:227], v16 offset:38720
v_mfma_f32_16x16x32_bf16 v[88:91], a[236:239], v[144:147], v[88:91]
s_addk_i32 m0, 3080
s_add_u32 s36, s34, 6291456
buffer_load_dwordx4 v53, s[16:19], s36 offen lds
ds_read_b64_tr_b16 a[228:229], v16 offset:37192
ds_read_b64_tr_b16 a[230:231], v16 offset:38728
v_mfma_f32_16x16x32_bf16 v[96:99], a[240:243], v[144:147], v[96:99]
s_waitcnt lgkmcnt(12)
ds_read_b64_tr_b16 a[232:233], v17 offset:37184
ds_read_b64_tr_b16 a[234:235], v17 offset:38720
buffer_load_dwordx4 v54, s[16:19], s36 offen offset:1024 lds
v_mfma_f32_16x16x32_bf16 v[104:107], a[244:247], v[144:147], v[104:107]
ds_read_b64_tr_b16 a[236:237], v17 offset:37192
ds_read_b64_tr_b16 a[238:239], v17 offset:38728
buffer_load_dwordx4 v55, s[16:19], s36 offen offset:2048 lds
v_mfma_f32_16x16x32_bf16 v[112:115], a[248:251], v[144:147], v[112:115]
ds_read_b64_tr_b16 a[240:241], v16 offset:37312
ds_read_b64_tr_b16 a[242:243], v16 offset:38848
v_mfma_f32_16x16x32_bf16 v[120:123], a[252:255], v[144:147], v[120:123]
s_waitcnt lgkmcnt(12)
s_add_u32 m0, s92, 0
s_add_u32 s37, s37, 128
buffer_load_dwordx4 v1, s[4:7], s37 offen lds
ds_read_b64_tr_b16 a[244:245], v16 offset:37320
ds_read_b64_tr_b16 a[246:247], v16 offset:38856
v_mfma_f32_16x16x32_bf16 v[32:35], a[208:211], v[152:155], v[32:35]
ds_read_b64_tr_b16 a[248:249], v17 offset:37312
ds_read_b64_tr_b16 a[250:251], v17 offset:38848
buffer_load_dwordx4 v2, s[4:7], s37 offen offset:1024 lds
v_mfma_f32_16x16x32_bf16 v[40:43], a[212:215], v[152:155], v[40:43]
ds_read_b64_tr_b16 a[252:253], v17 offset:37320
ds_read_b64_tr_b16 a[254:255], v17 offset:38856
v_mfma_f32_16x16x32_bf16 v[48:51], a[216:219], v[152:155], v[48:51]
s_waitcnt lgkmcnt(12)
v_mfma_f32_16x16x32_bf16 v[56:59], a[220:223], v[152:155], v[56:59]
s_waitcnt vmcnt(17)
s_barrier
s_mov_b32 m0, 114264
s_add_u32 s36, s34, 6389760
buffer_load_dwordx4 v53, s[16:19], s36 offen lds
ds_read_b64_tr_b16 a[208:209], v16 offset:49408
ds_read_b64_tr_b16 a[210:211], v16 offset:50944
ds_read_b64_tr_b16 a[212:213], v16 offset:49416
v_mfma_f32_16x16x32_bf16 v[64:67], a[224:227], v[152:155], v[64:67]
s_waitcnt vmcnt(24)
ds_read_b64_tr_b16 a[214:215], v16 offset:50952
ds_read_b64_tr_b16 a[216:217], v17 offset:49408
ds_read_b64_tr_b16 a[218:219], v17 offset:50944
ds_read_b128 v[160:163], v24 offset:14336
ds_read_b128 v[168:171], v25 offset:14336
buffer_load_dwordx4 v54, s[16:19], s36 offen offset:1024 lds
v_mfma_f32_16x16x32_bf16 v[72:75], a[228:231], v[152:155], v[72:75]
s_waitcnt lgkmcnt(14)
ds_read_b64_tr_b16 a[220:221], v17 offset:49416
ds_read_b64_tr_b16 a[222:223], v17 offset:50952
buffer_load_dwordx4 v55, s[16:19], s36 offen offset:2048 lds
v_mfma_f32_16x16x32_bf16 v[80:83], a[232:235], v[152:155], v[80:83]
s_addk_i32 m0, 3080
s_add_u32 s36, s34, 6488064
buffer_load_dwordx4 v53, s[16:19], s36 offen lds
ds_read_b64_tr_b16 a[224:225], v16 offset:49536
ds_read_b64_tr_b16 a[226:227], v16 offset:51072
buffer_load_dwordx4 v54, s[16:19], s36 offen offset:1024 lds
v_mfma_f32_16x16x32_bf16 v[88:91], a[236:239], v[152:155], v[88:91]
ds_read_b64_tr_b16 a[228:229], v16 offset:49544
ds_read_b64_tr_b16 a[230:231], v16 offset:51080
buffer_load_dwordx4 v55, s[16:19], s36 offen offset:2048 lds
v_mfma_f32_16x16x32_bf16 v[96:99], a[240:243], v[152:155], v[96:99]
s_waitcnt lgkmcnt(14)
s_addk_i32 m0, 3096
s_add_u32 s36, s34, 6586368
buffer_load_dwordx4 v53, s[16:19], s36 offen lds
ds_read_b64_tr_b16 a[232:233], v17 offset:49536
ds_read_b64_tr_b16 a[234:235], v17 offset:51072
buffer_load_dwordx4 v54, s[16:19], s36 offen offset:1024 lds
v_mfma_f32_16x16x32_bf16 v[104:107], a[244:247], v[152:155], v[104:107]
ds_read_b64_tr_b16 a[236:237], v17 offset:49544
ds_read_b64_tr_b16 a[238:239], v17 offset:51080
buffer_load_dwordx4 v55, s[16:19], s36 offen offset:2048 lds
v_mfma_f32_16x16x32_bf16 v[112:115], a[248:251], v[152:155], v[112:115]
s_addk_i32 m0, 3080
s_add_u32 s36, s34, 6684672
buffer_load_dwordx4 v53, s[16:19], s36 offen lds
ds_read_b64_tr_b16 a[240:241], v16 offset:49664
ds_read_b64_tr_b16 a[242:243], v16 offset:51200
buffer_load_dwordx4 v54, s[16:19], s36 offen offset:1024 lds
v_mfma_f32_16x16x32_bf16 v[120:123], a[252:255], v[152:155], v[120:123]
s_waitcnt lgkmcnt(12)
ds_read_b64_tr_b16 a[244:245], v16 offset:49672
ds_read_b64_tr_b16 a[246:247], v16 offset:51208
buffer_load_dwordx4 v55, s[16:19], s36 offen offset:2048 lds
v_mfma_f32_16x16x32_bf16 v[32:35], a[208:211], v[160:163], v[32:35]
s_addk_i32 m0, 3096
s_add_u32 s36, s34, 6782976
buffer_load_dwordx4 v53, s[16:19], s36 offen lds
ds_read_b64_tr_b16 a[248:249], v17 offset:49664
ds_read_b64_tr_b16 a[250:251], v17 offset:51200
buffer_load_dwordx4 v54, s[16:19], s36 offen offset:1024 lds
v_mfma_f32_16x16x32_bf16 v[40:43], a[212:215], v[160:163], v[40:43]
ds_read_b64_tr_b16 a[252:253], v17 offset:49672
ds_read_b64_tr_b16 a[254:255], v17 offset:51208
buffer_load_dwordx4 v55, s[16:19], s36 offen offset:2048 lds
v_mfma_f32_16x16x32_bf16 v[48:51], a[216:219], v[160:163], v[48:51]
s_waitcnt lgkmcnt(12)
s_addk_i32 m0, 3080
s_add_u32 s36, s34, 6881280
buffer_load_dwordx4 v53, s[16:19], s36 offen lds
buffer_load_dwordx4 v54, s[16:19], s36 offen offset:1024 lds
buffer_load_dwordx4 v55, s[16:19], s36 offen offset:2048 lds
v_mfma_f32_16x16x32_bf16 v[56:59], a[220:223], v[160:163], v[56:59]
s_waitcnt vmcnt(23)
s_barrier
s_addk_i32 m0, 3096
s_add_u32 s36, s34, 6979584
buffer_load_dwordx4 v53, s[16:19], s36 offen lds
ds_read_b64_tr_b16 a[208:209], v16 offset:0
ds_read_b64_tr_b16 a[210:211], v16 offset:1536
ds_read_b64_tr_b16 a[212:213], v16 offset:8
v_mfma_f32_16x16x32_bf16 v[64:67], a[224:227], v[160:163], v[64:67]
ds_read_b64_tr_b16 a[214:215], v16 offset:1544
ds_read_b64_tr_b16 a[216:217], v17 offset:0
ds_read_b64_tr_b16 a[218:219], v17 offset:1536
buffer_load_dwordx4 v54, s[16:19], s36 offen offset:1024 lds
v_mfma_f32_16x16x32_bf16 v[72:75], a[228:231], v[160:163], v[72:75]
s_waitcnt lgkmcnt(12)
ds_read_b64_tr_b16 a[220:221], v17 offset:8
ds_read_b64_tr_b16 a[222:223], v17 offset:1544
buffer_load_dwordx4 v55, s[16:19], s36 offen offset:2048 lds
v_mfma_f32_16x16x32_bf16 v[80:83], a[232:235], v[160:163], v[80:83]
ds_read_b64_tr_b16 a[224:225], v16 offset:128
ds_read_b64_tr_b16 a[226:227], v16 offset:1664
v_mfma_f32_16x16x32_bf16 v[88:91], a[236:239], v[160:163], v[88:91]
s_addk_i32 m0, 3080
s_add_u32 s36, s34, 7077888
buffer_load_dwordx4 v53, s[16:19], s36 offen lds
ds_read_b64_tr_b16 a[228:229], v16 offset:136
ds_read_b64_tr_b16 a[230:231], v16 offset:1672
v_mfma_f32_16x16x32_bf16 v[96:99], a[240:243], v[160:163], v[96:99]
s_waitcnt lgkmcnt(12)
ds_read_b64_tr_b16 a[232:233], v17 offset:128
ds_read_b64_tr_b16 a[234:235], v17 offset:1664
buffer_load_dwordx4 v54, s[16:19], s36 offen offset:1024 lds
v_mfma_f32_16x16x32_bf16 v[104:107], a[244:247], v[160:163], v[104:107]
ds_read_b64_tr_b16 a[236:237], v17 offset:136
ds_read_b64_tr_b16 a[238:239], v17 offset:1672
buffer_load_dwordx4 v55, s[16:19], s36 offen offset:2048 lds
v_mfma_f32_16x16x32_bf16 v[112:115], a[248:251], v[160:163], v[112:115]
ds_read_b64_tr_b16 a[240:241], v16 offset:256
ds_read_b64_tr_b16 a[242:243], v16 offset:1792
v_mfma_f32_16x16x32_bf16 v[120:123], a[252:255], v[160:163], v[120:123]
s_waitcnt lgkmcnt(12)
s_add_u32 m0, s92, 14336
s_add_u32 s37, s37, 128
buffer_load_dwordx4 v1, s[4:7], s37 offen lds
ds_read_b64_tr_b16 a[244:245], v16 offset:264
ds_read_b64_tr_b16 a[246:247], v16 offset:1800
v_mfma_f32_16x16x32_bf16 v[32:35], a[208:211], v[168:171], v[32:35]
ds_read_b64_tr_b16 a[248:249], v17 offset:256
ds_read_b64_tr_b16 a[250:251], v17 offset:1792
buffer_load_dwordx4 v2, s[4:7], s37 offen offset:1024 lds
v_mfma_f32_16x16x32_bf16 v[40:43], a[212:215], v[168:171], v[40:43]
ds_read_b64_tr_b16 a[252:253], v17 offset:264
ds_read_b64_tr_b16 a[254:255], v17 offset:1800
v_mfma_f32_16x16x32_bf16 v[48:51], a[216:219], v[168:171], v[48:51]
s_waitcnt lgkmcnt(12)
v_mfma_f32_16x16x32_bf16 v[56:59], a[220:223], v[168:171], v[56:59]
s_waitcnt vmcnt(17)
s_barrier
s_cmp_eq_u32 s28, 0
s_cbranch_scc1 L_first16
L_first16r:
ds_read_b64_tr_b16 a[208:209], v16 offset:12352
ds_read_b64_tr_b16 a[210:211], v16 offset:13888
ds_read_b64_tr_b16 a[212:213], v16 offset:12360
ds_read_b64_tr_b16 a[214:215], v16 offset:13896
v_mfma_f32_16x16x32_bf16 v[64:67], a[224:227], v[168:171], v[64:67]
s_waitcnt vmcnt(26)
s_mov_b32 m0, 138968
s_add_u32 s36, s34, 7176192
buffer_load_dwordx4 v53, s[16:19], s36 offen lds
ds_read_b64_tr_b16 a[216:217], v17 offset:12352
ds_read_b64_tr_b16 a[218:219], v17 offset:13888
ds_read_b128 v[144:147], v24 offset:0
ds_read_b128 v[152:155], v25 offset:0
v_mfma_f32_16x16x32_bf16 v[72:75], a[228:231], v[168:171], v[72:75]
s_waitcnt lgkmcnt(14)
ds_read_b64_tr_b16 a[220:221], v17 offset:12360
ds_read_b64_tr_b16 a[222:223], v17 offset:13896
buffer_load_dwordx4 v54, s[16:19], s36 offen offset:1024 lds
buffer_load_dwordx4 v55, s[16:19], s36 offen offset:2048 lds
v_mfma_f32_16x16x32_bf16 v[80:83], a[232:235], v[168:171], v[80:83]
s_addk_i32 m0, 3080
s_add_u32 s36, s34, 7274496
buffer_load_dwordx4 v53, s[16:19], s36 offen lds
ds_read_b64_tr_b16 a[224:225], v16 offset:12480
ds_read_b64_tr_b16 a[226:227], v16 offset:14016
buffer_load_dwordx4 v54, s[16:19], s36 offen offset:1024 lds
v_mfma_f32_16x16x32_bf16 v[88:91], a[236:239], v[168:171], v[88:91]
ds_read_b64_tr_b16 a[228:229], v16 offset:12488
ds_read_b64_tr_b16 a[230:231], v16 offset:14024
buffer_load_dwordx4 v55, s[16:19], s36 offen offset:2048 lds
v_mfma_f32_16x16x32_bf16 v[96:99], a[240:243], v[168:171], v[96:99]
s_waitcnt lgkmcnt(14)
s_addk_i32 m0, 3096
s_add_u32 s36, s34, 7372800
buffer_load_dwordx4 v53, s[16:19], s36 offen lds
ds_read_b64_tr_b16 a[232:233], v17 offset:12480
ds_read_b64_tr_b16 a[234:235], v17 offset:14016
v_mfma_f32_16x16x32_bf16 v[104:107], a[244:247], v[168:171], v[104:107]
ds_read_b64_tr_b16 a[236:237], v17 offset:12488
ds_read_b64_tr_b16 a[238:239], v17 offset:14024
buffer_load_dwordx4 v54, s[16:19], s36 offen offset:1024 lds
buffer_load_dwordx4 v55, s[16:19], s36 offen offset:2048 lds
v_mfma_f32_16x16x32_bf16 v[112:115], a[248:251], v[168:171], v[112:115]
s_addk_i32 m0, 3080
s_add_u32 s36, s34, 7471104
buffer_load_dwordx4 v53, s[16:19], s36 offen lds
ds_read_b64_tr_b16 a[240:241], v16 offset:12608
ds_read_b64_tr_b16 a[242:243], v16 offset:14144
v_mfma_f32_16x16x32_bf16 v[120:123], a[252:255], v[168:171], v[120:123]
s_waitcnt lgkmcnt(12)
ds_read_b64_tr_b16 a[244:245], v16 offset:12616
ds_read_b64_tr_b16 a[246:247], v16 offset:14152
buffer_load_dwordx4 v54, s[16:19], s36 offen offset:1024 lds
v_mfma_f32_16x16x32_bf16 v[32:35], a[208:211], v[144:147], v[32:35]
ds_read_b64_tr_b16 a[248:249], v17 offset:12608
ds_read_b64_tr_b16 a[250:251], v17 offset:14144
buffer_load_dwordx4 v55, s[16:19], s36 offen offset:2048 lds
v_mfma_f32_16x16x32_bf16 v[40:43], a[212:215], v[144:147], v[40:43]
s_addk_i32 m0, 3096
s_add_u32 s36, s34, 7569408
buffer_load_dwordx4 v53, s[16:19], s36 offen lds
ds_read_b64_tr_b16 a[252:253], v17 offset:12616
ds_read_b64_tr_b16 a[254:255], v17 offset:14152
buffer_load_dwordx4 v54, s[16:19], s36 offen offset:1024 lds
v_mfma_f32_16x16x32_bf16 v[48:51], a[216:219], v[144:147], v[48:51]
s_waitcnt lgkmcnt(12)
buffer_load_dwordx4 v55, s[16:19], s36 offen offset:2048 lds
v_mfma_f32_16x16x32_bf16 v[56:59], a[220:223], v[144:147], v[56:59]
s_waitcnt vmcnt(20)
s_barrier
s_cmp_eq_u32 s28, 0
s_cbranch_scc1 L_first17
L_first17r:
ds_read_b64_tr_b16 a[208:209], v16 offset:24704
ds_read_b64_tr_b16 a[210:211], v16 offset:26240
ds_read_b64_tr_b16 a[212:213], v16 offset:24712
ds_read_b64_tr_b16 a[214:215], v16 offset:26248
v_mfma_f32_16x16x32_bf16 v[64:67], a[224:227], v[144:147], v[64:67]
s_mov_b32 m0, 154400
s_add_u32 s36, s34, 7667712
buffer_load_dwordx4 v53, s[16:19], s36 offen lds
ds_read_b64_tr_b16 a[216:217], v17 offset:24704
ds_read_b64_tr_b16 a[218:219], v17 offset:26240
v_mfma_f32_16x16x32_bf16 v[72:75], a[228:231], v[144:147], v[72:75]
s_waitcnt lgkmcnt(12)
ds_read_b64_tr_b16 a[220:221], v17 offset:24712
ds_read_b64_tr_b16 a[222:223], v17 offset:26248
buffer_load_dwordx4 v54, s[16:19], s36 offen offset:1024 lds
v_mfma_f32_16x16x32_bf16 v[80:83], a[232:235], v[144:147], v[80:83]
ds_read_b64_tr_b16 a[224:225], v16 offset:24832
ds_read_b64_tr_b16 a[226:227], v16 offset:26368
v_mfma_f32_16x16x32_bf16 v[88:91], a[236:239], v[144:147], v[88:91]
ds_read_b64_tr_b16 a[228:229], v16 offset:24840
ds_read_b64_tr_b16 a[230:231], v16 offset:26376
buffer_load_dwordx4 v55, s[16:19], s36 offen offset:2048 lds
v_mfma_f32_16x16x32_bf16 v[96:99], a[240:243], v[144:147], v[96:99]
s_waitcnt lgkmcnt(12)
s_addk_i32 m0, 3096
s_add_u32 s36, s34, 7766016
buffer_load_dwordx4 v53, s[16:19], s36 offen lds
ds_read_b64_tr_b16 a[232:233], v17 offset:24832
ds_read_b64_tr_b16 a[234:235], v17 offset:26368
v_mfma_f32_16x16x32_bf16 v[104:107], a[244:247], v[144:147], v[104:107]
ds_read_b64_tr_b16 a[236:237], v17 offset:24840
ds_read_b64_tr_b16 a[238:239], v17 offset:26376
buffer_load_dwordx4 v54, s[16:19], s36 offen offset:1024 lds
v_mfma_f32_16x16x32_bf16 v[112:115], a[248:251], v[144:147], v[112:115]
ds_read_b64_tr_b16 a[240:241], v16 offset:24960
ds_read_b64_tr_b16 a[242:243], v16 offset:26496
v_mfma_f32_16x16x32_bf16 v[120:123], a[252:255], v[144:147], v[120:123]
s_waitcnt lgkmcnt(12)
ds_read_b64_tr_b16 a[244:245], v16 offset:24968
ds_read_b64_tr_b16 a[246:247], v16 offset:26504
buffer_load_dwordx4 v55, s[16:19], s36 offen offset:2048 lds
v_mfma_f32_16x16x32_bf16 v[32:35], a[208:211], v[152:155], v[32:35]
s_cmp_eq_u32 s28, 0
s_cbranch_scc1 L_nfV2_0
s_mov_b32 m0, 61760
s_addk_i32 s33, 4096
buffer_load_dwordx4 v46, s[12:15], s33 offen nt lds
buffer_load_dwordx4 v47, s[12:15], s33 offen offset:1024 nt lds
buffer_load_dwordx4 v52, s[12:15], s33 offen offset:2048 nt lds
buffer_load_dwordx4 v46, s[12:15], s33 offen offset:3072 nt lds
L_nfV2_0:
v_mfma_f32_16x16x32_bf16 v[40:43], a[212:215], v[152:155], v[40:43]
s_cmp_eq_u32 s28, 0
s_cbranch_scc1 L_nfV2_1
s_mov_b32 m0, 65856
s_addk_i32 s33, 4096
buffer_load_dwordx4 v47, s[12:15], s33 offen nt lds
buffer_load_dwordx4 v52, s[12:15], s33 offen offset:1024 nt lds
buffer_load_dwordx4 v46, s[12:15], s33 offen offset:2048 nt lds
buffer_load_dwordx4 v47, s[12:15], s33 offen offset:3072 nt lds
L_nfV2_1:
ds_read_b64_tr_b16 a[248:249], v17 offset:24960
ds_read_b64_tr_b16 a[250:251], v17 offset:26496
v_mfma_f32_16x16x32_bf16 v[48:51], a[216:219], v[152:155], v[48:51]
s_waitcnt lgkmcnt(10)
ds_read_b64_tr_b16 a[252:253], v17 offset:24968
ds_read_b64_tr_b16 a[254:255], v17 offset:26504
v_mfma_f32_16x16x32_bf16 v[56:59], a[220:223], v[152:155], v[56:59]
s_waitcnt vmcnt(20)
s_barrier
s_cmp_eq_u32 s28, 0
s_cbranch_scc1 L_first18
L_first18r:
ds_read_b64_tr_b16 a[208:209], v16 offset:37056
ds_read_b64_tr_b16 a[210:211], v16 offset:38592
ds_read_b64_tr_b16 a[212:213], v16 offset:37064
ds_read_b64_tr_b16 a[214:215], v16 offset:38600
v_mfma_f32_16x16x32_bf16 v[64:67], a[224:227], v[152:155], v[64:67]
s_waitcnt vmcnt(29)
s_mov_b32 m0, 98816
s_add_u32 s36, s35, 0
buffer_load_dwordx4 v63, s[20:23], s36 offen lds
ds_read_b64_tr_b16 a[216:217], v17 offset:37056
ds_read_b64_tr_b16 a[218:219], v17 offset:38592
ds_read_b128 v[160:163], v24 offset:14336
ds_read_b128 v[168:171], v25 offset:14336
v_mfma_f32_16x16x32_bf16 v[72:75], a[228:231], v[152:155], v[72:75]
s_waitcnt lgkmcnt(14)
ds_read_b64_tr_b16 a[220:221], v17 offset:37064
ds_read_b64_tr_b16 a[222:223], v17 offset:38600
buffer_load_dwordx4 v68, s[20:23], s36 offen offset:1024 lds
v_mfma_f32_16x16x32_bf16 v[80:83], a[232:235], v[152:155], v[80:83]
ds_read_b64_tr_b16 a[224:225], v16 offset:37184
ds_read_b64_tr_b16 a[226:227], v16 offset:38720
v_mfma_f32_16x16x32_bf16 v[88:91], a[236:239], v[152:155], v[88:91]
ds_read_b64_tr_b16 a[228:229], v16 offset:37192
ds_read_b64_tr_b16 a[230:231], v16 offset:38728
buffer_load_dwordx4 v69, s[20:23], s36 offen offset:2048 lds
v_mfma_f32_16x16x32_bf16 v[96:99], a[240:243], v[152:155], v[96:99]
s_waitcnt lgkmcnt(14)
ds_read_b64_tr_b16 a[232:233], v17 offset:37184
ds_read_b64_tr_b16 a[234:235], v17 offset:38720
buffer_load_dwordx4 v70, s[20:23], s36 offen offset:3072 lds
v_mfma_f32_16x16x32_bf16 v[104:107], a[244:247], v[152:155], v[104:107]
s_add_u32 s36, s35, s43
buffer_load_dword v254, v85, s[20:23], s36 offen offset:0
s_add_u32 s36, s36, 7168
buffer_load_dword v254, v85, s[20:23], s36 offen offset:0
ds_read_b64_tr_b16 a[236:237], v17 offset:37192
ds_read_b64_tr_b16 a[238:239], v17 offset:38728
v_mfma_f32_16x16x32_bf16 v[112:115], a[248:251], v[152:155], v[112:115]
ds_read_b64_tr_b16 a[240:241], v16 offset:37312
ds_read_b64_tr_b16 a[242:243], v16 offset:38848
v_mfma_f32_16x16x32_bf16 v[120:123], a[252:255], v[152:155], v[120:123]
s_waitcnt lgkmcnt(12)
ds_read_b64_tr_b16 a[244:245], v16 offset:37320
ds_read_b64_tr_b16 a[246:247], v16 offset:38856
v_mfma_f32_16x16x32_bf16 v[32:35], a[208:211], v[160:163], v[32:35]
ds_read_b64_tr_b16 a[248:249], v17 offset:37312
ds_read_b64_tr_b16 a[250:251], v17 offset:38848
v_mfma_f32_16x16x32_bf16 v[40:43], a[212:215], v[160:163], v[40:43]
ds_read_b64_tr_b16 a[252:253], v17 offset:37320
ds_read_b64_tr_b16 a[254:255], v17 offset:38856
v_mfma_f32_16x16x32_bf16 v[48:51], a[216:219], v[160:163], v[48:51]
s_waitcnt lgkmcnt(12)
v_mfma_f32_16x16x32_bf16 v[56:59], a[220:223], v[160:163], v[56:59]
s_waitcnt vmcnt(14)
s_barrier
s_cmp_eq_u32 s28, 0
s_cbranch_scc1 L_first19
L_first19r:
ds_read_b64_tr_b16 a[208:209], v16 offset:49408
ds_read_b64_tr_b16 a[210:211], v16 offset:50944
ds_read_b64_tr_b16 a[212:213], v16 offset:49416
ds_read_b64_tr_b16 a[214:215], v16 offset:50952
v_mfma_f32_16x16x32_bf16 v[64:67], a[224:227], v[160:163], v[64:67]
s_mov_b32 m0, 102912
s_add_u32 s36, s35, 40960
buffer_load_dwordx4 v63, s[20:23], s36 offen lds
ds_read_b64_tr_b16 a[216:217], v17 offset:49408
ds_read_b64_tr_b16 a[218:219], v17 offset:50944
v_mfma_f32_16x16x32_bf16 v[72:75], a[228:231], v[160:163], v[72:75]
s_waitcnt lgkmcnt(12)
ds_read_b64_tr_b16 a[220:221], v17 offset:49416
ds_read_b64_tr_b16 a[222:223], v17 offset:50952
buffer_load_dwordx4 v68, s[20:23], s36 offen offset:1024 lds
v_mfma_f32_16x16x32_bf16 v[80:83], a[232:235], v[160:163], v[80:83]
ds_read_b64_tr_b16 a[224:225], v16 offset:49536
ds_read_b64_tr_b16 a[226:227], v16 offset:51072
v_mfma_f32_16x16x32_bf16 v[88:91], a[236:239], v[160:163], v[88:91]
ds_read_b64_tr_b16 a[228:229], v16 offset:49544
ds_read_b64_tr_b16 a[230:231], v16 offset:51080
buffer_load_dwordx4 v69, s[20:23], s36 offen offset:2048 lds
v_mfma_f32_16x16x32_bf16 v[96:99], a[240:243], v[160:163], v[96:99]
s_waitcnt lgkmcnt(12)
ds_read_b64_tr_b16 a[232:233], v17 offset:49536
ds_read_b64_tr_b16 a[234:235], v17 offset:51072
buffer_load_dwordx4 v70, s[20:23], s36 offen offset:3072 lds
v_mfma_f32_16x16x32_bf16 v[104:107], a[244:247], v[160:163], v[104:107]
s_cmp_eq_u32 s28, 0
s_cbranch_scc1 L_nfV2_2
s_mov_b32 m0, 69952
s_addk_i32 s33, 4096
buffer_load_dwordx4 v52, s[12:15], s33 offen nt lds
buffer_load_dwordx4 v46, s[12:15], s33 offen offset:1024 nt lds
buffer_load_dwordx4 v47, s[12:15], s33 offen offset:2048 nt lds
buffer_load_dwordx4 v52, s[12:15], s33 offen offset:3072 nt lds
L_nfV2_2:
v_mfma_f32_16x16x32_bf16 v[112:115], a[248:251], v[160:163], v[112:115]
ds_read_b64_tr_b16 a[236:237], v17 offset:49544
ds_read_b64_tr_b16 a[238:239], v17 offset:51080
ds_read_b64_tr_b16 a[240:241], v16 offset:49664
ds_read_b64_tr_b16 a[242:243], v16 offset:51200
v_mfma_f32_16x16x32_bf16 v[120:123], a[252:255], v[160:163], v[120:123]
s_waitcnt lgkmcnt(12)
s_cmp_eq_u32 s28, 0
s_cbranch_scc1 L_nfV3_0
s_mov_b32 m0, 86464
s_addk_i32 s33, 4096
buffer_load_dwordx4 v46, s[12:15], s33 offen nt lds
buffer_load_dwordx4 v47, s[12:15], s33 offen offset:1024 nt lds
buffer_load_dwordx4 v52, s[12:15], s33 offen offset:2048 nt lds
buffer_load_dwordx4 v46, s[12:15], s33 offen offset:3072 nt lds
L_nfV3_0:
v_mfma_f32_16x16x32_bf16 v[32:35], a[208:211], v[168:171], v[32:35]
ds_read_b64_tr_b16 a[244:245], v16 offset:49672
ds_read_b64_tr_b16 a[246:247], v16 offset:51208
ds_read_b64_tr_b16 a[248:249], v17 offset:49664
ds_read_b64_tr_b16 a[250:251], v17 offset:51200
v_mfma_f32_16x16x32_bf16 v[40:43], a[212:215], v[168:171], v[40:43]
ds_read_b64_tr_b16 a[252:253], v17 offset:49672
ds_read_b64_tr_b16 a[254:255], v17 offset:51208
v_mfma_f32_16x16x32_bf16 v[48:51], a[216:219], v[168:171], v[48:51]
s_waitcnt lgkmcnt(12)
v_mul_f32_e32 v32, s40, v32
v_mul_f32_e32 v33, s40, v33
v_cvt_pk_bf16_f32 v192, v32, v33
v_mul_f32_e32 v34, s40, v34
v_mul_f32_e32 v35, s40, v35
v_cvt_pk_bf16_f32 v193, v34, v35
v_mul_f32_e32 v40, s40, v40
v_mul_f32_e32 v41, s40, v41
v_cvt_pk_bf16_f32 v194, v40, v41
v_mfma_f32_16x16x32_bf16 v[56:59], a[220:223], v[168:171], v[56:59]
s_waitcnt vmcnt(63)
s_barrier
s_mov_b32 m0, 74112
s_addk_i32 s32, 4096
buffer_load_dwordx4 v36, s[8:11], s32 offen nt lds
ds_read_b128 a[208:211], v4 offset:0
ds_read_b128 a[212:215], v5 offset:0
v_mul_f32_e32 v42, s40, v42
v_mfma_f32_16x16x32_bf16 v[64:67], a[224:227], v[168:171], v[64:67]
ds_read_b128 a[216:219], v4 offset:128
v_mul_f32_e32 v43, s40, v43
v_cvt_pk_bf16_f32 v195, v42, v43
v_mul_f32_e32 v48, s40, v48
v_mul_f32_e32 v49, s40, v49
v_cvt_pk_bf16_f32 v200, v48, v49
v_mul_f32_e32 v50, s40, v50
v_mul_f32_e32 v51, s40, v51
v_cvt_pk_bf16_f32 v201, v50, v51
v_mfma_f32_16x16x32_bf16 v[72:75], a[228:231], v[168:171], v[72:75]
s_waitcnt lgkmcnt(9)
ds_read_b128 a[220:223], v5 offset:128
v_mul_f32_e32 v56, s40, v56
v_mul_f32_e32 v57, s40, v57
v_cvt_pk_bf16_f32 v202, v56, v57
v_mul_f32_e32 v58, s40, v58
v_mul_f32_e32 v59, s40, v59
v_cvt_pk_bf16_f32 v203, v58, v59
v_mul_f32_e32 v64, s40, v64
v_mul_f32_e32 v65, s40, v65
v_mfma_f32_16x16x32_bf16 v[80:83], a[232:235], v[168:171], v[80:83]
ds_read_b128 a[224:227], v4 offset:256
v_cvt_pk_bf16_f32 v208, v64, v65
v_mul_f32_e32 v66, s40, v66
v_mul_f32_e32 v67, s40, v67
v_cvt_pk_bf16_f32 v209, v66, v67
v_mul_f32_e32 v72, s40, v72
v_mul_f32_e32 v73, s40, v73
v_cvt_pk_bf16_f32 v210, v72, v73
v_mul_f32_e32 v74, s40, v74
v_mfma_f32_16x16x32_bf16 v[88:91], a[236:239], v[168:171], v[88:91]
ds_read_b128 a[228:231], v5 offset:256
v_mul_f32_e32 v75, s40, v75
v_cvt_pk_bf16_f32 v211, v74, v75
v_mul_f32_e32 v80, s40, v80
v_mul_f32_e32 v81, s40, v81
v_cvt_pk_bf16_f32 v216, v80, v81
v_mul_f32_e32 v82, s40, v82
v_mul_f32_e32 v83, s40, v83
v_cvt_pk_bf16_f32 v217, v82, v83
v_mfma_f32_16x16x32_bf16 v[96:99], a[240:243], v[168:171], v[96:99]
s_waitcnt lgkmcnt(6)
ds_read_b128 a[232:235], v4 offset:6144
v_mul_f32_e32 v88, s40, v88
v_mul_f32_e32 v89, s40, v89
v_cvt_pk_bf16_f32 v218, v88, v89
v_mul_f32_e32 v90, s40, v90
v_mul_f32_e32 v91, s40, v91
v_cvt_pk_bf16_f32 v219, v90, v91
v_mfma_f32_16x16x32_bf16 v[104:107], a[244:247], v[168:171], v[104:107]
ds_read_b128 a[236:239], v5 offset:6144
buffer_load_dwordx4 v37, s[8:11], s32 offen offset:1024 nt lds
buffer_load_dwordx4 v38, s[8:11], s32 offen offset:2048 nt lds
buffer_load_dwordx4 v39, s[8:11], s32 offen offset:3072 nt lds
v_mfma_f32_16x16x32_bf16 v[112:115], a[248:251], v[168:171], v[112:115]
s_mov_b32 m0, 107008
s_add_u32 s36, s35, 81920
buffer_load_dwordx4 v63, s[20:23], s36 offen lds
ds_read_b128 a[240:243], v4 offset:6272
buffer_load_dwordx4 v68, s[20:23], s36 offen offset:1024 lds
v_mul_f32_e32 v96, s40, v96
v_mul_f32_e32 v97, s40, v97
v_mfma_f32_16x16x32_bf16 v[120:123], a[252:255], v[168:171], v[120:123]
s_waitcnt lgkmcnt(6)
ds_read_b128 a[244:247], v5 offset:6272
buffer_load_dwordx4 v69, s[20:23], s36 offen offset:2048 lds
buffer_load_dwordx4 v70, s[20:23], s36 offen offset:3072 lds
v_cvt_pk_bf16_f32 v224, v96, v97
v_mul_f32_e32 v98, s40, v98
v_mul_f32_e32 v99, s40, v99
v_mfma_f32_16x16x32_bf16 v[176:179], a[208:211], v[192:195], 0
s_addk_i32 m0, 4160
s_add_u32 s36, s35, 122880
buffer_load_dwordx4 v63, s[20:23], s36 offen lds
ds_read_b128 a[248:251], v4 offset:6400
buffer_load_dwordx4 v68, s[20:23], s36 offen offset:1024 lds
v_cvt_pk_bf16_f32 v225, v98, v99
v_mul_f32_e32 v104, s40, v104
v_mfma_f32_16x16x32_bf16 v[176:179], a[212:215], v[200:203], v[176:179]
ds_read_b128 a[252:255], v5 offset:6400
buffer_load_dwordx4 v69, s[20:23], s36 offen offset:2048 lds
buffer_load_dwordx4 v70, s[20:23], s36 offen offset:3072 lds
v_mul_f32_e32 v105, s40, v105
v_cvt_pk_bf16_f32 v226, v104, v105
v_mul_f32_e32 v106, s40, v106
v_mfma_f32_16x16x32_bf16 v[176:179], a[216:219], v[208:211], v[176:179]
s_waitcnt lgkmcnt(6)
s_addk_i32 m0, 4096
s_add_u32 s36, s35, 163840
buffer_load_dwordx4 v63, s[20:23], s36 offen lds
buffer_load_dwordx4 v68, s[20:23], s36 offen offset:1024 lds
buffer_load_dwordx4 v69, s[20:23], s36 offen offset:2048 lds
buffer_load_dwordx4 v70, s[20:23], s36 offen offset:3072 lds
v_mul_f32_e32 v107, s40, v107
v_cvt_pk_bf16_f32 v227, v106, v107
v_mfma_f32_16x16x32_bf16 v[176:179], a[220:223], v[216:219], v[176:179]
s_waitcnt vmcnt(63)
s_barrier
ds_read_b128 a[208:211], v4 offset:24704
v_mul_f32_e32 v112, s40, v112
v_mul_f32_e32 v113, s40, v113
v_cvt_pk_bf16_f32 v232, v112, v113
v_mul_f32_e32 v114, s40, v114
v_mul_f32_e32 v115, s40, v115
v_cvt_pk_bf16_f32 v233, v114, v115
v_mul_f32_e32 v120, s40, v120
v_mul_f32_e32 v121, s40, v121
v_cvt_pk_bf16_f32 v234, v120, v121
v_mul_f32_e32 v122, s40, v122
v_mul_f32_e32 v123, s40, v123
v_cvt_pk_bf16_f32 v235, v122, v123
v_mfma_f32_16x16x32_bf16 v[176:179], a[224:227], v[224:227], v[176:179]
s_mov_b32 m0, 78208
s_addk_i32 s32, 4096
buffer_load_dwordx4 v44, s[8:11], s32 offen nt lds
ds_read_b128 a[212:215], v5 offset:24704
ds_read_b128 a[216:219], v4 offset:24832
buffer_load_dwordx4 v45, s[8:11], s32 offen offset:1024 nt lds
v_mfma_f32_16x16x32_bf16 v[176:179], a[228:231], v[232:235], v[176:179]
s_waitcnt lgkmcnt(6)
ds_read_b128 a[220:223], v5 offset:24832
buffer_load_dwordx4 v36, s[8:11], s32 offen offset:2048 nt lds
v_mfma_f32_16x16x32_bf16 v[184:187], a[232:235], v[192:195], 0
ds_read_b128 a[224:227], v4 offset:24960
v_mfma_f32_16x16x32_bf16 v[184:187], a[236:239], v[200:203], v[184:187]
ds_read_b128 a[228:231], v5 offset:24960
buffer_load_dwordx4 v37, s[8:11], s32 offen offset:3072 nt lds
v_max3_f32 v28, v176, v177, v178
v_max_f32_e32 v28, v28, v179
v_mov_b32_e32 v27, v28
v_mfma_f32_16x16x32_bf16 v[184:187], a[240:243], v[208:211], v[184:187]
s_waitcnt lgkmcnt(6)
ds_read_b128 a[232:235], v4 offset:30848
v_permlane32_swap_b32 v28, v27
v_max_f32_e32 v28, v28, v27
v_mov_b32_e32 v27, v28
s_nop 1
v_permlane16_swap_b32 v28, v27
v_max_f32_e32 v28, v28, v27
v_sub_f32_e32 v136, 0, v28
v_mfma_f32_16x16x32_bf16 v[184:187], a[244:247], v[216:219], v[184:187]
s_mov_b32 m0, 119360
s_add_u32 s36, s35, 204800
buffer_load_dwordx4 v63, s[20:23], s36 offen lds
ds_read_b128 a[236:239], v5 offset:30848
v_sub_f32_e32 v137, 0, v28
v_sub_f32_e32 v138, 0, v28
v_sub_f32_e32 v139, 0, v28
v_sub_f32_e32 v176, v176, v28
v_mfma_f32_16x16x32_bf16 v[184:187], a[248:251], v[224:227], v[184:187]
ds_read_b128 a[240:243], v4 offset:30976
buffer_load_dwordx4 v68, s[20:23], s36 offen offset:1024 lds
v_exp_f32_e32 v176, v176
v_sub_f32_e32 v177, v177, v28
v_exp_f32_e32 v177, v177
v_mfma_f32_16x16x32_bf16 v[184:187], a[252:255], v[232:235], v[184:187]
s_waitcnt lgkmcnt(6)
ds_read_b128 a[244:247], v5 offset:30976
buffer_load_dwordx4 v69, s[20:23], s36 offen offset:2048 lds
v_sub_f32_e32 v178, v178, v28
v_exp_f32_e32 v178, v178
v_sub_f32_e32 v179, v179, v28
v_cvt_pk_bf16_f32 v160, v176, v177
v_mfma_f32_16x16x32_bf16 v[144:147], a[208:211], v[192:195], v[136:139]
ds_read_b128 a[248:251], v4 offset:31104
buffer_load_dwordx4 v70, s[20:23], s36 offen offset:3072 lds
v_exp_f32_e32 v179, v179
v_sub_f32_e32 v184, v184, v28
v_exp_f32_e32 v184, v184
v_mfma_f32_16x16x32_bf16 v[144:147], a[212:215], v[200:203], v[144:147]
ds_read_b128 a[252:255], v5 offset:31104
v_sub_f32_e32 v185, v185, v28
v_exp_f32_e32 v185, v185
v_sub_f32_e32 v186, v186, v28
v_exp_f32_e32 v186, v186
v_sub_f32_e32 v187, v187, v28
v_cvt_pk_bf16_f32 v161, v178, v179
v_mfma_f32_16x16x32_bf16 v[144:147], a[216:219], v[208:211], v[144:147]
s_waitcnt lgkmcnt(6)
v_exp_f32_e32 v187, v187
v_cvt_pk_bf16_f32 v162, v184, v185
v_cvt_pk_bf16_f32 v163, v186, v187
v_add_f32_e32 v128, v176, v184
v_add_f32_e32 v129, v177, v185
v_add_f32_e32 v130, v178, v186
v_add_f32_e32 v131, v179, v187
v_mfma_f32_16x16x32_bf16 v[144:147], a[220:223], v[216:219], v[144:147]
s_waitcnt vmcnt(63)
s_barrier
s_mov_b32 m0, 82304
s_addk_i32 s32, 4096
buffer_load_dwordx4 v38, s[8:11], s32 offen nt lds
ds_read_b64_tr_b16 a[208:209], v8 offset:12352
ds_read_b64_tr_b16 a[210:211], v8 offset:18496
ds_read_b64_tr_b16 a[212:213], v9 offset:12352
v_mfma_f32_16x16x32_bf16 v[144:147], a[224:227], v[224:227], v[144:147]
ds_read_b64_tr_b16 a[214:215], v9 offset:18496
ds_read_b64_tr_b16 a[216:217], v10 offset:12352
ds_read_b64_tr_b16 a[218:219], v10 offset:18496
buffer_load_dwordx4 v39, s[8:11], s32 offen offset:1024 nt lds
buffer_load_dwordx4 v44, s[8:11], s32 offen offset:2048 nt lds
v_mfma_f32_16x16x32_bf16 v[144:147], a[228:231], v[232:235], v[144:147]
s_waitcnt lgkmcnt(9)
ds_read_b64_tr_b16 a[220:221], v11 offset:12352
ds_read_b64_tr_b16 a[222:223], v11 offset:18496
buffer_load_dwordx4 v45, s[8:11], s32 offen offset:3072 nt lds
v_mfma_f32_16x16x32_bf16 v[152:155], a[232:235], v[192:195], v[136:139]
s_movk_i32 m0, 0
s_addk_i32 s32, 4096
buffer_load_dwordx4 v36, s[8:11], s32 offen nt lds
ds_read_b64_tr_b16 a[224:225], v8 offset:12480
v_exp_f32_e32 v144, v144
v_exp_f32_e32 v145, v145
v_mfma_f32_16x16x32_bf16 v[152:155], a[236:239], v[200:203], v[152:155]
ds_read_b64_tr_b16 a[226:227], v8 offset:18624
ds_read_b64_tr_b16 a[228:229], v9 offset:12480
ds_read_b64_tr_b16 a[230:231], v9 offset:18624
v_exp_f32_e32 v146, v146
v_exp_f32_e32 v147, v147
v_add_f32_e32 v128, v128, v144
v_add_f32_e32 v129, v129, v145
v_mfma_f32_16x16x32_bf16 v[152:155], a[240:243], v[208:211], v[152:155]
s_waitcnt lgkmcnt(12)
ds_read_b64_tr_b16 a[232:233], v10 offset:12480
ds_read_b64_tr_b16 a[234:235], v10 offset:18624
buffer_load_dwordx4 v37, s[8:11], s32 offen offset:1024 nt lds
buffer_load_dwordx4 v38, s[8:11], s32 offen offset:2048 nt lds
v_add_f32_e32 v130, v130, v146
v_add_f32_e32 v131, v131, v147
v_mfma_f32_16x16x32_bf16 v[152:155], a[244:247], v[216:219], v[152:155]
ds_read_b64_tr_b16 a[236:237], v11 offset:12480
ds_read_b64_tr_b16 a[238:239], v11 offset:18624
buffer_load_dwordx4 v39, s[8:11], s32 offen offset:3072 nt lds
v_cvt_pk_bf16_f32 v168, v144, v145
v_cvt_pk_bf16_f32 v169, v146, v147
v_mfma_f32_16x16x32_bf16 v[152:155], a[248:251], v[224:227], v[152:155]
s_movk_i32 m0, 4096
s_addk_i32 s32, 4096
buffer_load_dwordx4 v44, s[8:11], s32 offen nt lds
ds_read_b64_tr_b16 a[240:241], v8 offset:12608
ds_read_b64_tr_b16 a[242:243], v8 offset:18752
buffer_load_dwordx4 v45, s[8:11], s32 offen offset:1024 nt lds
v_mfma_f32_16x16x32_bf16 v[152:155], a[252:255], v[232:235], v[152:155]
s_waitcnt lgkmcnt(12)
ds_read_b64_tr_b16 a[244:245], v9 offset:12608
ds_read_b64_tr_b16 a[246:247], v9 offset:18752
buffer_load_dwordx4 v36, s[8:11], s32 offen offset:2048 nt lds
buffer_load_dwordx4 v37, s[8:11], s32 offen offset:3072 nt lds
v_mfma_f32_16x16x32_bf16 v[32:35], a[208:211], v[160:163], 0
s_movk_i32 m0, 8192
s_addk_i32 s32, 4096
buffer_load_dwordx4 v38, s[8:11], s32 offen nt lds
ds_read_b64_tr_b16 a[248:249], v10 offset:12608
v_exp_f32_e32 v152, v152
v_exp_f32_e32 v153, v153
v_mfma_f32_16x16x32_bf16 v[40:43], a[212:215], v[160:163], 0
ds_read_b64_tr_b16 a[250:251], v10 offset:18752
ds_read_b64_tr_b16 a[252:253], v11 offset:12608
ds_read_b64_tr_b16 a[254:255], v11 offset:18752
buffer_load_dwordx4 v39, s[8:11], s32 offen offset:1024 nt lds
buffer_load_dwordx4 v44, s[8:11], s32 offen offset:2048 nt lds
v_cvt_pk_bf16_f32 v170, v152, v153
v_mfma_f32_16x16x32_bf16 v[48:51], a[216:219], v[160:163], 0
s_waitcnt lgkmcnt(12)
buffer_load_dwordx4 v45, s[8:11], s32 offen offset:3072 nt lds
s_mov_b32 m0, 90560
s_addk_i32 s33, 4096
buffer_load_dwordx4 v47, s[12:15], s33 offen nt lds
buffer_load_dwordx4 v52, s[12:15], s33 offen offset:1024 nt lds
buffer_load_dwordx4 v46, s[12:15], s33 offen offset:2048 nt lds
buffer_load_dwordx4 v47, s[12:15], s33 offen offset:3072 nt lds
s_addk_i32 m0, 4096
s_addk_i32 s33, 4096
buffer_load_dwordx4 v52, s[12:15], s33 offen nt lds
buffer_load_dwordx4 v46, s[12:15], s33 offen offset:1024 nt lds
buffer_load_dwordx4 v47, s[12:15], s33 offen offset:2048 nt lds
buffer_load_dwordx4 v52, s[12:15], s33 offen offset:3072 nt lds
v_mfma_f32_16x16x32_bf16 v[56:59], a[220:223], v[160:163], 0
s_waitcnt vmcnt(63)
s_barrier
s_movk_i32 m0, 24704
s_addk_i32 s32, 4096
buffer_load_dwordx4 v36, s[8:11], s32 offen nt lds
ds_read_b128 a[208:211], v6 offset:0
ds_read_b128 a[212:215], v7 offset:0
v_mfma_f32_16x16x32_bf16 v[64:67], a[224:227], v[160:163], 0
ds_read_b128 a[216:219], v6 offset:128
buffer_load_dwordx4 v37, s[8:11], s32 offen offset:1024 nt lds
buffer_load_dwordx4 v38, s[8:11], s32 offen offset:2048 nt lds
v_mfma_f32_16x16x32_bf16 v[72:75], a[228:231], v[160:163], 0
s_waitcnt lgkmcnt(9)
ds_read_b128 a[220:223], v7 offset:128
buffer_load_dwordx4 v39, s[8:11], s32 offen offset:3072 nt lds
v_mfma_f32_16x16x32_bf16 v[80:83], a[232:235], v[160:163], 0
s_movk_i32 m0, 28800
s_addk_i32 s32, 4096
buffer_load_dwordx4 v44, s[8:11], s32 offen nt lds
ds_read_b128 a[224:227], v6 offset:256
buffer_load_dwordx4 v45, s[8:11], s32 offen offset:1024 nt lds
v_mfma_f32_16x16x32_bf16 v[88:91], a[236:239], v[160:163], 0
ds_read_b128 a[228:231], v7 offset:256
buffer_load_dwordx4 v36, s[8:11], s32 offen offset:2048 nt lds
v_mfma_f32_16x16x32_bf16 v[96:99], a[240:243], v[160:163], 0
s_waitcnt lgkmcnt(6)
ds_read_b128 a[232:235], v6 offset:6144
buffer_load_dwordx4 v37, s[8:11], s32 offen offset:3072 nt lds
v_mfma_f32_16x16x32_bf16 v[104:107], a[244:247], v[160:163], 0
s_addk_i32 m0, 4096
s_addk_i32 s32, 4096
buffer_load_dwordx4 v38, s[8:11], s32 offen nt lds
ds_read_b128 a[236:239], v7 offset:6144
buffer_load_dwordx4 v39, s[8:11], s32 offen offset:1024 nt lds
v_mfma_f32_16x16x32_bf16 v[112:115], a[248:251], v[160:163], 0
ds_read_b128 a[240:243], v6 offset:6272
buffer_load_dwordx4 v44, s[8:11], s32 offen offset:2048 nt lds
v_mfma_f32_16x16x32_bf16 v[120:123], a[252:255], v[160:163], 0
buffer_load_dwordx4 v45, s[8:11], s32 offen offset:3072 nt lds
s_cmp_eq_u32 s28, 0
s_cbranch_scc1 L_AF
s_waitcnt lgkmcnt(6)
v_mfma_f32_16x16x32_bf16 v[144:147], a[208:211], v[192:195], v[136:139]
ds_read_b128 a[244:247], v7 offset:6272
ds_read_b128 a[248:251], v6 offset:6400
v_exp_f32_e32 v154, v154
v_exp_f32_e32 v155, v155
v_add_f32_e32 v128, v128, v152
v_add_f32_e32 v129, v129, v153
v_add_f32_e32 v130, v130, v154
v_mfma_f32_16x16x32_bf16 v[144:147], a[212:215], v[200:203], v[144:147]
ds_read_b128 a[252:255], v7 offset:6400
v_add_f32_e32 v131, v131, v155
v_cvt_pk_bf16_f32 v171, v154, v155
v_mfma_f32_16x16x32_bf16 v[144:147], a[216:219], v[208:211], v[144:147]
s_waitcnt lgkmcnt(6)
v_mfma_f32_16x16x32_bf16 v[144:147], a[220:223], v[216:219], v[144:147]
s_waitcnt vmcnt(63)
s_barrier
s_movk_i32 m0, 12352
s_addk_i32 s33, 4096
buffer_load_dwordx4 v46, s[12:15], s33 offen nt lds
ds_read_b64_tr_b16 a[208:209], v8 offset:37056
ds_read_b64_tr_b16 a[210:211], v8 offset:43200
ds_read_b64_tr_b16 a[212:213], v9 offset:37056
v_mfma_f32_16x16x32_bf16 v[144:147], a[224:227], v[224:227], v[144:147]
ds_read_b64_tr_b16 a[214:215], v9 offset:43200
ds_read_b64_tr_b16 a[216:217], v10 offset:37056
ds_read_b64_tr_b16 a[218:219], v10 offset:43200
buffer_load_dwordx4 v47, s[12:15], s33 offen offset:1024 nt lds
v_mfma_f32_16x16x32_bf16 v[144:147], a[228:231], v[232:235], v[144:147]
s_waitcnt lgkmcnt(9)
ds_read_b64_tr_b16 a[220:221], v11 offset:37056
ds_read_b64_tr_b16 a[222:223], v11 offset:43200
buffer_load_dwordx4 v52, s[12:15], s33 offen offset:2048 nt lds
v_mfma_f32_16x16x32_bf16 v[152:155], a[232:235], v[192:195], v[136:139]
ds_read_b64_tr_b16 a[224:225], v8 offset:37184
ds_read_b64_tr_b16 a[226:227], v8 offset:43328
buffer_load_dwordx4 v46, s[12:15], s33 offen offset:3072 nt lds
v_exp_f32_e32 v144, v144
v_exp_f32_e32 v145, v145
v_mfma_f32_16x16x32_bf16 v[152:155], a[236:239], v[200:203], v[152:155]
s_movk_i32 m0, 16448
s_addk_i32 s33, 4096
buffer_load_dwordx4 v47, s[12:15], s33 offen nt lds
ds_read_b64_tr_b16 a[228:229], v9 offset:37184
v_exp_f32_e32 v146, v146
v_exp_f32_e32 v147, v147
v_mfma_f32_16x16x32_bf16 v[152:155], a[240:243], v[208:211], v[152:155]
s_waitcnt lgkmcnt(11)
ds_read_b64_tr_b16 a[230:231], v9 offset:43328
ds_read_b64_tr_b16 a[232:233], v10 offset:37184
ds_read_b64_tr_b16 a[234:235], v10 offset:43328
buffer_load_dwordx4 v52, s[12:15], s33 offen offset:1024 nt lds
v_add_f32_e32 v128, v128, v144
v_add_f32_e32 v129, v129, v145
v_add_f32_e32 v130, v130, v146
v_mfma_f32_16x16x32_bf16 v[152:155], a[244:247], v[216:219], v[152:155]
ds_read_b64_tr_b16 a[236:237], v11 offset:37184
ds_read_b64_tr_b16 a[238:239], v11 offset:43328
buffer_load_dwordx4 v46, s[12:15], s33 offen offset:2048 nt lds
v_add_f32_e32 v131, v131, v147
v_cvt_pk_bf16_f32 v160, v144, v145
v_cvt_pk_bf16_f32 v161, v146, v147
v_mfma_f32_16x16x32_bf16 v[152:155], a[248:251], v[224:227], v[152:155]
ds_read_b64_tr_b16 a[240:241], v8 offset:37312
ds_read_b64_tr_b16 a[242:243], v8 offset:43456
buffer_load_dwordx4 v47, s[12:15], s33 offen offset:3072 nt lds
v_mfma_f32_16x16x32_bf16 v[152:155], a[252:255], v[232:235], v[152:155]
s_waitcnt lgkmcnt(12)
s_movk_i32 m0, 20544
s_addk_i32 s33, 4096
buffer_load_dwordx4 v52, s[12:15], s33 offen nt lds
ds_read_b64_tr_b16 a[244:245], v9 offset:37312
ds_read_b64_tr_b16 a[246:247], v9 offset:43456
v_mfma_f32_16x16x32_bf16 v[32:35], a[208:211], v[168:171], v[32:35]
ds_read_b64_tr_b16 a[248:249], v10 offset:37312
ds_read_b64_tr_b16 a[250:251], v10 offset:43456
buffer_load_dwordx4 v46, s[12:15], s33 offen offset:1024 nt lds
v_exp_f32_e32 v152, v152
v_exp_f32_e32 v153, v153
v_mfma_f32_16x16x32_bf16 v[40:43], a[212:215], v[168:171], v[40:43]
ds_read_b64_tr_b16 a[252:253], v11 offset:37312
ds_read_b64_tr_b16 a[254:255], v11 offset:43456
buffer_load_dwordx4 v47, s[12:15], s33 offen offset:2048 nt lds
v_cvt_pk_bf16_f32 v162, v152, v153
v_mfma_f32_16x16x32_bf16 v[48:51], a[216:219], v[168:171], v[48:51]
s_waitcnt lgkmcnt(12)
buffer_load_dwordx4 v52, s[12:15], s33 offen offset:3072 nt lds
v_mfma_f32_16x16x32_bf16 v[56:59], a[220:223], v[168:171], v[56:59]
s_waitcnt vmcnt(44)
s_barrier
s_addk_i32 m0, 28864
s_addk_i32 s32, 4096
buffer_load_dwordx4 v36, s[8:11], s32 offen nt lds
ds_read_b128 a[208:211], v6 offset:24704
ds_read_b128 a[212:215], v7 offset:24704
v_mfma_f32_16x16x32_bf16 v[64:67], a[224:227], v[168:171], v[64:67]
ds_read_b128 a[216:219], v6 offset:24832
buffer_load_dwordx4 v37, s[8:11], s32 offen offset:1024 nt lds
v_mfma_f32_16x16x32_bf16 v[72:75], a[228:231], v[168:171], v[72:75]
s_waitcnt lgkmcnt(9)
ds_read_b128 a[220:223], v7 offset:24832
buffer_load_dwordx4 v38, s[8:11], s32 offen offset:2048 nt lds
v_mfma_f32_16x16x32_bf16 v[80:83], a[232:235], v[168:171], v[80:83]
ds_read_b128 a[224:227], v6 offset:24960
v_mfma_f32_16x16x32_bf16 v[88:91], a[236:239], v[168:171], v[88:91]
ds_read_b128 a[228:231], v7 offset:24960
buffer_load_dwordx4 v39, s[8:11], s32 offen offset:3072 nt lds
v_mfma_f32_16x16x32_bf16 v[96:99], a[240:243], v[168:171], v[96:99]
s_waitcnt lgkmcnt(6)
s_mov_b32 m0, 123520
s_add_u32 s36, s35, 128
buffer_load_dwordx4 v63, s[20:23], s36 offen lds
ds_read_b128 a[232:235], v6 offset:30848
v_mfma_f32_16x16x32_bf16 v[104:107], a[244:247], v[168:171], v[104:107]
ds_read_b128 a[236:239], v7 offset:30848
buffer_load_dwordx4 v68, s[20:23], s36 offen offset:1024 lds
v_mfma_f32_16x16x32_bf16 v[112:115], a[248:251], v[168:171], v[112:115]
ds_read_b128 a[240:243], v6 offset:30976
v_mfma_f32_16x16x32_bf16 v[120:123], a[252:255], v[168:171], v[120:123]
s_waitcnt lgkmcnt(6)
ds_read_b128 a[244:247], v7 offset:30976
buffer_load_dwordx4 v69, s[20:23], s36 offen offset:2048 lds
v_mfma_f32_16x16x32_bf16 v[144:147], a[208:211], v[192:195], v[136:139]
ds_read_b128 a[248:251], v6 offset:31104
buffer_load_dwordx4 v70, s[20:23], s36 offen offset:3072 lds
v_exp_f32_e32 v154, v154
v_exp_f32_e32 v155, v155
v_add_f32_e32 v128, v128, v152
v_mfma_f32_16x16x32_bf16 v[144:147], a[212:215], v[200:203], v[144:147]
ds_read_b128 a[252:255], v7 offset:31104
v_add_f32_e32 v129, v129, v153
v_add_f32_e32 v130, v130, v154
v_add_f32_e32 v131, v131, v155
v_cvt_pk_bf16_f32 v163, v154, v155
v_mfma_f32_16x16x32_bf16 v[144:147], a[216:219], v[208:211], v[144:147]
s_waitcnt lgkmcnt(6)
v_mfma_f32_16x16x32_bf16 v[144:147], a[220:223], v[216:219], v[144:147]
s_waitcnt vmcnt(63)
s_barrier
s_mov_b32 m0, 53504
s_addk_i32 s32, 4096
buffer_load_dwordx4 v44, s[8:11], s32 offen nt lds
ds_read_b64_tr_b16 a[208:209], v12 offset:12352
ds_read_b64_tr_b16 a[210:211], v12 offset:18496
ds_read_b64_tr_b16 a[212:213], v13 offset:12352
v_mfma_f32_16x16x32_bf16 v[144:147], a[224:227], v[224:227], v[144:147]
ds_read_b64_tr_b16 a[214:215], v13 offset:18496
ds_read_b64_tr_b16 a[216:217], v14 offset:12352
ds_read_b64_tr_b16 a[218:219], v14 offset:18496
buffer_load_dwordx4 v45, s[8:11], s32 offen offset:1024 nt lds
v_mfma_f32_16x16x32_bf16 v[144:147], a[228:231], v[232:235], v[144:147]
s_waitcnt lgkmcnt(9)
ds_read_b64_tr_b16 a[220:221], v15 offset:12352
ds_read_b64_tr_b16 a[222:223], v15 offset:18496
buffer_load_dwordx4 v36, s[8:11], s32 offen offset:2048 nt lds
v_mfma_f32_16x16x32_bf16 v[152:155], a[232:235], v[192:195], v[136:139]
ds_read_b64_tr_b16 a[224:225], v12 offset:12480
ds_read_b64_tr_b16 a[226:227], v12 offset:18624
buffer_load_dwordx4 v37, s[8:11], s32 offen offset:3072 nt lds
v_exp_f32_e32 v144, v144
v_exp_f32_e32 v145, v145
v_mfma_f32_16x16x32_bf16 v[152:155], a[236:239], v[200:203], v[152:155]
s_addk_i32 m0, 4096
s_addk_i32 s32, 4096
buffer_load_dwordx4 v38, s[8:11], s32 offen nt lds
ds_read_b64_tr_b16 a[228:229], v13 offset:12480
v_exp_f32_e32 v146, v146
v_exp_f32_e32 v147, v147
v_mfma_f32_16x16x32_bf16 v[152:155], a[240:243], v[208:211], v[152:155]
s_waitcnt lgkmcnt(11)
ds_read_b64_tr_b16 a[230:231], v13 offset:18624
ds_read_b64_tr_b16 a[232:233], v14 offset:12480
ds_read_b64_tr_b16 a[234:235], v14 offset:18624
buffer_load_dwordx4 v39, s[8:11], s32 offen offset:1024 nt lds
v_add_f32_e32 v128, v128, v144
v_add_f32_e32 v129, v129, v145
v_add_f32_e32 v130, v130, v146
v_mfma_f32_16x16x32_bf16 v[152:155], a[244:247], v[216:219], v[152:155]
ds_read_b64_tr_b16 a[236:237], v15 offset:12480
ds_read_b64_tr_b16 a[238:239], v15 offset:18624
buffer_load_dwordx4 v44, s[8:11], s32 offen offset:2048 nt lds
v_add_f32_e32 v131, v131, v147
v_cvt_pk_bf16_f32 v168, v144, v145
v_cvt_pk_bf16_f32 v169, v146, v147
v_mfma_f32_16x16x32_bf16 v[152:155], a[248:251], v[224:227], v[152:155]
ds_read_b64_tr_b16 a[240:241], v12 offset:12608
ds_read_b64_tr_b16 a[242:243], v12 offset:18752
buffer_load_dwordx4 v45, s[8:11], s32 offen offset:3072 nt lds
v_mfma_f32_16x16x32_bf16 v[152:155], a[252:255], v[232:235], v[152:155]
s_waitcnt lgkmcnt(12)
s_addk_i32 m0, -20544
s_addk_i32 s33, 4096
buffer_load_dwordx4 v46, s[12:15], s33 offen nt lds
ds_read_b64_tr_b16 a[244:245], v13 offset:12608
ds_read_b64_tr_b16 a[246:247], v13 offset:18752
v_mfma_f32_16x16x32_bf16 v[32:35], a[208:211], v[160:163], v[32:35]
ds_read_b64_tr_b16 a[248:249], v14 offset:12608
ds_read_b64_tr_b16 a[250:251], v14 offset:18752
buffer_load_dwordx4 v47, s[12:15], s33 offen offset:1024 nt lds
v_exp_f32_e32 v152, v152
v_exp_f32_e32 v153, v153
v_mfma_f32_16x16x32_bf16 v[40:43], a[212:215], v[160:163], v[40:43]
ds_read_b64_tr_b16 a[252:253], v15 offset:12608
ds_read_b64_tr_b16 a[254:255], v15 offset:18752
buffer_load_dwordx4 v52, s[12:15], s33 offen offset:2048 nt lds
v_cvt_pk_bf16_f32 v170, v152, v153
v_mfma_f32_16x16x32_bf16 v[48:51], a[216:219], v[160:163], v[48:51]
s_waitcnt lgkmcnt(12)
buffer_load_dwordx4 v46, s[12:15], s33 offen offset:3072 nt lds
v_mfma_f32_16x16x32_bf16 v[56:59], a[220:223], v[160:163], v[56:59]
s_waitcnt vmcnt(52)
s_barrier
s_mov_b32 m0, 74112
s_addk_i32 s32, 4096
buffer_load_dwordx4 v36, s[8:11], s32 offen nt lds
ds_read_b128 a[208:211], v4 offset:0
ds_read_b128 a[212:215], v5 offset:0
v_mfma_f32_16x16x32_bf16 v[64:67], a[224:227], v[160:163], v[64:67]
ds_read_b128 a[216:219], v4 offset:128
buffer_load_dwordx4 v37, s[8:11], s32 offen offset:1024 nt lds
v_mfma_f32_16x16x32_bf16 v[72:75], a[228:231], v[160:163], v[72:75]
s_waitcnt lgkmcnt(9)
ds_read_b128 a[220:223], v5 offset:128
buffer_load_dwordx4 v38, s[8:11], s32 offen offset:2048 nt lds
v_mfma_f32_16x16x32_bf16 v[80:83], a[232:235], v[160:163], v[80:83]
ds_read_b128 a[224:227], v4 offset:256
v_mfma_f32_16x16x32_bf16 v[88:91], a[236:239], v[160:163], v[88:91]
ds_read_b128 a[228:231], v5 offset:256
buffer_load_dwordx4 v39, s[8:11], s32 offen offset:3072 nt lds
v_mfma_f32_16x16x32_bf16 v[96:99], a[240:243], v[160:163], v[96:99]
s_waitcnt lgkmcnt(6)
s_mov_b32 m0, 127616
s_add_u32 s36, s35, 41088
buffer_load_dwordx4 v63, s[20:23], s36 offen lds
ds_read_b128 a[232:235], v4 offset:6144
v_mfma_f32_16x16x32_bf16 v[104:107], a[244:247], v[160:163], v[104:107]
ds_read_b128 a[236:239], v5 offset:6144
buffer_load_dwordx4 v68, s[20:23], s36 offen offset:1024 lds
v_mfma_f32_16x16x32_bf16 v[112:115], a[248:251], v[160:163], v[112:115]
ds_read_b128 a[240:243], v4 offset:6272
v_mfma_f32_16x16x32_bf16 v[120:123], a[252:255], v[160:163], v[120:123]
s_waitcnt lgkmcnt(6)
ds_read_b128 a[244:247], v5 offset:6272
buffer_load_dwordx4 v69, s[20:23], s36 offen offset:2048 lds
v_mfma_f32_16x16x32_bf16 v[144:147], a[208:211], v[192:195], v[136:139]
ds_read_b128 a[248:251], v4 offset:6400
buffer_load_dwordx4 v70, s[20:23], s36 offen offset:3072 lds
v_exp_f32_e32 v154, v154
v_exp_f32_e32 v155, v155
v_add_f32_e32 v128, v128, v152
v_mfma_f32_16x16x32_bf16 v[144:147], a[212:215], v[200:203], v[144:147]
ds_read_b128 a[252:255], v5 offset:6400
v_add_f32_e32 v129, v129, v153
v_add_f32_e32 v130, v130, v154
v_add_f32_e32 v131, v131, v155
v_cvt_pk_bf16_f32 v171, v154, v155
v_mfma_f32_16x16x32_bf16 v[144:147], a[216:219], v[208:211], v[144:147]
s_waitcnt lgkmcnt(6)
v_mfma_f32_16x16x32_bf16 v[144:147], a[220:223], v[216:219], v[144:147]
s_waitcnt vmcnt(52)
s_barrier
s_addk_i32 m0, 4096
s_add_u32 s36, s35, 82048
buffer_load_dwordx4 v63, s[20:23], s36 offen lds
ds_read_b64_tr_b16 a[208:209], v12 offset:37056
ds_read_b64_tr_b16 a[210:211], v12 offset:43200
ds_read_b64_tr_b16 a[212:213], v13 offset:37056
v_mfma_f32_16x16x32_bf16 v[144:147], a[224:227], v[224:227], v[144:147]
ds_read_b64_tr_b16 a[214:215], v13 offset:43200
ds_read_b64_tr_b16 a[216:217], v14 offset:37056
ds_read_b64_tr_b16 a[218:219], v14 offset:43200
buffer_load_dwordx4 v68, s[20:23], s36 offen offset:1024 lds
v_mfma_f32_16x16x32_bf16 v[144:147], a[228:231], v[232:235], v[144:147]
s_waitcnt lgkmcnt(9)
ds_read_b64_tr_b16 a[220:221], v15 offset:37056
ds_read_b64_tr_b16 a[222:223], v15 offset:43200
buffer_load_dwordx4 v69, s[20:23], s36 offen offset:2048 lds
v_mfma_f32_16x16x32_bf16 v[152:155], a[232:235], v[192:195], v[136:139]
ds_read_b64_tr_b16 a[224:225], v12 offset:37184
ds_read_b64_tr_b16 a[226:227], v12 offset:43328
buffer_load_dwordx4 v70, s[20:23], s36 offen offset:3072 lds
v_exp_f32_e32 v144, v144
v_exp_f32_e32 v145, v145
v_mfma_f32_16x16x32_bf16 v[152:155], a[236:239], v[200:203], v[152:155]
s_addk_i32 m0, 4160
s_add_u32 s36, s35, 123008
buffer_load_dwordx4 v63, s[20:23], s36 offen lds
ds_read_b64_tr_b16 a[228:229], v13 offset:37184
v_exp_f32_e32 v146, v146
v_exp_f32_e32 v147, v147
v_mfma_f32_16x16x32_bf16 v[152:155], a[240:243], v[208:211], v[152:155]
s_waitcnt lgkmcnt(11)
ds_read_b64_tr_b16 a[230:231], v13 offset:43328
ds_read_b64_tr_b16 a[232:233], v14 offset:37184
ds_read_b64_tr_b16 a[234:235], v14 offset:43328
buffer_load_dwordx4 v68, s[20:23], s36 offen offset:1024 lds
v_add_f32_e32 v128, v128, v144
v_add_f32_e32 v129, v129, v145
v_add_f32_e32 v130, v130, v146
v_mfma_f32_16x16x32_bf16 v[152:155], a[244:247], v[216:219], v[152:155]
ds_read_b64_tr_b16 a[236:237], v15 offset:37184
ds_read_b64_tr_b16 a[238:239], v15 offset:43328
buffer_load_dwordx4 v69, s[20:23], s36 offen offset:2048 lds
v_add_f32_e32 v131, v131, v147
v_cvt_pk_bf16_f32 v160, v144, v145
v_cvt_pk_bf16_f32 v161, v146, v147
v_mfma_f32_16x16x32_bf16 v[152:155], a[248:251], v[224:227], v[152:155]
ds_read_b64_tr_b16 a[240:241], v12 offset:37312
ds_read_b64_tr_b16 a[242:243], v12 offset:43456
buffer_load_dwordx4 v70, s[20:23], s36 offen offset:3072 lds
v_mfma_f32_16x16x32_bf16 v[152:155], a[252:255], v[232:235], v[152:155]
s_waitcnt lgkmcnt(12)
s_addk_i32 m0, 4096
s_add_u32 s36, s35, 163968
buffer_load_dwordx4 v63, s[20:23], s36 offen lds
ds_read_b64_tr_b16 a[244:245], v13 offset:37312
ds_read_b64_tr_b16 a[246:247], v13 offset:43456
v_mfma_f32_16x16x32_bf16 v[32:35], a[208:211], v[168:171], v[32:35]
ds_read_b64_tr_b16 a[248:249], v14 offset:37312
ds_read_b64_tr_b16 a[250:251], v14 offset:43456
buffer_load_dwordx4 v68, s[20:23], s36 offen offset:1024 lds
v_exp_f32_e32 v152, v152
v_exp_f32_e32 v153, v153
v_mfma_f32_16x16x32_bf16 v[40:43], a[212:215], v[168:171], v[40:43]
ds_read_b64_tr_b16 a[252:253], v15 offset:37312
ds_read_b64_tr_b16 a[254:255], v15 offset:43456
buffer_load_dwordx4 v69, s[20:23], s36 offen offset:2048 lds
v_cvt_pk_bf16_f32 v162, v152, v153
v_mfma_f32_16x16x32_bf16 v[48:51], a[216:219], v[168:171], v[48:51]
s_waitcnt lgkmcnt(12)
buffer_load_dwordx4 v70, s[20:23], s36 offen offset:3072 lds
v_mfma_f32_16x16x32_bf16 v[56:59], a[220:223], v[168:171], v[56:59]
s_waitcnt vmcnt(52)
s_barrier
s_addk_i32 m0, 4096
s_add_u32 s36, s35, 204928
buffer_load_dwordx4 v63, s[20:23], s36 offen lds
ds_read_b128 a[208:211], v4 offset:24704
ds_read_b128 a[212:215], v5 offset:24704
v_mfma_f32_16x16x32_bf16 v[64:67], a[224:227], v[168:171], v[64:67]
ds_read_b128 a[216:219], v4 offset:24832
buffer_load_dwordx4 v68, s[20:23], s36 offen offset:1024 lds
v_mfma_f32_16x16x32_bf16 v[72:75], a[228:231], v[168:171], v[72:75]
s_waitcnt lgkmcnt(9)
ds_read_b128 a[220:223], v5 offset:24832
buffer_load_dwordx4 v69, s[20:23], s36 offen offset:2048 lds
v_mfma_f32_16x16x32_bf16 v[80:83], a[232:235], v[168:171], v[80:83]
ds_read_b128 a[224:227], v4 offset:24960
v_mfma_f32_16x16x32_bf16 v[88:91], a[236:239], v[168:171], v[88:91]
ds_read_b128 a[228:231], v5 offset:24960
buffer_load_dwordx4 v70, s[20:23], s36 offen offset:3072 lds
v_mfma_f32_16x16x32_bf16 v[96:99], a[240:243], v[168:171], v[96:99]
s_waitcnt lgkmcnt(6)
s_addk_i32 m0, 4160
s_add_u32 s36, s35, 256
buffer_load_dwordx4 v63, s[20:23], s36 offen lds
ds_read_b128 a[232:235], v4 offset:30848
v_mfma_f32_16x16x32_bf16 v[104:107], a[244:247], v[168:171], v[104:107]
ds_read_b128 a[236:239], v5 offset:30848
buffer_load_dwordx4 v68, s[20:23], s36 offen offset:1024 lds
v_mfma_f32_16x16x32_bf16 v[112:115], a[248:251], v[168:171], v[112:115]
ds_read_b128 a[240:243], v4 offset:30976
v_mfma_f32_16x16x32_bf16 v[120:123], a[252:255], v[168:171], v[120:123]
s_waitcnt lgkmcnt(6)
ds_read_b128 a[244:247], v5 offset:30976
buffer_load_dwordx4 v69, s[20:23], s36 offen offset:2048 lds
v_mfma_f32_16x16x32_bf16 v[144:147], a[208:211], v[192:195], v[136:139]
ds_read_b128 a[248:251], v4 offset:31104
buffer_load_dwordx4 v70, s[20:23], s36 offen offset:3072 lds
v_exp_f32_e32 v154, v154
v_exp_f32_e32 v155, v155
v_add_f32_e32 v128, v128, v152
v_mfma_f32_16x16x32_bf16 v[144:147], a[212:215], v[200:203], v[144:147]
ds_read_b128 a[252:255], v5 offset:31104
v_add_f32_e32 v129, v129, v153
v_add_f32_e32 v130, v130, v154
v_add_f32_e32 v131, v131, v155
v_cvt_pk_bf16_f32 v163, v154, v155
v_mfma_f32_16x16x32_bf16 v[144:147], a[216:219], v[208:211], v[144:147]
s_waitcnt lgkmcnt(6)
v_mfma_f32_16x16x32_bf16 v[144:147], a[220:223], v[216:219], v[144:147]
s_waitcnt vmcnt(48)
s_barrier
s_addk_i32 m0, 4096
s_add_u32 s36, s35, 41216
buffer_load_dwordx4 v63, s[20:23], s36 offen lds
ds_read_b64_tr_b16 a[208:209], v8 offset:12352
ds_read_b64_tr_b16 a[210:211], v8 offset:18496
ds_read_b64_tr_b16 a[212:213], v9 offset:12352
v_mfma_f32_16x16x32_bf16 v[144:147], a[224:227], v[224:227], v[144:147]
ds_read_b64_tr_b16 a[214:215], v9 offset:18496
ds_read_b64_tr_b16 a[216:217], v10 offset:12352
ds_read_b64_tr_b16 a[218:219], v10 offset:18496
buffer_load_dwordx4 v68, s[20:23], s36 offen offset:1024 lds
v_mfma_f32_16x16x32_bf16 v[144:147], a[228:231], v[232:235], v[144:147]
s_waitcnt lgkmcnt(9)
ds_read_b64_tr_b16 a[220:221], v11 offset:12352
ds_read_b64_tr_b16 a[222:223], v11 offset:18496
buffer_load_dwordx4 v69, s[20:23], s36 offen offset:2048 lds
v_mfma_f32_16x16x32_bf16 v[152:155], a[232:235], v[192:195], v[136:139]
ds_read_b64_tr_b16 a[224:225], v8 offset:12480
ds_read_b64_tr_b16 a[226:227], v8 offset:18624
buffer_load_dwordx4 v70, s[20:23], s36 offen offset:3072 lds
v_exp_f32_e32 v144, v144
v_exp_f32_e32 v145, v145
v_mfma_f32_16x16x32_bf16 v[152:155], a[236:239], v[200:203], v[152:155]
s_addk_i32 m0, 4096
s_add_u32 s36, s35, 82176
buffer_load_dwordx4 v63, s[20:23], s36 offen lds
ds_read_b64_tr_b16 a[228:229], v9 offset:12480
v_exp_f32_e32 v146, v146
v_exp_f32_e32 v147, v147
v_mfma_f32_16x16x32_bf16 v[152:155], a[240:243], v[208:211], v[152:155]
s_waitcnt lgkmcnt(11)
ds_read_b64_tr_b16 a[230:231], v9 offset:18624
ds_read_b64_tr_b16 a[232:233], v10 offset:12480
ds_read_b64_tr_b16 a[234:235], v10 offset:18624
buffer_load_dwordx4 v68, s[20:23], s36 offen offset:1024 lds
v_add_f32_e32 v128, v128, v144
v_add_f32_e32 v129, v129, v145
v_add_f32_e32 v130, v130, v146
v_mfma_f32_16x16x32_bf16 v[152:155], a[244:247], v[216:219], v[152:155]
ds_read_b64_tr_b16 a[236:237], v11 offset:12480
ds_read_b64_tr_b16 a[238:239], v11 offset:18624
buffer_load_dwordx4 v69, s[20:23], s36 offen offset:2048 lds
v_add_f32_e32 v131, v131, v147
v_cvt_pk_bf16_f32 v168, v144, v145
v_cvt_pk_bf16_f32 v169, v146, v147
v_mfma_f32_16x16x32_bf16 v[152:155], a[248:251], v[224:227], v[152:155]
ds_read_b64_tr_b16 a[240:241], v8 offset:12608
ds_read_b64_tr_b16 a[242:243], v8 offset:18752
buffer_load_dwordx4 v70, s[20:23], s36 offen offset:3072 lds
v_mfma_f32_16x16x32_bf16 v[152:155], a[252:255], v[232:235], v[152:155]
s_waitcnt lgkmcnt(12)
s_mov_b32 m0, 41152
s_addk_i32 s33, 4096
buffer_load_dwordx4 v47, s[12:15], s33 offen nt lds
ds_read_b64_tr_b16 a[244:245], v9 offset:12608
ds_read_b64_tr_b16 a[246:247], v9 offset:18752
v_mfma_f32_16x16x32_bf16 v[32:35], a[208:211], v[160:163], v[32:35]
ds_read_b64_tr_b16 a[248:249], v10 offset:12608
ds_read_b64_tr_b16 a[250:251], v10 offset:18752
buffer_load_dwordx4 v52, s[12:15], s33 offen offset:1024 nt lds
v_exp_f32_e32 v152, v152
v_exp_f32_e32 v153, v153
v_mfma_f32_16x16x32_bf16 v[40:43], a[212:215], v[160:163], v[40:43]
ds_read_b64_tr_b16 a[252:253], v11 offset:12608
ds_read_b64_tr_b16 a[254:255], v11 offset:18752
buffer_load_dwordx4 v46, s[12:15], s33 offen offset:2048 nt lds
v_cvt_pk_bf16_f32 v170, v152, v153
v_mfma_f32_16x16x32_bf16 v[48:51], a[216:219], v[160:163], v[48:51]
s_waitcnt lgkmcnt(12)
buffer_load_dwordx4 v47, s[12:15], s33 offen offset:3072 nt lds
v_mfma_f32_16x16x32_bf16 v[56:59], a[220:223], v[160:163], v[56:59]
s_waitcnt vmcnt(44)
s_barrier
s_mov_b32 m0, 78208
s_addk_i32 s32, 4096
buffer_load_dwordx4 v44, s[8:11], s32 offen nt lds
ds_read_b128 a[208:211], v6 offset:0
ds_read_b128 a[212:215], v7 offset:0
v_mfma_f32_16x16x32_bf16 v[64:67], a[224:227], v[160:163], v[64:67]
ds_read_b128 a[216:219], v6 offset:128
buffer_load_dwordx4 v45, s[8:11], s32 offen offset:1024 nt lds
buffer_load_dwordx4 v36, s[8:11], s32 offen offset:2048 nt lds
v_mfma_f32_16x16x32_bf16 v[72:75], a[228:231], v[160:163], v[72:75]
s_waitcnt lgkmcnt(9)
ds_read_b128 a[220:223], v7 offset:128
buffer_load_dwordx4 v37, s[8:11], s32 offen offset:3072 nt lds
v_mfma_f32_16x16x32_bf16 v[80:83], a[232:235], v[160:163], v[80:83]
s_addk_i32 m0, 4096
s_addk_i32 s32, 4096
buffer_load_dwordx4 v38, s[8:11], s32 offen nt lds
ds_read_b128 a[224:227], v6 offset:256
buffer_load_dwordx4 v39, s[8:11], s32 offen offset:1024 nt lds
v_mfma_f32_16x16x32_bf16 v[88:91], a[236:239], v[160:163], v[88:91]
ds_read_b128 a[228:231], v7 offset:256
buffer_load_dwordx4 v44, s[8:11], s32 offen offset:2048 nt lds
v_mfma_f32_16x16x32_bf16 v[96:99], a[240:243], v[160:163], v[96:99]
s_waitcnt lgkmcnt(6)
ds_read_b128 a[232:235], v6 offset:6144
buffer_load_dwordx4 v45, s[8:11], s32 offen offset:3072 nt lds
v_mfma_f32_16x16x32_bf16 v[104:107], a[244:247], v[160:163], v[104:107]
s_mov_b32 m0, 45248
s_addk_i32 s33, 4096
buffer_load_dwordx4 v52, s[12:15], s33 offen nt lds
ds_read_b128 a[236:239], v7 offset:6144
buffer_load_dwordx4 v46, s[12:15], s33 offen offset:1024 nt lds
v_mfma_f32_16x16x32_bf16 v[112:115], a[248:251], v[160:163], v[112:115]
ds_read_b128 a[240:243], v6 offset:6272
buffer_load_dwordx4 v47, s[12:15], s33 offen offset:2048 nt lds
v_mfma_f32_16x16x32_bf16 v[120:123], a[252:255], v[160:163], v[120:123]
buffer_load_dwordx4 v52, s[12:15], s33 offen offset:3072 nt lds
L_O1a:
s_waitcnt vmcnt(63)
s_barrier
ds_read_b64_tr_b16 a[208:209], v20 offset:0
ds_read_b64_tr_b16 a[210:211], v20 offset:2048
ds_read_b64_tr_b16 a[212:213], v20 offset:4096
ds_read_b64_tr_b16 a[214:215], v20 offset:6144
ds_read_b64_tr_b16 a[216:217], v20 offset:8192
ds_read_b64_tr_b16 a[218:219], v20 offset:10240
ds_read_b64_tr_b16 a[220:221], v21 offset:0
ds_read_b64_tr_b16 a[222:223], v21 offset:2048
ds_read_b64_tr_b16 a[224:225], v21 offset:4096
ds_read_b64_tr_b16 a[226:227], v21 offset:6144
ds_read_b64_tr_b16 a[228:229], v21 offset:8192
ds_read_b64_tr_b16 a[230:231], v21 offset:10240
ds_read_b64_tr_b16 a[232:233], v22 offset:0
ds_read_b64_tr_b16 a[234:235], v22 offset:2048
ds_read_b64_tr_b16 a[236:237], v22 offset:4096
ds_read_b64_tr_b16 a[238:239], v22 offset:6144
ds_read_b64_tr_b16 a[240:241], v22 offset:8192
ds_read_b64_tr_b16 a[242:243], v22 offset:10240
s_waitcnt lgkmcnt(12)
v_mfma_f32_16x16x32_bf16 a[0:3], a[208:211], a[160:163], a[0:3]
s_movk_i32 m0, 0
s_addk_i32 s32, 4096
buffer_load_dwordx4 v36, s[8:11], s32 offen nt lds
ds_read_b64_tr_b16 a[244:245], v23 offset:0
ds_read_b64_tr_b16 a[246:247], v23 offset:2048
ds_read_b64_tr_b16 a[248:249], v23 offset:4096
ds_read_b64_tr_b16 a[250:251], v23 offset:6144
v_mfma_f32_16x16x32_bf16 a[0:3], a[212:215], a[168:171], a[0:3]
ds_read_b64_tr_b16 a[252:253], v23 offset:8192
ds_read_b64_tr_b16 a[254:255], v23 offset:10240
buffer_load_dwordx4 v37, s[8:11], s32 offen offset:1024 nt lds
buffer_load_dwordx4 v38, s[8:11], s32 offen offset:2048 nt lds
v_mfma_f32_16x16x32_bf16 a[0:3], a[216:219], a[176:179], a[0:3]
s_waitcnt lgkmcnt(12)
buffer_load_dwordx4 v39, s[8:11], s32 offen offset:3072 nt lds
v_mfma_f32_16x16x32_bf16 a[4:7], a[220:223], a[160:163], a[4:7]
s_waitcnt vmcnt(63)
s_barrier
s_mov_b32 m0, 61760
s_addk_i32 s33, 4096
buffer_load_dwordx4 v46, s[12:15], s33 offen nt lds
ds_read_b64_tr_b16 a[208:209], v20 offset:12352
ds_read_b64_tr_b16 a[210:211], v20 offset:14400
ds_read_b64_tr_b16 a[212:213], v20 offset:16448
v_mfma_f32_16x16x32_bf16 a[4:7], a[224:227], a[168:171], a[4:7]
ds_read_b64_tr_b16 a[214:215], v20 offset:18496
ds_read_b64_tr_b16 a[216:217], v20 offset:20544
ds_read_b64_tr_b16 a[218:219], v20 offset:22592
buffer_load_dwordx4 v47, s[12:15], s33 offen offset:1024 nt lds
v_mfma_f32_16x16x32_bf16 a[4:7], a[228:231], a[176:179], a[4:7]
s_waitcnt lgkmcnt(12)
ds_read_b64_tr_b16 a[220:221], v21 offset:12352
ds_read_b64_tr_b16 a[222:223], v21 offset:14400
buffer_load_dwordx4 v52, s[12:15], s33 offen offset:2048 nt lds
v_mfma_f32_16x16x32_bf16 a[8:11], a[232:235], a[160:163], a[8:11]
ds_read_b64_tr_b16 a[224:225], v21 offset:16448
ds_read_b64_tr_b16 a[226:227], v21 offset:18496
v_mfma_f32_16x16x32_bf16 a[8:11], a[236:239], a[168:171], a[8:11]
ds_read_b64_tr_b16 a[228:229], v21 offset:20544
ds_read_b64_tr_b16 a[230:231], v21 offset:22592
buffer_load_dwordx4 v46, s[12:15], s33 offen offset:3072 nt lds
v_mfma_f32_16x16x32_bf16 a[8:11], a[240:243], a[176:179], a[8:11]
s_waitcnt lgkmcnt(12)
s_addk_i32 m0, 4096
s_addk_i32 s33, 4096
buffer_load_dwordx4 v47, s[12:15], s33 offen nt lds
ds_read_b64_tr_b16 a[232:233], v22 offset:12352
ds_read_b64_tr_b16 a[234:235], v22 offset:14400
v_mfma_f32_16x16x32_bf16 a[12:15], a[244:247], a[160:163], a[12:15]
ds_read_b64_tr_b16 a[236:237], v22 offset:16448
ds_read_b64_tr_b16 a[238:239], v22 offset:18496
buffer_load_dwordx4 v52, s[12:15], s33 offen offset:1024 nt lds
v_mfma_f32_16x16x32_bf16 a[12:15], a[248:251], a[168:171], a[12:15]
ds_read_b64_tr_b16 a[240:241], v22 offset:20544
ds_read_b64_tr_b16 a[242:243], v22 offset:22592
v_mfma_f32_16x16x32_bf16 a[12:15], a[252:255], a[176:179], a[12:15]
s_waitcnt lgkmcnt(12)
ds_read_b64_tr_b16 a[244:245], v23 offset:12352
ds_read_b64_tr_b16 a[246:247], v23 offset:14400
buffer_load_dwordx4 v46, s[12:15], s33 offen offset:2048 nt lds
v_mfma_f32_16x16x32_bf16 a[0:3], a[208:211], a[184:187], a[0:3]
ds_read_b64_tr_b16 a[248:249], v23 offset:16448
ds_read_b64_tr_b16 a[250:251], v23 offset:18496
buffer_load_dwordx4 v47, s[12:15], s33 offen offset:3072 nt lds
v_mfma_f32_16x16x32_bf16 a[0:3], a[212:215], a[192:195], a[0:3]
ds_read_b64_tr_b16 a[252:253], v23 offset:20544
ds_read_b64_tr_b16 a[254:255], v23 offset:22592
v_mfma_f32_16x16x32_bf16 a[0:3], a[216:219], a[200:203], a[0:3]
s_waitcnt lgkmcnt(12)
v_mfma_f32_16x16x32_bf16 a[4:7], a[220:223], a[184:187], a[4:7]
s_waitcnt vmcnt(52)
s_barrier
s_mov_b32 m0, 98816
s_add_u32 s36, s35, 123136
buffer_load_dwordx4 v63, s[20:23], s36 offen lds
ds_read_b64_tr_b16 a[208:209], v20 offset:24704
ds_read_b64_tr_b16 a[210:211], v20 offset:26752
ds_read_b64_tr_b16 a[212:213], v20 offset:28800
v_mfma_f32_16x16x32_bf16 a[4:7], a[224:227], a[192:195], a[4:7]
ds_read_b64_tr_b16 a[214:215], v20 offset:30848
ds_read_b64_tr_b16 a[216:217], v20 offset:32896
ds_read_b64_tr_b16 a[218:219], v20 offset:34944
buffer_load_dwordx4 v68, s[20:23], s36 offen offset:1024 lds
v_mfma_f32_16x16x32_bf16 a[4:7], a[228:231], a[200:203], a[4:7]
s_waitcnt lgkmcnt(12)
ds_read_b64_tr_b16 a[220:221], v21 offset:24704
ds_read_b64_tr_b16 a[222:223], v21 offset:26752
buffer_load_dwordx4 v69, s[20:23], s36 offen offset:2048 lds
v_mfma_f32_16x16x32_bf16 a[8:11], a[232:235], a[184:187], a[8:11]
ds_read_b64_tr_b16 a[224:225], v21 offset:28800
ds_read_b64_tr_b16 a[226:227], v21 offset:30848
buffer_load_dwordx4 v70, s[20:23], s36 offen offset:3072 lds
v_mfma_f32_16x16x32_bf16 a[8:11], a[236:239], a[192:195], a[8:11]
s_addk_i32 m0, 4096
s_add_u32 s36, s35, 164096
buffer_load_dwordx4 v63, s[20:23], s36 offen lds
ds_read_b64_tr_b16 a[228:229], v21 offset:32896
ds_read_b64_tr_b16 a[230:231], v21 offset:34944
v_mfma_f32_16x16x32_bf16 a[8:11], a[240:243], a[200:203], a[8:11]
s_waitcnt lgkmcnt(12)
ds_read_b64_tr_b16 a[232:233], v22 offset:24704
ds_read_b64_tr_b16 a[234:235], v22 offset:26752
buffer_load_dwordx4 v68, s[20:23], s36 offen offset:1024 lds
v_mfma_f32_16x16x32_bf16 a[12:15], a[244:247], a[184:187], a[12:15]
ds_read_b64_tr_b16 a[236:237], v22 offset:28800
ds_read_b64_tr_b16 a[238:239], v22 offset:30848
buffer_load_dwordx4 v69, s[20:23], s36 offen offset:2048 lds
v_mfma_f32_16x16x32_bf16 a[12:15], a[248:251], a[192:195], a[12:15]
ds_read_b64_tr_b16 a[240:241], v22 offset:32896
ds_read_b64_tr_b16 a[242:243], v22 offset:34944
buffer_load_dwordx4 v70, s[20:23], s36 offen offset:3072 lds
v_mfma_f32_16x16x32_bf16 a[12:15], a[252:255], a[200:203], a[12:15]
s_waitcnt lgkmcnt(12)
s_addk_i32 m0, 4096
s_add_u32 s36, s35, 205056
buffer_load_dwordx4 v63, s[20:23], s36 offen lds
ds_read_b64_tr_b16 a[244:245], v23 offset:24704
ds_read_b64_tr_b16 a[246:247], v23 offset:26752
v_mfma_f32_16x16x32_bf16 a[16:19], a[208:211], a[160:163], a[16:19]
ds_read_b64_tr_b16 a[248:249], v23 offset:28800
ds_read_b64_tr_b16 a[250:251], v23 offset:30848
buffer_load_dwordx4 v68, s[20:23], s36 offen offset:1024 lds
v_mfma_f32_16x16x32_bf16 a[16:19], a[212:215], a[168:171], a[16:19]
ds_read_b64_tr_b16 a[252:253], v23 offset:32896
ds_read_b64_tr_b16 a[254:255], v23 offset:34944
buffer_load_dwordx4 v69, s[20:23], s36 offen offset:2048 lds
v_mfma_f32_16x16x32_bf16 a[16:19], a[216:219], a[176:179], a[16:19]
s_waitcnt lgkmcnt(12)
buffer_load_dwordx4 v70, s[20:23], s36 offen offset:3072 lds
v_mfma_f32_16x16x32_bf16 a[20:23], a[220:223], a[160:163], a[20:23]
s_waitcnt vmcnt(52)
s_barrier
s_movk_i32 m0, 4096
s_addk_i32 s32, 4096
buffer_load_dwordx4 v44, s[8:11], s32 offen nt lds
ds_read_b64_tr_b16 a[208:209], v20 offset:37056
ds_read_b64_tr_b16 a[210:211], v20 offset:39104
ds_read_b64_tr_b16 a[212:213], v20 offset:41152
v_mfma_f32_16x16x32_bf16 a[20:23], a[224:227], a[168:171], a[20:23]
ds_read_b64_tr_b16 a[214:215], v20 offset:43200
ds_read_b64_tr_b16 a[216:217], v20 offset:45248
ds_read_b64_tr_b16 a[218:219], v20 offset:47296
buffer_load_dwordx4 v45, s[8:11], s32 offen offset:1024 nt lds
buffer_load_dwordx4 v36, s[8:11], s32 offen offset:2048 nt lds
v_mfma_f32_16x16x32_bf16 a[20:23], a[228:231], a[176:179], a[20:23]
s_waitcnt lgkmcnt(12)
ds_read_b64_tr_b16 a[220:221], v21 offset:37056
ds_read_b64_tr_b16 a[222:223], v21 offset:39104
buffer_load_dwordx4 v37, s[8:11], s32 offen offset:3072 nt lds
v_mfma_f32_16x16x32_bf16 a[24:27], a[232:235], a[160:163], a[24:27]
s_mov_b32 m0, 69952
s_addk_i32 s33, 4096
buffer_load_dwordx4 v52, s[12:15], s33 offen nt lds
ds_read_b64_tr_b16 a[224:225], v21 offset:41152
ds_read_b64_tr_b16 a[226:227], v21 offset:43200
buffer_load_dwordx4 v46, s[12:15], s33 offen offset:1024 nt lds
v_mfma_f32_16x16x32_bf16 a[24:27], a[236:239], a[168:171], a[24:27]
ds_read_b64_tr_b16 a[228:229], v21 offset:45248
ds_read_b64_tr_b16 a[230:231], v21 offset:47296
buffer_load_dwordx4 v47, s[12:15], s33 offen offset:2048 nt lds
v_mfma_f32_16x16x32_bf16 a[24:27], a[240:243], a[176:179], a[24:27]
s_waitcnt lgkmcnt(12)
ds_read_b64_tr_b16 a[232:233], v22 offset:37056
ds_read_b64_tr_b16 a[234:235], v22 offset:39104
buffer_load_dwordx4 v52, s[12:15], s33 offen offset:3072 nt lds
v_mfma_f32_16x16x32_bf16 a[28:31], a[244:247], a[160:163], a[28:31]
s_addk_i32 m0, 16512
s_addk_i32 s33, 4096
buffer_load_dwordx4 v46, s[12:15], s33 offen nt lds
ds_read_b64_tr_b16 a[236:237], v22 offset:41152
ds_read_b64_tr_b16 a[238:239], v22 offset:43200
buffer_load_dwordx4 v47, s[12:15], s33 offen offset:1024 nt lds
v_mfma_f32_16x16x32_bf16 a[28:31], a[248:251], a[168:171], a[28:31]
ds_read_b64_tr_b16 a[240:241], v22 offset:45248
ds_read_b64_tr_b16 a[242:243], v22 offset:47296
buffer_load_dwordx4 v52, s[12:15], s33 offen offset:2048 nt lds
v_mfma_f32_16x16x32_bf16 a[28:31], a[252:255], a[176:179], a[28:31]
s_waitcnt lgkmcnt(12)
ds_read_b64_tr_b16 a[244:245], v23 offset:37056
ds_read_b64_tr_b16 a[246:247], v23 offset:39104
buffer_load_dwordx4 v46, s[12:15], s33 offen offset:3072 nt lds
v_mfma_f32_16x16x32_bf16 a[16:19], a[208:211], a[184:187], a[16:19]
s_addk_i32 m0, 4096
s_addk_i32 s33, 4096
buffer_load_dwordx4 v47, s[12:15], s33 offen nt lds
ds_read_b64_tr_b16 a[248:249], v23 offset:41152
ds_read_b64_tr_b16 a[250:251], v23 offset:43200
buffer_load_dwordx4 v52, s[12:15], s33 offen offset:1024 nt lds
v_mfma_f32_16x16x32_bf16 a[16:19], a[212:215], a[192:195], a[16:19]
ds_read_b64_tr_b16 a[252:253], v23 offset:45248
ds_read_b64_tr_b16 a[254:255], v23 offset:47296
buffer_load_dwordx4 v46, s[12:15], s33 offen offset:2048 nt lds
v_mfma_f32_16x16x32_bf16 a[16:19], a[216:219], a[200:203], a[16:19]
s_waitcnt lgkmcnt(12)
buffer_load_dwordx4 v47, s[12:15], s33 offen offset:3072 nt lds
v_mfma_f32_16x16x32_bf16 a[20:23], a[220:223], a[184:187], a[20:23]
s_waitcnt vmcnt(56)
s_barrier
s_movk_i32 m0, 8192
s_addk_i32 s32, 4096
buffer_load_dwordx4 v38, s[8:11], s32 offen nt lds
ds_read_b64_tr_b16 a[208:209], v20 offset:49408
ds_read_b64_tr_b16 a[210:211], v20 offset:51456
ds_read_b64_tr_b16 a[212:213], v20 offset:53504
v_mfma_f32_16x16x32_bf16 a[20:23], a[224:227], a[192:195], a[20:23]
ds_read_b64_tr_b16 a[214:215], v20 offset:55552
ds_read_b64_tr_b16 a[216:217], v20 offset:57600
ds_read_b64_tr_b16 a[218:219], v20 offset:59648
buffer_load_dwordx4 v39, s[8:11], s32 offen offset:1024 nt lds
v_mfma_f32_16x16x32_bf16 a[20:23], a[228:231], a[200:203], a[20:23]
s_waitcnt lgkmcnt(12)
ds_read_b64_tr_b16 a[220:221], v21 offset:49408
ds_read_b64_tr_b16 a[222:223], v21 offset:51456
buffer_load_dwordx4 v44, s[8:11], s32 offen offset:2048 nt lds
v_mfma_f32_16x16x32_bf16 a[24:27], a[232:235], a[184:187], a[24:27]
ds_read_b64_tr_b16 a[224:225], v21 offset:53504
ds_read_b64_tr_b16 a[226:227], v21 offset:55552
buffer_load_dwordx4 v45, s[8:11], s32 offen offset:3072 nt lds
v_mfma_f32_16x16x32_bf16 a[24:27], a[236:239], a[192:195], a[24:27]
s_mov_b32 m0, 94656
s_addk_i32 s33, 4096
buffer_load_dwordx4 v52, s[12:15], s33 offen nt lds
ds_read_b64_tr_b16 a[228:229], v21 offset:57600
ds_read_b64_tr_b16 a[230:231], v21 offset:59648
v_mfma_f32_16x16x32_bf16 a[24:27], a[240:243], a[200:203], a[24:27]
s_waitcnt lgkmcnt(12)
ds_read_b64_tr_b16 a[232:233], v22 offset:49408
ds_read_b64_tr_b16 a[234:235], v22 offset:51456
buffer_load_dwordx4 v46, s[12:15], s33 offen offset:1024 nt lds
v_mfma_f32_16x16x32_bf16 a[28:31], a[244:247], a[184:187], a[28:31]
ds_read_b64_tr_b16 a[236:237], v22 offset:53504
ds_read_b64_tr_b16 a[238:239], v22 offset:55552
buffer_load_dwordx4 v47, s[12:15], s33 offen offset:2048 nt lds
v_mfma_f32_16x16x32_bf16 a[28:31], a[248:251], a[192:195], a[28:31]
ds_read_b64_tr_b16 a[240:241], v22 offset:57600
ds_read_b64_tr_b16 a[242:243], v22 offset:59648
buffer_load_dwordx4 v52, s[12:15], s33 offen offset:3072 nt lds
v_mfma_f32_16x16x32_bf16 a[28:31], a[252:255], a[200:203], a[28:31]
s_waitcnt lgkmcnt(12)
s_movk_i32 m0, 12352
s_addk_i32 s33, 4096
buffer_load_dwordx4 v46, s[12:15], s33 offen nt lds
ds_read_b64_tr_b16 a[244:245], v23 offset:49408
ds_read_b64_tr_b16 a[246:247], v23 offset:51456
v_mfma_f32_16x16x32_bf16 a[32:35], a[208:211], a[160:163], a[32:35]
ds_read_b64_tr_b16 a[248:249], v23 offset:53504
ds_read_b64_tr_b16 a[250:251], v23 offset:55552
buffer_load_dwordx4 v47, s[12:15], s33 offen offset:1024 nt lds
v_mfma_f32_16x16x32_bf16 a[32:35], a[212:215], a[168:171], a[32:35]
ds_read_b64_tr_b16 a[252:253], v23 offset:57600
ds_read_b64_tr_b16 a[254:255], v23 offset:59648
buffer_load_dwordx4 v52, s[12:15], s33 offen offset:2048 nt lds
v_mfma_f32_16x16x32_bf16 a[32:35], a[216:219], a[176:179], a[32:35]
s_waitcnt lgkmcnt(12)
buffer_load_dwordx4 v46, s[12:15], s33 offen offset:3072 nt lds
v_mfma_f32_16x16x32_bf16 a[36:39], a[220:223], a[160:163], a[36:39]
s_waitcnt vmcnt(28)
s_barrier
s_mov_b32 m0, 111168
s_add_u32 s36, s35, 384
buffer_load_dwordx4 v63, s[20:23], s36 offen lds
ds_read_b64_tr_b16 a[208:209], v20 offset:0
ds_read_b64_tr_b16 a[210:211], v20 offset:2048
ds_read_b64_tr_b16 a[212:213], v20 offset:4096
v_mfma_f32_16x16x32_bf16 a[36:39], a[224:227], a[168:171], a[36:39]
ds_read_b64_tr_b16 a[214:215], v20 offset:6144
ds_read_b64_tr_b16 a[216:217], v20 offset:8192
ds_read_b64_tr_b16 a[218:219], v20 offset:10240
buffer_load_dwordx4 v68, s[20:23], s36 offen offset:1024 lds
buffer_load_dwordx4 v69, s[20:23], s36 offen offset:2048 lds
v_mfma_f32_16x16x32_bf16 a[36:39], a[228:231], a[176:179], a[36:39]
s_waitcnt lgkmcnt(12)
ds_read_b64_tr_b16 a[220:221], v21 offset:0
ds_read_b64_tr_b16 a[222:223], v21 offset:2048
buffer_load_dwordx4 v70, s[20:23], s36 offen offset:3072 lds
v_mfma_f32_16x16x32_bf16 a[40:43], a[232:235], a[160:163], a[40:43]
s_addk_i32 m0, 4096
s_add_u32 s36, s35, 41344
buffer_load_dwordx4 v63, s[20:23], s36 offen lds
ds_read_b64_tr_b16 a[224:225], v21 offset:4096
ds_read_b64_tr_b16 a[226:227], v21 offset:6144
buffer_load_dwordx4 v68, s[20:23], s36 offen offset:1024 lds
v_mfma_f32_16x16x32_bf16 a[40:43], a[236:239], a[168:171], a[40:43]
ds_read_b64_tr_b16 a[228:229], v21 offset:8192
ds_read_b64_tr_b16 a[230:231], v21 offset:10240
buffer_load_dwordx4 v69, s[20:23], s36 offen offset:2048 lds
buffer_load_dwordx4 v70, s[20:23], s36 offen offset:3072 lds
v_mfma_f32_16x16x32_bf16 a[40:43], a[240:243], a[176:179], a[40:43]
s_waitcnt lgkmcnt(12)
s_addk_i32 m0, 4096
s_add_u32 s36, s35, 82304
buffer_load_dwordx4 v63, s[20:23], s36 offen lds
ds_read_b64_tr_b16 a[232:233], v22 offset:0
ds_read_b64_tr_b16 a[234:235], v22 offset:2048
buffer_load_dwordx4 v68, s[20:23], s36 offen offset:1024 lds
v_mfma_f32_16x16x32_bf16 a[44:47], a[244:247], a[160:163], a[44:47]
ds_read_b64_tr_b16 a[236:237], v22 offset:4096
ds_read_b64_tr_b16 a[238:239], v22 offset:6144
buffer_load_dwordx4 v69, s[20:23], s36 offen offset:2048 lds
buffer_load_dwordx4 v70, s[20:23], s36 offen offset:3072 lds
v_mfma_f32_16x16x32_bf16 a[44:47], a[248:251], a[168:171], a[44:47]
s_addk_i32 m0, 4160
s_add_u32 s36, s35, 123264
buffer_load_dwordx4 v63, s[20:23], s36 offen lds
ds_read_b64_tr_b16 a[240:241], v22 offset:8192
ds_read_b64_tr_b16 a[242:243], v22 offset:10240
buffer_load_dwordx4 v68, s[20:23], s36 offen offset:1024 lds
v_mfma_f32_16x16x32_bf16 a[44:47], a[252:255], a[176:179], a[44:47]
s_waitcnt lgkmcnt(12)
ds_read_b64_tr_b16 a[244:245], v23 offset:0
ds_read_b64_tr_b16 a[246:247], v23 offset:2048
buffer_load_dwordx4 v69, s[20:23], s36 offen offset:2048 lds
buffer_load_dwordx4 v70, s[20:23], s36 offen offset:3072 lds
v_mfma_f32_16x16x32_bf16 a[32:35], a[208:211], a[184:187], a[32:35]
s_addk_i32 m0, 4096
s_add_u32 s36, s35, 164224
buffer_load_dwordx4 v63, s[20:23], s36 offen lds
ds_read_b64_tr_b16 a[248:249], v23 offset:4096
ds_read_b64_tr_b16 a[250:251], v23 offset:6144
buffer_load_dwordx4 v68, s[20:23], s36 offen offset:1024 lds
v_mfma_f32_16x16x32_bf16 a[32:35], a[212:215], a[192:195], a[32:35]
ds_read_b64_tr_b16 a[252:253], v23 offset:8192
ds_read_b64_tr_b16 a[254:255], v23 offset:10240
buffer_load_dwordx4 v69, s[20:23], s36 offen offset:2048 lds
v_mfma_f32_16x16x32_bf16 a[32:35], a[216:219], a[200:203], a[32:35]
s_waitcnt lgkmcnt(12)
ds_read_b128 a[208:211], v6 offset:0
buffer_load_dwordx4 v70, s[20:23], s36 offen offset:3072 lds
v_mfma_f32_16x16x32_bf16 a[36:39], a[220:223], a[184:187], a[36:39]
s_addk_i32 m0, 4096
s_add_u32 s36, s35, 205184
buffer_load_dwordx4 v63, s[20:23], s36 offen lds
ds_read_b128 a[212:215], v7 offset:0
buffer_load_dwordx4 v68, s[20:23], s36 offen offset:1024 lds
v_mfma_f32_16x16x32_bf16 a[36:39], a[224:227], a[192:195], a[36:39]
ds_read_b128 a[216:219], v6 offset:128
buffer_load_dwordx4 v69, s[20:23], s36 offen offset:2048 lds
buffer_load_dwordx4 v70, s[20:23], s36 offen offset:3072 lds
v_mfma_f32_16x16x32_bf16 a[36:39], a[228:231], a[200:203], a[36:39]
s_waitcnt lgkmcnt(9)
s_addk_i32 m0, 4160
s_add_u32 s36, s35, 512
buffer_load_dwordx4 v63, s[20:23], s36 offen lds
ds_read_b128 a[220:223], v7 offset:128
buffer_load_dwordx4 v68, s[20:23], s36 offen offset:1024 lds
v_mfma_f32_16x16x32_bf16 a[40:43], a[232:235], a[184:187], a[40:43]
ds_read_b128 a[224:227], v6 offset:256
buffer_load_dwordx4 v69, s[20:23], s36 offen offset:2048 lds
buffer_load_dwordx4 v70, s[20:23], s36 offen offset:3072 lds
v_mfma_f32_16x16x32_bf16 a[40:43], a[236:239], a[192:195], a[40:43]
s_addk_i32 m0, 4096
s_add_u32 s36, s35, 41472
buffer_load_dwordx4 v63, s[20:23], s36 offen lds
ds_read_b128 a[228:231], v7 offset:256
buffer_load_dwordx4 v68, s[20:23], s36 offen offset:1024 lds
v_mfma_f32_16x16x32_bf16 a[40:43], a[240:243], a[200:203], a[40:43]
s_waitcnt lgkmcnt(6)
ds_read_b128 a[232:235], v6 offset:6144
buffer_load_dwordx4 v69, s[20:23], s36 offen offset:2048 lds
v_mfma_f32_16x16x32_bf16 a[44:47], a[244:247], a[184:187], a[44:47]
ds_read_b128 a[236:239], v7 offset:6144
buffer_load_dwordx4 v70, s[20:23], s36 offen offset:3072 lds
v_mfma_f32_16x16x32_bf16 a[44:47], a[248:251], a[192:195], a[44:47]
s_addk_i32 m0, 4096
s_add_u32 s36, s35, 82432
buffer_load_dwordx4 v63, s[20:23], s36 offen lds
ds_read_b128 a[240:243], v6 offset:6272
buffer_load_dwordx4 v68, s[20:23], s36 offen offset:1024 lds
v_mfma_f32_16x16x32_bf16 a[44:47], a[252:255], a[200:203], a[44:47]
buffer_load_dwordx4 v69, s[20:23], s36 offen offset:2048 lds
buffer_load_dwordx4 v70, s[20:23], s36 offen offset:3072 lds
s_waitcnt lgkmcnt(6)
v_mfma_f32_16x16x32_bf16 v[144:147], a[208:211], v[192:195], v[136:139]
ds_read_b128 a[244:247], v7 offset:6272
ds_read_b128 a[248:251], v6 offset:6400
v_exp_f32_e32 v154, v154
v_exp_f32_e32 v155, v155
v_add_f32_e32 v128, v128, v152
v_add_f32_e32 v129, v129, v153
v_add_f32_e32 v130, v130, v154
v_mfma_f32_16x16x32_bf16 v[144:147], a[212:215], v[200:203], v[144:147]
ds_read_b128 a[252:255], v7 offset:6400
v_add_f32_e32 v131, v131, v155
v_cvt_pk_bf16_f32 v171, v154, v155
v_mfma_f32_16x16x32_bf16 v[144:147], a[216:219], v[208:211], v[144:147]
s_waitcnt lgkmcnt(6)
v_mfma_f32_16x16x32_bf16 v[144:147], a[220:223], v[216:219], v[144:147]
s_waitcnt vmcnt(63)
s_barrier
s_mov_b32 m0, 148224
s_add_u32 s36, s35, 123392
buffer_load_dwordx4 v63, s[20:23], s36 offen lds
ds_read_b64_tr_b16 a[208:209], v8 offset:37056
ds_read_b64_tr_b16 a[210:211], v8 offset:43200
ds_read_b64_tr_b16 a[212:213], v9 offset:37056
v_mfma_f32_16x16x32_bf16 v[144:147], a[224:227], v[224:227], v[144:147]
ds_read_b64_tr_b16 a[214:215], v9 offset:43200
ds_read_b64_tr_b16 a[216:217], v10 offset:37056
ds_read_b64_tr_b16 a[218:219], v10 offset:43200
buffer_load_dwordx4 v68, s[20:23], s36 offen offset:1024 lds
v_mfma_f32_16x16x32_bf16 v[144:147], a[228:231], v[232:235], v[144:147]
s_waitcnt lgkmcnt(9)
ds_read_b64_tr_b16 a[220:221], v11 offset:37056
ds_read_b64_tr_b16 a[222:223], v11 offset:43200
buffer_load_dwordx4 v69, s[20:23], s36 offen offset:2048 lds
v_mfma_f32_16x16x32_bf16 v[152:155], a[232:235], v[192:195], v[136:139]
ds_read_b64_tr_b16 a[224:225], v8 offset:37184
ds_read_b64_tr_b16 a[226:227], v8 offset:43328
buffer_load_dwordx4 v70, s[20:23], s36 offen offset:3072 lds
v_exp_f32_e32 v144, v144
v_exp_f32_e32 v145, v145
v_mfma_f32_16x16x32_bf16 v[152:155], a[236:239], v[200:203], v[152:155]
s_movk_i32 m0, 24704
s_addk_i32 s32, 4096
buffer_load_dwordx4 v36, s[8:11], s32 offen nt lds
ds_read_b64_tr_b16 a[228:229], v9 offset:37184
v_exp_f32_e32 v146, v146
v_exp_f32_e32 v147, v147
v_mfma_f32_16x16x32_bf16 v[152:155], a[240:243], v[208:211], v[152:155]
s_waitcnt lgkmcnt(11)
ds_read_b64_tr_b16 a[230:231], v9 offset:43328
ds_read_b64_tr_b16 a[232:233], v10 offset:37184
ds_read_b64_tr_b16 a[234:235], v10 offset:43328
buffer_load_dwordx4 v37, s[8:11], s32 offen offset:1024 nt lds
v_add_f32_e32 v128, v128, v144
v_add_f32_e32 v129, v129, v145
v_add_f32_e32 v130, v130, v146
v_mfma_f32_16x16x32_bf16 v[152:155], a[244:247], v[216:219], v[152:155]
ds_read_b64_tr_b16 a[236:237], v11 offset:37184
ds_read_b64_tr_b16 a[238:239], v11 offset:43328
buffer_load_dwordx4 v38, s[8:11], s32 offen offset:2048 nt lds
v_add_f32_e32 v131, v131, v147
v_cvt_pk_bf16_f32 v160, v144, v145
v_cvt_pk_bf16_f32 v161, v146, v147
v_mfma_f32_16x16x32_bf16 v[152:155], a[248:251], v[224:227], v[152:155]
ds_read_b64_tr_b16 a[240:241], v8 offset:37312
ds_read_b64_tr_b16 a[242:243], v8 offset:43456
buffer_load_dwordx4 v39, s[8:11], s32 offen offset:3072 nt lds
v_mfma_f32_16x16x32_bf16 v[152:155], a[252:255], v[232:235], v[152:155]
s_waitcnt lgkmcnt(12)
s_movk_i32 m0, 16448
s_addk_i32 s33, 4096
buffer_load_dwordx4 v47, s[12:15], s33 offen nt lds
ds_read_b64_tr_b16 a[244:245], v9 offset:37312
ds_read_b64_tr_b16 a[246:247], v9 offset:43456
v_mfma_f32_16x16x32_bf16 v[32:35], a[208:211], v[168:171], v[32:35]
ds_read_b64_tr_b16 a[248:249], v10 offset:37312
ds_read_b64_tr_b16 a[250:251], v10 offset:43456
buffer_load_dwordx4 v52, s[12:15], s33 offen offset:1024 nt lds
v_exp_f32_e32 v152, v152
v_exp_f32_e32 v153, v153
v_mfma_f32_16x16x32_bf16 v[40:43], a[212:215], v[168:171], v[40:43]
ds_read_b64_tr_b16 a[252:253], v11 offset:37312
ds_read_b64_tr_b16 a[254:255], v11 offset:43456
buffer_load_dwordx4 v46, s[12:15], s33 offen offset:2048 nt lds
v_cvt_pk_bf16_f32 v162, v152, v153
v_mfma_f32_16x16x32_bf16 v[48:51], a[216:219], v[168:171], v[48:51]
s_waitcnt lgkmcnt(12)
buffer_load_dwordx4 v47, s[12:15], s33 offen offset:3072 nt lds
v_mfma_f32_16x16x32_bf16 v[56:59], a[220:223], v[168:171], v[56:59]
s_waitcnt vmcnt(63)
s_barrier
s_movk_i32 m0, 28800
s_addk_i32 s32, 4096
buffer_load_dwordx4 v44, s[8:11], s32 offen nt lds
ds_read_b128 a[208:211], v6 offset:24704
ds_read_b128 a[212:215], v7 offset:24704
v_mfma_f32_16x16x32_bf16 v[64:67], a[224:227], v[168:171], v[64:67]
ds_read_b128 a[216:219], v6 offset:24832
buffer_load_dwordx4 v45, s[8:11], s32 offen offset:1024 nt lds
v_mfma_f32_16x16x32_bf16 v[72:75], a[228:231], v[168:171], v[72:75]
s_waitcnt lgkmcnt(9)
ds_read_b128 a[220:223], v7 offset:24832
buffer_load_dwordx4 v36, s[8:11], s32 offen offset:2048 nt lds
v_mfma_f32_16x16x32_bf16 v[80:83], a[232:235], v[168:171], v[80:83]
ds_read_b128 a[224:227], v6 offset:24960
buffer_load_dwordx4 v37, s[8:11], s32 offen offset:3072 nt lds
v_mfma_f32_16x16x32_bf16 v[88:91], a[236:239], v[168:171], v[88:91]
s_addk_i32 m0, 4096
s_addk_i32 s32, 4096
buffer_load_dwordx4 v38, s[8:11], s32 offen nt lds
ds_read_b128 a[228:231], v7 offset:24960
v_mfma_f32_16x16x32_bf16 v[96:99], a[240:243], v[168:171], v[96:99]
s_waitcnt lgkmcnt(6)
ds_read_b128 a[232:235], v6 offset:30848
buffer_load_dwordx4 v39, s[8:11], s32 offen offset:1024 nt lds
v_mfma_f32_16x16x32_bf16 v[104:107], a[244:247], v[168:171], v[104:107]
ds_read_b128 a[236:239], v7 offset:30848
buffer_load_dwordx4 v44, s[8:11], s32 offen offset:2048 nt lds
v_mfma_f32_16x16x32_bf16 v[112:115], a[248:251], v[168:171], v[112:115]
ds_read_b128 a[240:243], v6 offset:30976
buffer_load_dwordx4 v45, s[8:11], s32 offen offset:3072 nt lds
v_mfma_f32_16x16x32_bf16 v[120:123], a[252:255], v[168:171], v[120:123]
s_waitcnt lgkmcnt(6)
s_movk_i32 m0, 20544
s_addk_i32 s33, 4096
buffer_load_dwordx4 v52, s[12:15], s33 offen nt lds
ds_read_b128 a[244:247], v7 offset:30976
v_mfma_f32_16x16x32_bf16 v[144:147], a[208:211], v[192:195], v[136:139]
ds_read_b128 a[248:251], v6 offset:31104
buffer_load_dwordx4 v46, s[12:15], s33 offen offset:1024 nt lds
v_exp_f32_e32 v154, v154
v_exp_f32_e32 v155, v155
v_add_f32_e32 v128, v128, v152
v_mfma_f32_16x16x32_bf16 v[144:147], a[212:215], v[200:203], v[144:147]
ds_read_b128 a[252:255], v7 offset:31104
buffer_load_dwordx4 v47, s[12:15], s33 offen offset:2048 nt lds
v_add_f32_e32 v129, v129, v153
v_add_f32_e32 v130, v130, v154
v_add_f32_e32 v131, v131, v155
v_cvt_pk_bf16_f32 v163, v154, v155
v_mfma_f32_16x16x32_bf16 v[144:147], a[216:219], v[208:211], v[144:147]
s_waitcnt lgkmcnt(6)
buffer_load_dwordx4 v52, s[12:15], s33 offen offset:3072 nt lds
v_mfma_f32_16x16x32_bf16 v[144:147], a[220:223], v[216:219], v[144:147]
s_waitcnt vmcnt(63)
s_barrier
s_addk_i32 m0, 28864
s_addk_i32 s32, 4096
buffer_load_dwordx4 v36, s[8:11], s32 offen nt lds
ds_read_b64_tr_b16 a[208:209], v12 offset:12352
ds_read_b64_tr_b16 a[210:211], v12 offset:18496
ds_read_b64_tr_b16 a[212:213], v13 offset:12352
v_mfma_f32_16x16x32_bf16 v[144:147], a[224:227], v[224:227], v[144:147]
ds_read_b64_tr_b16 a[214:215], v13 offset:18496
ds_read_b64_tr_b16 a[216:217], v14 offset:12352
ds_read_b64_tr_b16 a[218:219], v14 offset:18496
buffer_load_dwordx4 v37, s[8:11], s32 offen offset:1024 nt lds
v_mfma_f32_16x16x32_bf16 v[144:147], a[228:231], v[232:235], v[144:147]
s_waitcnt lgkmcnt(9)
ds_read_b64_tr_b16 a[220:221], v15 offset:12352
ds_read_b64_tr_b16 a[222:223], v15 offset:18496
buffer_load_dwordx4 v38, s[8:11], s32 offen offset:2048 nt lds
v_mfma_f32_16x16x32_bf16 v[152:155], a[232:235], v[192:195], v[136:139]
ds_read_b64_tr_b16 a[224:225], v12 offset:12480
ds_read_b64_tr_b16 a[226:227], v12 offset:18624
buffer_load_dwordx4 v39, s[8:11], s32 offen offset:3072 nt lds
v_exp_f32_e32 v144, v144
v_exp_f32_e32 v145, v145
v_mfma_f32_16x16x32_bf16 v[152:155], a[236:239], v[200:203], v[152:155]
s_addk_i32 m0, 4096
s_addk_i32 s32, 4096
buffer_load_dwordx4 v44, s[8:11], s32 offen nt lds
ds_read_b64_tr_b16 a[228:229], v13 offset:12480
v_exp_f32_e32 v146, v146
v_exp_f32_e32 v147, v147
v_mfma_f32_16x16x32_bf16 v[152:155], a[240:243], v[208:211], v[152:155]
s_waitcnt lgkmcnt(11)
ds_read_b64_tr_b16 a[230:231], v13 offset:18624
ds_read_b64_tr_b16 a[232:233], v14 offset:12480
ds_read_b64_tr_b16 a[234:235], v14 offset:18624
buffer_load_dwordx4 v45, s[8:11], s32 offen offset:1024 nt lds
v_add_f32_e32 v128, v128, v144
v_add_f32_e32 v129, v129, v145
v_add_f32_e32 v130, v130, v146
v_mfma_f32_16x16x32_bf16 v[152:155], a[244:247], v[216:219], v[152:155]
ds_read_b64_tr_b16 a[236:237], v15 offset:12480
ds_read_b64_tr_b16 a[238:239], v15 offset:18624
buffer_load_dwordx4 v36, s[8:11], s32 offen offset:2048 nt lds
v_add_f32_e32 v131, v131, v147
v_cvt_pk_bf16_f32 v168, v144, v145
v_cvt_pk_bf16_f32 v169, v146, v147
v_mfma_f32_16x16x32_bf16 v[152:155], a[248:251], v[224:227], v[152:155]
ds_read_b64_tr_b16 a[240:241], v12 offset:12608
ds_read_b64_tr_b16 a[242:243], v12 offset:18752
buffer_load_dwordx4 v37, s[8:11], s32 offen offset:3072 nt lds
v_mfma_f32_16x16x32_bf16 v[152:155], a[252:255], v[232:235], v[152:155]
s_waitcnt lgkmcnt(12)
s_addk_i32 m0, 4096
s_addk_i32 s32, 4096
buffer_load_dwordx4 v38, s[8:11], s32 offen nt lds
ds_read_b64_tr_b16 a[244:245], v13 offset:12608
ds_read_b64_tr_b16 a[246:247], v13 offset:18752
v_mfma_f32_16x16x32_bf16 v[32:35], a[208:211], v[160:163], v[32:35]
ds_read_b64_tr_b16 a[248:249], v14 offset:12608
ds_read_b64_tr_b16 a[250:251], v14 offset:18752
buffer_load_dwordx4 v39, s[8:11], s32 offen offset:1024 nt lds
v_exp_f32_e32 v152, v152
v_exp_f32_e32 v153, v153
v_mfma_f32_16x16x32_bf16 v[40:43], a[212:215], v[160:163], v[40:43]
ds_read_b64_tr_b16 a[252:253], v15 offset:12608
ds_read_b64_tr_b16 a[254:255], v15 offset:18752
buffer_load_dwordx4 v44, s[8:11], s32 offen offset:2048 nt lds
v_cvt_pk_bf16_f32 v170, v152, v153
v_mfma_f32_16x16x32_bf16 v[48:51], a[216:219], v[160:163], v[48:51]
s_waitcnt lgkmcnt(12)
buffer_load_dwordx4 v45, s[8:11], s32 offen offset:3072 nt lds
v_mfma_f32_16x16x32_bf16 v[56:59], a[220:223], v[160:163], v[56:59]
s_waitcnt vmcnt(63)
s_barrier
s_addk_i32 m0, -20544
s_addk_i32 s33, 4096
buffer_load_dwordx4 v46, s[12:15], s33 offen nt lds
ds_read_b128 a[208:211], v4 offset:0
ds_read_b128 a[212:215], v5 offset:0
v_mfma_f32_16x16x32_bf16 v[64:67], a[224:227], v[160:163], v[64:67]
ds_read_b128 a[216:219], v4 offset:128
buffer_load_dwordx4 v47, s[12:15], s33 offen offset:1024 nt lds
v_mfma_f32_16x16x32_bf16 v[72:75], a[228:231], v[160:163], v[72:75]
s_waitcnt lgkmcnt(9)
ds_read_b128 a[220:223], v5 offset:128
buffer_load_dwordx4 v52, s[12:15], s33 offen offset:2048 nt lds
v_mfma_f32_16x16x32_bf16 v[80:83], a[232:235], v[160:163], v[80:83]
ds_read_b128 a[224:227], v4 offset:256
v_mfma_f32_16x16x32_bf16 v[88:91], a[236:239], v[160:163], v[88:91]
ds_read_b128 a[228:231], v5 offset:256
buffer_load_dwordx4 v46, s[12:15], s33 offen offset:3072 nt lds
v_mfma_f32_16x16x32_bf16 v[96:99], a[240:243], v[160:163], v[96:99]
s_waitcnt lgkmcnt(6)
s_addk_i32 m0, 4096
s_addk_i32 s33, 4096
buffer_load_dwordx4 v47, s[12:15], s33 offen nt lds
ds_read_b128 a[232:235], v4 offset:6144
v_mfma_f32_16x16x32_bf16 v[104:107], a[244:247], v[160:163], v[104:107]
ds_read_b128 a[236:239], v5 offset:6144
buffer_load_dwordx4 v52, s[12:15], s33 offen offset:1024 nt lds
v_mfma_f32_16x16x32_bf16 v[112:115], a[248:251], v[160:163], v[112:115]
ds_read_b128 a[240:243], v4 offset:6272
v_mfma_f32_16x16x32_bf16 v[120:123], a[252:255], v[160:163], v[120:123]
s_waitcnt lgkmcnt(6)
ds_read_b128 a[244:247], v5 offset:6272
buffer_load_dwordx4 v46, s[12:15], s33 offen offset:2048 nt lds
v_mfma_f32_16x16x32_bf16 v[144:147], a[208:211], v[192:195], v[136:139]
ds_read_b128 a[248:251], v4 offset:6400
buffer_load_dwordx4 v47, s[12:15], s33 offen offset:3072 nt lds
v_exp_f32_e32 v154, v154
v_exp_f32_e32 v155, v155
v_add_f32_e32 v128, v128, v152
v_mfma_f32_16x16x32_bf16 v[144:147], a[212:215], v[200:203], v[144:147]
ds_read_b128 a[252:255], v5 offset:6400
v_add_f32_e32 v129, v129, v153
v_add_f32_e32 v130, v130, v154
v_add_f32_e32 v131, v131, v155
v_cvt_pk_bf16_f32 v171, v154, v155
v_mfma_f32_16x16x32_bf16 v[144:147], a[216:219], v[208:211], v[144:147]
s_waitcnt lgkmcnt(6)
v_mfma_f32_16x16x32_bf16 v[144:147], a[220:223], v[216:219], v[144:147]
s_waitcnt vmcnt(63)
s_barrier
s_mov_b32 m0, 74112
s_addk_i32 s32, 4096
buffer_load_dwordx4 v36, s[8:11], s32 offen nt lds
ds_read_b64_tr_b16 a[208:209], v12 offset:37056
ds_read_b64_tr_b16 a[210:211], v12 offset:43200
ds_read_b64_tr_b16 a[212:213], v13 offset:37056
v_mfma_f32_16x16x32_bf16 v[144:147], a[224:227], v[224:227], v[144:147]
ds_read_b64_tr_b16 a[214:215], v13 offset:43200
ds_read_b64_tr_b16 a[216:217], v14 offset:37056
ds_read_b64_tr_b16 a[218:219], v14 offset:43200
buffer_load_dwordx4 v37, s[8:11], s32 offen offset:1024 nt lds
v_mfma_f32_16x16x32_bf16 v[144:147], a[228:231], v[232:235], v[144:147]
s_waitcnt lgkmcnt(9)
ds_read_b64_tr_b16 a[220:221], v15 offset:37056
ds_read_b64_tr_b16 a[222:223], v15 offset:43200
buffer_load_dwordx4 v38, s[8:11], s32 offen offset:2048 nt lds
v_mfma_f32_16x16x32_bf16 v[152:155], a[232:235], v[192:195], v[136:139]
ds_read_b64_tr_b16 a[224:225], v12 offset:37184
ds_read_b64_tr_b16 a[226:227], v12 offset:43328
buffer_load_dwordx4 v39, s[8:11], s32 offen offset:3072 nt lds
v_exp_f32_e32 v144, v144
v_exp_f32_e32 v145, v145
v_mfma_f32_16x16x32_bf16 v[152:155], a[236:239], v[200:203], v[152:155]
s_addk_i32 m0, -28864
s_addk_i32 s33, 4096
buffer_load_dwordx4 v52, s[12:15], s33 offen nt lds
ds_read_b64_tr_b16 a[228:229], v13 offset:37184
v_exp_f32_e32 v146, v146
v_exp_f32_e32 v147, v147
v_mfma_f32_16x16x32_bf16 v[152:155], a[240:243], v[208:211], v[152:155]
s_waitcnt lgkmcnt(11)
ds_read_b64_tr_b16 a[230:231], v13 offset:43328
ds_read_b64_tr_b16 a[232:233], v14 offset:37184
ds_read_b64_tr_b16 a[234:235], v14 offset:43328
buffer_load_dwordx4 v46, s[12:15], s33 offen offset:1024 nt lds
v_add_f32_e32 v128, v128, v144
v_add_f32_e32 v129, v129, v145
v_add_f32_e32 v130, v130, v146
v_mfma_f32_16x16x32_bf16 v[152:155], a[244:247], v[216:219], v[152:155]
ds_read_b64_tr_b16 a[236:237], v15 offset:37184
ds_read_b64_tr_b16 a[238:239], v15 offset:43328
buffer_load_dwordx4 v47, s[12:15], s33 offen offset:2048 nt lds
v_add_f32_e32 v131, v131, v147
v_cvt_pk_bf16_f32 v160, v144, v145
v_cvt_pk_bf16_f32 v161, v146, v147
v_mfma_f32_16x16x32_bf16 v[152:155], a[248:251], v[224:227], v[152:155]
ds_read_b64_tr_b16 a[240:241], v12 offset:37312
ds_read_b64_tr_b16 a[242:243], v12 offset:43456
buffer_load_dwordx4 v52, s[12:15], s33 offen offset:3072 nt lds
v_mfma_f32_16x16x32_bf16 v[152:155], a[252:255], v[232:235], v[152:155]
s_waitcnt lgkmcnt(12)
s_mov_b32 m0, 152320
s_add_u32 s36, s35, 164352
buffer_load_dwordx4 v63, s[20:23], s36 offen lds
ds_read_b64_tr_b16 a[244:245], v13 offset:37312
ds_read_b64_tr_b16 a[246:247], v13 offset:43456
v_mfma_f32_16x16x32_bf16 v[32:35], a[208:211], v[168:171], v[32:35]
ds_read_b64_tr_b16 a[248:249], v14 offset:37312
ds_read_b64_tr_b16 a[250:251], v14 offset:43456
buffer_load_dwordx4 v68, s[20:23], s36 offen offset:1024 lds
v_exp_f32_e32 v152, v152
v_exp_f32_e32 v153, v153
v_mfma_f32_16x16x32_bf16 v[40:43], a[212:215], v[168:171], v[40:43]
ds_read_b64_tr_b16 a[252:253], v15 offset:37312
ds_read_b64_tr_b16 a[254:255], v15 offset:43456
buffer_load_dwordx4 v69, s[20:23], s36 offen offset:2048 lds
v_cvt_pk_bf16_f32 v162, v152, v153
v_mfma_f32_16x16x32_bf16 v[48:51], a[216:219], v[168:171], v[48:51]
s_waitcnt lgkmcnt(12)
buffer_load_dwordx4 v70, s[20:23], s36 offen offset:3072 lds
v_mfma_f32_16x16x32_bf16 v[56:59], a[220:223], v[168:171], v[56:59]
s_waitcnt vmcnt(36)
s_barrier
s_addk_i32 m0, 4096
s_add_u32 s36, s35, 205312
buffer_load_dwordx4 v63, s[20:23], s36 offen lds
ds_read_b128 a[208:211], v4 offset:24704
ds_read_b128 a[212:215], v5 offset:24704
v_mfma_f32_16x16x32_bf16 v[64:67], a[224:227], v[168:171], v[64:67]
ds_read_b128 a[216:219], v4 offset:24832
buffer_load_dwordx4 v68, s[20:23], s36 offen offset:1024 lds
v_mfma_f32_16x16x32_bf16 v[72:75], a[228:231], v[168:171], v[72:75]
s_waitcnt lgkmcnt(9)
ds_read_b128 a[220:223], v5 offset:24832
buffer_load_dwordx4 v69, s[20:23], s36 offen offset:2048 lds
v_mfma_f32_16x16x32_bf16 v[80:83], a[232:235], v[168:171], v[80:83]
ds_read_b128 a[224:227], v4 offset:24960
buffer_load_dwordx4 v70, s[20:23], s36 offen offset:3072 lds
v_mfma_f32_16x16x32_bf16 v[88:91], a[236:239], v[168:171], v[88:91]
s_mov_b32 m0, 78208
s_addk_i32 s32, 4096
buffer_load_dwordx4 v44, s[8:11], s32 offen nt lds
ds_read_b128 a[228:231], v5 offset:24960
v_mfma_f32_16x16x32_bf16 v[96:99], a[240:243], v[168:171], v[96:99]
s_waitcnt lgkmcnt(6)
ds_read_b128 a[232:235], v4 offset:30848
buffer_load_dwordx4 v45, s[8:11], s32 offen offset:1024 nt lds
v_mfma_f32_16x16x32_bf16 v[104:107], a[244:247], v[168:171], v[104:107]
ds_read_b128 a[236:239], v5 offset:30848
buffer_load_dwordx4 v36, s[8:11], s32 offen offset:2048 nt lds
v_mfma_f32_16x16x32_bf16 v[112:115], a[248:251], v[168:171], v[112:115]
ds_read_b128 a[240:243], v4 offset:30976
buffer_load_dwordx4 v37, s[8:11], s32 offen offset:3072 nt lds
v_mfma_f32_16x16x32_bf16 v[120:123], a[252:255], v[168:171], v[120:123]
s_waitcnt lgkmcnt(6)
s_addk_i32 m0, -16448
s_addk_i32 s33, 4096
buffer_load_dwordx4 v46, s[12:15], s33 offen nt lds
ds_read_b128 a[244:247], v5 offset:30976
v_mfma_f32_16x16x32_bf16 v[144:147], a[208:211], v[192:195], v[136:139]
ds_read_b128 a[248:251], v4 offset:31104
buffer_load_dwordx4 v47, s[12:15], s33 offen offset:1024 nt lds
v_exp_f32_e32 v154, v154
v_exp_f32_e32 v155, v155
v_add_f32_e32 v128, v128, v152
v_mfma_f32_16x16x32_bf16 v[144:147], a[212:215], v[200:203], v[144:147]
ds_read_b128 a[252:255], v5 offset:31104
buffer_load_dwordx4 v52, s[12:15], s33 offen offset:2048 nt lds
v_add_f32_e32 v129, v129, v153
v_add_f32_e32 v130, v130, v154
v_add_f32_e32 v131, v131, v155
v_cvt_pk_bf16_f32 v163, v154, v155
v_mfma_f32_16x16x32_bf16 v[144:147], a[216:219], v[208:211], v[144:147]
s_waitcnt lgkmcnt(6)
buffer_load_dwordx4 v46, s[12:15], s33 offen offset:3072 nt lds
v_mfma_f32_16x16x32_bf16 v[144:147], a[220:223], v[216:219], v[144:147]
s_waitcnt vmcnt(44)
s_barrier
s_addk_i32 m0, 4096
s_addk_i32 s33, 4096
buffer_load_dwordx4 v47, s[12:15], s33 offen nt lds
ds_read_b64_tr_b16 a[208:209], v8 offset:12352
ds_read_b64_tr_b16 a[210:211], v8 offset:18496
ds_read_b64_tr_b16 a[212:213], v9 offset:12352
v_mfma_f32_16x16x32_bf16 v[144:147], a[224:227], v[224:227], v[144:147]
ds_read_b64_tr_b16 a[214:215], v9 offset:18496
ds_read_b64_tr_b16 a[216:217], v10 offset:12352
ds_read_b64_tr_b16 a[218:219], v10 offset:18496
buffer_load_dwordx4 v52, s[12:15], s33 offen offset:1024 nt lds
v_mfma_f32_16x16x32_bf16 v[144:147], a[228:231], v[232:235], v[144:147]
s_waitcnt lgkmcnt(9)
ds_read_b64_tr_b16 a[220:221], v11 offset:12352
ds_read_b64_tr_b16 a[222:223], v11 offset:18496
buffer_load_dwordx4 v46, s[12:15], s33 offen offset:2048 nt lds
v_mfma_f32_16x16x32_bf16 v[152:155], a[232:235], v[192:195], v[136:139]
ds_read_b64_tr_b16 a[224:225], v8 offset:12480
ds_read_b64_tr_b16 a[226:227], v8 offset:18624
v_mfma_f32_16x16x32_bf16 v[152:155], a[236:239], v[200:203], v[152:155]
ds_read_b64_tr_b16 a[228:229], v9 offset:12480
v_exp_f32_e32 v144, v144
v_exp_f32_e32 v145, v145
v_exp_f32_e32 v146, v146
v_exp_f32_e32 v147, v147
v_mfma_f32_16x16x32_bf16 v[152:155], a[240:243], v[208:211], v[152:155]
s_waitcnt lgkmcnt(11)
ds_read_b64_tr_b16 a[230:231], v9 offset:18624
ds_read_b64_tr_b16 a[232:233], v10 offset:12480
ds_read_b64_tr_b16 a[234:235], v10 offset:18624
buffer_load_dwordx4 v47, s[12:15], s33 offen offset:3072 nt lds
v_add_f32_e32 v128, v128, v144
v_add_f32_e32 v129, v129, v145
v_add_f32_e32 v130, v130, v146
v_mfma_f32_16x16x32_bf16 v[152:155], a[244:247], v[216:219], v[152:155]
s_addk_i32 m0, 4096
s_addk_i32 s33, 4096
buffer_load_dwordx4 v52, s[12:15], s33 offen nt lds
ds_read_b64_tr_b16 a[236:237], v11 offset:12480
ds_read_b64_tr_b16 a[238:239], v11 offset:18624
buffer_load_dwordx4 v46, s[12:15], s33 offen offset:1024 nt lds
v_add_f32_e32 v131, v131, v147
v_mfma_f32_16x16x32_bf16 v[152:155], a[248:251], v[224:227], v[152:155]
ds_read_b64_tr_b16 a[240:241], v8 offset:12608
ds_read_b64_tr_b16 a[242:243], v8 offset:18752
v_cvt_pk_bf16_f32 v168, v144, v145
v_cvt_pk_bf16_f32 v169, v146, v147
v_mfma_f32_16x16x32_bf16 v[152:155], a[252:255], v[232:235], v[152:155]
s_waitcnt lgkmcnt(12)
ds_read_b64_tr_b16 a[244:245], v9 offset:12608
ds_read_b64_tr_b16 a[246:247], v9 offset:18752
buffer_load_dwordx4 v47, s[12:15], s33 offen offset:2048 nt lds
v_mfma_f32_16x16x32_bf16 v[32:35], a[208:211], v[160:163], v[32:35]
ds_read_b64_tr_b16 a[248:249], v10 offset:12608
ds_read_b64_tr_b16 a[250:251], v10 offset:18752
buffer_load_dwordx4 v52, s[12:15], s33 offen offset:3072 nt lds
v_exp_f32_e32 v152, v152
v_exp_f32_e32 v153, v153
v_mfma_f32_16x16x32_bf16 v[40:43], a[212:215], v[160:163], v[40:43]
ds_read_b64_tr_b16 a[252:253], v11 offset:12608
ds_read_b64_tr_b16 a[254:255], v11 offset:18752
v_cvt_pk_bf16_f32 v170, v152, v153
v_mfma_f32_16x16x32_bf16 v[48:51], a[216:219], v[160:163], v[48:51]
s_waitcnt lgkmcnt(12)
v_mfma_f32_16x16x32_bf16 v[56:59], a[220:223], v[160:163], v[56:59]
s_waitcnt vmcnt(40)
s_barrier
s_addk_i32 m0, 28864
s_add_u32 s36, s35, 640
buffer_load_dwordx4 v63, s[20:23], s36 offen lds
ds_read_b128 a[208:211], v6 offset:0
ds_read_b128 a[212:215], v7 offset:0
v_mfma_f32_16x16x32_bf16 v[64:67], a[224:227], v[160:163], v[64:67]
ds_read_b128 a[216:219], v6 offset:128
buffer_load_dwordx4 v68, s[20:23], s36 offen offset:1024 lds
buffer_load_dwordx4 v69, s[20:23], s36 offen offset:2048 lds
v_mfma_f32_16x16x32_bf16 v[72:75], a[228:231], v[160:163], v[72:75]
s_waitcnt lgkmcnt(9)
ds_read_b128 a[220:223], v7 offset:128
buffer_load_dwordx4 v70, s[20:23], s36 offen offset:3072 lds
v_mfma_f32_16x16x32_bf16 v[80:83], a[232:235], v[160:163], v[80:83]
s_addk_i32 m0, -16512
s_addk_i32 s32, 4096
buffer_load_dwordx4 v38, s[8:11], s32 offen nt lds
ds_read_b128 a[224:227], v6 offset:256
buffer_load_dwordx4 v39, s[8:11], s32 offen offset:1024 nt lds
v_mfma_f32_16x16x32_bf16 v[88:91], a[236:239], v[160:163], v[88:91]
ds_read_b128 a[228:231], v7 offset:256
buffer_load_dwordx4 v44, s[8:11], s32 offen offset:2048 nt lds
v_mfma_f32_16x16x32_bf16 v[96:99], a[240:243], v[160:163], v[96:99]
s_waitcnt lgkmcnt(6)
ds_read_b128 a[232:235], v6 offset:6144
buffer_load_dwordx4 v45, s[8:11], s32 offen offset:3072 nt lds
v_mfma_f32_16x16x32_bf16 v[104:107], a[244:247], v[160:163], v[104:107]
s_movk_i32 m0, 0
s_addk_i32 s32, 4096
buffer_load_dwordx4 v36, s[8:11], s32 offen nt lds
ds_read_b128 a[236:239], v7 offset:6144
buffer_load_dwordx4 v37, s[8:11], s32 offen offset:1024 nt lds
v_mfma_f32_16x16x32_bf16 v[112:115], a[248:251], v[160:163], v[112:115]
ds_read_b128 a[240:243], v6 offset:6272
buffer_load_dwordx4 v38, s[8:11], s32 offen offset:2048 nt lds
v_mfma_f32_16x16x32_bf16 v[120:123], a[252:255], v[160:163], v[120:123]
buffer_load_dwordx4 v39, s[8:11], s32 offen offset:3072 nt lds
L_O1b:
s_waitcnt vmcnt(63)
s_barrier
ds_read_b64_tr_b16 a[208:209], v20 offset:12352
ds_read_b64_tr_b16 a[210:211], v20 offset:14400
ds_read_b64_tr_b16 a[212:213], v20 offset:16448
ds_read_b64_tr_b16 a[214:215], v20 offset:18496
ds_read_b64_tr_b16 a[216:217], v20 offset:20544
ds_read_b64_tr_b16 a[218:219], v20 offset:22592
ds_read_b64_tr_b16 a[220:221], v21 offset:12352
ds_read_b64_tr_b16 a[222:223], v21 offset:14400
ds_read_b64_tr_b16 a[224:225], v21 offset:16448
ds_read_b64_tr_b16 a[226:227], v21 offset:18496
ds_read_b64_tr_b16 a[228:229], v21 offset:20544
ds_read_b64_tr_b16 a[230:231], v21 offset:22592
ds_read_b64_tr_b16 a[232:233], v22 offset:12352
ds_read_b64_tr_b16 a[234:235], v22 offset:14400
ds_read_b64_tr_b16 a[236:237], v22 offset:16448
ds_read_b64_tr_b16 a[238:239], v22 offset:18496
ds_read_b64_tr_b16 a[240:241], v22 offset:20544
ds_read_b64_tr_b16 a[242:243], v22 offset:22592
s_waitcnt lgkmcnt(12)
v_mfma_f32_16x16x32_bf16 a[48:51], a[208:211], a[160:163], a[48:51]
s_movk_i32 m0, 4096
s_addk_i32 s32, 4096
buffer_load_dwordx4 v44, s[8:11], s32 offen nt lds
ds_read_b64_tr_b16 a[244:245], v23 offset:12352
ds_read_b64_tr_b16 a[246:247], v23 offset:14400
ds_read_b64_tr_b16 a[248:249], v23 offset:16448
ds_read_b64_tr_b16 a[250:251], v23 offset:18496
v_mfma_f32_16x16x32_bf16 a[48:51], a[212:215], a[168:171], a[48:51]
ds_read_b64_tr_b16 a[252:253], v23 offset:20544
ds_read_b64_tr_b16 a[254:255], v23 offset:22592
buffer_load_dwordx4 v45, s[8:11], s32 offen offset:1024 nt lds
buffer_load_dwordx4 v36, s[8:11], s32 offen offset:2048 nt lds
v_mfma_f32_16x16x32_bf16 a[48:51], a[216:219], a[176:179], a[48:51]
s_waitcnt lgkmcnt(12)
buffer_load_dwordx4 v37, s[8:11], s32 offen offset:3072 nt lds
v_mfma_f32_16x16x32_bf16 a[52:55], a[220:223], a[160:163], a[52:55]
s_waitcnt vmcnt(63)
s_barrier
s_mov_b32 m0, 102912
s_add_u32 s36, s35, 41600
buffer_load_dwordx4 v63, s[20:23], s36 offen lds
ds_read_b64_tr_b16 a[208:209], v20 offset:24704
ds_read_b64_tr_b16 a[210:211], v20 offset:26752
ds_read_b64_tr_b16 a[212:213], v20 offset:28800
v_mfma_f32_16x16x32_bf16 a[52:55], a[224:227], a[168:171], a[52:55]
ds_read_b64_tr_b16 a[214:215], v20 offset:30848
ds_read_b64_tr_b16 a[216:217], v20 offset:32896
ds_read_b64_tr_b16 a[218:219], v20 offset:34944
buffer_load_dwordx4 v68, s[20:23], s36 offen offset:1024 lds
v_mfma_f32_16x16x32_bf16 a[52:55], a[228:231], a[176:179], a[52:55]
s_waitcnt lgkmcnt(12)
ds_read_b64_tr_b16 a[220:221], v21 offset:24704
ds_read_b64_tr_b16 a[222:223], v21 offset:26752
buffer_load_dwordx4 v69, s[20:23], s36 offen offset:2048 lds
v_mfma_f32_16x16x32_bf16 a[56:59], a[232:235], a[160:163], a[56:59]
ds_read_b64_tr_b16 a[224:225], v21 offset:28800
ds_read_b64_tr_b16 a[226:227], v21 offset:30848
buffer_load_dwordx4 v70, s[20:23], s36 offen offset:3072 lds
v_mfma_f32_16x16x32_bf16 a[56:59], a[236:239], a[168:171], a[56:59]
s_addk_i32 m0, 4096
s_add_u32 s36, s35, 82560
buffer_load_dwordx4 v63, s[20:23], s36 offen lds
ds_read_b64_tr_b16 a[228:229], v21 offset:32896
ds_read_b64_tr_b16 a[230:231], v21 offset:34944
v_mfma_f32_16x16x32_bf16 a[56:59], a[240:243], a[176:179], a[56:59]
s_waitcnt lgkmcnt(12)
ds_read_b64_tr_b16 a[232:233], v22 offset:24704
ds_read_b64_tr_b16 a[234:235], v22 offset:26752
buffer_load_dwordx4 v68, s[20:23], s36 offen offset:1024 lds
v_mfma_f32_16x16x32_bf16 a[60:63], a[244:247], a[160:163], a[60:63]
ds_read_b64_tr_b16 a[236:237], v22 offset:28800
ds_read_b64_tr_b16 a[238:239], v22 offset:30848
buffer_load_dwordx4 v69, s[20:23], s36 offen offset:2048 lds
v_mfma_f32_16x16x32_bf16 a[60:63], a[248:251], a[168:171], a[60:63]
ds_read_b64_tr_b16 a[240:241], v22 offset:32896
ds_read_b64_tr_b16 a[242:243], v22 offset:34944
buffer_load_dwordx4 v70, s[20:23], s36 offen offset:3072 lds
v_mfma_f32_16x16x32_bf16 a[60:63], a[252:255], a[176:179], a[60:63]
s_waitcnt lgkmcnt(12)
s_movk_i32 m0, 8192
s_addk_i32 s32, 4096
buffer_load_dwordx4 v38, s[8:11], s32 offen nt lds
ds_read_b64_tr_b16 a[244:245], v23 offset:24704
ds_read_b64_tr_b16 a[246:247], v23 offset:26752
v_mfma_f32_16x16x32_bf16 a[48:51], a[208:211], a[184:187], a[48:51]
ds_read_b64_tr_b16 a[248:249], v23 offset:28800
ds_read_b64_tr_b16 a[250:251], v23 offset:30848
buffer_load_dwordx4 v39, s[8:11], s32 offen offset:1024 nt lds
v_mfma_f32_16x16x32_bf16 a[48:51], a[212:215], a[192:195], a[48:51]
ds_read_b64_tr_b16 a[252:253], v23 offset:32896
ds_read_b64_tr_b16 a[254:255], v23 offset:34944
buffer_load_dwordx4 v44, s[8:11], s32 offen offset:2048 nt lds
v_mfma_f32_16x16x32_bf16 a[48:51], a[216:219], a[200:203], a[48:51]
s_waitcnt lgkmcnt(12)
buffer_load_dwordx4 v45, s[8:11], s32 offen offset:3072 nt lds
v_mfma_f32_16x16x32_bf16 a[52:55], a[220:223], a[184:187], a[52:55]
s_waitcnt vmcnt(63)
s_barrier
s_mov_b32 m0, 111168
s_add_u32 s36, s35, 123520
buffer_load_dwordx4 v63, s[20:23], s36 offen lds
ds_read_b64_tr_b16 a[208:209], v20 offset:37056
ds_read_b64_tr_b16 a[210:211], v20 offset:39104
ds_read_b64_tr_b16 a[212:213], v20 offset:41152
v_mfma_f32_16x16x32_bf16 a[52:55], a[224:227], a[192:195], a[52:55]
ds_read_b64_tr_b16 a[214:215], v20 offset:43200
ds_read_b64_tr_b16 a[216:217], v20 offset:45248
ds_read_b64_tr_b16 a[218:219], v20 offset:47296
buffer_load_dwordx4 v68, s[20:23], s36 offen offset:1024 lds
v_mfma_f32_16x16x32_bf16 a[52:55], a[228:231], a[200:203], a[52:55]
s_waitcnt lgkmcnt(12)
ds_read_b64_tr_b16 a[220:221], v21 offset:37056
ds_read_b64_tr_b16 a[222:223], v21 offset:39104
buffer_load_dwordx4 v69, s[20:23], s36 offen offset:2048 lds
v_mfma_f32_16x16x32_bf16 a[56:59], a[232:235], a[184:187], a[56:59]
ds_read_b64_tr_b16 a[224:225], v21 offset:41152
ds_read_b64_tr_b16 a[226:227], v21 offset:43200
v_mfma_f32_16x16x32_bf16 a[56:59], a[236:239], a[192:195], a[56:59]
ds_read_b64_tr_b16 a[228:229], v21 offset:45248
ds_read_b64_tr_b16 a[230:231], v21 offset:47296
buffer_load_dwordx4 v70, s[20:23], s36 offen offset:3072 lds
v_mfma_f32_16x16x32_bf16 a[56:59], a[240:243], a[200:203], a[56:59]
s_waitcnt lgkmcnt(12)
s_addk_i32 m0, 4096
s_add_u32 s36, s35, 164480
buffer_load_dwordx4 v63, s[20:23], s36 offen lds
ds_read_b64_tr_b16 a[232:233], v22 offset:37056
ds_read_b64_tr_b16 a[234:235], v22 offset:39104
v_mfma_f32_16x16x32_bf16 a[60:63], a[244:247], a[184:187], a[60:63]
ds_read_b64_tr_b16 a[236:237], v22 offset:41152
ds_read_b64_tr_b16 a[238:239], v22 offset:43200
buffer_load_dwordx4 v68, s[20:23], s36 offen offset:1024 lds
v_mfma_f32_16x16x32_bf16 a[60:63], a[248:251], a[192:195], a[60:63]
ds_read_b64_tr_b16 a[240:241], v22 offset:45248
ds_read_b64_tr_b16 a[242:243], v22 offset:47296
v_mfma_f32_16x16x32_bf16 a[60:63], a[252:255], a[200:203], a[60:63]
s_waitcnt lgkmcnt(12)
ds_read_b64_tr_b16 a[244:245], v23 offset:37056
ds_read_b64_tr_b16 a[246:247], v23 offset:39104
buffer_load_dwordx4 v69, s[20:23], s36 offen offset:2048 lds
v_mfma_f32_16x16x32_bf16 a[64:67], a[208:211], a[160:163], a[64:67]
ds_read_b64_tr_b16 a[248:249], v23 offset:41152
ds_read_b64_tr_b16 a[250:251], v23 offset:43200
buffer_load_dwordx4 v70, s[20:23], s36 offen offset:3072 lds
v_mfma_f32_16x16x32_bf16 a[64:67], a[212:215], a[168:171], a[64:67]
ds_read_b64_tr_b16 a[252:253], v23 offset:45248
ds_read_b64_tr_b16 a[254:255], v23 offset:47296
v_mfma_f32_16x16x32_bf16 a[64:67], a[216:219], a[176:179], a[64:67]
s_waitcnt lgkmcnt(12)
v_mfma_f32_16x16x32_bf16 a[68:71], a[220:223], a[160:163], a[68:71]
s_waitcnt vmcnt(52)
s_barrier
s_addk_i32 m0, 4096
s_add_u32 s36, s35, 205440
buffer_load_dwordx4 v63, s[20:23], s36 offen lds
ds_read_b64_tr_b16 a[208:209], v20 offset:49408
ds_read_b64_tr_b16 a[210:211], v20 offset:51456
ds_read_b64_tr_b16 a[212:213], v20 offset:53504
v_mfma_f32_16x16x32_bf16 a[68:71], a[224:227], a[168:171], a[68:71]
ds_read_b64_tr_b16 a[214:215], v20 offset:55552
ds_read_b64_tr_b16 a[216:217], v20 offset:57600
ds_read_b64_tr_b16 a[218:219], v20 offset:59648
buffer_load_dwordx4 v68, s[20:23], s36 offen offset:1024 lds
buffer_load_dwordx4 v69, s[20:23], s36 offen offset:2048 lds
v_mfma_f32_16x16x32_bf16 a[68:71], a[228:231], a[176:179], a[68:71]
s_waitcnt lgkmcnt(12)
ds_read_b64_tr_b16 a[220:221], v21 offset:49408
ds_read_b64_tr_b16 a[222:223], v21 offset:51456
buffer_load_dwordx4 v70, s[20:23], s36 offen offset:3072 lds
v_mfma_f32_16x16x32_bf16 a[72:75], a[232:235], a[160:163], a[72:75]
s_addk_i32 m0, 4160
s_add_u32 s36, s35, 768
buffer_load_dwordx4 v63, s[20:23], s36 offen lds
ds_read_b64_tr_b16 a[224:225], v21 offset:53504
ds_read_b64_tr_b16 a[226:227], v21 offset:55552
buffer_load_dwordx4 v68, s[20:23], s36 offen offset:1024 lds
v_mfma_f32_16x16x32_bf16 a[72:75], a[236:239], a[168:171], a[72:75]
ds_read_b64_tr_b16 a[228:229], v21 offset:57600
ds_read_b64_tr_b16 a[230:231], v21 offset:59648
buffer_load_dwordx4 v69, s[20:23], s36 offen offset:2048 lds
v_mfma_f32_16x16x32_bf16 a[72:75], a[240:243], a[176:179], a[72:75]
s_waitcnt lgkmcnt(12)
ds_read_b64_tr_b16 a[232:233], v22 offset:49408
ds_read_b64_tr_b16 a[234:235], v22 offset:51456
buffer_load_dwordx4 v70, s[20:23], s36 offen offset:3072 lds
v_mfma_f32_16x16x32_bf16 a[76:79], a[244:247], a[160:163], a[76:79]
s_addk_i32 m0, 4096
s_add_u32 s36, s35, 41728
buffer_load_dwordx4 v63, s[20:23], s36 offen lds
ds_read_b64_tr_b16 a[236:237], v22 offset:53504
ds_read_b64_tr_b16 a[238:239], v22 offset:55552
buffer_load_dwordx4 v68, s[20:23], s36 offen offset:1024 lds
v_mfma_f32_16x16x32_bf16 a[76:79], a[248:251], a[168:171], a[76:79]
ds_read_b64_tr_b16 a[240:241], v22 offset:57600
ds_read_b64_tr_b16 a[242:243], v22 offset:59648
buffer_load_dwordx4 v69, s[20:23], s36 offen offset:2048 lds
v_mfma_f32_16x16x32_bf16 a[76:79], a[252:255], a[176:179], a[76:79]
s_waitcnt lgkmcnt(12)
ds_read_b64_tr_b16 a[244:245], v23 offset:49408
ds_read_b64_tr_b16 a[246:247], v23 offset:51456
buffer_load_dwordx4 v70, s[20:23], s36 offen offset:3072 lds
v_mfma_f32_16x16x32_bf16 a[64:67], a[208:211], a[184:187], a[64:67]
s_addk_i32 m0, 4096
s_add_u32 s36, s35, 82688
buffer_load_dwordx4 v63, s[20:23], s36 offen lds
ds_read_b64_tr_b16 a[248:249], v23 offset:53504
ds_read_b64_tr_b16 a[250:251], v23 offset:55552
buffer_load_dwordx4 v68, s[20:23], s36 offen offset:1024 lds
v_mfma_f32_16x16x32_bf16 a[64:67], a[212:215], a[192:195], a[64:67]
ds_read_b64_tr_b16 a[252:253], v23 offset:57600
ds_read_b64_tr_b16 a[254:255], v23 offset:59648
buffer_load_dwordx4 v69, s[20:23], s36 offen offset:2048 lds
v_mfma_f32_16x16x32_bf16 a[64:67], a[216:219], a[200:203], a[64:67]
s_waitcnt lgkmcnt(12)
buffer_load_dwordx4 v70, s[20:23], s36 offen offset:3072 lds
v_mfma_f32_16x16x32_bf16 a[68:71], a[220:223], a[184:187], a[68:71]
s_waitcnt vmcnt(28)
s_barrier
s_addk_i32 m0, 4160
s_add_u32 s36, s35, 123648
buffer_load_dwordx4 v63, s[20:23], s36 offen lds
ds_read_b64_tr_b16 a[208:209], v20 offset:0
ds_read_b64_tr_b16 a[210:211], v20 offset:2048
ds_read_b64_tr_b16 a[212:213], v20 offset:4096
v_mfma_f32_16x16x32_bf16 a[68:71], a[224:227], a[192:195], a[68:71]
ds_read_b64_tr_b16 a[214:215], v20 offset:6144
ds_read_b64_tr_b16 a[216:217], v20 offset:8192
ds_read_b64_tr_b16 a[218:219], v20 offset:10240
buffer_load_dwordx4 v68, s[20:23], s36 offen offset:1024 lds
buffer_load_dwordx4 v69, s[20:23], s36 offen offset:2048 lds
v_mfma_f32_16x16x32_bf16 a[68:71], a[228:231], a[200:203], a[68:71]
s_waitcnt lgkmcnt(12)
ds_read_b64_tr_b16 a[220:221], v21 offset:0
ds_read_b64_tr_b16 a[222:223], v21 offset:2048
buffer_load_dwordx4 v70, s[20:23], s36 offen offset:3072 lds
v_mfma_f32_16x16x32_bf16 a[72:75], a[232:235], a[184:187], a[72:75]
s_addk_i32 m0, 4096
s_add_u32 s36, s35, 164608
buffer_load_dwordx4 v63, s[20:23], s36 offen lds
ds_read_b64_tr_b16 a[224:225], v21 offset:4096
ds_read_b64_tr_b16 a[226:227], v21 offset:6144
buffer_load_dwordx4 v68, s[20:23], s36 offen offset:1024 lds
v_mfma_f32_16x16x32_bf16 a[72:75], a[236:239], a[192:195], a[72:75]
ds_read_b64_tr_b16 a[228:229], v21 offset:8192
ds_read_b64_tr_b16 a[230:231], v21 offset:10240
buffer_load_dwordx4 v69, s[20:23], s36 offen offset:2048 lds
buffer_load_dwordx4 v70, s[20:23], s36 offen offset:3072 lds
v_mfma_f32_16x16x32_bf16 a[72:75], a[240:243], a[200:203], a[72:75]
s_waitcnt lgkmcnt(12)
s_addk_i32 m0, 4096
s_add_u32 s36, s35, 205568
buffer_load_dwordx4 v63, s[20:23], s36 offen lds
ds_read_b64_tr_b16 a[232:233], v22 offset:0
ds_read_b64_tr_b16 a[234:235], v22 offset:2048
v_mfma_f32_16x16x32_bf16 a[76:79], a[244:247], a[184:187], a[76:79]
ds_read_b64_tr_b16 a[236:237], v22 offset:4096
ds_read_b64_tr_b16 a[238:239], v22 offset:6144
buffer_load_dwordx4 v68, s[20:23], s36 offen offset:1024 lds
v_mfma_f32_16x16x32_bf16 a[76:79], a[248:251], a[192:195], a[76:79]
ds_read_b64_tr_b16 a[240:241], v22 offset:8192
ds_read_b64_tr_b16 a[242:243], v22 offset:10240
buffer_load_dwordx4 v69, s[20:23], s36 offen offset:2048 lds
buffer_load_dwordx4 v70, s[20:23], s36 offen offset:3072 lds
v_mfma_f32_16x16x32_bf16 a[76:79], a[252:255], a[200:203], a[76:79]
s_waitcnt lgkmcnt(12)
s_movk_i32 m0, 24704
s_addk_i32 s32, 4096
buffer_load_dwordx4 v36, s[8:11], s32 offen nt lds
ds_read_b64_tr_b16 a[244:245], v23 offset:0
ds_read_b64_tr_b16 a[246:247], v23 offset:2048
v_mfma_f32_16x16x32_bf16 a[80:83], a[208:211], a[160:163], a[80:83]
ds_read_b64_tr_b16 a[248:249], v23 offset:4096
ds_read_b64_tr_b16 a[250:251], v23 offset:6144
buffer_load_dwordx4 v37, s[8:11], s32 offen offset:1024 nt lds
buffer_load_dwordx4 v38, s[8:11], s32 offen offset:2048 nt lds
v_mfma_f32_16x16x32_bf16 a[80:83], a[212:215], a[168:171], a[80:83]
ds_read_b64_tr_b16 a[252:253], v23 offset:8192
ds_read_b64_tr_b16 a[254:255], v23 offset:10240
buffer_load_dwordx4 v39, s[8:11], s32 offen offset:3072 nt lds
v_mfma_f32_16x16x32_bf16 a[80:83], a[216:219], a[176:179], a[80:83]
s_waitcnt lgkmcnt(12)
s_cmp_eq_u32 s28, 3
s_cbranch_scc1 L_pq
s_mul_i32 s36, s28, 384
s_add_u32 s36, s36, s101
buffer_load_dword v254, v79, s[16:19], s36 offen offset:0
buffer_load_dword v254, v84, s[16:19], s36 offen offset:0
L_pqr:
v_mfma_f32_16x16x32_bf16 a[84:87], a[220:223], a[160:163], a[84:87]
s_waitcnt vmcnt(30)
s_barrier
s_mov_b32 m0, 86464
s_addk_i32 s33, 4096
buffer_load_dwordx4 v46, s[12:15], s33 offen nt lds
ds_read_b64_tr_b16 a[208:209], v20 offset:12352
ds_read_b64_tr_b16 a[210:211], v20 offset:14400
ds_read_b64_tr_b16 a[212:213], v20 offset:16448
v_mfma_f32_16x16x32_bf16 a[84:87], a[224:227], a[168:171], a[84:87]
ds_read_b64_tr_b16 a[214:215], v20 offset:18496
ds_read_b64_tr_b16 a[216:217], v20 offset:20544
ds_read_b64_tr_b16 a[218:219], v20 offset:22592
buffer_load_dwordx4 v47, s[12:15], s33 offen offset:1024 nt lds
v_mfma_f32_16x16x32_bf16 a[84:87], a[228:231], a[176:179], a[84:87]
s_waitcnt lgkmcnt(12)
ds_read_b64_tr_b16 a[220:221], v21 offset:12352
ds_read_b64_tr_b16 a[222:223], v21 offset:14400
buffer_load_dwordx4 v52, s[12:15], s33 offen offset:2048 nt lds
v_mfma_f32_16x16x32_bf16 a[88:91], a[232:235], a[160:163], a[88:91]
ds_read_b64_tr_b16 a[224:225], v21 offset:16448
ds_read_b64_tr_b16 a[226:227], v21 offset:18496
buffer_load_dwordx4 v46, s[12:15], s33 offen offset:3072 nt lds
v_mfma_f32_16x16x32_bf16 a[88:91], a[236:239], a[168:171], a[88:91]
s_addk_i32 m0, 4096
s_addk_i32 s33, 4096
buffer_load_dwordx4 v47, s[12:15], s33 offen nt lds
ds_read_b64_tr_b16 a[228:229], v21 offset:20544
ds_read_b64_tr_b16 a[230:231], v21 offset:22592
v_mfma_f32_16x16x32_bf16 a[88:91], a[240:243], a[176:179], a[88:91]
s_waitcnt lgkmcnt(12)
ds_read_b64_tr_b16 a[232:233], v22 offset:12352
ds_read_b64_tr_b16 a[234:235], v22 offset:14400
buffer_load_dwordx4 v52, s[12:15], s33 offen offset:1024 nt lds
v_mfma_f32_16x16x32_bf16 a[92:95], a[244:247], a[160:163], a[92:95]
ds_read_b64_tr_b16 a[236:237], v22 offset:16448
ds_read_b64_tr_b16 a[238:239], v22 offset:18496
buffer_load_dwordx4 v46, s[12:15], s33 offen offset:2048 nt lds
v_mfma_f32_16x16x32_bf16 a[92:95], a[248:251], a[168:171], a[92:95]
ds_read_b64_tr_b16 a[240:241], v22 offset:20544
ds_read_b64_tr_b16 a[242:243], v22 offset:22592
buffer_load_dwordx4 v47, s[12:15], s33 offen offset:3072 nt lds
v_mfma_f32_16x16x32_bf16 a[92:95], a[252:255], a[176:179], a[92:95]
s_waitcnt lgkmcnt(12)
s_addk_i32 m0, 4096
s_addk_i32 s33, 4096
buffer_load_dwordx4 v52, s[12:15], s33 offen nt lds
ds_read_b64_tr_b16 a[244:245], v23 offset:12352
ds_read_b64_tr_b16 a[246:247], v23 offset:14400
v_mfma_f32_16x16x32_bf16 a[80:83], a[208:211], a[184:187], a[80:83]
ds_read_b64_tr_b16 a[248:249], v23 offset:16448
ds_read_b64_tr_b16 a[250:251], v23 offset:18496
buffer_load_dwordx4 v46, s[12:15], s33 offen offset:1024 nt lds
v_mfma_f32_16x16x32_bf16 a[80:83], a[212:215], a[192:195], a[80:83]
ds_read_b64_tr_b16 a[252:253], v23 offset:20544
ds_read_b64_tr_b16 a[254:255], v23 offset:22592
buffer_load_dwordx4 v47, s[12:15], s33 offen offset:2048 nt lds
v_mfma_f32_16x16x32_bf16 a[80:83], a[216:219], a[200:203], a[80:83]
s_waitcnt lgkmcnt(12)
buffer_load_dwordx4 v52, s[12:15], s33 offen offset:3072 nt lds
v_mfma_f32_16x16x32_bf16 a[84:87], a[220:223], a[184:187], a[84:87]
s_waitcnt vmcnt(30)
s_barrier
s_movk_i32 m0, 28800
s_addk_i32 s32, 4096
buffer_load_dwordx4 v44, s[8:11], s32 offen nt lds
ds_read_b64_tr_b16 a[208:209], v20 offset:24704
ds_read_b64_tr_b16 a[210:211], v20 offset:26752
ds_read_b64_tr_b16 a[212:213], v20 offset:28800
v_mfma_f32_16x16x32_bf16 a[84:87], a[224:227], a[192:195], a[84:87]
ds_read_b64_tr_b16 a[214:215], v20 offset:30848
ds_read_b64_tr_b16 a[216:217], v20 offset:32896
ds_read_b64_tr_b16 a[218:219], v20 offset:34944
buffer_load_dwordx4 v45, s[8:11], s32 offen offset:1024 nt lds
v_mfma_f32_16x16x32_bf16 a[84:87], a[228:231], a[200:203], a[84:87]
s_waitcnt lgkmcnt(12)
ds_read_b64_tr_b16 a[220:221], v21 offset:24704
ds_read_b64_tr_b16 a[222:223], v21 offset:26752
buffer_load_dwordx4 v36, s[8:11], s32 offen offset:2048 nt lds
v_mfma_f32_16x16x32_bf16 a[88:91], a[232:235], a[184:187], a[88:91]
ds_read_b64_tr_b16 a[224:225], v21 offset:28800
ds_read_b64_tr_b16 a[226:227], v21 offset:30848
v_mfma_f32_16x16x32_bf16 a[88:91], a[236:239], a[192:195], a[88:91]
ds_read_b64_tr_b16 a[228:229], v21 offset:32896
ds_read_b64_tr_b16 a[230:231], v21 offset:34944
buffer_load_dwordx4 v37, s[8:11], s32 offen offset:3072 nt lds
v_mfma_f32_16x16x32_bf16 a[88:91], a[240:243], a[200:203], a[88:91]
s_waitcnt lgkmcnt(12)
ds_read_b64_tr_b16 a[232:233], v22 offset:24704
ds_read_b64_tr_b16 a[234:235], v22 offset:26752
v_mfma_f32_16x16x32_bf16 a[92:95], a[244:247], a[184:187], a[92:95]
ds_read_b64_tr_b16 a[236:237], v22 offset:28800
ds_read_b64_tr_b16 a[238:239], v22 offset:30848
v_mfma_f32_16x16x32_bf16 a[92:95], a[248:251], a[192:195], a[92:95]
ds_read_b64_tr_b16 a[240:241], v22 offset:32896
ds_read_b64_tr_b16 a[242:243], v22 offset:34944
v_mfma_f32_16x16x32_bf16 a[92:95], a[252:255], a[200:203], a[92:95]
s_waitcnt lgkmcnt(12)
ds_read_b64_tr_b16 a[244:245], v23 offset:24704
ds_read_b64_tr_b16 a[246:247], v23 offset:26752
v_mfma_f32_16x16x32_bf16 a[96:99], a[208:211], a[160:163], a[96:99]
ds_read_b64_tr_b16 a[248:249], v23 offset:28800
ds_read_b64_tr_b16 a[250:251], v23 offset:30848
v_mfma_f32_16x16x32_bf16 a[96:99], a[212:215], a[168:171], a[96:99]
ds_read_b64_tr_b16 a[252:253], v23 offset:32896
ds_read_b64_tr_b16 a[254:255], v23 offset:34944
v_mfma_f32_16x16x32_bf16 a[96:99], a[216:219], a[176:179], a[96:99]
s_waitcnt lgkmcnt(12)
v_mfma_f32_16x16x32_bf16 a[100:103], a[220:223], a[160:163], a[100:103]
s_waitcnt vmcnt(22)
s_barrier
s_movk_i32 m0, 12352
s_addk_i32 s33, 4096
buffer_load_dwordx4 v46, s[12:15], s33 offen nt lds
ds_read_b64_tr_b16 a[208:209], v20 offset:37056
ds_read_b64_tr_b16 a[210:211], v20 offset:39104
ds_read_b64_tr_b16 a[212:213], v20 offset:41152
v_mfma_f32_16x16x32_bf16 a[100:103], a[224:227], a[168:171], a[100:103]
ds_read_b64_tr_b16 a[214:215], v20 offset:43200
ds_read_b64_tr_b16 a[216:217], v20 offset:45248
ds_read_b64_tr_b16 a[218:219], v20 offset:47296
buffer_load_dwordx4 v47, s[12:15], s33 offen offset:1024 nt lds
buffer_load_dwordx4 v52, s[12:15], s33 offen offset:2048 nt lds
v_mfma_f32_16x16x32_bf16 a[100:103], a[228:231], a[176:179], a[100:103]
s_waitcnt lgkmcnt(12)
ds_read_b64_tr_b16 a[220:221], v21 offset:37056
ds_read_b64_tr_b16 a[222:223], v21 offset:39104
buffer_load_dwordx4 v46, s[12:15], s33 offen offset:3072 nt lds
v_mfma_f32_16x16x32_bf16 a[104:107], a[232:235], a[160:163], a[104:107]
s_movk_i32 m0, 16448
s_addk_i32 s33, 4096
buffer_load_dwordx4 v47, s[12:15], s33 offen nt lds
ds_read_b64_tr_b16 a[224:225], v21 offset:41152
ds_read_b64_tr_b16 a[226:227], v21 offset:43200
v_mfma_f32_16x16x32_bf16 a[104:107], a[236:239], a[168:171], a[104:107]
ds_read_b64_tr_b16 a[228:229], v21 offset:45248
ds_read_b64_tr_b16 a[230:231], v21 offset:47296
buffer_load_dwordx4 v52, s[12:15], s33 offen offset:1024 nt lds
v_mfma_f32_16x16x32_bf16 a[104:107], a[240:243], a[176:179], a[104:107]
s_waitcnt lgkmcnt(12)
ds_read_b64_tr_b16 a[232:233], v22 offset:37056
ds_read_b64_tr_b16 a[234:235], v22 offset:39104
buffer_load_dwordx4 v46, s[12:15], s33 offen offset:2048 nt lds
v_mfma_f32_16x16x32_bf16 a[108:111], a[244:247], a[160:163], a[108:111]
ds_read_b64_tr_b16 a[236:237], v22 offset:41152
ds_read_b64_tr_b16 a[238:239], v22 offset:43200
buffer_load_dwordx4 v47, s[12:15], s33 offen offset:3072 nt lds
v_mfma_f32_16x16x32_bf16 a[108:111], a[248:251], a[168:171], a[108:111]
s_movk_i32 m0, 20544
s_addk_i32 s33, 4096
buffer_load_dwordx4 v52, s[12:15], s33 offen nt lds
ds_read_b64_tr_b16 a[240:241], v22 offset:45248
ds_read_b64_tr_b16 a[242:243], v22 offset:47296
buffer_load_dwordx4 v46, s[12:15], s33 offen offset:1024 nt lds
v_mfma_f32_16x16x32_bf16 a[108:111], a[252:255], a[176:179], a[108:111]
s_waitcnt lgkmcnt(12)
ds_read_b64_tr_b16 a[244:245], v23 offset:37056
ds_read_b64_tr_b16 a[246:247], v23 offset:39104
buffer_load_dwordx4 v47, s[12:15], s33 offen offset:2048 nt lds
v_mfma_f32_16x16x32_bf16 a[96:99], a[208:211], a[184:187], a[96:99]
ds_read_b64_tr_b16 a[248:249], v23 offset:41152
ds_read_b64_tr_b16 a[250:251], v23 offset:43200
buffer_load_dwordx4 v52, s[12:15], s33 offen offset:3072 nt lds
v_mfma_f32_16x16x32_bf16 a[96:99], a[212:215], a[192:195], a[96:99]
s_mov_b32 m0, 148224
s_add_u32 s36, s35, 896
buffer_load_dwordx4 v63, s[20:23], s36 offen lds
ds_read_b64_tr_b16 a[252:253], v23 offset:45248
ds_read_b64_tr_b16 a[254:255], v23 offset:47296
v_mfma_f32_16x16x32_bf16 a[96:99], a[216:219], a[200:203], a[96:99]
s_waitcnt lgkmcnt(12)
ds_read_b128 a[208:211], v6 offset:0
buffer_load_dwordx4 v68, s[20:23], s36 offen offset:1024 lds
v_mfma_f32_16x16x32_bf16 a[100:103], a[220:223], a[184:187], a[100:103]
ds_read_b128 a[212:215], v7 offset:0
buffer_load_dwordx4 v69, s[20:23], s36 offen offset:2048 lds
v_mfma_f32_16x16x32_bf16 a[100:103], a[224:227], a[192:195], a[100:103]
ds_read_b128 a[216:219], v6 offset:128
buffer_load_dwordx4 v70, s[20:23], s36 offen offset:3072 lds
v_mfma_f32_16x16x32_bf16 a[100:103], a[228:231], a[200:203], a[100:103]
s_waitcnt lgkmcnt(9)
s_addk_i32 m0, 4096
s_add_u32 s36, s35, 41856
buffer_load_dwordx4 v63, s[20:23], s36 offen lds
ds_read_b128 a[220:223], v7 offset:128
buffer_load_dwordx4 v68, s[20:23], s36 offen offset:1024 lds
v_mfma_f32_16x16x32_bf16 a[104:107], a[232:235], a[184:187], a[104:107]
ds_read_b128 a[224:227], v6 offset:256
buffer_load_dwordx4 v69, s[20:23], s36 offen offset:2048 lds
v_mfma_f32_16x16x32_bf16 a[104:107], a[236:239], a[192:195], a[104:107]
ds_read_b128 a[228:231], v7 offset:256
buffer_load_dwordx4 v70, s[20:23], s36 offen offset:3072 lds
v_mfma_f32_16x16x32_bf16 a[104:107], a[240:243], a[200:203], a[104:107]
s_waitcnt lgkmcnt(6)
s_addk_i32 m0, 4096
s_add_u32 s36, s35, 82816
buffer_load_dwordx4 v63, s[20:23], s36 offen lds
ds_read_b128 a[232:235], v6 offset:6144
v_mfma_f32_16x16x32_bf16 a[108:111], a[244:247], a[184:187], a[108:111]
ds_read_b128 a[236:239], v7 offset:6144
buffer_load_dwordx4 v68, s[20:23], s36 offen offset:1024 lds
v_mfma_f32_16x16x32_bf16 a[108:111], a[248:251], a[192:195], a[108:111]
ds_read_b128 a[240:243], v6 offset:6272
buffer_load_dwordx4 v69, s[20:23], s36 offen offset:2048 lds
v_mfma_f32_16x16x32_bf16 a[108:111], a[252:255], a[200:203], a[108:111]
buffer_load_dwordx4 v70, s[20:23], s36 offen offset:3072 lds
s_waitcnt lgkmcnt(6)
v_mfma_f32_16x16x32_bf16 v[144:147], a[208:211], v[192:195], v[136:139]
ds_read_b128 a[244:247], v7 offset:6272
ds_read_b128 a[248:251], v6 offset:6400
v_exp_f32_e32 v154, v154
v_exp_f32_e32 v155, v155
v_add_f32_e32 v128, v128, v152
v_add_f32_e32 v129, v129, v153
v_add_f32_e32 v130, v130, v154
v_mfma_f32_16x16x32_bf16 v[144:147], a[212:215], v[200:203], v[144:147]
ds_read_b128 a[252:255], v7 offset:6400
v_add_f32_e32 v131, v131, v155
v_cvt_pk_bf16_f32 v171, v154, v155
v_mfma_f32_16x16x32_bf16 v[144:147], a[216:219], v[208:211], v[144:147]
s_waitcnt lgkmcnt(6)
v_mfma_f32_16x16x32_bf16 v[144:147], a[220:223], v[216:219], v[144:147]
s_waitcnt vmcnt(63)
s_barrier
s_mov_b32 m0, 32896
s_addk_i32 s32, 4096
buffer_load_dwordx4 v38, s[8:11], s32 offen nt lds
ds_read_b64_tr_b16 a[208:209], v8 offset:37056
ds_read_b64_tr_b16 a[210:211], v8 offset:43200
ds_read_b64_tr_b16 a[212:213], v9 offset:37056
v_mfma_f32_16x16x32_bf16 v[144:147], a[224:227], v[224:227], v[144:147]
ds_read_b64_tr_b16 a[214:215], v9 offset:43200
ds_read_b64_tr_b16 a[216:217], v10 offset:37056
ds_read_b64_tr_b16 a[218:219], v10 offset:43200
buffer_load_dwordx4 v39, s[8:11], s32 offen offset:1024 nt lds
v_mfma_f32_16x16x32_bf16 v[144:147], a[228:231], v[232:235], v[144:147]
s_waitcnt lgkmcnt(9)
ds_read_b64_tr_b16 a[220:221], v11 offset:37056
ds_read_b64_tr_b16 a[222:223], v11 offset:43200
buffer_load_dwordx4 v44, s[8:11], s32 offen offset:2048 nt lds
v_mfma_f32_16x16x32_bf16 v[152:155], a[232:235], v[192:195], v[136:139]
ds_read_b64_tr_b16 a[224:225], v8 offset:37184
ds_read_b64_tr_b16 a[226:227], v8 offset:43328
v_mfma_f32_16x16x32_bf16 v[152:155], a[236:239], v[200:203], v[152:155]
ds_read_b64_tr_b16 a[228:229], v9 offset:37184
v_exp_f32_e32 v144, v144
v_exp_f32_e32 v145, v145
v_exp_f32_e32 v146, v146
v_exp_f32_e32 v147, v147
v_mfma_f32_16x16x32_bf16 v[152:155], a[240:243], v[208:211], v[152:155]
s_waitcnt lgkmcnt(11)
ds_read_b64_tr_b16 a[230:231], v9 offset:43328
ds_read_b64_tr_b16 a[232:233], v10 offset:37184
ds_read_b64_tr_b16 a[234:235], v10 offset:43328
buffer_load_dwordx4 v45, s[8:11], s32 offen offset:3072 nt lds
v_add_f32_e32 v128, v128, v144
v_add_f32_e32 v129, v129, v145
v_add_f32_e32 v130, v130, v146
v_mfma_f32_16x16x32_bf16 v[152:155], a[244:247], v[216:219], v[152:155]
s_mov_b32 m0, 98816
s_add_u32 s36, s35, 123776
buffer_load_dwordx4 v63, s[20:23], s36 offen lds
ds_read_b64_tr_b16 a[236:237], v11 offset:37184
ds_read_b64_tr_b16 a[238:239], v11 offset:43328
buffer_load_dwordx4 v68, s[20:23], s36 offen offset:1024 lds
v_add_f32_e32 v131, v131, v147
v_mfma_f32_16x16x32_bf16 v[152:155], a[248:251], v[224:227], v[152:155]
ds_read_b64_tr_b16 a[240:241], v8 offset:37312
ds_read_b64_tr_b16 a[242:243], v8 offset:43456
v_cvt_pk_bf16_f32 v160, v144, v145
v_cvt_pk_bf16_f32 v161, v146, v147
v_mfma_f32_16x16x32_bf16 v[152:155], a[252:255], v[232:235], v[152:155]
s_waitcnt lgkmcnt(12)
ds_read_b64_tr_b16 a[244:245], v9 offset:37312
ds_read_b64_tr_b16 a[246:247], v9 offset:43456
buffer_load_dwordx4 v69, s[20:23], s36 offen offset:2048 lds
v_mfma_f32_16x16x32_bf16 v[32:35], a[208:211], v[168:171], v[32:35]
ds_read_b64_tr_b16 a[248:249], v10 offset:37312
ds_read_b64_tr_b16 a[250:251], v10 offset:43456
buffer_load_dwordx4 v70, s[20:23], s36 offen offset:3072 lds
v_exp_f32_e32 v152, v152
v_exp_f32_e32 v153, v153
v_mfma_f32_16x16x32_bf16 v[40:43], a[212:215], v[168:171], v[40:43]
ds_read_b64_tr_b16 a[252:253], v11 offset:37312
ds_read_b64_tr_b16 a[254:255], v11 offset:43456
v_cvt_pk_bf16_f32 v162, v152, v153
v_mfma_f32_16x16x32_bf16 v[48:51], a[216:219], v[168:171], v[48:51]
s_waitcnt lgkmcnt(12)
v_mfma_f32_16x16x32_bf16 v[56:59], a[220:223], v[168:171], v[56:59]
s_waitcnt vmcnt(63)
s_barrier
s_mov_b32 m0, 49408
s_addk_i32 s32, 4096
buffer_load_dwordx4 v36, s[8:11], s32 offen nt lds
ds_read_b128 a[208:211], v6 offset:24704
ds_read_b128 a[212:215], v7 offset:24704
v_mfma_f32_16x16x32_bf16 v[64:67], a[224:227], v[168:171], v[64:67]
ds_read_b128 a[216:219], v6 offset:24832
buffer_load_dwordx4 v37, s[8:11], s32 offen offset:1024 nt lds
v_mfma_f32_16x16x32_bf16 v[72:75], a[228:231], v[168:171], v[72:75]
s_waitcnt lgkmcnt(9)
ds_read_b128 a[220:223], v7 offset:24832
buffer_load_dwordx4 v38, s[8:11], s32 offen offset:2048 nt lds
v_mfma_f32_16x16x32_bf16 v[80:83], a[232:235], v[168:171], v[80:83]
ds_read_b128 a[224:227], v6 offset:24960
v_mfma_f32_16x16x32_bf16 v[88:91], a[236:239], v[168:171], v[88:91]
ds_read_b128 a[228:231], v7 offset:24960
buffer_load_dwordx4 v39, s[8:11], s32 offen offset:3072 nt lds
v_mfma_f32_16x16x32_bf16 v[96:99], a[240:243], v[168:171], v[96:99]
s_waitcnt lgkmcnt(6)
s_mov_b32 m0, 102912
s_add_u32 s36, s35, 164736
buffer_load_dwordx4 v63, s[20:23], s36 offen lds
ds_read_b128 a[232:235], v6 offset:30848
v_mfma_f32_16x16x32_bf16 v[104:107], a[244:247], v[168:171], v[104:107]
ds_read_b128 a[236:239], v7 offset:30848
buffer_load_dwordx4 v68, s[20:23], s36 offen offset:1024 lds
v_mfma_f32_16x16x32_bf16 v[112:115], a[248:251], v[168:171], v[112:115]
ds_read_b128 a[240:243], v6 offset:30976
v_mfma_f32_16x16x32_bf16 v[120:123], a[252:255], v[168:171], v[120:123]
s_waitcnt lgkmcnt(6)
ds_read_b128 a[244:247], v7 offset:30976
buffer_load_dwordx4 v69, s[20:23], s36 offen offset:2048 lds
v_mfma_f32_16x16x32_bf16 v[144:147], a[208:211], v[192:195], v[136:139]
ds_read_b128 a[248:251], v6 offset:31104
buffer_load_dwordx4 v70, s[20:23], s36 offen offset:3072 lds
v_exp_f32_e32 v154, v154
v_exp_f32_e32 v155, v155
v_add_f32_e32 v128, v128, v152
v_mfma_f32_16x16x32_bf16 v[144:147], a[212:215], v[200:203], v[144:147]
ds_read_b128 a[252:255], v7 offset:31104
v_add_f32_e32 v129, v129, v153
v_add_f32_e32 v130, v130, v154
v_add_f32_e32 v131, v131, v155
v_cvt_pk_bf16_f32 v163, v154, v155
v_mfma_f32_16x16x32_bf16 v[144:147], a[216:219], v[208:211], v[144:147]
s_waitcnt lgkmcnt(6)
v_mfma_f32_16x16x32_bf16 v[144:147], a[220:223], v[216:219], v[144:147]
s_waitcnt vmcnt(63)
s_barrier
s_mov_b32 m0, 53504
s_addk_i32 s32, 4096
buffer_load_dwordx4 v44, s[8:11], s32 offen nt lds
ds_read_b64_tr_b16 a[208:209], v12 offset:12352
ds_read_b64_tr_b16 a[210:211], v12 offset:18496
ds_read_b64_tr_b16 a[212:213], v13 offset:12352
v_mfma_f32_16x16x32_bf16 v[144:147], a[224:227], v[224:227], v[144:147]
ds_read_b64_tr_b16 a[214:215], v13 offset:18496
ds_read_b64_tr_b16 a[216:217], v14 offset:12352
ds_read_b64_tr_b16 a[218:219], v14 offset:18496
buffer_load_dwordx4 v45, s[8:11], s32 offen offset:1024 nt lds
v_mfma_f32_16x16x32_bf16 v[144:147], a[228:231], v[232:235], v[144:147]
s_waitcnt lgkmcnt(9)
ds_read_b64_tr_b16 a[220:221], v15 offset:12352
ds_read_b64_tr_b16 a[222:223], v15 offset:18496
buffer_load_dwordx4 v36, s[8:11], s32 offen offset:2048 nt lds
v_mfma_f32_16x16x32_bf16 v[152:155], a[232:235], v[192:195], v[136:139]
ds_read_b64_tr_b16 a[224:225], v12 offset:12480
ds_read_b64_tr_b16 a[226:227], v12 offset:18624
v_mfma_f32_16x16x32_bf16 v[152:155], a[236:239], v[200:203], v[152:155]
ds_read_b64_tr_b16 a[228:229], v13 offset:12480
v_exp_f32_e32 v144, v144
v_exp_f32_e32 v145, v145
v_exp_f32_e32 v146, v146
v_exp_f32_e32 v147, v147
v_mfma_f32_16x16x32_bf16 v[152:155], a[240:243], v[208:211], v[152:155]
s_waitcnt lgkmcnt(11)
ds_read_b64_tr_b16 a[230:231], v13 offset:18624
ds_read_b64_tr_b16 a[232:233], v14 offset:12480
ds_read_b64_tr_b16 a[234:235], v14 offset:18624
buffer_load_dwordx4 v37, s[8:11], s32 offen offset:3072 nt lds
v_add_f32_e32 v128, v128, v144
v_add_f32_e32 v129, v129, v145
v_add_f32_e32 v130, v130, v146
v_mfma_f32_16x16x32_bf16 v[152:155], a[244:247], v[216:219], v[152:155]
s_addk_i32 m0, 4096
s_addk_i32 s32, 4096
buffer_load_dwordx4 v38, s[8:11], s32 offen nt lds
ds_read_b64_tr_b16 a[236:237], v15 offset:12480
ds_read_b64_tr_b16 a[238:239], v15 offset:18624
buffer_load_dwordx4 v39, s[8:11], s32 offen offset:1024 nt lds
v_add_f32_e32 v131, v131, v147
v_mfma_f32_16x16x32_bf16 v[152:155], a[248:251], v[224:227], v[152:155]
ds_read_b64_tr_b16 a[240:241], v12 offset:12608
ds_read_b64_tr_b16 a[242:243], v12 offset:18752
v_cvt_pk_bf16_f32 v168, v144, v145
v_cvt_pk_bf16_f32 v169, v146, v147
v_mfma_f32_16x16x32_bf16 v[152:155], a[252:255], v[232:235], v[152:155]
s_waitcnt lgkmcnt(12)
ds_read_b64_tr_b16 a[244:245], v13 offset:12608
ds_read_b64_tr_b16 a[246:247], v13 offset:18752
buffer_load_dwordx4 v44, s[8:11], s32 offen offset:2048 nt lds
v_mfma_f32_16x16x32_bf16 v[32:35], a[208:211], v[160:163], v[32:35]
ds_read_b64_tr_b16 a[248:249], v14 offset:12608
ds_read_b64_tr_b16 a[250:251], v14 offset:18752
buffer_load_dwordx4 v45, s[8:11], s32 offen offset:3072 nt lds
v_exp_f32_e32 v152, v152
v_exp_f32_e32 v153, v153
v_mfma_f32_16x16x32_bf16 v[40:43], a[212:215], v[160:163], v[40:43]
ds_read_b64_tr_b16 a[252:253], v15 offset:12608
ds_read_b64_tr_b16 a[254:255], v15 offset:18752
v_cvt_pk_bf16_f32 v170, v152, v153
v_mfma_f32_16x16x32_bf16 v[48:51], a[216:219], v[160:163], v[48:51]
s_waitcnt lgkmcnt(12)
v_mfma_f32_16x16x32_bf16 v[56:59], a[220:223], v[160:163], v[56:59]
s_waitcnt vmcnt(63)
s_barrier
s_addk_i32 m0, 16512
s_addk_i32 s32, 4096
buffer_load_dwordx4 v36, s[8:11], s32 offen nt lds
ds_read_b128 a[208:211], v4 offset:0
ds_read_b128 a[212:215], v5 offset:0
v_mfma_f32_16x16x32_bf16 v[64:67], a[224:227], v[160:163], v[64:67]
ds_read_b128 a[216:219], v4 offset:128
buffer_load_dwordx4 v37, s[8:11], s32 offen offset:1024 nt lds
v_mfma_f32_16x16x32_bf16 v[72:75], a[228:231], v[160:163], v[72:75]
s_waitcnt lgkmcnt(9)
ds_read_b128 a[220:223], v5 offset:128
buffer_load_dwordx4 v38, s[8:11], s32 offen offset:2048 nt lds
v_mfma_f32_16x16x32_bf16 v[80:83], a[232:235], v[160:163], v[80:83]
ds_read_b128 a[224:227], v4 offset:256
v_mfma_f32_16x16x32_bf16 v[88:91], a[236:239], v[160:163], v[88:91]
ds_read_b128 a[228:231], v5 offset:256
buffer_load_dwordx4 v39, s[8:11], s32 offen offset:3072 nt lds
v_mfma_f32_16x16x32_bf16 v[96:99], a[240:243], v[160:163], v[96:99]
s_waitcnt lgkmcnt(6)
s_addk_i32 m0, 4096
s_addk_i32 s32, 4096
buffer_load_dwordx4 v44, s[8:11], s32 offen nt lds
ds_read_b128 a[232:235], v4 offset:6144
v_mfma_f32_16x16x32_bf16 v[104:107], a[244:247], v[160:163], v[104:107]
ds_read_b128 a[236:239], v5 offset:6144
buffer_load_dwordx4 v45, s[8:11], s32 offen offset:1024 nt lds
v_mfma_f32_16x16x32_bf16 v[112:115], a[248:251], v[160:163], v[112:115]
ds_read_b128 a[240:243], v4 offset:6272
v_mfma_f32_16x16x32_bf16 v[120:123], a[252:255], v[160:163], v[120:123]
s_waitcnt lgkmcnt(6)
ds_read_b128 a[244:247], v5 offset:6272
buffer_load_dwordx4 v36, s[8:11], s32 offen offset:2048 nt lds
v_mfma_f32_16x16x32_bf16 v[144:147], a[208:211], v[192:195], v[136:139]
ds_read_b128 a[248:251], v4 offset:6400
buffer_load_dwordx4 v37, s[8:11], s32 offen offset:3072 nt lds
v_exp_f32_e32 v154, v154
v_exp_f32_e32 v155, v155
v_add_f32_e32 v128, v128, v152
v_mfma_f32_16x16x32_bf16 v[144:147], a[212:215], v[200:203], v[144:147]
ds_read_b128 a[252:255], v5 offset:6400
v_add_f32_e32 v129, v129, v153
v_add_f32_e32 v130, v130, v154
v_add_f32_e32 v131, v131, v155
v_cvt_pk_bf16_f32 v171, v154, v155
v_mfma_f32_16x16x32_bf16 v[144:147], a[216:219], v[208:211], v[144:147]
s_waitcnt lgkmcnt(6)
v_mfma_f32_16x16x32_bf16 v[144:147], a[220:223], v[216:219], v[144:147]
s_waitcnt vmcnt(60)
s_barrier
s_addk_i32 m0, 4096
s_addk_i32 s32, 4096
buffer_load_dwordx4 v38, s[8:11], s32 offen nt lds
ds_read_b64_tr_b16 a[208:209], v12 offset:37056
ds_read_b64_tr_b16 a[210:211], v12 offset:43200
ds_read_b64_tr_b16 a[212:213], v13 offset:37056
v_mfma_f32_16x16x32_bf16 v[144:147], a[224:227], v[224:227], v[144:147]
ds_read_b64_tr_b16 a[214:215], v13 offset:43200
ds_read_b64_tr_b16 a[216:217], v14 offset:37056
ds_read_b64_tr_b16 a[218:219], v14 offset:43200
buffer_load_dwordx4 v39, s[8:11], s32 offen offset:1024 nt lds
v_mfma_f32_16x16x32_bf16 v[144:147], a[228:231], v[232:235], v[144:147]
s_waitcnt lgkmcnt(9)
ds_read_b64_tr_b16 a[220:221], v15 offset:37056
ds_read_b64_tr_b16 a[222:223], v15 offset:43200
buffer_load_dwordx4 v44, s[8:11], s32 offen offset:2048 nt lds
v_mfma_f32_16x16x32_bf16 v[152:155], a[232:235], v[192:195], v[136:139]
ds_read_b64_tr_b16 a[224:225], v12 offset:37184
ds_read_b64_tr_b16 a[226:227], v12 offset:43328
buffer_load_dwordx4 v45, s[8:11], s32 offen offset:3072 nt lds
v_exp_f32_e32 v144, v144
v_exp_f32_e32 v145, v145
v_mfma_f32_16x16x32_bf16 v[152:155], a[236:239], v[200:203], v[152:155]
s_addk_i32 m0, 24704
s_add_u32 s36, s35, 205696
buffer_load_dwordx4 v63, s[20:23], s36 offen lds
ds_read_b64_tr_b16 a[228:229], v13 offset:37184
v_exp_f32_e32 v146, v146
v_exp_f32_e32 v147, v147
v_mfma_f32_16x16x32_bf16 v[152:155], a[240:243], v[208:211], v[152:155]
s_waitcnt lgkmcnt(11)
ds_read_b64_tr_b16 a[230:231], v13 offset:43328
ds_read_b64_tr_b16 a[232:233], v14 offset:37184
ds_read_b64_tr_b16 a[234:235], v14 offset:43328
buffer_load_dwordx4 v68, s[20:23], s36 offen offset:1024 lds
v_add_f32_e32 v128, v128, v144
v_add_f32_e32 v129, v129, v145
v_add_f32_e32 v130, v130, v146
v_mfma_f32_16x16x32_bf16 v[152:155], a[244:247], v[216:219], v[152:155]
ds_read_b64_tr_b16 a[236:237], v15 offset:37184
ds_read_b64_tr_b16 a[238:239], v15 offset:43328
buffer_load_dwordx4 v69, s[20:23], s36 offen offset:2048 lds
v_add_f32_e32 v131, v131, v147
v_cvt_pk_bf16_f32 v160, v144, v145
v_cvt_pk_bf16_f32 v161, v146, v147
v_mfma_f32_16x16x32_bf16 v[152:155], a[248:251], v[224:227], v[152:155]
ds_read_b64_tr_b16 a[240:241], v12 offset:37312
ds_read_b64_tr_b16 a[242:243], v12 offset:43456
buffer_load_dwordx4 v70, s[20:23], s36 offen offset:3072 lds
v_mfma_f32_16x16x32_bf16 v[152:155], a[252:255], v[232:235], v[152:155]
s_waitcnt lgkmcnt(12)
s_addk_i32 m0, 4160
s_add_u32 s36, s35, 1024
buffer_load_dwordx4 v63, s[20:23], s36 offen lds
ds_read_b64_tr_b16 a[244:245], v13 offset:37312
ds_read_b64_tr_b16 a[246:247], v13 offset:43456
v_mfma_f32_16x16x32_bf16 v[32:35], a[208:211], v[168:171], v[32:35]
ds_read_b64_tr_b16 a[248:249], v14 offset:37312
ds_read_b64_tr_b16 a[250:251], v14 offset:43456
buffer_load_dwordx4 v68, s[20:23], s36 offen offset:1024 lds
v_exp_f32_e32 v152, v152
v_exp_f32_e32 v153, v153
v_mfma_f32_16x16x32_bf16 v[40:43], a[212:215], v[168:171], v[40:43]
ds_read_b64_tr_b16 a[252:253], v15 offset:37312
ds_read_b64_tr_b16 a[254:255], v15 offset:43456
buffer_load_dwordx4 v69, s[20:23], s36 offen offset:2048 lds
v_cvt_pk_bf16_f32 v162, v152, v153
v_mfma_f32_16x16x32_bf16 v[48:51], a[216:219], v[168:171], v[48:51]
s_waitcnt lgkmcnt(12)
buffer_load_dwordx4 v70, s[20:23], s36 offen offset:3072 lds
v_mfma_f32_16x16x32_bf16 v[56:59], a[220:223], v[168:171], v[56:59]
s_waitcnt vmcnt(40)
s_barrier
s_addk_i32 m0, 4096
s_add_u32 s36, s35, 41984
buffer_load_dwordx4 v63, s[20:23], s36 offen lds
ds_read_b128 a[208:211], v4 offset:24704
ds_read_b128 a[212:215], v5 offset:24704
v_mfma_f32_16x16x32_bf16 v[64:67], a[224:227], v[168:171], v[64:67]
ds_read_b128 a[216:219], v4 offset:24832
buffer_load_dwordx4 v68, s[20:23], s36 offen offset:1024 lds
v_mfma_f32_16x16x32_bf16 v[72:75], a[228:231], v[168:171], v[72:75]
s_waitcnt lgkmcnt(9)
ds_read_b128 a[220:223], v5 offset:24832
buffer_load_dwordx4 v69, s[20:23], s36 offen offset:2048 lds
v_mfma_f32_16x16x32_bf16 v[80:83], a[232:235], v[168:171], v[80:83]
ds_read_b128 a[224:227], v4 offset:24960
v_mfma_f32_16x16x32_bf16 v[88:91], a[236:239], v[168:171], v[88:91]
ds_read_b128 a[228:231], v5 offset:24960
buffer_load_dwordx4 v70, s[20:23], s36 offen offset:3072 lds
v_mfma_f32_16x16x32_bf16 v[96:99], a[240:243], v[168:171], v[96:99]
s_waitcnt lgkmcnt(6)
s_addk_i32 m0, 4096
s_add_u32 s36, s35, 82944
buffer_load_dwordx4 v63, s[20:23], s36 offen lds
ds_read_b128 a[232:235], v4 offset:30848
v_mfma_f32_16x16x32_bf16 v[104:107], a[244:247], v[168:171], v[104:107]
ds_read_b128 a[236:239], v5 offset:30848
buffer_load_dwordx4 v68, s[20:23], s36 offen offset:1024 lds
v_mfma_f32_16x16x32_bf16 v[112:115], a[248:251], v[168:171], v[112:115]
ds_read_b128 a[240:243], v4 offset:30976
v_mfma_f32_16x16x32_bf16 v[120:123], a[252:255], v[168:171], v[120:123]
s_waitcnt lgkmcnt(6)
ds_read_b128 a[244:247], v5 offset:30976
buffer_load_dwordx4 v69, s[20:23], s36 offen offset:2048 lds
v_mfma_f32_16x16x32_bf16 v[144:147], a[208:211], v[192:195], v[136:139]
ds_read_b128 a[248:251], v4 offset:31104
buffer_load_dwordx4 v70, s[20:23], s36 offen offset:3072 lds
v_exp_f32_e32 v154, v154
v_exp_f32_e32 v155, v155
v_add_f32_e32 v128, v128, v152
v_mfma_f32_16x16x32_bf16 v[144:147], a[212:215], v[200:203], v[144:147]
ds_read_b128 a[252:255], v5 offset:31104
v_add_f32_e32 v129, v129, v153
v_add_f32_e32 v130, v130, v154
v_add_f32_e32 v131, v131, v155
v_cvt_pk_bf16_f32 v163, v154, v155
v_mfma_f32_16x16x32_bf16 v[144:147], a[216:219], v[208:211], v[144:147]
s_waitcnt lgkmcnt(6)
v_mfma_f32_16x16x32_bf16 v[144:147], a[220:223], v[216:219], v[144:147]
s_waitcnt vmcnt(63)
s_barrier
s_addk_i32 m0, 4160
s_add_u32 s36, s35, 123904
buffer_load_dwordx4 v63, s[20:23], s36 offen lds
ds_read_b64_tr_b16 a[208:209], v8 offset:12352
ds_read_b64_tr_b16 a[210:211], v8 offset:18496
ds_read_b64_tr_b16 a[212:213], v9 offset:12352
v_mfma_f32_16x16x32_bf16 v[144:147], a[224:227], v[224:227], v[144:147]
ds_read_b64_tr_b16 a[214:215], v9 offset:18496
ds_read_b64_tr_b16 a[216:217], v10 offset:12352
ds_read_b64_tr_b16 a[218:219], v10 offset:18496
buffer_load_dwordx4 v68, s[20:23], s36 offen offset:1024 lds
v_mfma_f32_16x16x32_bf16 v[144:147], a[228:231], v[232:235], v[144:147]
s_waitcnt lgkmcnt(9)
ds_read_b64_tr_b16 a[220:221], v11 offset:12352
ds_read_b64_tr_b16 a[222:223], v11 offset:18496
buffer_load_dwordx4 v69, s[20:23], s36 offen offset:2048 lds
v_mfma_f32_16x16x32_bf16 v[152:155], a[232:235], v[192:195], v[136:139]
ds_read_b64_tr_b16 a[224:225], v8 offset:12480
ds_read_b64_tr_b16 a[226:227], v8 offset:18624
buffer_load_dwordx4 v70, s[20:23], s36 offen offset:3072 lds
v_exp_f32_e32 v144, v144
v_exp_f32_e32 v145, v145
v_mfma_f32_16x16x32_bf16 v[152:155], a[236:239], v[200:203], v[152:155]
s_addk_i32 m0, 4096
s_add_u32 s36, s35, 164864
buffer_load_dwordx4 v63, s[20:23], s36 offen lds
ds_read_b64_tr_b16 a[228:229], v9 offset:12480
v_exp_f32_e32 v146, v146
v_exp_f32_e32 v147, v147
v_mfma_f32_16x16x32_bf16 v[152:155], a[240:243], v[208:211], v[152:155]
s_waitcnt lgkmcnt(11)
ds_read_b64_tr_b16 a[230:231], v9 offset:18624
ds_read_b64_tr_b16 a[232:233], v10 offset:12480
ds_read_b64_tr_b16 a[234:235], v10 offset:18624
buffer_load_dwordx4 v68, s[20:23], s36 offen offset:1024 lds
v_add_f32_e32 v128, v128, v144
v_add_f32_e32 v129, v129, v145
v_add_f32_e32 v130, v130, v146
v_mfma_f32_16x16x32_bf16 v[152:155], a[244:247], v[216:219], v[152:155]
ds_read_b64_tr_b16 a[236:237], v11 offset:12480
ds_read_b64_tr_b16 a[238:239], v11 offset:18624
buffer_load_dwordx4 v69, s[20:23], s36 offen offset:2048 lds
v_add_f32_e32 v131, v131, v147
v_cvt_pk_bf16_f32 v168, v144, v145
v_cvt_pk_bf16_f32 v169, v146, v147
v_mfma_f32_16x16x32_bf16 v[152:155], a[248:251], v[224:227], v[152:155]
ds_read_b64_tr_b16 a[240:241], v8 offset:12608
ds_read_b64_tr_b16 a[242:243], v8 offset:18752
buffer_load_dwordx4 v70, s[20:23], s36 offen offset:3072 lds
v_mfma_f32_16x16x32_bf16 v[152:155], a[252:255], v[232:235], v[152:155]
s_waitcnt lgkmcnt(12)
s_addk_i32 m0, 4096
s_add_u32 s36, s35, 205824
buffer_load_dwordx4 v63, s[20:23], s36 offen lds
ds_read_b64_tr_b16 a[244:245], v9 offset:12608
ds_read_b64_tr_b16 a[246:247], v9 offset:18752
v_mfma_f32_16x16x32_bf16 v[32:35], a[208:211], v[160:163], v[32:35]
ds_read_b64_tr_b16 a[248:249], v10 offset:12608
ds_read_b64_tr_b16 a[250:251], v10 offset:18752
buffer_load_dwordx4 v68, s[20:23], s36 offen offset:1024 lds
v_exp_f32_e32 v152, v152
v_exp_f32_e32 v153, v153
v_mfma_f32_16x16x32_bf16 v[40:43], a[212:215], v[160:163], v[40:43]
ds_read_b64_tr_b16 a[252:253], v11 offset:12608
ds_read_b64_tr_b16 a[254:255], v11 offset:18752
buffer_load_dwordx4 v69, s[20:23], s36 offen offset:2048 lds
v_cvt_pk_bf16_f32 v170, v152, v153
v_mfma_f32_16x16x32_bf16 v[48:51], a[216:219], v[160:163], v[48:51]
s_waitcnt lgkmcnt(12)
buffer_load_dwordx4 v70, s[20:23], s36 offen offset:3072 lds
v_mfma_f32_16x16x32_bf16 v[56:59], a[220:223], v[160:163], v[56:59]
s_waitcnt vmcnt(40)
s_barrier
s_mov_b32 m0, 37056
s_addk_i32 s33, 4096
buffer_load_dwordx4 v46, s[12:15], s33 offen nt lds
ds_read_b128 a[208:211], v6 offset:0
ds_read_b128 a[212:215], v7 offset:0
v_mfma_f32_16x16x32_bf16 v[64:67], a[224:227], v[160:163], v[64:67]
ds_read_b128 a[216:219], v6 offset:128
buffer_load_dwordx4 v47, s[12:15], s33 offen offset:1024 nt lds
buffer_load_dwordx4 v52, s[12:15], s33 offen offset:2048 nt lds
buffer_load_dwordx4 v46, s[12:15], s33 offen offset:3072 nt lds
v_mfma_f32_16x16x32_bf16 v[72:75], a[228:231], v[160:163], v[72:75]
s_waitcnt lgkmcnt(9)
s_addk_i32 m0, 4096
s_addk_i32 s33, 4096
buffer_load_dwordx4 v47, s[12:15], s33 offen nt lds
ds_read_b128 a[220:223], v7 offset:128
buffer_load_dwordx4 v52, s[12:15], s33 offen offset:1024 nt lds
v_mfma_f32_16x16x32_bf16 v[80:83], a[232:235], v[160:163], v[80:83]
ds_read_b128 a[224:227], v6 offset:256
buffer_load_dwordx4 v46, s[12:15], s33 offen offset:2048 nt lds
buffer_load_dwordx4 v47, s[12:15], s33 offen offset:3072 nt lds
v_mfma_f32_16x16x32_bf16 v[88:91], a[236:239], v[160:163], v[88:91]
s_mov_b32 m0, 135872
s_add_u32 s36, s35, 1152
buffer_load_dwordx4 v63, s[20:23], s36 offen lds
ds_read_b128 a[228:231], v7 offset:256
v_mfma_f32_16x16x32_bf16 v[96:99], a[240:243], v[160:163], v[96:99]
s_waitcnt lgkmcnt(6)
ds_read_b128 a[232:235], v6 offset:6144
buffer_load_dwordx4 v68, s[20:23], s36 offen offset:1024 lds
buffer_load_dwordx4 v69, s[20:23], s36 offen offset:2048 lds
v_mfma_f32_16x16x32_bf16 v[104:107], a[244:247], v[160:163], v[104:107]
ds_read_b128 a[236:239], v7 offset:6144
buffer_load_dwordx4 v70, s[20:23], s36 offen offset:3072 lds
v_mfma_f32_16x16x32_bf16 v[112:115], a[248:251], v[160:163], v[112:115]
s_addk_i32 m0, 4096
s_add_u32 s36, s35, 42112
buffer_load_dwordx4 v63, s[20:23], s36 offen lds
ds_read_b128 a[240:243], v6 offset:6272
buffer_load_dwordx4 v68, s[20:23], s36 offen offset:1024 lds
v_mfma_f32_16x16x32_bf16 v[120:123], a[252:255], v[160:163], v[120:123]
buffer_load_dwordx4 v69, s[20:23], s36 offen offset:2048 lds
buffer_load_dwordx4 v70, s[20:23], s36 offen offset:3072 lds
L_O1c:
s_waitcnt vmcnt(63)
s_barrier
ds_read_b64_tr_b16 a[208:209], v20 offset:49408
ds_read_b64_tr_b16 a[210:211], v20 offset:51456
ds_read_b64_tr_b16 a[212:213], v20 offset:53504
ds_read_b64_tr_b16 a[214:215], v20 offset:55552
ds_read_b64_tr_b16 a[216:217], v20 offset:57600
ds_read_b64_tr_b16 a[218:219], v20 offset:59648
ds_read_b64_tr_b16 a[220:221], v21 offset:49408
ds_read_b64_tr_b16 a[222:223], v21 offset:51456
ds_read_b64_tr_b16 a[224:225], v21 offset:53504
ds_read_b64_tr_b16 a[226:227], v21 offset:55552
ds_read_b64_tr_b16 a[228:229], v21 offset:57600
ds_read_b64_tr_b16 a[230:231], v21 offset:59648
ds_read_b64_tr_b16 a[232:233], v22 offset:49408
ds_read_b64_tr_b16 a[234:235], v22 offset:51456
ds_read_b64_tr_b16 a[236:237], v22 offset:53504
ds_read_b64_tr_b16 a[238:239], v22 offset:55552
ds_read_b64_tr_b16 a[240:241], v22 offset:57600
ds_read_b64_tr_b16 a[242:243], v22 offset:59648
s_waitcnt lgkmcnt(12)
v_mfma_f32_16x16x32_bf16 a[112:115], a[208:211], a[160:163], a[112:115]
s_mov_b32 m0, 45248
s_addk_i32 s33, 4096
buffer_load_dwordx4 v52, s[12:15], s33 offen nt lds
ds_read_b64_tr_b16 a[244:245], v23 offset:49408
ds_read_b64_tr_b16 a[246:247], v23 offset:51456
ds_read_b64_tr_b16 a[248:249], v23 offset:53504
ds_read_b64_tr_b16 a[250:251], v23 offset:55552
v_mfma_f32_16x16x32_bf16 a[112:115], a[212:215], a[168:171], a[112:115]
ds_read_b64_tr_b16 a[252:253], v23 offset:57600
ds_read_b64_tr_b16 a[254:255], v23 offset:59648
buffer_load_dwordx4 v46, s[12:15], s33 offen offset:1024 nt lds
buffer_load_dwordx4 v47, s[12:15], s33 offen offset:2048 nt lds
v_mfma_f32_16x16x32_bf16 a[112:115], a[216:219], a[176:179], a[112:115]
s_waitcnt lgkmcnt(12)
buffer_load_dwordx4 v52, s[12:15], s33 offen offset:3072 nt lds
v_mfma_f32_16x16x32_bf16 a[116:119], a[220:223], a[160:163], a[116:119]
s_waitcnt vmcnt(44)
s_barrier
s_mov_b32 m0, 144064
s_add_u32 s36, s35, 83072
buffer_load_dwordx4 v63, s[20:23], s36 offen lds
ds_read_b64_tr_b16 a[208:209], v20 offset:0
ds_read_b64_tr_b16 a[210:211], v20 offset:2048
ds_read_b64_tr_b16 a[212:213], v20 offset:4096
v_mfma_f32_16x16x32_bf16 a[116:119], a[224:227], a[168:171], a[116:119]
ds_read_b64_tr_b16 a[214:215], v20 offset:6144
ds_read_b64_tr_b16 a[216:217], v20 offset:8192
ds_read_b64_tr_b16 a[218:219], v20 offset:10240
buffer_load_dwordx4 v68, s[20:23], s36 offen offset:1024 lds
v_mfma_f32_16x16x32_bf16 a[116:119], a[228:231], a[176:179], a[116:119]
s_waitcnt lgkmcnt(12)
ds_read_b64_tr_b16 a[220:221], v21 offset:0
ds_read_b64_tr_b16 a[222:223], v21 offset:2048
buffer_load_dwordx4 v69, s[20:23], s36 offen offset:2048 lds
v_mfma_f32_16x16x32_bf16 a[120:123], a[232:235], a[160:163], a[120:123]
ds_read_b64_tr_b16 a[224:225], v21 offset:4096
ds_read_b64_tr_b16 a[226:227], v21 offset:6144
v_mfma_f32_16x16x32_bf16 a[120:123], a[236:239], a[168:171], a[120:123]
ds_read_b64_tr_b16 a[228:229], v21 offset:8192
ds_read_b64_tr_b16 a[230:231], v21 offset:10240
buffer_load_dwordx4 v70, s[20:23], s36 offen offset:3072 lds
v_mfma_f32_16x16x32_bf16 a[120:123], a[240:243], a[176:179], a[120:123]
s_waitcnt lgkmcnt(12)
s_movk_i32 m0, 0
s_addk_i32 s32, 4096
buffer_load_dwordx4 v36, s[8:11], s32 offen nt lds
ds_read_b64_tr_b16 a[232:233], v22 offset:0
ds_read_b64_tr_b16 a[234:235], v22 offset:2048
v_mfma_f32_16x16x32_bf16 a[124:127], a[244:247], a[160:163], a[124:127]
ds_read_b64_tr_b16 a[236:237], v22 offset:4096
ds_read_b64_tr_b16 a[238:239], v22 offset:6144
buffer_load_dwordx4 v37, s[8:11], s32 offen offset:1024 nt lds
v_mfma_f32_16x16x32_bf16 a[124:127], a[248:251], a[168:171], a[124:127]
ds_read_b64_tr_b16 a[240:241], v22 offset:8192
ds_read_b64_tr_b16 a[242:243], v22 offset:10240
v_mfma_f32_16x16x32_bf16 a[124:127], a[252:255], a[176:179], a[124:127]
s_waitcnt lgkmcnt(12)
ds_read_b64_tr_b16 a[244:245], v23 offset:0
ds_read_b64_tr_b16 a[246:247], v23 offset:2048
buffer_load_dwordx4 v38, s[8:11], s32 offen offset:2048 nt lds
v_mfma_f32_16x16x32_bf16 a[112:115], a[208:211], a[184:187], a[112:115]
ds_read_b64_tr_b16 a[248:249], v23 offset:4096
ds_read_b64_tr_b16 a[250:251], v23 offset:6144
buffer_load_dwordx4 v39, s[8:11], s32 offen offset:3072 nt lds
v_mfma_f32_16x16x32_bf16 a[112:115], a[212:215], a[192:195], a[112:115]
ds_read_b64_tr_b16 a[252:253], v23 offset:8192
ds_read_b64_tr_b16 a[254:255], v23 offset:10240
v_mfma_f32_16x16x32_bf16 a[112:115], a[216:219], a[200:203], a[112:115]
s_waitcnt lgkmcnt(12)
v_mfma_f32_16x16x32_bf16 a[116:119], a[220:223], a[184:187], a[116:119]
s_waitcnt vmcnt(40)
s_barrier
s_mov_b32 m0, 148224
s_add_u32 s36, s35, 124032
buffer_load_dwordx4 v63, s[20:23], s36 offen lds
ds_read_b64_tr_b16 a[208:209], v20 offset:12352
ds_read_b64_tr_b16 a[210:211], v20 offset:14400
ds_read_b64_tr_b16 a[212:213], v20 offset:16448
v_mfma_f32_16x16x32_bf16 a[116:119], a[224:227], a[192:195], a[116:119]
ds_read_b64_tr_b16 a[214:215], v20 offset:18496
ds_read_b64_tr_b16 a[216:217], v20 offset:20544
ds_read_b64_tr_b16 a[218:219], v20 offset:22592
buffer_load_dwordx4 v68, s[20:23], s36 offen offset:1024 lds
v_mfma_f32_16x16x32_bf16 a[116:119], a[228:231], a[200:203], a[116:119]
s_waitcnt lgkmcnt(12)
ds_read_b64_tr_b16 a[220:221], v21 offset:12352
ds_read_b64_tr_b16 a[222:223], v21 offset:14400
buffer_load_dwordx4 v69, s[20:23], s36 offen offset:2048 lds
v_mfma_f32_16x16x32_bf16 a[120:123], a[232:235], a[184:187], a[120:123]
ds_read_b64_tr_b16 a[224:225], v21 offset:16448
ds_read_b64_tr_b16 a[226:227], v21 offset:18496
buffer_load_dwordx4 v70, s[20:23], s36 offen offset:3072 lds
v_mfma_f32_16x16x32_bf16 a[120:123], a[236:239], a[192:195], a[120:123]
s_addk_i32 m0, 4096
s_add_u32 s36, s35, 164992
buffer_load_dwordx4 v63, s[20:23], s36 offen lds
ds_read_b64_tr_b16 a[228:229], v21 offset:20544
ds_read_b64_tr_b16 a[230:231], v21 offset:22592
v_mfma_f32_16x16x32_bf16 a[120:123], a[240:243], a[200:203], a[120:123]
s_waitcnt lgkmcnt(12)
ds_read_b64_tr_b16 a[232:233], v22 offset:12352
ds_read_b64_tr_b16 a[234:235], v22 offset:14400
buffer_load_dwordx4 v68, s[20:23], s36 offen offset:1024 lds
v_mfma_f32_16x16x32_bf16 a[124:127], a[244:247], a[184:187], a[124:127]
ds_read_b64_tr_b16 a[236:237], v22 offset:16448
ds_read_b64_tr_b16 a[238:239], v22 offset:18496
buffer_load_dwordx4 v69, s[20:23], s36 offen offset:2048 lds
v_mfma_f32_16x16x32_bf16 a[124:127], a[248:251], a[192:195], a[124:127]
ds_read_b64_tr_b16 a[240:241], v22 offset:20544
ds_read_b64_tr_b16 a[242:243], v22 offset:22592
buffer_load_dwordx4 v70, s[20:23], s36 offen offset:3072 lds
v_mfma_f32_16x16x32_bf16 a[124:127], a[252:255], a[200:203], a[124:127]
s_waitcnt lgkmcnt(12)
s_addk_i32 m0, 4096
s_add_u32 s36, s35, 205952
buffer_load_dwordx4 v63, s[20:23], s36 offen lds
ds_read_b64_tr_b16 a[244:245], v23 offset:12352
ds_read_b64_tr_b16 a[246:247], v23 offset:14400
v_mfma_f32_16x16x32_bf16 a[128:131], a[208:211], a[160:163], a[128:131]
ds_read_b64_tr_b16 a[248:249], v23 offset:16448
ds_read_b64_tr_b16 a[250:251], v23 offset:18496
buffer_load_dwordx4 v68, s[20:23], s36 offen offset:1024 lds
v_mfma_f32_16x16x32_bf16 a[128:131], a[212:215], a[168:171], a[128:131]
ds_read_b64_tr_b16 a[252:253], v23 offset:20544
ds_read_b64_tr_b16 a[254:255], v23 offset:22592
buffer_load_dwordx4 v69, s[20:23], s36 offen offset:2048 lds
v_mfma_f32_16x16x32_bf16 a[128:131], a[216:219], a[176:179], a[128:131]
s_waitcnt lgkmcnt(12)
buffer_load_dwordx4 v70, s[20:23], s36 offen offset:3072 lds
v_mfma_f32_16x16x32_bf16 a[132:135], a[220:223], a[160:163], a[132:135]
s_waitcnt vmcnt(40)
s_barrier
s_movk_i32 m0, 4096
s_addk_i32 s32, 4096
buffer_load_dwordx4 v44, s[8:11], s32 offen nt lds
ds_read_b64_tr_b16 a[208:209], v20 offset:24704
ds_read_b64_tr_b16 a[210:211], v20 offset:26752
ds_read_b64_tr_b16 a[212:213], v20 offset:28800
v_mfma_f32_16x16x32_bf16 a[132:135], a[224:227], a[168:171], a[132:135]
ds_read_b64_tr_b16 a[214:215], v20 offset:30848
ds_read_b64_tr_b16 a[216:217], v20 offset:32896
ds_read_b64_tr_b16 a[218:219], v20 offset:34944
buffer_load_dwordx4 v45, s[8:11], s32 offen offset:1024 nt lds
v_mfma_f32_16x16x32_bf16 a[132:135], a[228:231], a[176:179], a[132:135]
s_waitcnt lgkmcnt(12)
ds_read_b64_tr_b16 a[220:221], v21 offset:24704
ds_read_b64_tr_b16 a[222:223], v21 offset:26752
buffer_load_dwordx4 v36, s[8:11], s32 offen offset:2048 nt lds
v_mfma_f32_16x16x32_bf16 a[136:139], a[232:235], a[160:163], a[136:139]
ds_read_b64_tr_b16 a[224:225], v21 offset:28800
ds_read_b64_tr_b16 a[226:227], v21 offset:30848
buffer_load_dwordx4 v37, s[8:11], s32 offen offset:3072 nt lds
v_mfma_f32_16x16x32_bf16 a[136:139], a[236:239], a[168:171], a[136:139]
s_movk_i32 m0, 8192
s_addk_i32 s32, 4096
buffer_load_dwordx4 v38, s[8:11], s32 offen nt lds
ds_read_b64_tr_b16 a[228:229], v21 offset:32896
ds_read_b64_tr_b16 a[230:231], v21 offset:34944
v_mfma_f32_16x16x32_bf16 a[136:139], a[240:243], a[176:179], a[136:139]
s_waitcnt lgkmcnt(12)
ds_read_b64_tr_b16 a[232:233], v22 offset:24704
ds_read_b64_tr_b16 a[234:235], v22 offset:26752
buffer_load_dwordx4 v39, s[8:11], s32 offen offset:1024 nt lds
v_mfma_f32_16x16x32_bf16 a[140:143], a[244:247], a[160:163], a[140:143]
ds_read_b64_tr_b16 a[236:237], v22 offset:28800
ds_read_b64_tr_b16 a[238:239], v22 offset:30848
buffer_load_dwordx4 v44, s[8:11], s32 offen offset:2048 nt lds
v_mfma_f32_16x16x32_bf16 a[140:143], a[248:251], a[168:171], a[140:143]
ds_read_b64_tr_b16 a[240:241], v22 offset:32896
ds_read_b64_tr_b16 a[242:243], v22 offset:34944
buffer_load_dwordx4 v45, s[8:11], s32 offen offset:3072 nt lds
v_mfma_f32_16x16x32_bf16 a[140:143], a[252:255], a[176:179], a[140:143]
s_waitcnt lgkmcnt(12)
s_movk_i32 m0, 24704
s_addk_i32 s32, 4096
buffer_load_dwordx4 v36, s[8:11], s32 offen nt lds
ds_read_b64_tr_b16 a[244:245], v23 offset:24704
ds_read_b64_tr_b16 a[246:247], v23 offset:26752
v_mfma_f32_16x16x32_bf16 a[128:131], a[208:211], a[184:187], a[128:131]
ds_read_b64_tr_b16 a[248:249], v23 offset:28800
ds_read_b64_tr_b16 a[250:251], v23 offset:30848
buffer_load_dwordx4 v37, s[8:11], s32 offen offset:1024 nt lds
v_mfma_f32_16x16x32_bf16 a[128:131], a[212:215], a[192:195], a[128:131]
ds_read_b64_tr_b16 a[252:253], v23 offset:32896
ds_read_b64_tr_b16 a[254:255], v23 offset:34944
buffer_load_dwordx4 v38, s[8:11], s32 offen offset:2048 nt lds
v_mfma_f32_16x16x32_bf16 a[128:131], a[216:219], a[200:203], a[128:131]
s_waitcnt lgkmcnt(12)
buffer_load_dwordx4 v39, s[8:11], s32 offen offset:3072 nt lds
v_mfma_f32_16x16x32_bf16 a[132:135], a[220:223], a[184:187], a[132:135]
s_waitcnt vmcnt(28)
s_barrier
s_movk_i32 m0, 28800
s_addk_i32 s32, 4096
buffer_load_dwordx4 v44, s[8:11], s32 offen nt lds
ds_read_b64_tr_b16 a[208:209], v20 offset:37056
ds_read_b64_tr_b16 a[210:211], v20 offset:39104
ds_read_b64_tr_b16 a[212:213], v20 offset:41152
v_mfma_f32_16x16x32_bf16 a[132:135], a[224:227], a[192:195], a[132:135]
ds_read_b64_tr_b16 a[214:215], v20 offset:43200
ds_read_b64_tr_b16 a[216:217], v20 offset:45248
ds_read_b64_tr_b16 a[218:219], v20 offset:47296
buffer_load_dwordx4 v45, s[8:11], s32 offen offset:1024 nt lds
v_mfma_f32_16x16x32_bf16 a[132:135], a[228:231], a[200:203], a[132:135]
s_waitcnt lgkmcnt(12)
ds_read_b64_tr_b16 a[220:221], v21 offset:37056
ds_read_b64_tr_b16 a[222:223], v21 offset:39104
buffer_load_dwordx4 v36, s[8:11], s32 offen offset:2048 nt lds
v_mfma_f32_16x16x32_bf16 a[136:139], a[232:235], a[184:187], a[136:139]
ds_read_b64_tr_b16 a[224:225], v21 offset:41152
ds_read_b64_tr_b16 a[226:227], v21 offset:43200
v_mfma_f32_16x16x32_bf16 a[136:139], a[236:239], a[192:195], a[136:139]
ds_read_b64_tr_b16 a[228:229], v21 offset:45248
ds_read_b64_tr_b16 a[230:231], v21 offset:47296
buffer_load_dwordx4 v37, s[8:11], s32 offen offset:3072 nt lds
v_mfma_f32_16x16x32_bf16 a[136:139], a[240:243], a[200:203], a[136:139]
s_waitcnt lgkmcnt(12)
s_addk_i32 m0, 4096
s_addk_i32 s32, 4096
buffer_load_dwordx4 v38, s[8:11], s32 offen nt lds
ds_read_b64_tr_b16 a[232:233], v22 offset:37056
ds_read_b64_tr_b16 a[234:235], v22 offset:39104
v_mfma_f32_16x16x32_bf16 a[140:143], a[244:247], a[184:187], a[140:143]
ds_read_b64_tr_b16 a[236:237], v22 offset:41152
ds_read_b64_tr_b16 a[238:239], v22 offset:43200
buffer_load_dwordx4 v39, s[8:11], s32 offen offset:1024 nt lds
v_mfma_f32_16x16x32_bf16 a[140:143], a[248:251], a[192:195], a[140:143]
ds_read_b64_tr_b16 a[240:241], v22 offset:45248
ds_read_b64_tr_b16 a[242:243], v22 offset:47296
v_mfma_f32_16x16x32_bf16 a[140:143], a[252:255], a[200:203], a[140:143]
s_waitcnt lgkmcnt(12)
ds_read_b64_tr_b16 a[244:245], v23 offset:37056
ds_read_b64_tr_b16 a[246:247], v23 offset:39104
buffer_load_dwordx4 v44, s[8:11], s32 offen offset:2048 nt lds
v_mfma_f32_16x16x32_bf16 a[144:147], a[208:211], a[160:163], a[144:147]
ds_read_b64_tr_b16 a[248:249], v23 offset:41152
ds_read_b64_tr_b16 a[250:251], v23 offset:43200
buffer_load_dwordx4 v45, s[8:11], s32 offen offset:3072 nt lds
v_mfma_f32_16x16x32_bf16 a[144:147], a[212:215], a[168:171], a[144:147]
ds_read_b64_tr_b16 a[252:253], v23 offset:45248
ds_read_b64_tr_b16 a[254:255], v23 offset:47296
v_mfma_f32_16x16x32_bf16 a[144:147], a[216:219], a[176:179], a[144:147]
s_waitcnt lgkmcnt(12)
v_mfma_f32_16x16x32_bf16 a[148:151], a[220:223], a[160:163], a[148:151]
s_waitcnt vmcnt(20)
s_barrier
s_addk_i32 m0, 28864
s_addk_i32 s33, 4096
buffer_load_dwordx4 v46, s[12:15], s33 offen nt lds
ds_read_b64_tr_b16 a[208:209], v20 offset:49408
ds_read_b64_tr_b16 a[210:211], v20 offset:51456
ds_read_b64_tr_b16 a[212:213], v20 offset:53504
v_mfma_f32_16x16x32_bf16 a[148:151], a[224:227], a[168:171], a[148:151]
ds_read_b64_tr_b16 a[214:215], v20 offset:55552
ds_read_b64_tr_b16 a[216:217], v20 offset:57600
ds_read_b64_tr_b16 a[218:219], v20 offset:59648
buffer_load_dwordx4 v47, s[12:15], s33 offen offset:1024 nt lds
buffer_load_dwordx4 v52, s[12:15], s33 offen offset:2048 nt lds
v_mfma_f32_16x16x32_bf16 a[148:151], a[228:231], a[176:179], a[148:151]
s_waitcnt lgkmcnt(12)
ds_read_b64_tr_b16 a[220:221], v21 offset:49408
ds_read_b64_tr_b16 a[222:223], v21 offset:51456
buffer_load_dwordx4 v46, s[12:15], s33 offen offset:3072 nt lds
v_mfma_f32_16x16x32_bf16 a[152:155], a[232:235], a[160:163], a[152:155]
s_addk_i32 m0, 4096
s_addk_i32 s33, 4096
buffer_load_dwordx4 v47, s[12:15], s33 offen nt lds
ds_read_b64_tr_b16 a[224:225], v21 offset:53504
ds_read_b64_tr_b16 a[226:227], v21 offset:55552
buffer_load_dwordx4 v52, s[12:15], s33 offen offset:1024 nt lds
v_mfma_f32_16x16x32_bf16 a[152:155], a[236:239], a[168:171], a[152:155]
ds_read_b64_tr_b16 a[228:229], v21 offset:57600
ds_read_b64_tr_b16 a[230:231], v21 offset:59648
buffer_load_dwordx4 v46, s[12:15], s33 offen offset:2048 nt lds
buffer_load_dwordx4 v47, s[12:15], s33 offen offset:3072 nt lds
v_mfma_f32_16x16x32_bf16 a[152:155], a[240:243], a[176:179], a[152:155]
s_waitcnt lgkmcnt(12)
s_addk_i32 m0, 4096
s_addk_i32 s33, 4096
buffer_load_dwordx4 v52, s[12:15], s33 offen nt lds
ds_read_b64_tr_b16 a[232:233], v22 offset:49408
ds_read_b64_tr_b16 a[234:235], v22 offset:51456
buffer_load_dwordx4 v46, s[12:15], s33 offen offset:1024 nt lds
v_mfma_f32_16x16x32_bf16 a[156:159], a[244:247], a[160:163], a[156:159]
ds_read_b64_tr_b16 a[236:237], v22 offset:53504
ds_read_b64_tr_b16 a[238:239], v22 offset:55552
buffer_load_dwordx4 v47, s[12:15], s33 offen offset:2048 nt lds
v_mfma_f32_16x16x32_bf16 a[156:159], a[248:251], a[168:171], a[156:159]
ds_read_b64_tr_b16 a[240:241], v22 offset:57600
ds_read_b64_tr_b16 a[242:243], v22 offset:59648
buffer_load_dwordx4 v52, s[12:15], s33 offen offset:3072 nt lds
v_mfma_f32_16x16x32_bf16 a[156:159], a[252:255], a[176:179], a[156:159]
s_waitcnt lgkmcnt(12)
s_addk_i32 m0, 16512
s_addk_i32 s33, 4096
buffer_load_dwordx4 v46, s[12:15], s33 offen nt lds
ds_read_b64_tr_b16 a[244:245], v23 offset:49408
ds_read_b64_tr_b16 a[246:247], v23 offset:51456
buffer_load_dwordx4 v47, s[12:15], s33 offen offset:1024 nt lds
v_mfma_f32_16x16x32_bf16 a[144:147], a[208:211], a[184:187], a[144:147]
ds_read_b64_tr_b16 a[248:249], v23 offset:53504
ds_read_b64_tr_b16 a[250:251], v23 offset:55552
buffer_load_dwordx4 v52, s[12:15], s33 offen offset:2048 nt lds
buffer_load_dwordx4 v46, s[12:15], s33 offen offset:3072 nt lds
v_mfma_f32_16x16x32_bf16 a[144:147], a[212:215], a[192:195], a[144:147]
s_addk_i32 m0, 4096
s_addk_i32 s33, 4096
buffer_load_dwordx4 v47, s[12:15], s33 offen nt lds
ds_read_b64_tr_b16 a[252:253], v23 offset:57600
ds_read_b64_tr_b16 a[254:255], v23 offset:59648
v_mfma_f32_16x16x32_bf16 a[144:147], a[216:219], a[200:203], a[144:147]
s_waitcnt lgkmcnt(12)
ds_read_b128 a[208:211], v6 offset:0
buffer_load_dwordx4 v52, s[12:15], s33 offen offset:1024 nt lds
buffer_load_dwordx4 v46, s[12:15], s33 offen offset:2048 nt lds
v_mfma_f32_16x16x32_bf16 a[148:151], a[220:223], a[184:187], a[148:151]
ds_read_b128 a[212:215], v7 offset:0
buffer_load_dwordx4 v47, s[12:15], s33 offen offset:3072 nt lds
v_mfma_f32_16x16x32_bf16 a[148:151], a[224:227], a[192:195], a[148:151]
s_addk_i32 m0, 4096
s_addk_i32 s33, 4096
buffer_load_dwordx4 v52, s[12:15], s33 offen nt lds
ds_read_b128 a[216:219], v6 offset:128
buffer_load_dwordx4 v46, s[12:15], s33 offen offset:1024 nt lds
v_mfma_f32_16x16x32_bf16 a[148:151], a[228:231], a[200:203], a[148:151]
s_waitcnt lgkmcnt(9)
ds_read_b128 a[220:223], v7 offset:128
buffer_load_dwordx4 v47, s[12:15], s33 offen offset:2048 nt lds
v_mfma_f32_16x16x32_bf16 a[152:155], a[232:235], a[184:187], a[152:155]
ds_read_b128 a[224:227], v6 offset:256
buffer_load_dwordx4 v52, s[12:15], s33 offen offset:3072 nt lds
v_mfma_f32_16x16x32_bf16 a[152:155], a[236:239], a[192:195], a[152:155]
s_movk_i32 m0, 12352
s_addk_i32 s33, 4096
buffer_load_dwordx4 v46, s[12:15], s33 offen nt lds
ds_read_b128 a[228:231], v7 offset:256
buffer_load_dwordx4 v47, s[12:15], s33 offen offset:1024 nt lds
v_mfma_f32_16x16x32_bf16 a[152:155], a[240:243], a[200:203], a[152:155]
s_waitcnt lgkmcnt(6)
ds_read_b128 a[232:235], v6 offset:6144
buffer_load_dwordx4 v52, s[12:15], s33 offen offset:2048 nt lds
buffer_load_dwordx4 v46, s[12:15], s33 offen offset:3072 nt lds
v_mfma_f32_16x16x32_bf16 a[156:159], a[244:247], a[184:187], a[156:159]
s_movk_i32 m0, 16448
s_addk_i32 s33, 4096
buffer_load_dwordx4 v47, s[12:15], s33 offen nt lds
ds_read_b128 a[236:239], v7 offset:6144
v_mfma_f32_16x16x32_bf16 a[156:159], a[248:251], a[192:195], a[156:159]
ds_read_b128 a[240:243], v6 offset:6272
buffer_load_dwordx4 v52, s[12:15], s33 offen offset:1024 nt lds
buffer_load_dwordx4 v46, s[12:15], s33 offen offset:2048 nt lds
v_mfma_f32_16x16x32_bf16 a[156:159], a[252:255], a[200:203], a[156:159]
buffer_load_dwordx4 v47, s[12:15], s33 offen offset:3072 nt lds
s_waitcnt lgkmcnt(6)
v_mfma_f32_16x16x32_bf16 v[144:147], a[208:211], v[192:195], v[136:139]
ds_read_b128 a[244:247], v7 offset:6272
ds_read_b128 a[248:251], v6 offset:6400
v_exp_f32_e32 v154, v154
v_exp_f32_e32 v155, v155
v_add_f32_e32 v128, v128, v152
v_add_f32_e32 v129, v129, v153
v_add_f32_e32 v130, v130, v154
v_mfma_f32_16x16x32_bf16 v[144:147], a[212:215], v[200:203], v[144:147]
ds_read_b128 a[252:255], v7 offset:6400
v_add_f32_e32 v131, v131, v155
v_cvt_pk_bf16_f32 v171, v154, v155
v_mfma_f32_16x16x32_bf16 v[144:147], a[216:219], v[208:211], v[144:147]
s_waitcnt lgkmcnt(6)
v_mfma_f32_16x16x32_bf16 v[144:147], a[220:223], v[216:219], v[144:147]
s_waitcnt vmcnt(63)
s_barrier
s_add_u32 s36, s28, 1
s_mul_i32 s34, s36, 384
s_mul_i32 s35, s28, 245760
s_cmp_eq_u32 s28, 3
s_cbranch_scc1 L_w0
s_mov_b32 m0, 98816
s_add_u32 s36, s34, 0
buffer_load_dwordx4 v53, s[16:19], s36 offen lds
buffer_load_dwordx4 v54, s[16:19], s36 offen offset:1024 lds
buffer_load_dwordx4 v55, s[16:19], s36 offen offset:2048 lds
s_addk_i32 m0, 3096
s_add_u32 s36, s34, 98304
buffer_load_dwordx4 v53, s[16:19], s36 offen lds
buffer_load_dwordx4 v54, s[16:19], s36 offen offset:1024 lds
buffer_load_dwordx4 v55, s[16:19], s36 offen offset:2048 lds
s_addk_i32 m0, 3080
s_add_u32 s36, s34, 196608
buffer_load_dwordx4 v53, s[16:19], s36 offen lds
buffer_load_dwordx4 v54, s[16:19], s36 offen offset:1024 lds
buffer_load_dwordx4 v55, s[16:19], s36 offen offset:2048 lds
s_addk_i32 m0, 3096
s_add_u32 s36, s34, 294912
buffer_load_dwordx4 v53, s[16:19], s36 offen lds
buffer_load_dwordx4 v54, s[16:19], s36 offen offset:1024 lds
buffer_load_dwordx4 v55, s[16:19], s36 offen offset:2048 lds
L_w0r:
ds_read_b64_tr_b16 a[208:209], v8 offset:37056
ds_read_b64_tr_b16 a[210:211], v8 offset:43200
v_mfma_f32_16x16x32_bf16 v[144:147], a[224:227], v[224:227], v[144:147]
s_cmp_eq_u32 s28, 3
s_cbranch_scc1 L_w1
s_mov_b32 m0, 111168
s_add_u32 s36, s34, 393216
buffer_load_dwordx4 v53, s[16:19], s36 offen lds
buffer_load_dwordx4 v54, s[16:19], s36 offen offset:1024 lds
buffer_load_dwordx4 v55, s[16:19], s36 offen offset:2048 lds
s_addk_i32 m0, 3096
s_add_u32 s36, s34, 491520
buffer_load_dwordx4 v53, s[16:19], s36 offen lds
buffer_load_dwordx4 v54, s[16:19], s36 offen offset:1024 lds
buffer_load_dwordx4 v55, s[16:19], s36 offen offset:2048 lds
s_addk_i32 m0, 3080
s_add_u32 s36, s34, 589824
buffer_load_dwordx4 v53, s[16:19], s36 offen lds
buffer_load_dwordx4 v54, s[16:19], s36 offen offset:1024 lds
buffer_load_dwordx4 v55, s[16:19], s36 offen offset:2048 lds
s_addk_i32 m0, 3096
s_add_u32 s36, s34, 688128
buffer_load_dwordx4 v53, s[16:19], s36 offen lds
buffer_load_dwordx4 v54, s[16:19], s36 offen offset:1024 lds
buffer_load_dwordx4 v55, s[16:19], s36 offen offset:2048 lds
L_w1r:
ds_read_b64_tr_b16 a[212:213], v9 offset:37056
ds_read_b64_tr_b16 a[214:215], v9 offset:43200
v_mfma_f32_16x16x32_bf16 v[144:147], a[228:231], v[232:235], v[144:147]
s_waitcnt lgkmcnt(7)
s_cmp_eq_u32 s28, 3
s_cbranch_scc1 L_pcf
L_pcfr:
ds_read_b64_tr_b16 a[216:217], v10 offset:37056
ds_read_b64_tr_b16 a[218:219], v10 offset:43200
ds_read_b64_tr_b16 a[220:221], v11 offset:37056
ds_read_b64_tr_b16 a[222:223], v11 offset:43200
v_mfma_f32_16x16x32_bf16 v[152:155], a[232:235], v[192:195], v[136:139]
ds_read_b64_tr_b16 a[224:225], v8 offset:37184
v_exp_f32_e32 v144, v144
v_exp_f32_e32 v145, v145
v_exp_f32_e32 v146, v146
v_exp_f32_e32 v147, v147
v_mfma_f32_16x16x32_bf16 v[152:155], a[236:239], v[200:203], v[152:155]
ds_read_b64_tr_b16 a[226:227], v8 offset:43328
ds_read_b64_tr_b16 a[228:229], v9 offset:37184
ds_read_b64_tr_b16 a[230:231], v9 offset:43328
v_add_f32_e32 v128, v128, v144
v_add_f32_e32 v129, v129, v145
v_add_f32_e32 v130, v130, v146
v_add_f32_e32 v131, v131, v147
v_cvt_pk_bf16_f32 v160, v144, v145
v_cvt_pk_bf16_f32 v161, v146, v147
v_mfma_f32_16x16x32_bf16 v[152:155], a[240:243], v[208:211], v[152:155]
s_waitcnt lgkmcnt(12)
ds_read_b64_tr_b16 a[232:233], v10 offset:37184
ds_read_b64_tr_b16 a[234:235], v10 offset:43328
v_mfma_f32_16x16x32_bf16 v[152:155], a[244:247], v[216:219], v[152:155]
ds_read_b64_tr_b16 a[236:237], v11 offset:37184
ds_read_b64_tr_b16 a[238:239], v11 offset:43328
v_mfma_f32_16x16x32_bf16 v[152:155], a[248:251], v[224:227], v[152:155]
ds_read_b64_tr_b16 a[240:241], v8 offset:37312
ds_read_b64_tr_b16 a[242:243], v8 offset:43456
v_mfma_f32_16x16x32_bf16 v[152:155], a[252:255], v[232:235], v[152:155]
s_waitcnt lgkmcnt(12)
ds_read_b64_tr_b16 a[244:245], v9 offset:37312
ds_read_b64_tr_b16 a[246:247], v9 offset:43456
v_mfma_f32_16x16x32_bf16 v[32:35], a[208:211], v[168:171], v[32:35]
ds_read_b64_tr_b16 a[248:249], v10 offset:37312
ds_read_b64_tr_b16 a[250:251], v10 offset:43456
v_mfma_f32_16x16x32_bf16 v[40:43], a[212:215], v[168:171], v[40:43]
ds_read_b64_tr_b16 a[252:253], v11 offset:37312
ds_read_b64_tr_b16 a[254:255], v11 offset:43456
v_exp_f32_e32 v152, v152
v_exp_f32_e32 v153, v153
v_mfma_f32_16x16x32_bf16 v[48:51], a[216:219], v[168:171], v[48:51]
s_waitcnt lgkmcnt(12)
v_cvt_pk_bf16_f32 v162, v152, v153
v_mfma_f32_16x16x32_bf16 v[56:59], a[220:223], v[168:171], v[56:59]
s_waitcnt vmcnt(63)
s_barrier
s_cmp_eq_u32 s28, 3
s_cbranch_scc1 L_w2
s_mov_b32 m0, 123520
s_add_u32 s36, s34, 786432
buffer_load_dwordx4 v53, s[16:19], s36 offen lds
buffer_load_dwordx4 v54, s[16:19], s36 offen offset:1024 lds
buffer_load_dwordx4 v55, s[16:19], s36 offen offset:2048 lds
s_addk_i32 m0, 3096
s_add_u32 s36, s34, 884736
buffer_load_dwordx4 v53, s[16:19], s36 offen lds
buffer_load_dwordx4 v54, s[16:19], s36 offen offset:1024 lds
buffer_load_dwordx4 v55, s[16:19], s36 offen offset:2048 lds
s_addk_i32 m0, 3080
s_add_u32 s36, s34, 983040
buffer_load_dwordx4 v53, s[16:19], s36 offen lds
buffer_load_dwordx4 v54, s[16:19], s36 offen offset:1024 lds
buffer_load_dwordx4 v55, s[16:19], s36 offen offset:2048 lds
s_addk_i32 m0, 3096
s_add_u32 s36, s34, 1081344
buffer_load_dwordx4 v53, s[16:19], s36 offen lds
buffer_load_dwordx4 v54, s[16:19], s36 offen offset:1024 lds
buffer_load_dwordx4 v55, s[16:19], s36 offen offset:2048 lds
L_w2r:
ds_read_b128 a[208:211], v6 offset:24704
v_mfma_f32_16x16x32_bf16 v[64:67], a[224:227], v[168:171], v[64:67]
ds_read_b128 a[212:215], v7 offset:24704
ds_read_b128 a[216:219], v6 offset:24832
v_mfma_f32_16x16x32_bf16 v[72:75], a[228:231], v[168:171], v[72:75]
s_waitcnt lgkmcnt(9)
ds_read_b128 a[220:223], v7 offset:24832
v_mfma_f32_16x16x32_bf16 v[80:83], a[232:235], v[168:171], v[80:83]
ds_read_b128 a[224:227], v6 offset:24960
v_mfma_f32_16x16x32_bf16 v[88:91], a[236:239], v[168:171], v[88:91]
ds_read_b128 a[228:231], v7 offset:24960
v_mfma_f32_16x16x32_bf16 v[96:99], a[240:243], v[168:171], v[96:99]
s_waitcnt lgkmcnt(6)
ds_read_b128 a[232:235], v6 offset:30848
v_mfma_f32_16x16x32_bf16 v[104:107], a[244:247], v[168:171], v[104:107]
ds_read_b128 a[236:239], v7 offset:30848
v_mfma_f32_16x16x32_bf16 v[112:115], a[248:251], v[168:171], v[112:115]
ds_read_b128 a[240:243], v6 offset:30976
v_mfma_f32_16x16x32_bf16 v[120:123], a[252:255], v[168:171], v[120:123]
s_waitcnt lgkmcnt(6)
ds_read_b128 a[244:247], v7 offset:30976
v_mfma_f32_16x16x32_bf16 v[144:147], a[208:211], v[192:195], v[136:139]
ds_read_b128 a[248:251], v6 offset:31104
v_exp_f32_e32 v154, v154
v_exp_f32_e32 v155, v155
v_add_f32_e32 v128, v128, v152
v_add_f32_e32 v129, v129, v153
v_add_f32_e32 v130, v130, v154
v_add_f32_e32 v131, v131, v155
v_mfma_f32_16x16x32_bf16 v[144:147], a[212:215], v[200:203], v[144:147]
ds_read_b128 a[252:255], v7 offset:31104
v_cvt_pk_bf16_f32 v163, v154, v155
v_mfma_f32_16x16x32_bf16 v[144:147], a[216:219], v[208:211], v[144:147]
s_waitcnt lgkmcnt(6)
v_mfma_f32_16x16x32_bf16 v[144:147], a[220:223], v[216:219], v[144:147]
s_waitcnt vmcnt(56)
s_barrier
s_cmp_eq_u32 s28, 3
s_cbranch_scc1 L_w3
s_mov_b32 m0, 135872
s_add_u32 s36, s34, 1179648
buffer_load_dwordx4 v53, s[16:19], s36 offen lds
buffer_load_dwordx4 v54, s[16:19], s36 offen offset:1024 lds
buffer_load_dwordx4 v55, s[16:19], s36 offen offset:2048 lds
s_addk_i32 m0, 3096
s_add_u32 s36, s34, 1277952
buffer_load_dwordx4 v53, s[16:19], s36 offen lds
buffer_load_dwordx4 v54, s[16:19], s36 offen offset:1024 lds
buffer_load_dwordx4 v55, s[16:19], s36 offen offset:2048 lds
s_addk_i32 m0, 3080
s_add_u32 s36, s34, 1376256
buffer_load_dwordx4 v53, s[16:19], s36 offen lds
buffer_load_dwordx4 v54, s[16:19], s36 offen offset:1024 lds
buffer_load_dwordx4 v55, s[16:19], s36 offen offset:2048 lds
s_addk_i32 m0, 3096
s_add_u32 s36, s34, 1474560
buffer_load_dwordx4 v53, s[16:19], s36 offen lds
buffer_load_dwordx4 v54, s[16:19], s36 offen offset:1024 lds
buffer_load_dwordx4 v55, s[16:19], s36 offen offset:2048 lds
L_w3r:
ds_read_b64_tr_b16 a[208:209], v12 offset:12352
ds_read_b64_tr_b16 a[210:211], v12 offset:18496
v_mfma_f32_16x16x32_bf16 v[144:147], a[224:227], v[224:227], v[144:147]
s_cmp_eq_u32 s28, 3
s_cbranch_scc1 L_x1
s_add_u32 m0, s93, 148224
s_mov_b32 s37, 0
buffer_load_dwordx4 v1, s[4:7], s37 offen lds
buffer_load_dwordx4 v2, s[4:7], s37 offen offset:1024 lds
L_x1:
ds_read_b64_tr_b16 a[212:213], v13 offset:12352
ds_read_b64_tr_b16 a[214:215], v13 offset:18496
v_mfma_f32_16x16x32_bf16 v[144:147], a[228:231], v[232:235], v[144:147]
s_waitcnt lgkmcnt(7)
ds_read_b64_tr_b16 a[216:217], v14 offset:12352
ds_read_b64_tr_b16 a[218:219], v14 offset:18496
ds_read_b64_tr_b16 a[220:221], v15 offset:12352
ds_read_b64_tr_b16 a[222:223], v15 offset:18496
v_mfma_f32_16x16x32_bf16 v[152:155], a[232:235], v[192:195], v[136:139]
ds_read_b64_tr_b16 a[224:225], v12 offset:12480
ds_read_b64_tr_b16 a[226:227], v12 offset:18624
v_exp_f32_e32 v144, v144
v_exp_f32_e32 v145, v145
v_exp_f32_e32 v146, v146
v_cvt_pk_bf16_f32 v168, v144, v145
v_mfma_f32_16x16x32_bf16 v[152:155], a[236:239], v[200:203], v[152:155]
ds_read_b64_tr_b16 a[228:229], v13 offset:12480
ds_read_b64_tr_b16 a[230:231], v13 offset:18624
v_exp_f32_e32 v147, v147
v_add_f32_e32 v128, v128, v144
v_cvt_pk_bf16_f32 v169, v146, v147
v_add_f32_e32 v129, v129, v145
v_add_f32_e32 v130, v130, v146
v_add_f32_e32 v131, v131, v147
v_mfma_f32_16x16x32_bf16 v[152:155], a[240:243], v[208:211], v[152:155]
s_waitcnt lgkmcnt(12)
ds_read_b64_tr_b16 a[232:233], v14 offset:12480
ds_read_b64_tr_b16 a[234:235], v14 offset:18624
v_mfma_f32_16x16x32_bf16 v[152:155], a[244:247], v[216:219], v[152:155]
ds_read_b64_tr_b16 a[236:237], v15 offset:12480
ds_read_b64_tr_b16 a[238:239], v15 offset:18624
v_mfma_f32_16x16x32_bf16 v[152:155], a[248:251], v[224:227], v[152:155]
ds_read_b64_tr_b16 a[240:241], v12 offset:12608
ds_read_b64_tr_b16 a[242:243], v12 offset:18752
v_mfma_f32_16x16x32_bf16 v[152:155], a[252:255], v[232:235], v[152:155]
s_waitcnt lgkmcnt(12)
ds_read_b64_tr_b16 a[244:245], v13 offset:12608
ds_read_b64_tr_b16 a[246:247], v13 offset:18752
v_mfma_f32_16x16x32_bf16 v[32:35], a[208:211], v[160:163], v[32:35]
ds_read_b64_tr_b16 a[248:249], v14 offset:12608
ds_read_b64_tr_b16 a[250:251], v14 offset:18752
v_mfma_f32_16x16x32_bf16 v[40:43], a[212:215], v[160:163], v[40:43]
ds_read_b64_tr_b16 a[252:253], v15 offset:12608
v_exp_f32_e32 v152, v152
v_exp_f32_e32 v153, v153
v_exp_f32_e32 v154, v154
v_exp_f32_e32 v155, v155
v_mfma_f32_16x16x32_bf16 v[48:51], a[216:219], v[160:163], v[48:51]
s_waitcnt lgkmcnt(11)
ds_read_b64_tr_b16 a[254:255], v15 offset:18752
v_cvt_pk_bf16_f32 v170, v152, v153
v_cvt_pk_bf16_f32 v171, v154, v155
v_add_f32_e32 v128, v128, v152
v_add_f32_e32 v129, v129, v153
v_add_f32_e32 v130, v130, v154
v_add_f32_e32 v131, v131, v155
v_mfma_f32_16x16x32_bf16 v[56:59], a[220:223], v[160:163], v[56:59]
s_waitcnt vmcnt(57)
s_barrier
s_mov_b32 m0, 49408
s_addk_i32 s32, 4096
buffer_load_dwordx4 v36, s[8:11], s32 offen nt lds
ds_read_b64_tr_b16 a[208:209], v12 offset:37056
ds_read_b64_tr_b16 a[210:211], v12 offset:43200
ds_read_b64_tr_b16 a[212:213], v13 offset:37056
v_mfma_f32_16x16x32_bf16 v[64:67], a[224:227], v[160:163], v[64:67]
ds_read_b64_tr_b16 a[214:215], v13 offset:43200
ds_read_b64_tr_b16 a[216:217], v14 offset:37056
ds_read_b64_tr_b16 a[218:219], v14 offset:43200
buffer_load_dwordx4 v37, s[8:11], s32 offen offset:1024 nt lds
buffer_load_dwordx4 v38, s[8:11], s32 offen offset:2048 nt lds
v_mfma_f32_16x16x32_bf16 v[72:75], a[228:231], v[160:163], v[72:75]
s_waitcnt lgkmcnt(12)
ds_read_b64_tr_b16 a[220:221], v15 offset:37056
ds_read_b64_tr_b16 a[222:223], v15 offset:43200
buffer_load_dwordx4 v39, s[8:11], s32 offen offset:3072 nt lds
v_mfma_f32_16x16x32_bf16 v[80:83], a[232:235], v[160:163], v[80:83]
s_addk_i32 m0, 4096
s_addk_i32 s32, 4096
buffer_load_dwordx4 v44, s[8:11], s32 offen nt lds
ds_read_b64_tr_b16 a[224:225], v12 offset:37184
ds_read_b64_tr_b16 a[226:227], v12 offset:43328
v_mfma_f32_16x16x32_bf16 v[88:91], a[236:239], v[160:163], v[88:91]
ds_read_b64_tr_b16 a[228:229], v13 offset:37184
ds_read_b64_tr_b16 a[230:231], v13 offset:43328
buffer_load_dwordx4 v45, s[8:11], s32 offen offset:1024 nt lds
v_mfma_f32_16x16x32_bf16 v[96:99], a[240:243], v[160:163], v[96:99]
s_waitcnt lgkmcnt(12)
ds_read_b64_tr_b16 a[232:233], v14 offset:37184
ds_read_b64_tr_b16 a[234:235], v14 offset:43328
buffer_load_dwordx4 v36, s[8:11], s32 offen offset:2048 nt lds
v_mfma_f32_16x16x32_bf16 v[104:107], a[244:247], v[160:163], v[104:107]
ds_read_b64_tr_b16 a[236:237], v15 offset:37184
ds_read_b64_tr_b16 a[238:239], v15 offset:43328
buffer_load_dwordx4 v37, s[8:11], s32 offen offset:3072 nt lds
v_mfma_f32_16x16x32_bf16 v[112:115], a[248:251], v[160:163], v[112:115]
s_addk_i32 m0, 4096
s_addk_i32 s32, 4096
buffer_load_dwordx4 v38, s[8:11], s32 offen nt lds
ds_read_b64_tr_b16 a[240:241], v12 offset:37312
ds_read_b64_tr_b16 a[242:243], v12 offset:43456
buffer_load_dwordx4 v39, s[8:11], s32 offen offset:1024 nt lds
v_mfma_f32_16x16x32_bf16 v[120:123], a[252:255], v[160:163], v[120:123]
s_waitcnt lgkmcnt(12)
ds_read_b64_tr_b16 a[244:245], v13 offset:37312
ds_read_b64_tr_b16 a[246:247], v13 offset:43456
buffer_load_dwordx4 v44, s[8:11], s32 offen offset:2048 nt lds
v_mfma_f32_16x16x32_bf16 v[32:35], a[208:211], v[168:171], v[32:35]
ds_read_b64_tr_b16 a[248:249], v14 offset:37312
ds_read_b64_tr_b16 a[250:251], v14 offset:43456
buffer_load_dwordx4 v45, s[8:11], s32 offen offset:3072 nt lds
v_add_f32_e32 v128, v128, v129
v_add_f32_e32 v130, v130, v131
v_add_f32_e32 v128, v128, v130
v_mov_b32_e32 v27, v128
v_mfma_f32_16x16x32_bf16 v[40:43], a[212:215], v[168:171], v[40:43]
s_movk_i32 m0, 20544
s_addk_i32 s33, 4096
buffer_load_dwordx4 v52, s[12:15], s33 offen nt lds
ds_read_b64_tr_b16 a[252:253], v15 offset:37312
ds_read_b64_tr_b16 a[254:255], v15 offset:43456
v_permlane32_swap_b32 v128, v27
v_add_f32_e32 v128, v128, v27
v_mfma_f32_16x16x32_bf16 v[48:51], a[216:219], v[168:171], v[48:51]
s_waitcnt lgkmcnt(12)
buffer_load_dwordx4 v46, s[12:15], s33 offen offset:1024 nt lds
v_mov_b32_e32 v27, v128
v_mfma_f32_16x16x32_bf16 v[56:59], a[220:223], v[168:171], v[56:59]
buffer_load_dwordx4 v47, s[12:15], s33 offen offset:2048 nt lds
v_permlane16_swap_b32 v128, v27
v_add_f32_e32 v128, v128, v27
v_rcp_f32_e32 v28, v128
v_cmp_nge_f32_e64 vcc, s42, v128
v_mfma_f32_16x16x32_bf16 v[64:67], a[224:227], v[168:171], v[64:67]
buffer_load_dwordx4 v52, s[12:15], s33 offen offset:3072 nt lds
v_mul_f32_e32 v32, v28, v32
v_mul_f32_e32 v33, v28, v33
v_mul_f32_e32 v34, v28, v34
v_mul_f32_e32 v35, v28, v35
v_mul_f32_e32 v40, v28, v40
v_mul_f32_e32 v41, v28, v41
v_mfma_f32_16x16x32_bf16 v[72:75], a[228:231], v[168:171], v[72:75]
s_waitcnt lgkmcnt(6)
s_addk_i32 m0, 16512
s_addk_i32 s33, 4096
buffer_load_dwordx4 v46, s[12:15], s33 offen nt lds
buffer_load_dwordx4 v47, s[12:15], s33 offen offset:1024 nt lds
v_mul_f32_e32 v42, v28, v42
v_mul_f32_e32 v43, v28, v43
v_mfma_f32_16x16x32_bf16 v[80:83], a[232:235], v[168:171], v[80:83]
buffer_load_dwordx4 v52, s[12:15], s33 offen offset:2048 nt lds
v_mul_f32_e32 v48, v28, v48
v_mul_f32_e32 v49, v28, v49
v_mul_f32_e32 v50, v28, v50
v_mul_f32_e32 v51, v28, v51
v_mfma_f32_16x16x32_bf16 v[88:91], a[236:239], v[168:171], v[88:91]
buffer_load_dwordx4 v46, s[12:15], s33 offen offset:3072 nt lds
v_mfma_f32_16x16x32_bf16 v[96:99], a[240:243], v[168:171], v[96:99]
s_waitcnt lgkmcnt(0)
s_addk_i32 m0, 4096
s_addk_i32 s33, 4096
buffer_load_dwordx4 v47, s[12:15], s33 offen nt lds
v_mfma_f32_16x16x32_bf16 v[104:107], a[244:247], v[168:171], v[104:107]
buffer_load_dwordx4 v52, s[12:15], s33 offen offset:1024 nt lds
v_mfma_f32_16x16x32_bf16 v[112:115], a[248:251], v[168:171], v[112:115]
buffer_load_dwordx4 v46, s[12:15], s33 offen offset:2048 nt lds
v_mfma_f32_16x16x32_bf16 v[120:123], a[252:255], v[168:171], v[120:123]
buffer_load_dwordx4 v47, s[12:15], s33 offen offset:3072 nt lds
L_T2:
s_cbranch_vccnz L_slow1
L_back1:
s_add_u32 s28, s28, 1
s_cmp_lt_u32 s28, 4
s_cbranch_scc1 L_item1
s_branch L_fb1
L_xt0:
s_mov_b32 m0, 135872
s_add_u32 s36, s34, 1179648
buffer_load_dwordx4 v53, s[16:19], s36 offen lds
buffer_load_dwordx4 v54, s[16:19], s36 offen offset:1024 lds
buffer_load_dwordx4 v55, s[16:19], s36 offen offset:2048 lds
s_mov_b32 m0, 138968
s_add_u32 s36, s34, 1277952
buffer_load_dwordx4 v53, s[16:19], s36 offen lds
buffer_load_dwordx4 v54, s[16:19], s36 offen offset:1024 lds
buffer_load_dwordx4 v55, s[16:19], s36 offen offset:2048 lds
s_mov_b32 m0, 142048
s_add_u32 s36, s34, 1376256
buffer_load_dwordx4 v53, s[16:19], s36 offen lds
buffer_load_dwordx4 v54, s[16:19], s36 offen offset:1024 lds
buffer_load_dwordx4 v55, s[16:19], s36 offen offset:2048 lds
s_mov_b32 m0, 145144
s_add_u32 s36, s34, 1474560
buffer_load_dwordx4 v53, s[16:19], s36 offen lds
buffer_load_dwordx4 v54, s[16:19], s36 offen offset:1024 lds
buffer_load_dwordx4 v55, s[16:19], s36 offen offset:2048 lds
s_branch L_xt0r
L_first1:
s_mov_b32 m0, 0
s_addk_i32 s32, 4096
buffer_load_dwordx4 v36, s[8:11], s32 offen nt lds
buffer_load_dwordx4 v37, s[8:11], s32 offen offset:1024 nt lds
buffer_load_dwordx4 v38, s[8:11], s32 offen offset:2048 nt lds
buffer_load_dwordx4 v39, s[8:11], s32 offen offset:3072 nt lds
s_mov_b32 m0, 4096
s_addk_i32 s32, 4096
buffer_load_dwordx4 v44, s[8:11], s32 offen nt lds
buffer_load_dwordx4 v45, s[8:11], s32 offen offset:1024 nt lds
buffer_load_dwordx4 v36, s[8:11], s32 offen offset:2048 nt lds
buffer_load_dwordx4 v37, s[8:11], s32 offen offset:3072 nt lds
s_mov_b32 m0, 8192
s_addk_i32 s32, 4096
buffer_load_dwordx4 v38, s[8:11], s32 offen nt lds
buffer_load_dwordx4 v39, s[8:11], s32 offen offset:1024 nt lds
buffer_load_dwordx4 v44, s[8:11], s32 offen offset:2048 nt lds
buffer_load_dwordx4 v45, s[8:11], s32 offen offset:3072 nt lds
s_mov_b32 m0, 24704
s_addk_i32 s32, 4096
buffer_load_dwordx4 v36, s[8:11], s32 offen nt lds
buffer_load_dwordx4 v37, s[8:11], s32 offen offset:1024 nt lds
buffer_load_dwordx4 v38, s[8:11], s32 offen offset:2048 nt lds
buffer_load_dwordx4 v39, s[8:11], s32 offen offset:3072 nt lds
s_branch L_first1r
L_first10:
s_mov_b32 m0, 28800
s_addk_i32 s32, 4096
buffer_load_dwordx4 v44, s[8:11], s32 offen nt lds
buffer_load_dwordx4 v45, s[8:11], s32 offen offset:1024 nt lds
buffer_load_dwordx4 v36, s[8:11], s32 offen offset:2048 nt lds
buffer_load_dwordx4 v37, s[8:11], s32 offen offset:3072 nt lds
s_mov_b32 m0, 32896
s_addk_i32 s32, 4096
buffer_load_dwordx4 v38, s[8:11], s32 offen nt lds
buffer_load_dwordx4 v39, s[8:11], s32 offen offset:1024 nt lds
buffer_load_dwordx4 v44, s[8:11], s32 offen offset:2048 nt lds
buffer_load_dwordx4 v45, s[8:11], s32 offen offset:3072 nt lds
s_mov_b32 m0, 49408
s_addk_i32 s32, 4096
buffer_load_dwordx4 v36, s[8:11], s32 offen nt lds
buffer_load_dwordx4 v37, s[8:11], s32 offen offset:1024 nt lds
buffer_load_dwordx4 v38, s[8:11], s32 offen offset:2048 nt lds
buffer_load_dwordx4 v39, s[8:11], s32 offen offset:3072 nt lds
s_mov_b32 m0, 53504
s_addk_i32 s32, 4096
buffer_load_dwordx4 v44, s[8:11], s32 offen nt lds
buffer_load_dwordx4 v45, s[8:11], s32 offen offset:1024 nt lds
buffer_load_dwordx4 v36, s[8:11], s32 offen offset:2048 nt lds
buffer_load_dwordx4 v37, s[8:11], s32 offen offset:3072 nt lds
s_branch L_first10r
L_first16:
s_mov_b32 m0, 57600
s_addk_i32 s32, 4096
buffer_load_dwordx4 v38, s[8:11], s32 offen nt lds
buffer_load_dwordx4 v39, s[8:11], s32 offen offset:1024 nt lds
buffer_load_dwordx4 v44, s[8:11], s32 offen offset:2048 nt lds
buffer_load_dwordx4 v45, s[8:11], s32 offen offset:3072 nt lds
s_branch L_first16r
L_first17:
s_mov_b32 m0, 12352
s_addk_i32 s33, 4096
buffer_load_dwordx4 v46, s[12:15], s33 offen nt lds
buffer_load_dwordx4 v47, s[12:15], s33 offen offset:1024 nt lds
buffer_load_dwordx4 v52, s[12:15], s33 offen offset:2048 nt lds
buffer_load_dwordx4 v46, s[12:15], s33 offen offset:3072 nt lds
s_mov_b32 m0, 16448
s_addk_i32 s33, 4096
buffer_load_dwordx4 v47, s[12:15], s33 offen nt lds
buffer_load_dwordx4 v52, s[12:15], s33 offen offset:1024 nt lds
buffer_load_dwordx4 v46, s[12:15], s33 offen offset:2048 nt lds
buffer_load_dwordx4 v47, s[12:15], s33 offen offset:3072 nt lds
s_mov_b32 m0, 20544
s_addk_i32 s33, 4096
buffer_load_dwordx4 v52, s[12:15], s33 offen nt lds
buffer_load_dwordx4 v46, s[12:15], s33 offen offset:1024 nt lds
buffer_load_dwordx4 v47, s[12:15], s33 offen offset:2048 nt lds
buffer_load_dwordx4 v52, s[12:15], s33 offen offset:3072 nt lds
s_mov_b32 m0, 37056
s_addk_i32 s33, 4096
buffer_load_dwordx4 v46, s[12:15], s33 offen nt lds
buffer_load_dwordx4 v47, s[12:15], s33 offen offset:1024 nt lds
buffer_load_dwordx4 v52, s[12:15], s33 offen offset:2048 nt lds
buffer_load_dwordx4 v46, s[12:15], s33 offen offset:3072 nt lds
s_branch L_first17r
L_first18:
s_mov_b32 m0, 41152
s_addk_i32 s33, 4096
buffer_load_dwordx4 v47, s[12:15], s33 offen nt lds
buffer_load_dwordx4 v52, s[12:15], s33 offen offset:1024 nt lds
buffer_load_dwordx4 v46, s[12:15], s33 offen offset:2048 nt lds
buffer_load_dwordx4 v47, s[12:15], s33 offen offset:3072 nt lds
s_mov_b32 m0, 45248
s_addk_i32 s33, 4096
buffer_load_dwordx4 v52, s[12:15], s33 offen nt lds
buffer_load_dwordx4 v46, s[12:15], s33 offen offset:1024 nt lds
buffer_load_dwordx4 v47, s[12:15], s33 offen offset:2048 nt lds
buffer_load_dwordx4 v52, s[12:15], s33 offen offset:3072 nt lds
s_mov_b32 m0, 61760
s_addk_i32 s33, 4096
buffer_load_dwordx4 v46, s[12:15], s33 offen nt lds
buffer_load_dwordx4 v47, s[12:15], s33 offen offset:1024 nt lds
buffer_load_dwordx4 v52, s[12:15], s33 offen offset:2048 nt lds
buffer_load_dwordx4 v46, s[12:15], s33 offen offset:3072 nt lds
s_mov_b32 m0, 65856
s_addk_i32 s33, 4096
buffer_load_dwordx4 v47, s[12:15], s33 offen nt lds
buffer_load_dwordx4 v52, s[12:15], s33 offen offset:1024 nt lds
buffer_load_dwordx4 v46, s[12:15], s33 offen offset:2048 nt lds
buffer_load_dwordx4 v47, s[12:15], s33 offen offset:3072 nt lds
s_branch L_first18r
L_first19:
s_mov_b32 m0, 69952
s_addk_i32 s33, 4096
buffer_load_dwordx4 v52, s[12:15], s33 offen nt lds
buffer_load_dwordx4 v46, s[12:15], s33 offen offset:1024 nt lds
buffer_load_dwordx4 v47, s[12:15], s33 offen offset:2048 nt lds
buffer_load_dwordx4 v52, s[12:15], s33 offen offset:3072 nt lds
s_mov_b32 m0, 86464
s_addk_i32 s33, 4096
buffer_load_dwordx4 v46, s[12:15], s33 offen nt lds
buffer_load_dwordx4 v47, s[12:15], s33 offen offset:1024 nt lds
buffer_load_dwordx4 v52, s[12:15], s33 offen offset:2048 nt lds
buffer_load_dwordx4 v46, s[12:15], s33 offen offset:3072 nt lds
s_branch L_first19r
L_pq:
s_add_u32 s36, s43, 737280
buffer_load_dword v254, v85, s[20:23], s36 offen offset:0
s_add_u32 s36, s36, 7168
buffer_load_dword v254, v85, s[20:23], s36 offen offset:0
s_branch L_pqr
L_w0:
s_mov_b32 m0, 98816
s_add_u32 s36, s35, 0
buffer_load_dwordx4 v63, s[20:23], s36 offen lds
buffer_load_dwordx4 v68, s[20:23], s36 offen offset:1024 lds
buffer_load_dwordx4 v69, s[20:23], s36 offen offset:2048 lds
buffer_load_dwordx4 v70, s[20:23], s36 offen offset:3072 lds
s_mov_b32 m0, 102912
s_add_u32 s36, s35, 40960
buffer_load_dwordx4 v63, s[20:23], s36 offen lds
buffer_load_dwordx4 v68, s[20:23], s36 offen offset:1024 lds
buffer_load_dwordx4 v69, s[20:23], s36 offen offset:2048 lds
buffer_load_dwordx4 v70, s[20:23], s36 offen offset:3072 lds
s_mov_b32 m0, 107008
s_add_u32 s36, s35, 81920
buffer_load_dwordx4 v63, s[20:23], s36 offen lds
buffer_load_dwordx4 v68, s[20:23], s36 offen offset:1024 lds
buffer_load_dwordx4 v69, s[20:23], s36 offen offset:2048 lds
buffer_load_dwordx4 v70, s[20:23], s36 offen offset:3072 lds
s_branch L_w0r
L_w1:
s_mov_b32 m0, 111168
s_add_u32 s36, s35, 122880
buffer_load_dwordx4 v63, s[20:23], s36 offen lds
buffer_load_dwordx4 v68, s[20:23], s36 offen offset:1024 lds
buffer_load_dwordx4 v69, s[20:23], s36 offen offset:2048 lds
buffer_load_dwordx4 v70, s[20:23], s36 offen offset:3072 lds
s_mov_b32 m0, 115264
s_add_u32 s36, s35, 163840
buffer_load_dwordx4 v63, s[20:23], s36 offen lds
buffer_load_dwordx4 v68, s[20:23], s36 offen offset:1024 lds
buffer_load_dwordx4 v69, s[20:23], s36 offen offset:2048 lds
buffer_load_dwordx4 v70, s[20:23], s36 offen offset:3072 lds
s_mov_b32 m0, 119360
s_add_u32 s36, s35, 204800
buffer_load_dwordx4 v63, s[20:23], s36 offen lds
buffer_load_dwordx4 v68, s[20:23], s36 offen offset:1024 lds
buffer_load_dwordx4 v69, s[20:23], s36 offen offset:2048 lds
buffer_load_dwordx4 v70, s[20:23], s36 offen offset:3072 lds
s_branch L_w1r
L_pcf:
global_load_dword v254, v71, s[72:73]
s_branch L_pcfr
L_w2:
s_mov_b32 m0, 123520
s_add_u32 s36, s35, 128
buffer_load_dwordx4 v63, s[20:23], s36 offen lds
buffer_load_dwordx4 v68, s[20:23], s36 offen offset:1024 lds
buffer_load_dwordx4 v69, s[20:23], s36 offen offset:2048 lds
buffer_load_dwordx4 v70, s[20:23], s36 offen offset:3072 lds
s_mov_b32 m0, 127616
s_add_u32 s36, s35, 41088
buffer_load_dwordx4 v63, s[20:23], s36 offen lds
buffer_load_dwordx4 v68, s[20:23], s36 offen offset:1024 lds
buffer_load_dwordx4 v69, s[20:23], s36 offen offset:2048 lds
buffer_load_dwordx4 v70, s[20:23], s36 offen offset:3072 lds
s_mov_b32 m0, 131712
s_add_u32 s36, s35, 82048
buffer_load_dwordx4 v63, s[20:23], s36 offen lds
buffer_load_dwordx4 v68, s[20:23], s36 offen offset:1024 lds
buffer_load_dwordx4 v69, s[20:23], s36 offen offset:2048 lds
buffer_load_dwordx4 v70, s[20:23], s36 offen offset:3072 lds
s_branch L_w2r
L_w3:
s_mov_b32 m0, 135872
s_add_u32 s36, s35, 123008
buffer_load_dwordx4 v63, s[20:23], s36 offen lds
buffer_load_dwordx4 v68, s[20:23], s36 offen offset:1024 lds
buffer_load_dwordx4 v69, s[20:23], s36 offen offset:2048 lds
buffer_load_dwordx4 v70, s[20:23], s36 offen offset:3072 lds
s_mov_b32 m0, 139968
s_add_u32 s36, s35, 163968
buffer_load_dwordx4 v63, s[20:23], s36 offen lds
buffer_load_dwordx4 v68, s[20:23], s36 offen offset:1024 lds
buffer_load_dwordx4 v69, s[20:23], s36 offen offset:2048 lds
buffer_load_dwordx4 v70, s[20:23], s36 offen offset:3072 lds
s_mov_b32 m0, 144064
s_add_u32 s36, s35, 204928
buffer_load_dwordx4 v63, s[20:23], s36 offen lds
buffer_load_dwordx4 v68, s[20:23], s36 offen offset:1024 lds
buffer_load_dwordx4 v69, s[20:23], s36 offen offset:2048 lds
buffer_load_dwordx4 v70, s[20:23], s36 offen offset:3072 lds
s_branch L_w3r
L_fb1:
s_nop 0
s_waitcnt vmcnt(61)
s_barrier
ds_read_b64_tr_b16 a[208:209], v20 offset:0
ds_read_b64_tr_b16 a[210:211], v20 offset:2048
ds_read_b64_tr_b16 a[212:213], v20 offset:4096
ds_read_b64_tr_b16 a[214:215], v20 offset:6144
ds_read_b64_tr_b16 a[216:217], v20 offset:8192
ds_read_b64_tr_b16 a[218:219], v20 offset:10240
ds_read_b64_tr_b16 a[220:221], v21 offset:0
ds_read_b64_tr_b16 a[222:223], v21 offset:2048
ds_read_b64_tr_b16 a[224:225], v21 offset:4096
ds_read_b64_tr_b16 a[226:227], v21 offset:6144
ds_read_b64_tr_b16 a[228:229], v21 offset:8192
ds_read_b64_tr_b16 a[230:231], v21 offset:10240
ds_read_b64_tr_b16 a[232:233], v22 offset:0
ds_read_b64_tr_b16 a[234:235], v22 offset:2048
ds_read_b64_tr_b16 a[236:237], v22 offset:4096
ds_read_b64_tr_b16 a[238:239], v22 offset:6144
ds_read_b64_tr_b16 a[240:241], v22 offset:8192
ds_read_b64_tr_b16 a[242:243], v22 offset:10240
v_cvt_pk_bf16_f32 v48, v48, v49
v_accvgpr_write_b32 a168, v48
v_cvt_pk_bf16_f32 v50, v50, v51
v_accvgpr_write_b32 a169, v50
v_pk_mul_f32 v[56:57], v[56:57], v[28:29] op_sel_hi:[1,0]
v_cvt_pk_bf16_f32 v56, v56, v57
v_accvgpr_write_b32 a170, v56
v_pk_mul_f32 v[58:59], v[58:59], v[28:29] op_sel_hi:[1,0]
v_cvt_pk_bf16_f32 v58, v58, v59
v_accvgpr_write_b32 a171, v58
v_pk_mul_f32 v[64:65], v[64:65], v[28:29] op_sel_hi:[1,0]
v_pk_mul_f32 v[66:67], v[66:67], v[28:29] op_sel_hi:[1,0]
v_pk_mul_f32 v[72:73], v[72:73], v[28:29] op_sel_hi:[1,0]
v_pk_mul_f32 v[74:75], v[74:75], v[28:29] op_sel_hi:[1,0]
v_pk_mul_f32 v[80:81], v[80:81], v[28:29] op_sel_hi:[1,0]
v_pk_mul_f32 v[82:83], v[82:83], v[28:29] op_sel_hi:[1,0]
v_pk_mul_f32 v[88:89], v[88:89], v[28:29] op_sel_hi:[1,0]
v_pk_mul_f32 v[90:91], v[90:91], v[28:29] op_sel_hi:[1,0]
v_pk_mul_f32 v[96:97], v[96:97], v[28:29] op_sel_hi:[1,0]
v_pk_mul_f32 v[98:99], v[98:99], v[28:29] op_sel_hi:[1,0]
v_pk_mul_f32 v[104:105], v[104:105], v[28:29] op_sel_hi:[1,0]
v_pk_mul_f32 v[106:107], v[106:107], v[28:29] op_sel_hi:[1,0]
v_pk_mul_f32 v[112:113], v[112:113], v[28:29] op_sel_hi:[1,0]
v_pk_mul_f32 v[114:115], v[114:115], v[28:29] op_sel_hi:[1,0]
v_pk_mul_f32 v[120:121], v[120:121], v[28:29] op_sel_hi:[1,0]
v_pk_mul_f32 v[122:123], v[122:123], v[28:29] op_sel_hi:[1,0]
v_cvt_pk_bf16_f32 v32, v32, v33
v_accvgpr_write_b32 a160, v32
v_cvt_pk_bf16_f32 v34, v34, v35
v_accvgpr_write_b32 a161, v34
v_cvt_pk_bf16_f32 v40, v40, v41
v_accvgpr_write_b32 a162, v40
v_cvt_pk_bf16_f32 v42, v42, v43
v_accvgpr_write_b32 a163, v42
s_waitcnt lgkmcnt(12)
s_nop 0
v_mfma_f32_16x16x32_bf16 a[0:3], a[208:211], a[160:163], a[0:3]
ds_read_b64_tr_b16 a[244:245], v23 offset:0
ds_read_b64_tr_b16 a[246:247], v23 offset:2048
v_cvt_pk_bf16_f32 v64, v64, v65
v_accvgpr_write_b32 a176, v64
v_cvt_pk_bf16_f32 v66, v66, v67
v_accvgpr_write_b32 a177, v66
v_cvt_pk_bf16_f32 v72, v72, v73
v_accvgpr_write_b32 a178, v72
v_cvt_pk_bf16_f32 v74, v74, v75
v_accvgpr_write_b32 a179, v74
v_mfma_f32_16x16x32_bf16 a[0:3], a[212:215], a[168:171], a[0:3]
s_mov_b32 m0, 148224
s_add_u32 s36, s35, 256
buffer_load_dwordx4 v63, s[20:23], s36 offen lds
ds_read_b64_tr_b16 a[248:249], v23 offset:4096
ds_read_b64_tr_b16 a[250:251], v23 offset:6144
ds_read_b64_tr_b16 a[252:253], v23 offset:8192
ds_read_b64_tr_b16 a[254:255], v23 offset:10240
v_cvt_pk_bf16_f32 v80, v80, v81
v_mfma_f32_16x16x32_bf16 a[0:3], a[216:219], a[176:179], a[0:3]
s_waitcnt lgkmcnt(12)
buffer_load_dwordx4 v68, s[20:23], s36 offen offset:1024 lds
buffer_load_dwordx4 v69, s[20:23], s36 offen offset:2048 lds
buffer_load_dwordx4 v70, s[20:23], s36 offen offset:3072 lds
s_addk_i32 m0, 4096
s_add_u32 s36, s35, 41216
buffer_load_dwordx4 v63, s[20:23], s36 offen lds
buffer_load_dwordx4 v68, s[20:23], s36 offen offset:1024 lds
buffer_load_dwordx4 v69, s[20:23], s36 offen offset:2048 lds
buffer_load_dwordx4 v70, s[20:23], s36 offen offset:3072 lds
s_addk_i32 m0, 4096
s_add_u32 s36, s35, 82176
buffer_load_dwordx4 v63, s[20:23], s36 offen lds
buffer_load_dwordx4 v68, s[20:23], s36 offen offset:1024 lds
buffer_load_dwordx4 v69, s[20:23], s36 offen offset:2048 lds
buffer_load_dwordx4 v70, s[20:23], s36 offen offset:3072 lds
v_mfma_f32_16x16x32_bf16 a[4:7], a[220:223], a[160:163], a[4:7]
s_waitcnt vmcnt(61)
s_barrier
ds_read_b64_tr_b16 a[208:209], v20 offset:12352
ds_read_b64_tr_b16 a[210:211], v20 offset:14400
ds_read_b64_tr_b16 a[212:213], v20 offset:16448
ds_read_b64_tr_b16 a[214:215], v20 offset:18496
v_accvgpr_write_b32 a184, v80
v_cvt_pk_bf16_f32 v82, v82, v83
v_accvgpr_write_b32 a185, v82
v_cvt_pk_bf16_f32 v88, v88, v89
v_mfma_f32_16x16x32_bf16 a[4:7], a[224:227], a[168:171], a[4:7]
ds_read_b64_tr_b16 a[216:217], v20 offset:20544
ds_read_b64_tr_b16 a[218:219], v20 offset:22592
v_accvgpr_write_b32 a186, v88
v_cvt_pk_bf16_f32 v90, v90, v91
v_accvgpr_write_b32 a187, v90
v_cvt_pk_bf16_f32 v96, v96, v97
v_accvgpr_write_b32 a192, v96
v_cvt_pk_bf16_f32 v98, v98, v99
v_accvgpr_write_b32 a193, v98
v_mfma_f32_16x16x32_bf16 a[4:7], a[228:231], a[176:179], a[4:7]
s_waitcnt lgkmcnt(12)
ds_read_b64_tr_b16 a[220:221], v21 offset:12352
ds_read_b64_tr_b16 a[222:223], v21 offset:14400
v_cvt_pk_bf16_f32 v104, v104, v105
v_accvgpr_write_b32 a194, v104
v_cvt_pk_bf16_f32 v106, v106, v107
v_accvgpr_write_b32 a195, v106
v_cvt_pk_bf16_f32 v112, v112, v113
v_accvgpr_write_b32 a200, v112
v_cvt_pk_bf16_f32 v114, v114, v115
v_mfma_f32_16x16x32_bf16 a[8:11], a[232:235], a[160:163], a[8:11]
ds_read_b64_tr_b16 a[224:225], v21 offset:16448
ds_read_b64_tr_b16 a[226:227], v21 offset:18496
v_accvgpr_write_b32 a201, v114
v_cvt_pk_bf16_f32 v120, v120, v121
v_accvgpr_write_b32 a202, v120
v_cvt_pk_bf16_f32 v122, v122, v123
v_accvgpr_write_b32 a203, v122
v_mfma_f32_16x16x32_bf16 a[8:11], a[236:239], a[168:171], a[8:11]
ds_read_b64_tr_b16 a[228:229], v21 offset:20544
ds_read_b64_tr_b16 a[230:231], v21 offset:22592
v_mfma_f32_16x16x32_bf16 a[8:11], a[240:243], a[176:179], a[8:11]
s_waitcnt lgkmcnt(12)
ds_read_b64_tr_b16 a[232:233], v22 offset:12352
ds_read_b64_tr_b16 a[234:235], v22 offset:14400
v_mfma_f32_16x16x32_bf16 a[12:15], a[244:247], a[160:163], a[12:15]
ds_read_b64_tr_b16 a[236:237], v22 offset:16448
ds_read_b64_tr_b16 a[238:239], v22 offset:18496
v_mfma_f32_16x16x32_bf16 a[12:15], a[248:251], a[168:171], a[12:15]
ds_read_b64_tr_b16 a[240:241], v22 offset:20544
ds_read_b64_tr_b16 a[242:243], v22 offset:22592
v_mfma_f32_16x16x32_bf16 a[12:15], a[252:255], a[176:179], a[12:15]
s_waitcnt lgkmcnt(12)
ds_read_b64_tr_b16 a[244:245], v23 offset:12352
ds_read_b64_tr_b16 a[246:247], v23 offset:14400
v_mfma_f32_16x16x32_bf16 a[0:3], a[208:211], a[184:187], a[0:3]
ds_read_b64_tr_b16 a[248:249], v23 offset:16448
ds_read_b64_tr_b16 a[250:251], v23 offset:18496
v_mfma_f32_16x16x32_bf16 a[0:3], a[212:215], a[192:195], a[0:3]
ds_read_b64_tr_b16 a[252:253], v23 offset:20544
ds_read_b64_tr_b16 a[254:255], v23 offset:22592
v_mfma_f32_16x16x32_bf16 a[0:3], a[216:219], a[200:203], a[0:3]
s_waitcnt lgkmcnt(12)
v_mfma_f32_16x16x32_bf16 a[4:7], a[220:223], a[184:187], a[4:7]
s_waitcnt vmcnt(48)
s_barrier
s_mov_b32 m0, 98816
s_add_u32 s36, s35, 123136
buffer_load_dwordx4 v63, s[20:23], s36 offen lds
ds_read_b64_tr_b16 a[208:209], v20 offset:24704
ds_read_b64_tr_b16 a[210:211], v20 offset:26752
ds_read_b64_tr_b16 a[212:213], v20 offset:28800
v_mfma_f32_16x16x32_bf16 a[4:7], a[224:227], a[192:195], a[4:7]
ds_read_b64_tr_b16 a[214:215], v20 offset:30848
ds_read_b64_tr_b16 a[216:217], v20 offset:32896
ds_read_b64_tr_b16 a[218:219], v20 offset:34944
buffer_load_dwordx4 v68, s[20:23], s36 offen offset:1024 lds
v_mfma_f32_16x16x32_bf16 a[4:7], a[228:231], a[200:203], a[4:7]
s_waitcnt lgkmcnt(12)
ds_read_b64_tr_b16 a[220:221], v21 offset:24704
ds_read_b64_tr_b16 a[222:223], v21 offset:26752
buffer_load_dwordx4 v69, s[20:23], s36 offen offset:2048 lds
v_mfma_f32_16x16x32_bf16 a[8:11], a[232:235], a[184:187], a[8:11]
ds_read_b64_tr_b16 a[224:225], v21 offset:28800
ds_read_b64_tr_b16 a[226:227], v21 offset:30848
buffer_load_dwordx4 v70, s[20:23], s36 offen offset:3072 lds
v_mfma_f32_16x16x32_bf16 a[8:11], a[236:239], a[192:195], a[8:11]
s_addk_i32 m0, 4096
s_add_u32 s36, s35, 164096
buffer_load_dwordx4 v63, s[20:23], s36 offen lds
ds_read_b64_tr_b16 a[228:229], v21 offset:32896
ds_read_b64_tr_b16 a[230:231], v21 offset:34944
v_mfma_f32_16x16x32_bf16 a[8:11], a[240:243], a[200:203], a[8:11]
s_waitcnt lgkmcnt(12)
ds_read_b64_tr_b16 a[232:233], v22 offset:24704
ds_read_b64_tr_b16 a[234:235], v22 offset:26752
buffer_load_dwordx4 v68, s[20:23], s36 offen offset:1024 lds
v_mfma_f32_16x16x32_bf16 a[12:15], a[244:247], a[184:187], a[12:15]
ds_read_b64_tr_b16 a[236:237], v22 offset:28800
ds_read_b64_tr_b16 a[238:239], v22 offset:30848
buffer_load_dwordx4 v69, s[20:23], s36 offen offset:2048 lds
v_mfma_f32_16x16x32_bf16 a[12:15], a[248:251], a[192:195], a[12:15]
ds_read_b64_tr_b16 a[240:241], v22 offset:32896
ds_read_b64_tr_b16 a[242:243], v22 offset:34944
buffer_load_dwordx4 v70, s[20:23], s36 offen offset:3072 lds
v_mfma_f32_16x16x32_bf16 a[12:15], a[252:255], a[200:203], a[12:15]
s_waitcnt lgkmcnt(12)
s_addk_i32 m0, 4096
s_add_u32 s36, s35, 205056
buffer_load_dwordx4 v63, s[20:23], s36 offen lds
ds_read_b64_tr_b16 a[244:245], v23 offset:24704
ds_read_b64_tr_b16 a[246:247], v23 offset:26752
v_mfma_f32_16x16x32_bf16 a[16:19], a[208:211], a[160:163], a[16:19]
ds_read_b64_tr_b16 a[248:249], v23 offset:28800
ds_read_b64_tr_b16 a[250:251], v23 offset:30848
buffer_load_dwordx4 v68, s[20:23], s36 offen offset:1024 lds
v_mfma_f32_16x16x32_bf16 a[16:19], a[212:215], a[168:171], a[16:19]
ds_read_b64_tr_b16 a[252:253], v23 offset:32896
ds_read_b64_tr_b16 a[254:255], v23 offset:34944
buffer_load_dwordx4 v69, s[20:23], s36 offen offset:2048 lds
v_accvgpr_read_b32 v192, a0
v_accvgpr_read_b32 v193, a1
v_accvgpr_read_b32 v194, a2
v_accvgpr_read_b32 v195, a3
v_mfma_f32_16x16x32_bf16 a[16:19], a[216:219], a[176:179], a[16:19]
s_waitcnt lgkmcnt(12)
buffer_load_dwordx4 v70, s[20:23], s36 offen offset:3072 lds
v_accvgpr_read_b32 v196, a4
v_accvgpr_read_b32 v197, a5
v_accvgpr_read_b32 v198, a6
v_accvgpr_read_b32 v199, a7
v_accvgpr_read_b32 v200, a8
v_accvgpr_read_b32 v201, a9
v_mfma_f32_16x16x32_bf16 a[20:23], a[220:223], a[160:163], a[20:23]
s_waitcnt vmcnt(48)
s_barrier
s_addk_i32 m0, 4160
s_add_u32 s36, s35, 384
buffer_load_dwordx4 v63, s[20:23], s36 offen lds
ds_read_b64_tr_b16 a[208:209], v20 offset:37056
ds_read_b64_tr_b16 a[210:211], v20 offset:39104
ds_read_b64_tr_b16 a[212:213], v20 offset:41152
v_mfma_f32_16x16x32_bf16 a[20:23], a[224:227], a[168:171], a[20:23]
ds_read_b64_tr_b16 a[214:215], v20 offset:43200
ds_read_b64_tr_b16 a[216:217], v20 offset:45248
ds_read_b64_tr_b16 a[218:219], v20 offset:47296
v_accvgpr_read_b32 v202, a10
v_accvgpr_read_b32 v203, a11
v_accvgpr_read_b32 v204, a12
v_accvgpr_read_b32 v205, a13
v_accvgpr_read_b32 v206, a14
v_accvgpr_read_b32 v207, a15
v_mfma_f32_16x16x32_bf16 a[20:23], a[228:231], a[176:179], a[20:23]
s_waitcnt lgkmcnt(12)
ds_read_b64_tr_b16 a[220:221], v21 offset:37056
ds_read_b64_tr_b16 a[222:223], v21 offset:39104
v_cvt_pk_bf16_f32 v32, v192, v193
v_cvt_pk_bf16_f32 v33, v194, v195
v_cvt_pk_bf16_f32 v34, v196, v197
v_cvt_pk_bf16_f32 v35, v198, v199
v_cvt_pk_bf16_f32 v40, v200, v201
v_cvt_pk_bf16_f32 v41, v202, v203
v_cvt_pk_bf16_f32 v42, v204, v205
v_mfma_f32_16x16x32_bf16 a[24:27], a[232:235], a[160:163], a[24:27]
ds_read_b64_tr_b16 a[224:225], v21 offset:41152
ds_read_b64_tr_b16 a[226:227], v21 offset:43200
buffer_load_dwordx4 v68, s[20:23], s36 offen offset:1024 lds
buffer_load_dwordx4 v69, s[20:23], s36 offen offset:2048 lds
v_cvt_pk_bf16_f32 v43, v206, v207
v_mfma_f32_16x16x32_bf16 a[24:27], a[236:239], a[168:171], a[24:27]
ds_read_b64_tr_b16 a[228:229], v21 offset:45248
ds_read_b64_tr_b16 a[230:231], v21 offset:47296
buffer_load_dwordx4 v70, s[20:23], s36 offen offset:3072 lds
v_mfma_f32_16x16x32_bf16 a[24:27], a[240:243], a[176:179], a[24:27]
s_waitcnt lgkmcnt(12)
s_addk_i32 m0, 4096
s_add_u32 s36, s35, 41344
buffer_load_dwordx4 v63, s[20:23], s36 offen lds
ds_read_b64_tr_b16 a[232:233], v22 offset:37056
ds_read_b64_tr_b16 a[234:235], v22 offset:39104
buffer_load_dwordx4 v68, s[20:23], s36 offen offset:1024 lds
v_mfma_f32_16x16x32_bf16 a[28:31], a[244:247], a[160:163], a[28:31]
ds_read_b64_tr_b16 a[236:237], v22 offset:41152
ds_read_b64_tr_b16 a[238:239], v22 offset:43200
buffer_load_dwordx4 v69, s[20:23], s36 offen offset:2048 lds
v_mfma_f32_16x16x32_bf16 a[28:31], a[248:251], a[168:171], a[28:31]
ds_read_b64_tr_b16 a[240:241], v22 offset:45248
ds_read_b64_tr_b16 a[242:243], v22 offset:47296
buffer_load_dwordx4 v70, s[20:23], s36 offen offset:3072 lds
v_mfma_f32_16x16x32_bf16 a[28:31], a[252:255], a[176:179], a[28:31]
s_waitcnt lgkmcnt(12)
s_addk_i32 m0, 4096
s_add_u32 s36, s35, 82304
buffer_load_dwordx4 v63, s[20:23], s36 offen lds
ds_read_b64_tr_b16 a[244:245], v23 offset:37056
ds_read_b64_tr_b16 a[246:247], v23 offset:39104
v_mfma_f32_16x16x32_bf16 a[16:19], a[208:211], a[184:187], a[16:19]
ds_read_b64_tr_b16 a[248:249], v23 offset:41152
ds_read_b64_tr_b16 a[250:251], v23 offset:43200
buffer_load_dwordx4 v68, s[20:23], s36 offen offset:1024 lds
v_mfma_f32_16x16x32_bf16 a[16:19], a[212:215], a[192:195], a[16:19]
ds_read_b64_tr_b16 a[252:253], v23 offset:45248
ds_read_b64_tr_b16 a[254:255], v23 offset:47296
buffer_load_dwordx4 v69, s[20:23], s36 offen offset:2048 lds
v_mfma_f32_16x16x32_bf16 a[16:19], a[216:219], a[200:203], a[16:19]
s_waitcnt lgkmcnt(12)
buffer_load_dwordx4 v70, s[20:23], s36 offen offset:3072 lds
v_mfma_f32_16x16x32_bf16 a[20:23], a[220:223], a[184:187], a[20:23]
s_waitcnt vmcnt(24)
s_barrier
s_addk_i32 m0, 4160
s_add_u32 s36, s35, 123264
buffer_load_dwordx4 v63, s[20:23], s36 offen lds
ds_read_b64_tr_b16 a[208:209], v20 offset:49408
ds_read_b64_tr_b16 a[210:211], v20 offset:51456
ds_read_b64_tr_b16 a[212:213], v20 offset:53504
v_mfma_f32_16x16x32_bf16 a[20:23], a[224:227], a[192:195], a[20:23]
ds_read_b64_tr_b16 a[214:215], v20 offset:55552
ds_read_b64_tr_b16 a[216:217], v20 offset:57600
ds_read_b64_tr_b16 a[218:219], v20 offset:59648
buffer_load_dwordx4 v68, s[20:23], s36 offen offset:1024 lds
v_mfma_f32_16x16x32_bf16 a[20:23], a[228:231], a[200:203], a[20:23]
s_waitcnt lgkmcnt(12)
ds_read_b64_tr_b16 a[220:221], v21 offset:49408
ds_read_b64_tr_b16 a[222:223], v21 offset:51456
buffer_load_dwordx4 v69, s[20:23], s36 offen offset:2048 lds
v_mfma_f32_16x16x32_bf16 a[24:27], a[232:235], a[184:187], a[24:27]
ds_read_b64_tr_b16 a[224:225], v21 offset:53504
ds_read_b64_tr_b16 a[226:227], v21 offset:55552
buffer_load_dwordx4 v70, s[20:23], s36 offen offset:3072 lds
v_mfma_f32_16x16x32_bf16 a[24:27], a[236:239], a[192:195], a[24:27]
s_addk_i32 m0, 4096
s_add_u32 s36, s35, 164224
buffer_load_dwordx4 v63, s[20:23], s36 offen lds
ds_read_b64_tr_b16 a[228:229], v21 offset:57600
ds_read_b64_tr_b16 a[230:231], v21 offset:59648
v_mfma_f32_16x16x32_bf16 a[24:27], a[240:243], a[200:203], a[24:27]
s_waitcnt lgkmcnt(12)
ds_read_b64_tr_b16 a[232:233], v22 offset:49408
ds_read_b64_tr_b16 a[234:235], v22 offset:51456
buffer_load_dwordx4 v68, s[20:23], s36 offen offset:1024 lds
v_mfma_f32_16x16x32_bf16 a[28:31], a[244:247], a[184:187], a[28:31]
ds_read_b64_tr_b16 a[236:237], v22 offset:53504
ds_read_b64_tr_b16 a[238:239], v22 offset:55552
buffer_load_dwordx4 v69, s[20:23], s36 offen offset:2048 lds
v_mfma_f32_16x16x32_bf16 a[28:31], a[248:251], a[192:195], a[28:31]
ds_read_b64_tr_b16 a[240:241], v22 offset:57600
ds_read_b64_tr_b16 a[242:243], v22 offset:59648
buffer_load_dwordx4 v70, s[20:23], s36 offen offset:3072 lds
v_mfma_f32_16x16x32_bf16 a[28:31], a[252:255], a[200:203], a[28:31]
s_waitcnt lgkmcnt(12)
s_addk_i32 m0, 4096
s_add_u32 s36, s35, 205184
buffer_load_dwordx4 v63, s[20:23], s36 offen lds
ds_read_b64_tr_b16 a[244:245], v23 offset:49408
ds_read_b64_tr_b16 a[246:247], v23 offset:51456
v_mfma_f32_16x16x32_bf16 a[32:35], a[208:211], a[160:163], a[32:35]
ds_read_b64_tr_b16 a[248:249], v23 offset:53504
ds_read_b64_tr_b16 a[250:251], v23 offset:55552
buffer_load_dwordx4 v68, s[20:23], s36 offen offset:1024 lds
v_mfma_f32_16x16x32_bf16 a[32:35], a[212:215], a[168:171], a[32:35]
ds_read_b64_tr_b16 a[252:253], v23 offset:57600
ds_read_b64_tr_b16 a[254:255], v23 offset:59648
buffer_load_dwordx4 v69, s[20:23], s36 offen offset:2048 lds
v_accvgpr_read_b32 v192, a16
v_accvgpr_read_b32 v193, a17
v_accvgpr_read_b32 v194, a18
v_accvgpr_read_b32 v195, a19
v_mfma_f32_16x16x32_bf16 a[32:35], a[216:219], a[176:179], a[32:35]
s_waitcnt lgkmcnt(12)
buffer_load_dwordx4 v70, s[20:23], s36 offen offset:3072 lds
v_accvgpr_read_b32 v196, a20
v_accvgpr_read_b32 v197, a21
v_accvgpr_read_b32 v198, a22
v_accvgpr_read_b32 v199, a23
v_accvgpr_read_b32 v200, a24
v_accvgpr_read_b32 v201, a25
v_mfma_f32_16x16x32_bf16 a[36:39], a[220:223], a[160:163], a[36:39]
s_waitcnt vmcnt(24)
s_barrier
s_addk_i32 m0, 4160
s_add_u32 s36, s35, 512
buffer_load_dwordx4 v63, s[20:23], s36 offen lds
ds_read_b64_tr_b16 a[208:209], v20 offset:0
ds_read_b64_tr_b16 a[210:211], v20 offset:2048
ds_read_b64_tr_b16 a[212:213], v20 offset:4096
v_mfma_f32_16x16x32_bf16 a[36:39], a[224:227], a[168:171], a[36:39]
ds_read_b64_tr_b16 a[214:215], v20 offset:6144
ds_read_b64_tr_b16 a[216:217], v20 offset:8192
ds_read_b64_tr_b16 a[218:219], v20 offset:10240
v_accvgpr_read_b32 v202, a26
v_accvgpr_read_b32 v203, a27
v_accvgpr_read_b32 v204, a28
v_accvgpr_read_b32 v205, a29
v_accvgpr_read_b32 v206, a30
v_accvgpr_read_b32 v207, a31
v_mfma_f32_16x16x32_bf16 a[36:39], a[228:231], a[176:179], a[36:39]
s_waitcnt lgkmcnt(12)
ds_read_b64_tr_b16 a[220:221], v21 offset:0
ds_read_b64_tr_b16 a[222:223], v21 offset:2048
v_cvt_pk_bf16_f32 v48, v192, v193
v_cvt_pk_bf16_f32 v49, v194, v195
v_cvt_pk_bf16_f32 v50, v196, v197
v_cvt_pk_bf16_f32 v51, v198, v199
v_cvt_pk_bf16_f32 v56, v200, v201
v_cvt_pk_bf16_f32 v57, v202, v203
v_cvt_pk_bf16_f32 v58, v204, v205
v_mfma_f32_16x16x32_bf16 a[40:43], a[232:235], a[160:163], a[40:43]
ds_read_b64_tr_b16 a[224:225], v21 offset:4096
ds_read_b64_tr_b16 a[226:227], v21 offset:6144
buffer_load_dwordx4 v68, s[20:23], s36 offen offset:1024 lds
buffer_load_dwordx4 v69, s[20:23], s36 offen offset:2048 lds
v_cvt_pk_bf16_f32 v59, v206, v207
v_mfma_f32_16x16x32_bf16 a[40:43], a[236:239], a[168:171], a[40:43]
ds_read_b64_tr_b16 a[228:229], v21 offset:8192
ds_read_b64_tr_b16 a[230:231], v21 offset:10240
buffer_load_dwordx4 v70, s[20:23], s36 offen offset:3072 lds
v_mfma_f32_16x16x32_bf16 a[40:43], a[240:243], a[176:179], a[40:43]
s_waitcnt lgkmcnt(12)
s_addk_i32 m0, 4096
s_add_u32 s36, s35, 41472
buffer_load_dwordx4 v63, s[20:23], s36 offen lds
ds_read_b64_tr_b16 a[232:233], v22 offset:0
ds_read_b64_tr_b16 a[234:235], v22 offset:2048
buffer_load_dwordx4 v68, s[20:23], s36 offen offset:1024 lds
v_mfma_f32_16x16x32_bf16 a[44:47], a[244:247], a[160:163], a[44:47]
ds_read_b64_tr_b16 a[236:237], v22 offset:4096
ds_read_b64_tr_b16 a[238:239], v22 offset:6144
buffer_load_dwordx4 v69, s[20:23], s36 offen offset:2048 lds
v_mfma_f32_16x16x32_bf16 a[44:47], a[248:251], a[168:171], a[44:47]
ds_read_b64_tr_b16 a[240:241], v22 offset:8192
ds_read_b64_tr_b16 a[242:243], v22 offset:10240
buffer_load_dwordx4 v70, s[20:23], s36 offen offset:3072 lds
v_mfma_f32_16x16x32_bf16 a[44:47], a[252:255], a[176:179], a[44:47]
s_waitcnt lgkmcnt(12)
s_addk_i32 m0, 4096
s_add_u32 s36, s35, 82432
buffer_load_dwordx4 v63, s[20:23], s36 offen lds
ds_read_b64_tr_b16 a[244:245], v23 offset:0
ds_read_b64_tr_b16 a[246:247], v23 offset:2048
v_mfma_f32_16x16x32_bf16 a[32:35], a[208:211], a[184:187], a[32:35]
ds_read_b64_tr_b16 a[248:249], v23 offset:4096
ds_read_b64_tr_b16 a[250:251], v23 offset:6144
buffer_load_dwordx4 v68, s[20:23], s36 offen offset:1024 lds
v_mfma_f32_16x16x32_bf16 a[32:35], a[212:215], a[192:195], a[32:35]
ds_read_b64_tr_b16 a[252:253], v23 offset:8192
ds_read_b64_tr_b16 a[254:255], v23 offset:10240
buffer_load_dwordx4 v69, s[20:23], s36 offen offset:2048 lds
v_mfma_f32_16x16x32_bf16 a[32:35], a[216:219], a[200:203], a[32:35]
s_waitcnt lgkmcnt(12)
buffer_load_dwordx4 v70, s[20:23], s36 offen offset:3072 lds
v_mfma_f32_16x16x32_bf16 a[36:39], a[220:223], a[184:187], a[36:39]
s_waitcnt vmcnt(24)
s_barrier
s_addk_i32 m0, 4160
s_add_u32 s36, s35, 123392
buffer_load_dwordx4 v63, s[20:23], s36 offen lds
ds_read_b64_tr_b16 a[208:209], v20 offset:12352
ds_read_b64_tr_b16 a[210:211], v20 offset:14400
ds_read_b64_tr_b16 a[212:213], v20 offset:16448
v_mfma_f32_16x16x32_bf16 a[36:39], a[224:227], a[192:195], a[36:39]
ds_read_b64_tr_b16 a[214:215], v20 offset:18496
ds_read_b64_tr_b16 a[216:217], v20 offset:20544
ds_read_b64_tr_b16 a[218:219], v20 offset:22592
buffer_load_dwordx4 v68, s[20:23], s36 offen offset:1024 lds
v_mfma_f32_16x16x32_bf16 a[36:39], a[228:231], a[200:203], a[36:39]
s_waitcnt lgkmcnt(12)
ds_read_b64_tr_b16 a[220:221], v21 offset:12352
ds_read_b64_tr_b16 a[222:223], v21 offset:14400
buffer_load_dwordx4 v69, s[20:23], s36 offen offset:2048 lds
v_mfma_f32_16x16x32_bf16 a[40:43], a[232:235], a[184:187], a[40:43]
ds_read_b64_tr_b16 a[224:225], v21 offset:16448
ds_read_b64_tr_b16 a[226:227], v21 offset:18496
buffer_load_dwordx4 v70, s[20:23], s36 offen offset:3072 lds
v_mfma_f32_16x16x32_bf16 a[40:43], a[236:239], a[192:195], a[40:43]
s_addk_i32 m0, 4096
s_add_u32 s36, s35, 164352
buffer_load_dwordx4 v63, s[20:23], s36 offen lds
ds_read_b64_tr_b16 a[228:229], v21 offset:20544
ds_read_b64_tr_b16 a[230:231], v21 offset:22592
v_mfma_f32_16x16x32_bf16 a[40:43], a[240:243], a[200:203], a[40:43]
s_waitcnt lgkmcnt(12)
ds_read_b64_tr_b16 a[232:233], v22 offset:12352
ds_read_b64_tr_b16 a[234:235], v22 offset:14400
buffer_load_dwordx4 v68, s[20:23], s36 offen offset:1024 lds
v_mfma_f32_16x16x32_bf16 a[44:47], a[244:247], a[184:187], a[44:47]
ds_read_b64_tr_b16 a[236:237], v22 offset:16448
ds_read_b64_tr_b16 a[238:239], v22 offset:18496
buffer_load_dwordx4 v69, s[20:23], s36 offen offset:2048 lds
v_mfma_f32_16x16x32_bf16 a[44:47], a[248:251], a[192:195], a[44:47]
ds_read_b64_tr_b16 a[240:241], v22 offset:20544
ds_read_b64_tr_b16 a[242:243], v22 offset:22592
buffer_load_dwordx4 v70, s[20:23], s36 offen offset:3072 lds
v_mfma_f32_16x16x32_bf16 a[44:47], a[252:255], a[200:203], a[44:47]
s_waitcnt lgkmcnt(12)
s_addk_i32 m0, 4096
s_add_u32 s36, s35, 205312
buffer_load_dwordx4 v63, s[20:23], s36 offen lds
ds_read_b64_tr_b16 a[244:245], v23 offset:12352
ds_read_b64_tr_b16 a[246:247], v23 offset:14400
v_mfma_f32_16x16x32_bf16 a[48:51], a[208:211], a[160:163], a[48:51]
ds_read_b64_tr_b16 a[248:249], v23 offset:16448
ds_read_b64_tr_b16 a[250:251], v23 offset:18496
buffer_load_dwordx4 v68, s[20:23], s36 offen offset:1024 lds
v_mfma_f32_16x16x32_bf16 a[48:51], a[212:215], a[168:171], a[48:51]
ds_read_b64_tr_b16 a[252:253], v23 offset:20544
ds_read_b64_tr_b16 a[254:255], v23 offset:22592
buffer_load_dwordx4 v69, s[20:23], s36 offen offset:2048 lds
v_accvgpr_read_b32 v192, a32
v_accvgpr_read_b32 v193, a33
v_accvgpr_read_b32 v194, a34
v_accvgpr_read_b32 v195, a35
v_mfma_f32_16x16x32_bf16 a[48:51], a[216:219], a[176:179], a[48:51]
s_waitcnt lgkmcnt(12)
buffer_load_dwordx4 v70, s[20:23], s36 offen offset:3072 lds
v_accvgpr_read_b32 v196, a36
v_accvgpr_read_b32 v197, a37
v_accvgpr_read_b32 v198, a38
v_accvgpr_read_b32 v199, a39
v_accvgpr_read_b32 v200, a40
v_accvgpr_read_b32 v201, a41
v_mfma_f32_16x16x32_bf16 a[52:55], a[220:223], a[160:163], a[52:55]
s_waitcnt vmcnt(24)
s_barrier
s_mov_b32 m0, 98816
s_add_u32 s36, s35, 640
buffer_load_dwordx4 v63, s[20:23], s36 offen lds
ds_read_b64_tr_b16 a[208:209], v20 offset:24704
ds_read_b64_tr_b16 a[210:211], v20 offset:26752
ds_read_b64_tr_b16 a[212:213], v20 offset:28800
v_mfma_f32_16x16x32_bf16 a[52:55], a[224:227], a[168:171], a[52:55]
ds_read_b64_tr_b16 a[214:215], v20 offset:30848
ds_read_b64_tr_b16 a[216:217], v20 offset:32896
ds_read_b64_tr_b16 a[218:219], v20 offset:34944
v_accvgpr_read_b32 v202, a42
v_accvgpr_read_b32 v203, a43
v_accvgpr_read_b32 v204, a44
v_accvgpr_read_b32 v205, a45
v_accvgpr_read_b32 v206, a46
v_accvgpr_read_b32 v207, a47
v_mfma_f32_16x16x32_bf16 a[52:55], a[228:231], a[176:179], a[52:55]
s_waitcnt lgkmcnt(12)
ds_read_b64_tr_b16 a[220:221], v21 offset:24704
ds_read_b64_tr_b16 a[222:223], v21 offset:26752
v_cvt_pk_bf16_f32 v64, v192, v193
v_cvt_pk_bf16_f32 v65, v194, v195
v_cvt_pk_bf16_f32 v66, v196, v197
v_cvt_pk_bf16_f32 v67, v198, v199
v_cvt_pk_bf16_f32 v72, v200, v201
v_cvt_pk_bf16_f32 v73, v202, v203
v_cvt_pk_bf16_f32 v74, v204, v205
v_mfma_f32_16x16x32_bf16 a[56:59], a[232:235], a[160:163], a[56:59]
ds_read_b64_tr_b16 a[224:225], v21 offset:28800
ds_read_b64_tr_b16 a[226:227], v21 offset:30848
buffer_load_dwordx4 v68, s[20:23], s36 offen offset:1024 lds
buffer_load_dwordx4 v69, s[20:23], s36 offen offset:2048 lds
v_cvt_pk_bf16_f32 v75, v206, v207
v_mfma_f32_16x16x32_bf16 a[56:59], a[236:239], a[168:171], a[56:59]
ds_read_b64_tr_b16 a[228:229], v21 offset:32896
ds_read_b64_tr_b16 a[230:231], v21 offset:34944
buffer_load_dwordx4 v70, s[20:23], s36 offen offset:3072 lds
v_mfma_f32_16x16x32_bf16 a[56:59], a[240:243], a[176:179], a[56:59]
s_waitcnt lgkmcnt(12)
s_addk_i32 m0, 4096
s_add_u32 s36, s35, 41600
buffer_load_dwordx4 v63, s[20:23], s36 offen lds
ds_read_b64_tr_b16 a[232:233], v22 offset:24704
ds_read_b64_tr_b16 a[234:235], v22 offset:26752
buffer_load_dwordx4 v68, s[20:23], s36 offen offset:1024 lds
v_mfma_f32_16x16x32_bf16 a[60:63], a[244:247], a[160:163], a[60:63]
ds_read_b64_tr_b16 a[236:237], v22 offset:28800
ds_read_b64_tr_b16 a[238:239], v22 offset:30848
buffer_load_dwordx4 v69, s[20:23], s36 offen offset:2048 lds
v_mfma_f32_16x16x32_bf16 a[60:63], a[248:251], a[168:171], a[60:63]
ds_read_b64_tr_b16 a[240:241], v22 offset:32896
ds_read_b64_tr_b16 a[242:243], v22 offset:34944
buffer_load_dwordx4 v70, s[20:23], s36 offen offset:3072 lds
v_mfma_f32_16x16x32_bf16 a[60:63], a[252:255], a[176:179], a[60:63]
s_waitcnt lgkmcnt(12)
s_addk_i32 m0, 4096
s_add_u32 s36, s35, 82560
buffer_load_dwordx4 v63, s[20:23], s36 offen lds
ds_read_b64_tr_b16 a[244:245], v23 offset:24704
ds_read_b64_tr_b16 a[246:247], v23 offset:26752
v_mfma_f32_16x16x32_bf16 a[48:51], a[208:211], a[184:187], a[48:51]
ds_read_b64_tr_b16 a[248:249], v23 offset:28800
ds_read_b64_tr_b16 a[250:251], v23 offset:30848
buffer_load_dwordx4 v68, s[20:23], s36 offen offset:1024 lds
v_mfma_f32_16x16x32_bf16 a[48:51], a[212:215], a[192:195], a[48:51]
ds_read_b64_tr_b16 a[252:253], v23 offset:32896
ds_read_b64_tr_b16 a[254:255], v23 offset:34944
buffer_load_dwordx4 v69, s[20:23], s36 offen offset:2048 lds
v_mfma_f32_16x16x32_bf16 a[48:51], a[216:219], a[200:203], a[48:51]
s_waitcnt lgkmcnt(12)
buffer_load_dwordx4 v70, s[20:23], s36 offen offset:3072 lds
v_mfma_f32_16x16x32_bf16 a[52:55], a[220:223], a[184:187], a[52:55]
s_waitcnt vmcnt(24)
s_barrier
s_addk_i32 m0, 4160
s_add_u32 s36, s35, 123520
buffer_load_dwordx4 v63, s[20:23], s36 offen lds
ds_read_b64_tr_b16 a[208:209], v20 offset:37056
ds_read_b64_tr_b16 a[210:211], v20 offset:39104
ds_read_b64_tr_b16 a[212:213], v20 offset:41152
v_mfma_f32_16x16x32_bf16 a[52:55], a[224:227], a[192:195], a[52:55]
ds_read_b64_tr_b16 a[214:215], v20 offset:43200
ds_read_b64_tr_b16 a[216:217], v20 offset:45248
ds_read_b64_tr_b16 a[218:219], v20 offset:47296
buffer_load_dwordx4 v68, s[20:23], s36 offen offset:1024 lds
v_mfma_f32_16x16x32_bf16 a[52:55], a[228:231], a[200:203], a[52:55]
s_waitcnt lgkmcnt(12)
ds_read_b64_tr_b16 a[220:221], v21 offset:37056
ds_read_b64_tr_b16 a[222:223], v21 offset:39104
buffer_load_dwordx4 v69, s[20:23], s36 offen offset:2048 lds
v_mfma_f32_16x16x32_bf16 a[56:59], a[232:235], a[184:187], a[56:59]
ds_read_b64_tr_b16 a[224:225], v21 offset:41152
ds_read_b64_tr_b16 a[226:227], v21 offset:43200
buffer_load_dwordx4 v70, s[20:23], s36 offen offset:3072 lds
v_mfma_f32_16x16x32_bf16 a[56:59], a[236:239], a[192:195], a[56:59]
s_addk_i32 m0, 4096
s_add_u32 s36, s35, 164480
buffer_load_dwordx4 v63, s[20:23], s36 offen lds
ds_read_b64_tr_b16 a[228:229], v21 offset:45248
ds_read_b64_tr_b16 a[230:231], v21 offset:47296
v_mfma_f32_16x16x32_bf16 a[56:59], a[240:243], a[200:203], a[56:59]
s_waitcnt lgkmcnt(12)
ds_read_b64_tr_b16 a[232:233], v22 offset:37056
ds_read_b64_tr_b16 a[234:235], v22 offset:39104
buffer_load_dwordx4 v68, s[20:23], s36 offen offset:1024 lds
v_mfma_f32_16x16x32_bf16 a[60:63], a[244:247], a[184:187], a[60:63]
ds_read_b64_tr_b16 a[236:237], v22 offset:41152
ds_read_b64_tr_b16 a[238:239], v22 offset:43200
buffer_load_dwordx4 v69, s[20:23], s36 offen offset:2048 lds
v_mfma_f32_16x16x32_bf16 a[60:63], a[248:251], a[192:195], a[60:63]
ds_read_b64_tr_b16 a[240:241], v22 offset:45248
ds_read_b64_tr_b16 a[242:243], v22 offset:47296
buffer_load_dwordx4 v70, s[20:23], s36 offen offset:3072 lds
v_mfma_f32_16x16x32_bf16 a[60:63], a[252:255], a[200:203], a[60:63]
s_waitcnt lgkmcnt(12)
s_addk_i32 m0, 4096
s_add_u32 s36, s35, 205440
buffer_load_dwordx4 v63, s[20:23], s36 offen lds
ds_read_b64_tr_b16 a[244:245], v23 offset:37056
ds_read_b64_tr_b16 a[246:247], v23 offset:39104
v_mfma_f32_16x16x32_bf16 a[64:67], a[208:211], a[160:163], a[64:67]
ds_read_b64_tr_b16 a[248:249], v23 offset:41152
ds_read_b64_tr_b16 a[250:251], v23 offset:43200
buffer_load_dwordx4 v68, s[20:23], s36 offen offset:1024 lds
v_mfma_f32_16x16x32_bf16 a[64:67], a[212:215], a[168:171], a[64:67]
ds_read_b64_tr_b16 a[252:253], v23 offset:45248
ds_read_b64_tr_b16 a[254:255], v23 offset:47296
buffer_load_dwordx4 v69, s[20:23], s36 offen offset:2048 lds
v_accvgpr_read_b32 v192, a48
v_accvgpr_read_b32 v193, a49
v_accvgpr_read_b32 v194, a50
v_accvgpr_read_b32 v195, a51
v_mfma_f32_16x16x32_bf16 a[64:67], a[216:219], a[176:179], a[64:67]
s_waitcnt lgkmcnt(12)
buffer_load_dwordx4 v70, s[20:23], s36 offen offset:3072 lds
v_accvgpr_read_b32 v196, a52
v_accvgpr_read_b32 v197, a53
v_accvgpr_read_b32 v198, a54
v_accvgpr_read_b32 v199, a55
v_accvgpr_read_b32 v200, a56
v_accvgpr_read_b32 v201, a57
v_mfma_f32_16x16x32_bf16 a[68:71], a[220:223], a[160:163], a[68:71]
s_waitcnt vmcnt(24)
s_barrier
s_addk_i32 m0, 4160
s_add_u32 s36, s35, 768
buffer_load_dwordx4 v63, s[20:23], s36 offen lds
ds_read_b64_tr_b16 a[208:209], v20 offset:49408
ds_read_b64_tr_b16 a[210:211], v20 offset:51456
ds_read_b64_tr_b16 a[212:213], v20 offset:53504
v_mfma_f32_16x16x32_bf16 a[68:71], a[224:227], a[168:171], a[68:71]
ds_read_b64_tr_b16 a[214:215], v20 offset:55552
ds_read_b64_tr_b16 a[216:217], v20 offset:57600
ds_read_b64_tr_b16 a[218:219], v20 offset:59648
v_accvgpr_read_b32 v202, a58
v_accvgpr_read_b32 v203, a59
v_accvgpr_read_b32 v204, a60
v_accvgpr_read_b32 v205, a61
v_accvgpr_read_b32 v206, a62
v_accvgpr_read_b32 v207, a63
v_mfma_f32_16x16x32_bf16 a[68:71], a[228:231], a[176:179], a[68:71]
s_waitcnt lgkmcnt(12)
ds_read_b64_tr_b16 a[220:221], v21 offset:49408
ds_read_b64_tr_b16 a[222:223], v21 offset:51456
v_cvt_pk_bf16_f32 v80, v192, v193
v_cvt_pk_bf16_f32 v81, v194, v195
v_cvt_pk_bf16_f32 v82, v196, v197
v_cvt_pk_bf16_f32 v83, v198, v199
v_cvt_pk_bf16_f32 v88, v200, v201
v_cvt_pk_bf16_f32 v89, v202, v203
v_cvt_pk_bf16_f32 v90, v204, v205
v_mfma_f32_16x16x32_bf16 a[72:75], a[232:235], a[160:163], a[72:75]
ds_read_b64_tr_b16 a[224:225], v21 offset:53504
ds_read_b64_tr_b16 a[226:227], v21 offset:55552
buffer_load_dwordx4 v68, s[20:23], s36 offen offset:1024 lds
buffer_load_dwordx4 v69, s[20:23], s36 offen offset:2048 lds
v_cvt_pk_bf16_f32 v91, v206, v207
v_mfma_f32_16x16x32_bf16 a[72:75], a[236:239], a[168:171], a[72:75]
ds_read_b64_tr_b16 a[228:229], v21 offset:57600
ds_read_b64_tr_b16 a[230:231], v21 offset:59648
buffer_load_dwordx4 v70, s[20:23], s36 offen offset:3072 lds
v_mfma_f32_16x16x32_bf16 a[72:75], a[240:243], a[176:179], a[72:75]
s_waitcnt lgkmcnt(12)
s_addk_i32 m0, 4096
s_add_u32 s36, s35, 41728
buffer_load_dwordx4 v63, s[20:23], s36 offen lds
ds_read_b64_tr_b16 a[232:233], v22 offset:49408
ds_read_b64_tr_b16 a[234:235], v22 offset:51456
buffer_load_dwordx4 v68, s[20:23], s36 offen offset:1024 lds
v_mfma_f32_16x16x32_bf16 a[76:79], a[244:247], a[160:163], a[76:79]
ds_read_b64_tr_b16 a[236:237], v22 offset:53504
ds_read_b64_tr_b16 a[238:239], v22 offset:55552
buffer_load_dwordx4 v69, s[20:23], s36 offen offset:2048 lds
v_mfma_f32_16x16x32_bf16 a[76:79], a[248:251], a[168:171], a[76:79]
ds_read_b64_tr_b16 a[240:241], v22 offset:57600
ds_read_b64_tr_b16 a[242:243], v22 offset:59648
buffer_load_dwordx4 v70, s[20:23], s36 offen offset:3072 lds
v_mfma_f32_16x16x32_bf16 a[76:79], a[252:255], a[176:179], a[76:79]
s_waitcnt lgkmcnt(12)
s_addk_i32 m0, 4096
s_add_u32 s36, s35, 82688
buffer_load_dwordx4 v63, s[20:23], s36 offen lds
ds_read_b64_tr_b16 a[244:245], v23 offset:49408
ds_read_b64_tr_b16 a[246:247], v23 offset:51456
v_mfma_f32_16x16x32_bf16 a[64:67], a[208:211], a[184:187], a[64:67]
ds_read_b64_tr_b16 a[248:249], v23 offset:53504
ds_read_b64_tr_b16 a[250:251], v23 offset:55552
buffer_load_dwordx4 v68, s[20:23], s36 offen offset:1024 lds
v_mfma_f32_16x16x32_bf16 a[64:67], a[212:215], a[192:195], a[64:67]
ds_read_b64_tr_b16 a[252:253], v23 offset:57600
ds_read_b64_tr_b16 a[254:255], v23 offset:59648
buffer_load_dwordx4 v69, s[20:23], s36 offen offset:2048 lds
v_mfma_f32_16x16x32_bf16 a[64:67], a[216:219], a[200:203], a[64:67]
s_waitcnt lgkmcnt(12)
buffer_load_dwordx4 v70, s[20:23], s36 offen offset:3072 lds
v_mfma_f32_16x16x32_bf16 a[68:71], a[220:223], a[184:187], a[68:71]
s_waitcnt vmcnt(24)
s_barrier
s_addk_i32 m0, 4160
s_add_u32 s36, s35, 123648
buffer_load_dwordx4 v63, s[20:23], s36 offen lds
ds_read_b64_tr_b16 a[208:209], v20 offset:0
ds_read_b64_tr_b16 a[210:211], v20 offset:2048
ds_read_b64_tr_b16 a[212:213], v20 offset:4096
v_mfma_f32_16x16x32_bf16 a[68:71], a[224:227], a[192:195], a[68:71]
ds_read_b64_tr_b16 a[214:215], v20 offset:6144
ds_read_b64_tr_b16 a[216:217], v20 offset:8192
ds_read_b64_tr_b16 a[218:219], v20 offset:10240
buffer_load_dwordx4 v68, s[20:23], s36 offen offset:1024 lds
v_mfma_f32_16x16x32_bf16 a[68:71], a[228:231], a[200:203], a[68:71]
s_waitcnt lgkmcnt(12)
ds_read_b64_tr_b16 a[220:221], v21 offset:0
ds_read_b64_tr_b16 a[222:223], v21 offset:2048
buffer_load_dwordx4 v69, s[20:23], s36 offen offset:2048 lds
v_mfma_f32_16x16x32_bf16 a[72:75], a[232:235], a[184:187], a[72:75]
ds_read_b64_tr_b16 a[224:225], v21 offset:4096
ds_read_b64_tr_b16 a[226:227], v21 offset:6144
buffer_load_dwordx4 v70, s[20:23], s36 offen offset:3072 lds
v_mfma_f32_16x16x32_bf16 a[72:75], a[236:239], a[192:195], a[72:75]
s_addk_i32 m0, 4096
s_add_u32 s36, s35, 164608
buffer_load_dwordx4 v63, s[20:23], s36 offen lds
ds_read_b64_tr_b16 a[228:229], v21 offset:8192
ds_read_b64_tr_b16 a[230:231], v21 offset:10240
v_mfma_f32_16x16x32_bf16 a[72:75], a[240:243], a[200:203], a[72:75]
s_waitcnt lgkmcnt(12)
ds_read_b64_tr_b16 a[232:233], v22 offset:0
ds_read_b64_tr_b16 a[234:235], v22 offset:2048
buffer_load_dwordx4 v68, s[20:23], s36 offen offset:1024 lds
v_mfma_f32_16x16x32_bf16 a[76:79], a[244:247], a[184:187], a[76:79]
ds_read_b64_tr_b16 a[236:237], v22 offset:4096
ds_read_b64_tr_b16 a[238:239], v22 offset:6144
buffer_load_dwordx4 v69, s[20:23], s36 offen offset:2048 lds
v_mfma_f32_16x16x32_bf16 a[76:79], a[248:251], a[192:195], a[76:79]
ds_read_b64_tr_b16 a[240:241], v22 offset:8192
ds_read_b64_tr_b16 a[242:243], v22 offset:10240
buffer_load_dwordx4 v70, s[20:23], s36 offen offset:3072 lds
v_mfma_f32_16x16x32_bf16 a[76:79], a[252:255], a[200:203], a[76:79]
s_waitcnt lgkmcnt(12)
s_addk_i32 m0, 4096
s_add_u32 s36, s35, 205568
buffer_load_dwordx4 v63, s[20:23], s36 offen lds
ds_read_b64_tr_b16 a[244:245], v23 offset:0
ds_read_b64_tr_b16 a[246:247], v23 offset:2048
v_mfma_f32_16x16x32_bf16 a[80:83], a[208:211], a[160:163], a[80:83]
ds_read_b64_tr_b16 a[248:249], v23 offset:4096
ds_read_b64_tr_b16 a[250:251], v23 offset:6144
buffer_load_dwordx4 v68, s[20:23], s36 offen offset:1024 lds
v_mfma_f32_16x16x32_bf16 a[80:83], a[212:215], a[168:171], a[80:83]
ds_read_b64_tr_b16 a[252:253], v23 offset:8192
ds_read_b64_tr_b16 a[254:255], v23 offset:10240
buffer_load_dwordx4 v69, s[20:23], s36 offen offset:2048 lds
v_accvgpr_read_b32 v192, a64
v_accvgpr_read_b32 v193, a65
v_accvgpr_read_b32 v194, a66
v_accvgpr_read_b32 v195, a67
v_mfma_f32_16x16x32_bf16 a[80:83], a[216:219], a[176:179], a[80:83]
s_waitcnt lgkmcnt(12)
buffer_load_dwordx4 v70, s[20:23], s36 offen offset:3072 lds
v_accvgpr_read_b32 v196, a68
v_accvgpr_read_b32 v197, a69
v_accvgpr_read_b32 v198, a70
v_accvgpr_read_b32 v199, a71
v_accvgpr_read_b32 v200, a72
v_accvgpr_read_b32 v201, a73
v_mfma_f32_16x16x32_bf16 a[84:87], a[220:223], a[160:163], a[84:87]
s_waitcnt vmcnt(24)
s_barrier
s_addk_i32 m0, 4160
s_add_u32 s36, s35, 896
buffer_load_dwordx4 v63, s[20:23], s36 offen lds
ds_read_b64_tr_b16 a[208:209], v20 offset:12352
ds_read_b64_tr_b16 a[210:211], v20 offset:14400
ds_read_b64_tr_b16 a[212:213], v20 offset:16448
v_mfma_f32_16x16x32_bf16 a[84:87], a[224:227], a[168:171], a[84:87]
ds_read_b64_tr_b16 a[214:215], v20 offset:18496
ds_read_b64_tr_b16 a[216:217], v20 offset:20544
ds_read_b64_tr_b16 a[218:219], v20 offset:22592
v_accvgpr_read_b32 v202, a74
v_accvgpr_read_b32 v203, a75
v_accvgpr_read_b32 v204, a76
v_accvgpr_read_b32 v205, a77
v_accvgpr_read_b32 v206, a78
v_accvgpr_read_b32 v207, a79
v_mfma_f32_16x16x32_bf16 a[84:87], a[228:231], a[176:179], a[84:87]
s_waitcnt lgkmcnt(12)
ds_read_b64_tr_b16 a[220:221], v21 offset:12352
ds_read_b64_tr_b16 a[222:223], v21 offset:14400
v_cvt_pk_bf16_f32 v96, v192, v193
v_cvt_pk_bf16_f32 v97, v194, v195
v_cvt_pk_bf16_f32 v98, v196, v197
v_cvt_pk_bf16_f32 v99, v198, v199
v_cvt_pk_bf16_f32 v104, v200, v201
v_cvt_pk_bf16_f32 v105, v202, v203
v_cvt_pk_bf16_f32 v106, v204, v205
v_mfma_f32_16x16x32_bf16 a[88:91], a[232:235], a[160:163], a[88:91]
ds_read_b64_tr_b16 a[224:225], v21 offset:16448
ds_read_b64_tr_b16 a[226:227], v21 offset:18496
buffer_load_dwordx4 v68, s[20:23], s36 offen offset:1024 lds
buffer_load_dwordx4 v69, s[20:23], s36 offen offset:2048 lds
v_cvt_pk_bf16_f32 v107, v206, v207
v_mfma_f32_16x16x32_bf16 a[88:91], a[236:239], a[168:171], a[88:91]
ds_read_b64_tr_b16 a[228:229], v21 offset:20544
ds_read_b64_tr_b16 a[230:231], v21 offset:22592
buffer_load_dwordx4 v70, s[20:23], s36 offen offset:3072 lds
v_mfma_f32_16x16x32_bf16 a[88:91], a[240:243], a[176:179], a[88:91]
s_waitcnt lgkmcnt(12)
s_addk_i32 m0, 4096
s_add_u32 s36, s35, 41856
buffer_load_dwordx4 v63, s[20:23], s36 offen lds
ds_read_b64_tr_b16 a[232:233], v22 offset:12352
ds_read_b64_tr_b16 a[234:235], v22 offset:14400
buffer_load_dwordx4 v68, s[20:23], s36 offen offset:1024 lds
v_mfma_f32_16x16x32_bf16 a[92:95], a[244:247], a[160:163], a[92:95]
ds_read_b64_tr_b16 a[236:237], v22 offset:16448
ds_read_b64_tr_b16 a[238:239], v22 offset:18496
buffer_load_dwordx4 v69, s[20:23], s36 offen offset:2048 lds
v_mfma_f32_16x16x32_bf16 a[92:95], a[248:251], a[168:171], a[92:95]
ds_read_b64_tr_b16 a[240:241], v22 offset:20544
ds_read_b64_tr_b16 a[242:243], v22 offset:22592
buffer_load_dwordx4 v70, s[20:23], s36 offen offset:3072 lds
v_mfma_f32_16x16x32_bf16 a[92:95], a[252:255], a[176:179], a[92:95]
s_waitcnt lgkmcnt(12)
s_addk_i32 m0, 4096
s_add_u32 s36, s35, 82816
buffer_load_dwordx4 v63, s[20:23], s36 offen lds
ds_read_b64_tr_b16 a[244:245], v23 offset:12352
ds_read_b64_tr_b16 a[246:247], v23 offset:14400
v_mfma_f32_16x16x32_bf16 a[80:83], a[208:211], a[184:187], a[80:83]
ds_read_b64_tr_b16 a[248:249], v23 offset:16448
ds_read_b64_tr_b16 a[250:251], v23 offset:18496
buffer_load_dwordx4 v68, s[20:23], s36 offen offset:1024 lds
v_mfma_f32_16x16x32_bf16 a[80:83], a[212:215], a[192:195], a[80:83]
ds_read_b64_tr_b16 a[252:253], v23 offset:20544
ds_read_b64_tr_b16 a[254:255], v23 offset:22592
buffer_load_dwordx4 v69, s[20:23], s36 offen offset:2048 lds
v_mfma_f32_16x16x32_bf16 a[80:83], a[216:219], a[200:203], a[80:83]
s_waitcnt lgkmcnt(12)
buffer_load_dwordx4 v70, s[20:23], s36 offen offset:3072 lds
v_mfma_f32_16x16x32_bf16 a[84:87], a[220:223], a[184:187], a[84:87]
s_waitcnt vmcnt(24)
s_barrier
s_mov_b32 m0, 98816
s_add_u32 s36, s35, 123776
buffer_load_dwordx4 v63, s[20:23], s36 offen lds
ds_read_b64_tr_b16 a[208:209], v20 offset:24704
ds_read_b64_tr_b16 a[210:211], v20 offset:26752
ds_read_b64_tr_b16 a[212:213], v20 offset:28800
v_mfma_f32_16x16x32_bf16 a[84:87], a[224:227], a[192:195], a[84:87]
ds_read_b64_tr_b16 a[214:215], v20 offset:30848
ds_read_b64_tr_b16 a[216:217], v20 offset:32896
ds_read_b64_tr_b16 a[218:219], v20 offset:34944
buffer_load_dwordx4 v68, s[20:23], s36 offen offset:1024 lds
v_mfma_f32_16x16x32_bf16 a[84:87], a[228:231], a[200:203], a[84:87]
s_waitcnt lgkmcnt(12)
ds_read_b64_tr_b16 a[220:221], v21 offset:24704
ds_read_b64_tr_b16 a[222:223], v21 offset:26752
buffer_load_dwordx4 v69, s[20:23], s36 offen offset:2048 lds
v_mfma_f32_16x16x32_bf16 a[88:91], a[232:235], a[184:187], a[88:91]
ds_read_b64_tr_b16 a[224:225], v21 offset:28800
ds_read_b64_tr_b16 a[226:227], v21 offset:30848
buffer_load_dwordx4 v70, s[20:23], s36 offen offset:3072 lds
v_mfma_f32_16x16x32_bf16 a[88:91], a[236:239], a[192:195], a[88:91]
s_addk_i32 m0, 4096
s_add_u32 s36, s35, 164736
buffer_load_dwordx4 v63, s[20:23], s36 offen lds
ds_read_b64_tr_b16 a[228:229], v21 offset:32896
ds_read_b64_tr_b16 a[230:231], v21 offset:34944
v_mfma_f32_16x16x32_bf16 a[88:91], a[240:243], a[200:203], a[88:91]
s_waitcnt lgkmcnt(12)
ds_read_b64_tr_b16 a[232:233], v22 offset:24704
ds_read_b64_tr_b16 a[234:235], v22 offset:26752
buffer_load_dwordx4 v68, s[20:23], s36 offen offset:1024 lds
v_mfma_f32_16x16x32_bf16 a[92:95], a[244:247], a[184:187], a[92:95]
ds_read_b64_tr_b16 a[236:237], v22 offset:28800
ds_read_b64_tr_b16 a[238:239], v22 offset:30848
buffer_load_dwordx4 v69, s[20:23], s36 offen offset:2048 lds
v_mfma_f32_16x16x32_bf16 a[92:95], a[248:251], a[192:195], a[92:95]
ds_read_b64_tr_b16 a[240:241], v22 offset:32896
ds_read_b64_tr_b16 a[242:243], v22 offset:34944
buffer_load_dwordx4 v70, s[20:23], s36 offen offset:3072 lds
v_mfma_f32_16x16x32_bf16 a[92:95], a[252:255], a[200:203], a[92:95]
s_waitcnt lgkmcnt(12)
s_addk_i32 m0, 4096
s_add_u32 s36, s35, 205696
buffer_load_dwordx4 v63, s[20:23], s36 offen lds
ds_read_b64_tr_b16 a[244:245], v23 offset:24704
ds_read_b64_tr_b16 a[246:247], v23 offset:26752
v_mfma_f32_16x16x32_bf16 a[96:99], a[208:211], a[160:163], a[96:99]
ds_read_b64_tr_b16 a[248:249], v23 offset:28800
ds_read_b64_tr_b16 a[250:251], v23 offset:30848
buffer_load_dwordx4 v68, s[20:23], s36 offen offset:1024 lds
v_mfma_f32_16x16x32_bf16 a[96:99], a[212:215], a[168:171], a[96:99]
ds_read_b64_tr_b16 a[252:253], v23 offset:32896
ds_read_b64_tr_b16 a[254:255], v23 offset:34944
buffer_load_dwordx4 v69, s[20:23], s36 offen offset:2048 lds
v_accvgpr_read_b32 v192, a80
v_accvgpr_read_b32 v193, a81
v_accvgpr_read_b32 v194, a82
v_accvgpr_read_b32 v195, a83
v_mfma_f32_16x16x32_bf16 a[96:99], a[216:219], a[176:179], a[96:99]
s_waitcnt lgkmcnt(12)
buffer_load_dwordx4 v70, s[20:23], s36 offen offset:3072 lds
v_accvgpr_read_b32 v196, a84
v_accvgpr_read_b32 v197, a85
v_accvgpr_read_b32 v198, a86
v_accvgpr_read_b32 v199, a87
v_accvgpr_read_b32 v200, a88
v_accvgpr_read_b32 v201, a89
v_mfma_f32_16x16x32_bf16 a[100:103], a[220:223], a[160:163], a[100:103]
s_waitcnt vmcnt(24)
s_barrier
s_addk_i32 m0, 4160
s_add_u32 s36, s35, 1024
buffer_load_dwordx4 v63, s[20:23], s36 offen lds
ds_read_b64_tr_b16 a[208:209], v20 offset:37056
ds_read_b64_tr_b16 a[210:211], v20 offset:39104
ds_read_b64_tr_b16 a[212:213], v20 offset:41152
v_mfma_f32_16x16x32_bf16 a[100:103], a[224:227], a[168:171], a[100:103]
ds_read_b64_tr_b16 a[214:215], v20 offset:43200
ds_read_b64_tr_b16 a[216:217], v20 offset:45248
ds_read_b64_tr_b16 a[218:219], v20 offset:47296
v_accvgpr_read_b32 v202, a90
v_accvgpr_read_b32 v203, a91
v_accvgpr_read_b32 v204, a92
v_accvgpr_read_b32 v205, a93
v_accvgpr_read_b32 v206, a94
v_accvgpr_read_b32 v207, a95
v_mfma_f32_16x16x32_bf16 a[100:103], a[228:231], a[176:179], a[100:103]
s_waitcnt lgkmcnt(12)
ds_read_b64_tr_b16 a[220:221], v21 offset:37056
ds_read_b64_tr_b16 a[222:223], v21 offset:39104
v_cvt_pk_bf16_f32 v112, v192, v193
v_cvt_pk_bf16_f32 v113, v194, v195
v_cvt_pk_bf16_f32 v114, v196, v197
v_cvt_pk_bf16_f32 v115, v198, v199
v_cvt_pk_bf16_f32 v120, v200, v201
v_cvt_pk_bf16_f32 v121, v202, v203
v_cvt_pk_bf16_f32 v122, v204, v205
v_mfma_f32_16x16x32_bf16 a[104:107], a[232:235], a[160:163], a[104:107]
ds_read_b64_tr_b16 a[224:225], v21 offset:41152
ds_read_b64_tr_b16 a[226:227], v21 offset:43200
buffer_load_dwordx4 v68, s[20:23], s36 offen offset:1024 lds
buffer_load_dwordx4 v69, s[20:23], s36 offen offset:2048 lds
v_cvt_pk_bf16_f32 v123, v206, v207
v_mfma_f32_16x16x32_bf16 a[104:107], a[236:239], a[168:171], a[104:107]
ds_read_b64_tr_b16 a[228:229], v21 offset:45248
ds_read_b64_tr_b16 a[230:231], v21 offset:47296
buffer_load_dwordx4 v70, s[20:23], s36 offen offset:3072 lds
v_mfma_f32_16x16x32_bf16 a[104:107], a[240:243], a[176:179], a[104:107]
s_waitcnt lgkmcnt(12)
s_addk_i32 m0, 4096
s_add_u32 s36, s35, 41984
buffer_load_dwordx4 v63, s[20:23], s36 offen lds
ds_read_b64_tr_b16 a[232:233], v22 offset:37056
ds_read_b64_tr_b16 a[234:235], v22 offset:39104
buffer_load_dwordx4 v68, s[20:23], s36 offen offset:1024 lds
v_mfma_f32_16x16x32_bf16 a[108:111], a[244:247], a[160:163], a[108:111]
ds_read_b64_tr_b16 a[236:237], v22 offset:41152
ds_read_b64_tr_b16 a[238:239], v22 offset:43200
buffer_load_dwordx4 v69, s[20:23], s36 offen offset:2048 lds
v_mfma_f32_16x16x32_bf16 a[108:111], a[248:251], a[168:171], a[108:111]
ds_read_b64_tr_b16 a[240:241], v22 offset:45248
ds_read_b64_tr_b16 a[242:243], v22 offset:47296
buffer_load_dwordx4 v70, s[20:23], s36 offen offset:3072 lds
v_mfma_f32_16x16x32_bf16 a[108:111], a[252:255], a[176:179], a[108:111]
s_waitcnt lgkmcnt(12)
s_addk_i32 m0, 4096
s_add_u32 s36, s35, 82944
buffer_load_dwordx4 v63, s[20:23], s36 offen lds
ds_read_b64_tr_b16 a[244:245], v23 offset:37056
ds_read_b64_tr_b16 a[246:247], v23 offset:39104
v_mfma_f32_16x16x32_bf16 a[96:99], a[208:211], a[184:187], a[96:99]
ds_read_b64_tr_b16 a[248:249], v23 offset:41152
ds_read_b64_tr_b16 a[250:251], v23 offset:43200
buffer_load_dwordx4 v68, s[20:23], s36 offen offset:1024 lds
v_mfma_f32_16x16x32_bf16 a[96:99], a[212:215], a[192:195], a[96:99]
ds_read_b64_tr_b16 a[252:253], v23 offset:45248
ds_read_b64_tr_b16 a[254:255], v23 offset:47296
buffer_load_dwordx4 v69, s[20:23], s36 offen offset:2048 lds
v_mfma_f32_16x16x32_bf16 a[96:99], a[216:219], a[200:203], a[96:99]
s_waitcnt lgkmcnt(12)
buffer_load_dwordx4 v70, s[20:23], s36 offen offset:3072 lds
v_mfma_f32_16x16x32_bf16 a[100:103], a[220:223], a[184:187], a[100:103]
s_waitcnt vmcnt(24)
s_barrier
s_addk_i32 m0, 4160
s_add_u32 s36, s35, 123904
buffer_load_dwordx4 v63, s[20:23], s36 offen lds
ds_read_b64_tr_b16 a[208:209], v20 offset:49408
ds_read_b64_tr_b16 a[210:211], v20 offset:51456
ds_read_b64_tr_b16 a[212:213], v20 offset:53504
v_mfma_f32_16x16x32_bf16 a[100:103], a[224:227], a[192:195], a[100:103]
ds_read_b64_tr_b16 a[214:215], v20 offset:55552
ds_read_b64_tr_b16 a[216:217], v20 offset:57600
ds_read_b64_tr_b16 a[218:219], v20 offset:59648
buffer_load_dwordx4 v68, s[20:23], s36 offen offset:1024 lds
v_mfma_f32_16x16x32_bf16 a[100:103], a[228:231], a[200:203], a[100:103]
s_waitcnt lgkmcnt(12)
ds_read_b64_tr_b16 a[220:221], v21 offset:49408
ds_read_b64_tr_b16 a[222:223], v21 offset:51456
buffer_load_dwordx4 v69, s[20:23], s36 offen offset:2048 lds
v_mfma_f32_16x16x32_bf16 a[104:107], a[232:235], a[184:187], a[104:107]
ds_read_b64_tr_b16 a[224:225], v21 offset:53504
ds_read_b64_tr_b16 a[226:227], v21 offset:55552
buffer_load_dwordx4 v70, s[20:23], s36 offen offset:3072 lds
v_mfma_f32_16x16x32_bf16 a[104:107], a[236:239], a[192:195], a[104:107]
s_addk_i32 m0, 4096
s_add_u32 s36, s35, 164864
buffer_load_dwordx4 v63, s[20:23], s36 offen lds
ds_read_b64_tr_b16 a[228:229], v21 offset:57600
ds_read_b64_tr_b16 a[230:231], v21 offset:59648
v_mfma_f32_16x16x32_bf16 a[104:107], a[240:243], a[200:203], a[104:107]
s_waitcnt lgkmcnt(12)
ds_read_b64_tr_b16 a[232:233], v22 offset:49408
ds_read_b64_tr_b16 a[234:235], v22 offset:51456
buffer_load_dwordx4 v68, s[20:23], s36 offen offset:1024 lds
v_mfma_f32_16x16x32_bf16 a[108:111], a[244:247], a[184:187], a[108:111]
ds_read_b64_tr_b16 a[236:237], v22 offset:53504
ds_read_b64_tr_b16 a[238:239], v22 offset:55552
buffer_load_dwordx4 v69, s[20:23], s36 offen offset:2048 lds
v_mfma_f32_16x16x32_bf16 a[108:111], a[248:251], a[192:195], a[108:111]
ds_read_b64_tr_b16 a[240:241], v22 offset:57600
ds_read_b64_tr_b16 a[242:243], v22 offset:59648
buffer_load_dwordx4 v70, s[20:23], s36 offen offset:3072 lds
v_mfma_f32_16x16x32_bf16 a[108:111], a[252:255], a[200:203], a[108:111]
s_waitcnt lgkmcnt(12)
s_addk_i32 m0, 4096
s_add_u32 s36, s35, 205824
buffer_load_dwordx4 v63, s[20:23], s36 offen lds
ds_read_b64_tr_b16 a[244:245], v23 offset:49408
ds_read_b64_tr_b16 a[246:247], v23 offset:51456
v_mfma_f32_16x16x32_bf16 a[112:115], a[208:211], a[160:163], a[112:115]
ds_read_b64_tr_b16 a[248:249], v23 offset:53504
ds_read_b64_tr_b16 a[250:251], v23 offset:55552
buffer_load_dwordx4 v68, s[20:23], s36 offen offset:1024 lds
v_mfma_f32_16x16x32_bf16 a[112:115], a[212:215], a[168:171], a[112:115]
ds_read_b64_tr_b16 a[252:253], v23 offset:57600
ds_read_b64_tr_b16 a[254:255], v23 offset:59648
buffer_load_dwordx4 v69, s[20:23], s36 offen offset:2048 lds
v_accvgpr_read_b32 v192, a96
v_accvgpr_read_b32 v193, a97
v_accvgpr_read_b32 v194, a98
v_accvgpr_read_b32 v195, a99
v_mfma_f32_16x16x32_bf16 a[112:115], a[216:219], a[176:179], a[112:115]
s_waitcnt lgkmcnt(12)
buffer_load_dwordx4 v70, s[20:23], s36 offen offset:3072 lds
v_accvgpr_read_b32 v196, a100
v_accvgpr_read_b32 v197, a101
v_accvgpr_read_b32 v198, a102
v_accvgpr_read_b32 v199, a103
v_accvgpr_read_b32 v200, a104
v_accvgpr_read_b32 v201, a105
v_mfma_f32_16x16x32_bf16 a[116:119], a[220:223], a[160:163], a[116:119]
s_waitcnt vmcnt(24)
s_barrier
s_addk_i32 m0, 4160
s_add_u32 s36, s35, 1152
buffer_load_dwordx4 v63, s[20:23], s36 offen lds
v_readlane_b32 s47, v93, s99
s_lshl_b32 s46, s99, 7
s_addk_i32 s46, 1024
s_nop 1
s_add_u32 s47, s47, 1
s_mov_b64 exec, 0xff
v_mov_b32_e32 v100, s47
v_mov_b32_e32 v101, s47
v_mov_b32_e32 v102, s47
v_mov_b32_e32 v103, s47
buffer_store_dwordx4 v[100:103], v76, s[68:71], s46 offen sc1
s_mov_b64 exec, -1
v_mfma_f32_16x16x32_bf16 a[116:119], a[224:227], a[168:171], a[116:119]
ds_read_b64_tr_b16 a[208:209], v20 offset:0
ds_read_b64_tr_b16 a[210:211], v20 offset:2048
ds_read_b64_tr_b16 a[212:213], v20 offset:4096
ds_read_b64_tr_b16 a[214:215], v20 offset:6144
ds_read_b64_tr_b16 a[216:217], v20 offset:8192
ds_read_b64_tr_b16 a[218:219], v20 offset:10240
v_accvgpr_read_b32 v202, a106
v_accvgpr_read_b32 v203, a107
v_accvgpr_read_b32 v204, a108
v_mfma_f32_16x16x32_bf16 a[116:119], a[228:231], a[176:179], a[116:119]
s_waitcnt lgkmcnt(12)
ds_read_b64_tr_b16 a[220:221], v21 offset:0
ds_read_b64_tr_b16 a[222:223], v21 offset:2048
v_accvgpr_read_b32 v205, a109
v_accvgpr_read_b32 v206, a110
v_accvgpr_read_b32 v207, a111
v_cvt_pk_bf16_f32 v208, v192, v193
v_cvt_pk_bf16_f32 v209, v194, v195
v_cvt_pk_bf16_f32 v210, v196, v197
v_cvt_pk_bf16_f32 v211, v198, v199
v_mfma_f32_16x16x32_bf16 a[120:123], a[232:235], a[160:163], a[120:123]
ds_read_b64_tr_b16 a[224:225], v21 offset:4096
ds_read_b64_tr_b16 a[226:227], v21 offset:6144
buffer_load_dwordx4 v68, s[20:23], s36 offen offset:1024 lds
v_cvt_pk_bf16_f32 v212, v200, v201
v_cvt_pk_bf16_f32 v213, v202, v203
v_cvt_pk_bf16_f32 v214, v204, v205
v_cvt_pk_bf16_f32 v215, v206, v207
v_mfma_f32_16x16x32_bf16 a[120:123], a[236:239], a[168:171], a[120:123]
ds_read_b64_tr_b16 a[228:229], v21 offset:8192
ds_read_b64_tr_b16 a[230:231], v21 offset:10240
buffer_load_dwordx4 v69, s[20:23], s36 offen offset:2048 lds
buffer_load_dwordx4 v70, s[20:23], s36 offen offset:3072 lds
v_mfma_f32_16x16x32_bf16 a[120:123], a[240:243], a[176:179], a[120:123]
s_waitcnt lgkmcnt(12)
s_addk_i32 m0, 4096
s_add_u32 s36, s35, 42112
buffer_load_dwordx4 v63, s[20:23], s36 offen lds
ds_read_b64_tr_b16 a[232:233], v22 offset:0
ds_read_b64_tr_b16 a[234:235], v22 offset:2048
buffer_load_dwordx4 v68, s[20:23], s36 offen offset:1024 lds
v_mfma_f32_16x16x32_bf16 a[124:127], a[244:247], a[160:163], a[124:127]
ds_read_b64_tr_b16 a[236:237], v22 offset:4096
ds_read_b64_tr_b16 a[238:239], v22 offset:6144
buffer_load_dwordx4 v69, s[20:23], s36 offen offset:2048 lds
v_mfma_f32_16x16x32_bf16 a[124:127], a[248:251], a[168:171], a[124:127]
ds_read_b64_tr_b16 a[240:241], v22 offset:8192
ds_read_b64_tr_b16 a[242:243], v22 offset:10240
buffer_load_dwordx4 v70, s[20:23], s36 offen offset:3072 lds
v_mfma_f32_16x16x32_bf16 a[124:127], a[252:255], a[176:179], a[124:127]
s_waitcnt lgkmcnt(12)
s_addk_i32 m0, 4096
s_add_u32 s36, s35, 83072
buffer_load_dwordx4 v63, s[20:23], s36 offen lds
ds_read_b64_tr_b16 a[244:245], v23 offset:0
ds_read_b64_tr_b16 a[246:247], v23 offset:2048
v_mfma_f32_16x16x32_bf16 a[112:115], a[208:211], a[184:187], a[112:115]
ds_read_b64_tr_b16 a[248:249], v23 offset:4096
ds_read_b64_tr_b16 a[250:251], v23 offset:6144
buffer_load_dwordx4 v68, s[20:23], s36 offen offset:1024 lds
v_mfma_f32_16x16x32_bf16 a[112:115], a[212:215], a[192:195], a[112:115]
ds_read_b64_tr_b16 a[252:253], v23 offset:8192
ds_read_b64_tr_b16 a[254:255], v23 offset:10240
buffer_load_dwordx4 v69, s[20:23], s36 offen offset:2048 lds
v_mfma_f32_16x16x32_bf16 a[112:115], a[216:219], a[200:203], a[112:115]
s_waitcnt lgkmcnt(12)
buffer_load_dwordx4 v70, s[20:23], s36 offen offset:3072 lds
v_mfma_f32_16x16x32_bf16 a[116:119], a[220:223], a[184:187], a[116:119]
s_waitcnt vmcnt(24)
s_barrier
s_addk_i32 m0, 4160
s_add_u32 s36, s35, 124032
buffer_load_dwordx4 v63, s[20:23], s36 offen lds
ds_read_b64_tr_b16 a[208:209], v20 offset:12352
ds_read_b64_tr_b16 a[210:211], v20 offset:14400
ds_read_b64_tr_b16 a[212:213], v20 offset:16448
v_mfma_f32_16x16x32_bf16 a[116:119], a[224:227], a[192:195], a[116:119]
ds_read_b64_tr_b16 a[214:215], v20 offset:18496
ds_read_b64_tr_b16 a[216:217], v20 offset:20544
ds_read_b64_tr_b16 a[218:219], v20 offset:22592
buffer_load_dwordx4 v68, s[20:23], s36 offen offset:1024 lds
v_mfma_f32_16x16x32_bf16 a[116:119], a[228:231], a[200:203], a[116:119]
s_waitcnt lgkmcnt(12)
ds_read_b64_tr_b16 a[220:221], v21 offset:12352
ds_read_b64_tr_b16 a[222:223], v21 offset:14400
buffer_load_dwordx4 v69, s[20:23], s36 offen offset:2048 lds
v_mfma_f32_16x16x32_bf16 a[120:123], a[232:235], a[184:187], a[120:123]
ds_read_b64_tr_b16 a[224:225], v21 offset:16448
ds_read_b64_tr_b16 a[226:227], v21 offset:18496
buffer_load_dwordx4 v70, s[20:23], s36 offen offset:3072 lds
v_mfma_f32_16x16x32_bf16 a[120:123], a[236:239], a[192:195], a[120:123]
s_addk_i32 m0, 4096
s_add_u32 s36, s35, 164992
buffer_load_dwordx4 v63, s[20:23], s36 offen lds
ds_read_b64_tr_b16 a[228:229], v21 offset:20544
ds_read_b64_tr_b16 a[230:231], v21 offset:22592
v_mfma_f32_16x16x32_bf16 a[120:123], a[240:243], a[200:203], a[120:123]
s_waitcnt lgkmcnt(12)
ds_read_b64_tr_b16 a[232:233], v22 offset:12352
ds_read_b64_tr_b16 a[234:235], v22 offset:14400
buffer_load_dwordx4 v68, s[20:23], s36 offen offset:1024 lds
v_mfma_f32_16x16x32_bf16 a[124:127], a[244:247], a[184:187], a[124:127]
ds_read_b64_tr_b16 a[236:237], v22 offset:16448
ds_read_b64_tr_b16 a[238:239], v22 offset:18496
buffer_load_dwordx4 v69, s[20:23], s36 offen offset:2048 lds
v_mfma_f32_16x16x32_bf16 a[124:127], a[248:251], a[192:195], a[124:127]
ds_read_b64_tr_b16 a[240:241], v22 offset:20544
ds_read_b64_tr_b16 a[242:243], v22 offset:22592
buffer_load_dwordx4 v70, s[20:23], s36 offen offset:3072 lds
v_mfma_f32_16x16x32_bf16 a[124:127], a[252:255], a[200:203], a[124:127]
s_waitcnt lgkmcnt(12)
s_addk_i32 m0, 4096
s_add_u32 s36, s35, 205952
buffer_load_dwordx4 v63, s[20:23], s36 offen lds
ds_read_b64_tr_b16 a[244:245], v23 offset:12352
ds_read_b64_tr_b16 a[246:247], v23 offset:14400
v_mfma_f32_16x16x32_bf16 a[128:131], a[208:211], a[160:163], a[128:131]
ds_read_b64_tr_b16 a[248:249], v23 offset:16448
ds_read_b64_tr_b16 a[250:251], v23 offset:18496
buffer_load_dwordx4 v68, s[20:23], s36 offen offset:1024 lds
v_mfma_f32_16x16x32_bf16 a[128:131], a[212:215], a[168:171], a[128:131]
ds_read_b64_tr_b16 a[252:253], v23 offset:20544
ds_read_b64_tr_b16 a[254:255], v23 offset:22592
buffer_load_dwordx4 v69, s[20:23], s36 offen offset:2048 lds
v_accvgpr_read_b32 v192, a112
v_accvgpr_read_b32 v193, a113
v_accvgpr_read_b32 v194, a114
v_accvgpr_read_b32 v195, a115
v_mfma_f32_16x16x32_bf16 a[128:131], a[216:219], a[176:179], a[128:131]
s_waitcnt lgkmcnt(12)
buffer_load_dwordx4 v70, s[20:23], s36 offen offset:3072 lds
v_accvgpr_read_b32 v196, a116
v_accvgpr_read_b32 v197, a117
v_accvgpr_read_b32 v198, a118
v_accvgpr_read_b32 v199, a119
v_accvgpr_read_b32 v200, a120
v_accvgpr_read_b32 v201, a121
v_mfma_f32_16x16x32_bf16 a[132:135], a[220:223], a[160:163], a[132:135]
s_waitcnt vmcnt(24)
s_barrier
s_mov_b32 s94, 0
buffer_store_dwordx4 v[32:35], v26, s[24:27], s94 offen offset:0 sc1
ds_read_b64_tr_b16 a[208:209], v20 offset:24704
ds_read_b64_tr_b16 a[210:211], v20 offset:26752
ds_read_b64_tr_b16 a[212:213], v20 offset:28800
ds_read_b64_tr_b16 a[214:215], v20 offset:30848
v_mfma_f32_16x16x32_bf16 a[132:135], a[224:227], a[168:171], a[132:135]
ds_read_b64_tr_b16 a[216:217], v20 offset:32896
ds_read_b64_tr_b16 a[218:219], v20 offset:34944
v_accvgpr_read_b32 v202, a122
v_accvgpr_read_b32 v203, a123
v_accvgpr_read_b32 v204, a124
v_accvgpr_read_b32 v205, a125
v_accvgpr_read_b32 v206, a126
v_accvgpr_read_b32 v207, a127
v_cvt_pk_bf16_f32 v216, v192, v193
v_mfma_f32_16x16x32_bf16 a[132:135], a[228:231], a[176:179], a[132:135]
s_waitcnt lgkmcnt(12)
ds_read_b64_tr_b16 a[220:221], v21 offset:24704
ds_read_b64_tr_b16 a[222:223], v21 offset:26752
v_cvt_pk_bf16_f32 v217, v194, v195
v_cvt_pk_bf16_f32 v218, v196, v197
v_cvt_pk_bf16_f32 v219, v198, v199
v_cvt_pk_bf16_f32 v220, v200, v201
v_cvt_pk_bf16_f32 v221, v202, v203
v_cvt_pk_bf16_f32 v222, v204, v205
v_cvt_pk_bf16_f32 v223, v206, v207
v_mfma_f32_16x16x32_bf16 a[136:139], a[232:235], a[160:163], a[136:139]
ds_read_b64_tr_b16 a[224:225], v21 offset:28800
ds_read_b64_tr_b16 a[226:227], v21 offset:30848
buffer_store_dwordx4 v[40:43], v26, s[24:27], s94 offen offset:1024 sc1
buffer_store_dwordx4 v[48:51], v26, s[24:27], s94 offen offset:2048 sc1
v_mfma_f32_16x16x32_bf16 a[136:139], a[236:239], a[168:171], a[136:139]
ds_read_b64_tr_b16 a[228:229], v21 offset:32896
ds_read_b64_tr_b16 a[230:231], v21 offset:34944
buffer_store_dwordx4 v[56:59], v26, s[24:27], s94 offen offset:3072 sc1
v_mfma_f32_16x16x32_bf16 a[136:139], a[240:243], a[176:179], a[136:139]
s_waitcnt lgkmcnt(12)
s_mov_b32 s94, 4096
buffer_store_dwordx4 v[64:67], v26, s[24:27], s94 offen offset:0 sc1
ds_read_b64_tr_b16 a[232:233], v22 offset:24704
ds_read_b64_tr_b16 a[234:235], v22 offset:26752
v_mfma_f32_16x16x32_bf16 a[140:143], a[244:247], a[160:163], a[140:143]
ds_read_b64_tr_b16 a[236:237], v22 offset:28800
ds_read_b64_tr_b16 a[238:239], v22 offset:30848
buffer_store_dwordx4 v[72:75], v26, s[24:27], s94 offen offset:1024 sc1
v_mfma_f32_16x16x32_bf16 a[140:143], a[248:251], a[168:171], a[140:143]
ds_read_b64_tr_b16 a[240:241], v22 offset:32896
ds_read_b64_tr_b16 a[242:243], v22 offset:34944
v_mfma_f32_16x16x32_bf16 a[140:143], a[252:255], a[176:179], a[140:143]
s_waitcnt lgkmcnt(12)
ds_read_b64_tr_b16 a[244:245], v23 offset:24704
ds_read_b64_tr_b16 a[246:247], v23 offset:26752
v_mfma_f32_16x16x32_bf16 a[128:131], a[208:211], a[184:187], a[128:131]
ds_read_b64_tr_b16 a[248:249], v23 offset:28800
ds_read_b64_tr_b16 a[250:251], v23 offset:30848
v_mfma_f32_16x16x32_bf16 a[128:131], a[212:215], a[192:195], a[128:131]
ds_read_b64_tr_b16 a[252:253], v23 offset:32896
ds_read_b64_tr_b16 a[254:255], v23 offset:34944
v_mfma_f32_16x16x32_bf16 a[128:131], a[216:219], a[200:203], a[128:131]
s_waitcnt lgkmcnt(12)
v_mfma_f32_16x16x32_bf16 a[132:135], a[220:223], a[184:187], a[132:135]
s_waitcnt vmcnt(18)
s_barrier
s_mov_b32 s94, 4096
buffer_store_dwordx4 v[80:83], v26, s[24:27], s94 offen offset:2048 sc1
ds_read_b64_tr_b16 a[208:209], v20 offset:37056
ds_read_b64_tr_b16 a[210:211], v20 offset:39104
ds_read_b64_tr_b16 a[212:213], v20 offset:41152
ds_read_b64_tr_b16 a[214:215], v20 offset:43200
v_mfma_f32_16x16x32_bf16 a[132:135], a[224:227], a[192:195], a[132:135]
ds_read_b64_tr_b16 a[216:217], v20 offset:45248
ds_read_b64_tr_b16 a[218:219], v20 offset:47296
buffer_store_dwordx4 v[88:91], v26, s[24:27], s94 offen offset:3072 sc1
v_mfma_f32_16x16x32_bf16 a[132:135], a[228:231], a[200:203], a[132:135]
s_waitcnt lgkmcnt(12)
s_mov_b32 s94, 8192
buffer_store_dwordx4 v[96:99], v26, s[24:27], s94 offen offset:0 sc1
ds_read_b64_tr_b16 a[220:221], v21 offset:37056
ds_read_b64_tr_b16 a[222:223], v21 offset:39104
v_mfma_f32_16x16x32_bf16 a[136:139], a[232:235], a[184:187], a[136:139]
ds_read_b64_tr_b16 a[224:225], v21 offset:41152
ds_read_b64_tr_b16 a[226:227], v21 offset:43200
v_mfma_f32_16x16x32_bf16 a[136:139], a[236:239], a[192:195], a[136:139]
ds_read_b64_tr_b16 a[228:229], v21 offset:45248
ds_read_b64_tr_b16 a[230:231], v21 offset:47296
buffer_store_dwordx4 v[104:107], v26, s[24:27], s94 offen offset:1024 sc1
v_mfma_f32_16x16x32_bf16 a[136:139], a[240:243], a[200:203], a[136:139]
s_waitcnt lgkmcnt(12)
ds_read_b64_tr_b16 a[232:233], v22 offset:37056
ds_read_b64_tr_b16 a[234:235], v22 offset:39104
buffer_store_dwordx4 v[112:115], v26, s[24:27], s94 offen offset:2048 sc1
v_mfma_f32_16x16x32_bf16 a[140:143], a[244:247], a[184:187], a[140:143]
ds_read_b64_tr_b16 a[236:237], v22 offset:41152
ds_read_b64_tr_b16 a[238:239], v22 offset:43200
v_mfma_f32_16x16x32_bf16 a[140:143], a[248:251], a[192:195], a[140:143]
ds_read_b64_tr_b16 a[240:241], v22 offset:45248
ds_read_b64_tr_b16 a[242:243], v22 offset:47296
v_mfma_f32_16x16x32_bf16 a[140:143], a[252:255], a[200:203], a[140:143]
s_waitcnt lgkmcnt(12)
ds_read_b64_tr_b16 a[244:245], v23 offset:37056
ds_read_b64_tr_b16 a[246:247], v23 offset:39104
v_mfma_f32_16x16x32_bf16 a[144:147], a[208:211], a[160:163], a[144:147]
ds_read_b64_tr_b16 a[248:249], v23 offset:41152
ds_read_b64_tr_b16 a[250:251], v23 offset:43200
v_mfma_f32_16x16x32_bf16 a[144:147], a[212:215], a[168:171], a[144:147]
ds_read_b64_tr_b16 a[252:253], v23 offset:45248
ds_read_b64_tr_b16 a[254:255], v23 offset:47296
v_accvgpr_read_b32 v192, a128
v_accvgpr_read_b32 v193, a129
v_accvgpr_read_b32 v194, a130
v_accvgpr_read_b32 v195, a131
v_accvgpr_read_b32 v196, a132
v_accvgpr_read_b32 v197, a133
v_accvgpr_read_b32 v198, a134
v_mfma_f32_16x16x32_bf16 a[144:147], a[216:219], a[176:179], a[144:147]
s_waitcnt lgkmcnt(12)
v_accvgpr_read_b32 v199, a135
v_accvgpr_read_b32 v200, a136
v_accvgpr_read_b32 v201, a137
v_accvgpr_read_b32 v202, a138
v_accvgpr_read_b32 v203, a139
v_accvgpr_read_b32 v204, a140
v_accvgpr_read_b32 v205, a141
v_accvgpr_read_b32 v206, a142
v_accvgpr_read_b32 v207, a143
v_mfma_f32_16x16x32_bf16 a[148:151], a[220:223], a[160:163], a[148:151]
s_waitcnt vmcnt(11)
s_barrier
s_mov_b32 s94, 8192
buffer_store_dwordx4 v[120:123], v26, s[24:27], s94 offen offset:3072 sc1
ds_read_b64_tr_b16 a[208:209], v20 offset:49408
ds_read_b64_tr_b16 a[210:211], v20 offset:51456
ds_read_b64_tr_b16 a[212:213], v20 offset:53504
ds_read_b64_tr_b16 a[214:215], v20 offset:55552
v_mfma_f32_16x16x32_bf16 a[148:151], a[224:227], a[168:171], a[148:151]
s_mov_b32 s94, 12288
buffer_store_dwordx4 v[208:211], v26, s[24:27], s94 offen offset:0 sc1
ds_read_b64_tr_b16 a[216:217], v20 offset:57600
ds_read_b64_tr_b16 a[218:219], v20 offset:59648
v_cvt_pk_bf16_f32 v224, v192, v193
v_cvt_pk_bf16_f32 v225, v194, v195
v_cvt_pk_bf16_f32 v226, v196, v197
v_cvt_pk_bf16_f32 v227, v198, v199
v_mfma_f32_16x16x32_bf16 a[148:151], a[228:231], a[176:179], a[148:151]
s_waitcnt lgkmcnt(12)
ds_read_b64_tr_b16 a[220:221], v21 offset:49408
ds_read_b64_tr_b16 a[222:223], v21 offset:51456
buffer_store_dwordx4 v[212:215], v26, s[24:27], s94 offen offset:1024 sc1
v_cvt_pk_bf16_f32 v228, v200, v201
v_cvt_pk_bf16_f32 v229, v202, v203
v_cvt_pk_bf16_f32 v230, v204, v205
v_cvt_pk_bf16_f32 v231, v206, v207
v_mfma_f32_16x16x32_bf16 a[152:155], a[232:235], a[160:163], a[152:155]
ds_read_b64_tr_b16 a[224:225], v21 offset:53504
ds_read_b64_tr_b16 a[226:227], v21 offset:55552
v_mfma_f32_16x16x32_bf16 a[152:155], a[236:239], a[168:171], a[152:155]
ds_read_b64_tr_b16 a[228:229], v21 offset:57600
ds_read_b64_tr_b16 a[230:231], v21 offset:59648
buffer_store_dwordx4 v[216:219], v26, s[24:27], s94 offen offset:2048 sc1
v_mfma_f32_16x16x32_bf16 a[152:155], a[240:243], a[176:179], a[152:155]
s_waitcnt lgkmcnt(12)
ds_read_b64_tr_b16 a[232:233], v22 offset:49408
ds_read_b64_tr_b16 a[234:235], v22 offset:51456
buffer_store_dwordx4 v[220:223], v26, s[24:27], s94 offen offset:3072 sc1
v_mfma_f32_16x16x32_bf16 a[156:159], a[244:247], a[160:163], a[156:159]
ds_read_b64_tr_b16 a[236:237], v22 offset:53504
ds_read_b64_tr_b16 a[238:239], v22 offset:55552
v_mfma_f32_16x16x32_bf16 a[156:159], a[248:251], a[168:171], a[156:159]
ds_read_b64_tr_b16 a[240:241], v22 offset:57600
ds_read_b64_tr_b16 a[242:243], v22 offset:59648
v_mfma_f32_16x16x32_bf16 a[156:159], a[252:255], a[176:179], a[156:159]
s_waitcnt lgkmcnt(12)
ds_read_b64_tr_b16 a[244:245], v23 offset:49408
ds_read_b64_tr_b16 a[246:247], v23 offset:51456
v_mfma_f32_16x16x32_bf16 a[144:147], a[208:211], a[184:187], a[144:147]
ds_read_b64_tr_b16 a[248:249], v23 offset:53504
ds_read_b64_tr_b16 a[250:251], v23 offset:55552
v_mfma_f32_16x16x32_bf16 a[144:147], a[212:215], a[192:195], a[144:147]
ds_read_b64_tr_b16 a[252:253], v23 offset:57600
ds_read_b64_tr_b16 a[254:255], v23 offset:59648
v_mfma_f32_16x16x32_bf16 a[144:147], a[216:219], a[200:203], a[144:147]
s_waitcnt lgkmcnt(12)
v_mfma_f32_16x16x32_bf16 a[148:151], a[220:223], a[184:187], a[148:151]
v_mfma_f32_16x16x32_bf16 a[148:151], a[224:227], a[192:195], a[148:151]
v_mfma_f32_16x16x32_bf16 a[148:151], a[228:231], a[200:203], a[148:151]
s_waitcnt lgkmcnt(6)
v_mfma_f32_16x16x32_bf16 a[152:155], a[232:235], a[184:187], a[152:155]
v_mfma_f32_16x16x32_bf16 a[152:155], a[236:239], a[192:195], a[152:155]
v_mfma_f32_16x16x32_bf16 a[152:155], a[240:243], a[200:203], a[152:155]
s_waitcnt lgkmcnt(0)
v_mfma_f32_16x16x32_bf16 a[156:159], a[244:247], a[184:187], a[156:159]
v_mfma_f32_16x16x32_bf16 a[156:159], a[248:251], a[192:195], a[156:159]
v_mfma_f32_16x16x32_bf16 a[156:159], a[252:255], a[200:203], a[156:159]
s_nop 7
v_accvgpr_read_b32 v192, a144
v_accvgpr_read_b32 v193, a145
v_accvgpr_read_b32 v194, a146
v_accvgpr_read_b32 v195, a147
v_accvgpr_read_b32 v196, a148
v_accvgpr_read_b32 v197, a149
v_accvgpr_read_b32 v198, a150
v_accvgpr_read_b32 v199, a151
v_accvgpr_read_b32 v200, a152
v_accvgpr_read_b32 v201, a153
v_accvgpr_read_b32 v202, a154
v_accvgpr_read_b32 v203, a155
v_accvgpr_read_b32 v204, a156
v_accvgpr_read_b32 v205, a157
v_accvgpr_read_b32 v206, a158
v_accvgpr_read_b32 v207, a159
v_cvt_pk_bf16_f32 v232, v192, v193
v_cvt_pk_bf16_f32 v233, v194, v195
v_cvt_pk_bf16_f32 v234, v196, v197
v_cvt_pk_bf16_f32 v235, v198, v199
v_cvt_pk_bf16_f32 v236, v200, v201
v_cvt_pk_bf16_f32 v237, v202, v203
v_cvt_pk_bf16_f32 v238, v204, v205
v_cvt_pk_bf16_f32 v239, v206, v207
s_mov_b32 s94, 16384
buffer_store_dwordx4 v[224:227], v26, s[24:27], s94 offen offset:0 sc1
buffer_store_dwordx4 v[228:231], v26, s[24:27], s94 offen offset:1024 sc1
buffer_store_dwordx4 v[232:235], v26, s[24:27], s94 offen offset:2048 sc1
buffer_store_dwordx4 v[236:239], v26, s[24:27], s94 offen offset:3072 sc1
L_end1:
s_mov_b64 exec, 0xff
L_polla:
buffer_load_dword v87, v86, s[68:71], 0 offen offset:1024 sc1
s_waitcnt vmcnt(0)
v_cmp_ne_u32_e64 s[44:45], v87, v93
s_lshl_b32 s46, 1, s99
s_nop 2
s_or_b32 s44, s44, s46
s_cmp_eq_u32 s44, 0xff
s_cbranch_scc1 L_pda
s_sleep 2
s_branch L_polla
L_pda:
s_mov_b64 exec, -1
L_fin:
s_load_dwordx2 s[4:5], s[0:1], 80
v_mbcnt_lo_u32_b32 v4, -1, 0
v_mbcnt_hi_u32_b32 v4, -1, v4
v_and_b32_e32 v6, 15, v4
v_mul_u32_u24_e32 v6, 2560, v6
v_lshrrev_b32_e32 v7, 4, v4
v_lshl_add_u32 v6, v7, 4, v6
s_and_b32 s54, s98, 15
s_mul_i32 s54, s54, 286720
s_lshr_b32 s55, s98, 4
s_mul_i32 s55, s55, 1280
s_add_u32 s54, s54, s55
s_waitcnt vmcnt(0) lgkmcnt(0)
s_mov_b32 s6, 4587520
s_mov_b32 s7, 0x20000
s_barrier
s_cmp_lg_u32 s3, 3
s_cbranch_scc1 L_go1
v_readlane_b32 s47, v94, s99
s_lshl_b32 s46, s99, 7
s_addk_i32 s46, 2048
s_nop 1
s_add_u32 s47, s47, 1
s_mov_b64 exec, 0xff
v_mov_b32_e32 v100, s47
v_mov_b32_e32 v101, s47
v_mov_b32_e32 v102, s47
v_mov_b32_e32 v103, s47
buffer_store_dwordx4 v[100:103], v76, s[68:71], s46 offen sc1
s_mov_b64 exec, -1
L_go1:
v_lshlrev_b32_e32 v5, 4, v4
s_add_u32 s50, s3, 0
s_lshl_b32 s52, s50, 3
s_add_u32 s52, s52, s99
s_mul_hi_u32 s55, s52, 214748365
s_mul_i32 s56, s55, 20
s_sub_u32 s56, s52, s56
s_add_u32 s56, s56, 0
s_mul_i32 s53, s55, 40
s_add_u32 s53, s53, s56
s_lshl_b32 s53, s53, 10
s_cmp_lt_u32 s52, 60
s_cselect_b32 s53, s53, 0x40000000
buffer_load_dwordx4 v[32:35], v5, s[64:67], s53 offen sc1
s_add_u32 s53, s53, 143360
buffer_load_dwordx4 v[36:39], v5, s[64:67], s53 offen sc1
s_add_u32 s53, s53, 143360
buffer_load_dwordx4 v[40:43], v5, s[64:67], s53 offen sc1
s_add_u32 s53, s53, 143360
buffer_load_dwordx4 v[44:47], v5, s[64:67], s53 offen sc1
s_add_u32 s53, s53, 143360
buffer_load_dwordx4 v[48:51], v5, s[64:67], s53 offen sc1
s_add_u32 s53, s53, 143360
buffer_load_dwordx4 v[52:55], v5, s[64:67], s53 offen sc1
s_add_u32 s53, s53, 143360
buffer_load_dwordx4 v[56:59], v5, s[64:67], s53 offen sc1
s_add_u32 s53, s53, 143360
buffer_load_dwordx4 v[60:63], v5, s[64:67], s53 offen sc1
s_add_u32 s50, s3, 4
s_lshl_b32 s52, s50, 3
s_add_u32 s52, s52, s99
s_mul_hi_u32 s55, s52, 214748365
s_mul_i32 s56, s55, 20
s_sub_u32 s56, s52, s56
s_add_u32 s56, s56, 0
s_mul_i32 s53, s55, 40
s_add_u32 s53, s53, s56
s_lshl_b32 s53, s53, 10
s_cmp_lt_u32 s52, 60
s_cselect_b32 s53, s53, 0x40000000
buffer_load_dwordx4 v[64:67], v5, s[64:67], s53 offen sc1
s_add_u32 s53, s53, 143360
buffer_load_dwordx4 v[68:71], v5, s[64:67], s53 offen sc1
s_add_u32 s53, s53, 143360
buffer_load_dwordx4 v[72:75], v5, s[64:67], s53 offen sc1
s_add_u32 s53, s53, 143360
buffer_load_dwordx4 v[80:83], v5, s[64:67], s53 offen sc1
s_add_u32 s53, s53, 143360
buffer_load_dwordx4 v[88:91], v5, s[64:67], s53 offen sc1
s_add_u32 s53, s53, 143360
buffer_load_dwordx4 v[96:99], v5, s[64:67], s53 offen sc1
s_add_u32 s53, s53, 143360
buffer_load_dwordx4 v[104:107], v5, s[64:67], s53 offen sc1
s_add_u32 s53, s53, 143360
buffer_load_dwordx4 v[108:111], v5, s[64:67], s53 offen sc1
s_lshl_b32 s50, s3, 13
v_add_u32_e32 v7, s50, v5
s_cmp_lg_u32 s3, 3
s_cbranch_scc1 L_go2
s_mov_b64 exec, 0xff
L_pollb:
buffer_load_dword v87, v86, s[68:71], 0 offen offset:2048 sc1
s_waitcnt vmcnt(0)
v_cmp_ne_u32_e64 s[44:45], v87, v94
s_lshl_b32 s46, 1, s99
s_nop 2
s_or_b32 s44, s44, s46
s_cmp_eq_u32 s44, 0xff
s_cbranch_scc1 L_pdb
s_sleep 2
s_branch L_pollb
L_pdb:
s_mov_b64 exec, -1
L_go2:
s_barrier
s_lshl_b32 s52, s99, 2
s_add_u32 s52, s52, s3
s_add_u32 s52, s52, 0
s_mul_hi_u32 s55, s52, 214748365
s_min_u32 s55, s55, 3
s_mul_i32 s56, s55, 20
s_sub_u32 s56, s52, s56
s_cmp_eq_u32 s55, 3
s_cselect_b32 s57, 0, 20
s_add_u32 s56, s56, s57
s_mul_i32 s53, s55, 40
s_add_u32 s53, s53, s56
s_lshl_b32 s53, s53, 10
s_cmp_lt_u32 s52, 80
s_cselect_b32 s53, s53, 0x40000000
buffer_load_dwordx4 v[112:115], v5, s[64:67], s53 offen sc1
s_add_u32 s53, s53, 143360
buffer_load_dwordx4 v[116:119], v5, s[64:67], s53 offen sc1
s_add_u32 s53, s53, 143360
buffer_load_dwordx4 v[120:123], v5, s[64:67], s53 offen sc1
s_add_u32 s53, s53, 143360
buffer_load_dwordx4 v[124:127], v5, s[64:67], s53 offen sc1
s_add_u32 s53, s53, 143360
buffer_load_dwordx4 v[128:131], v5, s[64:67], s53 offen sc1
s_add_u32 s53, s53, 143360
buffer_load_dwordx4 v[132:135], v5, s[64:67], s53 offen sc1
s_add_u32 s53, s53, 143360
buffer_load_dwordx4 v[136:139], v5, s[64:67], s53 offen sc1
s_add_u32 s53, s53, 143360
buffer_load_dwordx4 v[140:143], v5, s[64:67], s53 offen sc1
s_lshl_b32 s52, s99, 2
s_add_u32 s52, s52, s3
s_add_u32 s52, s52, 32
s_mul_hi_u32 s55, s52, 214748365
s_min_u32 s55, s55, 3
s_mul_i32 s56, s55, 20
s_sub_u32 s56, s52, s56
s_cmp_eq_u32 s55, 3
s_cselect_b32 s57, 0, 20
s_add_u32 s56, s56, s57
s_mul_i32 s53, s55, 40
s_add_u32 s53, s53, s56
s_lshl_b32 s53, s53, 10
s_cmp_lt_u32 s52, 80
s_cselect_b32 s53, s53, 0x40000000
buffer_load_dwordx4 v[144:147], v5, s[64:67], s53 offen sc1
s_add_u32 s53, s53, 143360
buffer_load_dwordx4 v[148:151], v5, s[64:67], s53 offen sc1
s_add_u32 s53, s53, 143360
buffer_load_dwordx4 v[152:155], v5, s[64:67], s53 offen sc1
s_add_u32 s53, s53, 143360
buffer_load_dwordx4 v[156:159], v5, s[64:67], s53 offen sc1
s_add_u32 s53, s53, 143360
buffer_load_dwordx4 v[160:163], v5, s[64:67], s53 offen sc1
s_add_u32 s53, s53, 143360
buffer_load_dwordx4 v[164:167], v5, s[64:67], s53 offen sc1
s_add_u32 s53, s53, 143360
buffer_load_dwordx4 v[168:171], v5, s[64:67], s53 offen sc1
s_add_u32 s53, s53, 143360
buffer_load_dwordx4 v[172:175], v5, s[64:67], s53 offen sc1
s_lshl_b32 s52, s99, 2
s_add_u32 s52, s52, s3
s_add_u32 s52, s52, 64
s_mul_hi_u32 s55, s52, 214748365
s_min_u32 s55, s55, 3
s_mul_i32 s56, s55, 20
s_sub_u32 s56, s52, s56
s_cmp_eq_u32 s55, 3
s_cselect_b32 s57, 0, 20
s_add_u32 s56, s56, s57
s_mul_i32 s53, s55, 40
s_add_u32 s53, s53, s56
s_lshl_b32 s53, s53, 10
s_cmp_lt_u32 s52, 80
s_cselect_b32 s53, s53, 0x40000000
buffer_load_dwordx4 v[176:179], v5, s[64:67], s53 offen sc1
s_add_u32 s53, s53, 143360
buffer_load_dwordx4 v[180:183], v5, s[64:67], s53 offen sc1
s_add_u32 s53, s53, 143360
buffer_load_dwordx4 v[184:187], v5, s[64:67], s53 offen sc1
s_add_u32 s53, s53, 143360
buffer_load_dwordx4 v[188:191], v5, s[64:67], s53 offen sc1
s_add_u32 s53, s53, 143360
buffer_load_dwordx4 v[192:195], v5, s[64:67], s53 offen sc1
s_add_u32 s53, s53, 143360
buffer_load_dwordx4 v[196:199], v5, s[64:67], s53 offen sc1
s_add_u32 s53, s53, 143360
buffer_load_dwordx4 v[200:203], v5, s[64:67], s53 offen sc1
s_add_u32 s53, s53, 143360
buffer_load_dwordx4 v[204:207], v5, s[64:67], s53 offen sc1
s_add_u32 s50, s3, 0
s_lshl_b32 s52, s50, 3
s_add_u32 s52, s52, s99
s_mul_hi_u32 s55, s52, 214748365
s_mul_i32 s56, s55, 20
s_sub_u32 s56, s52, s56
s_add_u32 s56, s56, 0
s_mul_i32 s53, s55, 40
s_add_u32 s53, s53, s56
s_lshl_b32 s53, s53, 10
s_cmp_lt_u32 s52, 60
s_cselect_b32 s59, 0, 0x40000000
s_lshr_b32 s57, s56, 1
s_and_b32 s58, s56, 1
s_cmp_eq_u32 s55, 3
s_cselect_b32 s57, s56, s57
s_cselect_b32 s58, 0, s58
s_lshl_b32 s55, s55, 1
s_add_u32 s55, s55, s58
s_mul_i32 s55, s55, 40960
s_lshl_b32 s57, s57, 6
s_add_u32 s55, s55, s57
s_add_u32 s55, s55, s54
s_add_u32 s55, s55, s59
s_waitcnt vmcnt(24)
v_mfma_f32_16x16x32_bf16 v[8:11], v[244:247], v[32:35], 0
v_mfma_f32_16x16x32_bf16 v[12:15], v[248:251], v[32:35], 0
v_mfma_f32_16x16x32_bf16 v[8:11], v[244:247], v[36:39], v[8:11]
v_mfma_f32_16x16x32_bf16 v[12:15], v[248:251], v[36:39], v[12:15]
v_mfma_f32_16x16x32_bf16 v[8:11], v[244:247], v[40:43], v[8:11]
v_mfma_f32_16x16x32_bf16 v[12:15], v[248:251], v[40:43], v[12:15]
v_mfma_f32_16x16x32_bf16 v[8:11], v[244:247], v[44:47], v[8:11]
v_mfma_f32_16x16x32_bf16 v[12:15], v[248:251], v[44:47], v[12:15]
v_mfma_f32_16x16x32_bf16 v[8:11], v[244:247], v[48:51], v[8:11]
v_mfma_f32_16x16x32_bf16 v[12:15], v[248:251], v[48:51], v[12:15]
v_mfma_f32_16x16x32_bf16 v[8:11], v[244:247], v[52:55], v[8:11]
v_mfma_f32_16x16x32_bf16 v[12:15], v[248:251], v[52:55], v[12:15]
v_mfma_f32_16x16x32_bf16 v[8:11], v[244:247], v[56:59], v[8:11]
v_mfma_f32_16x16x32_bf16 v[12:15], v[248:251], v[56:59], v[12:15]
v_mfma_f32_16x16x32_bf16 v[8:11], v[244:247], v[60:63], v[8:11]
v_mfma_f32_16x16x32_bf16 v[12:15], v[248:251], v[60:63], v[12:15]
s_nop 7
v_cvt_pk_bf16_f32 v32, v8, v9
v_cvt_pk_bf16_f32 v33, v10, v11
v_cvt_pk_bf16_f32 v34, v12, v13
v_cvt_pk_bf16_f32 v35, v14, v15
s_nop 1
v_permlane32_swap_b32 v32, v34
v_permlane32_swap_b32 v33, v35
s_nop 1
v_permlane16_swap_b32 v32, v34
v_permlane16_swap_b32 v33, v35
s_nop 1
s_mov_b32 s24, s55
s_add_u32 s50, s3, 4
s_lshl_b32 s52, s50, 3
s_add_u32 s52, s52, s99
s_mul_hi_u32 s55, s52, 214748365
s_mul_i32 s56, s55, 20
s_sub_u32 s56, s52, s56
s_add_u32 s56, s56, 0
s_mul_i32 s53, s55, 40
s_add_u32 s53, s53, s56
s_lshl_b32 s53, s53, 10
s_cmp_lt_u32 s52, 60
s_cselect_b32 s59, 0, 0x40000000
s_lshr_b32 s57, s56, 1
s_and_b32 s58, s56, 1
s_cmp_eq_u32 s55, 3
s_cselect_b32 s57, s56, s57
s_cselect_b32 s58, 0, s58
s_lshl_b32 s55, s55, 1
s_add_u32 s55, s55, s58
s_mul_i32 s55, s55, 40960
s_lshl_b32 s57, s57, 6
s_add_u32 s55, s55, s57
s_add_u32 s55, s55, s54
s_add_u32 s55, s55, s59
v_mfma_f32_16x16x32_bf16 v[8:11], v[244:247], v[64:67], 0
v_mfma_f32_16x16x32_bf16 v[12:15], v[248:251], v[64:67], 0
v_mfma_f32_16x16x32_bf16 v[8:11], v[244:247], v[68:71], v[8:11]
v_mfma_f32_16x16x32_bf16 v[12:15], v[248:251], v[68:71], v[12:15]
v_mfma_f32_16x16x32_bf16 v[8:11], v[244:247], v[72:75], v[8:11]
v_mfma_f32_16x16x32_bf16 v[12:15], v[248:251], v[72:75], v[12:15]
v_mfma_f32_16x16x32_bf16 v[8:11], v[244:247], v[80:83], v[8:11]
v_mfma_f32_16x16x32_bf16 v[12:15], v[248:251], v[80:83], v[12:15]
v_mfma_f32_16x16x32_bf16 v[8:11], v[244:247], v[88:91], v[8:11]
v_mfma_f32_16x16x32_bf16 v[12:15], v[248:251], v[88:91], v[12:15]
v_mfma_f32_16x16x32_bf16 v[8:11], v[244:247], v[96:99], v[8:11]
v_mfma_f32_16x16x32_bf16 v[12:15], v[248:251], v[96:99], v[12:15]
v_mfma_f32_16x16x32_bf16 v[8:11], v[244:247], v[104:107], v[8:11]
v_mfma_f32_16x16x32_bf16 v[12:15], v[248:251], v[104:107], v[12:15]
v_mfma_f32_16x16x32_bf16 v[8:11], v[244:247], v[108:111], v[8:11]
v_mfma_f32_16x16x32_bf16 v[12:15], v[248:251], v[108:111], v[12:15]
s_nop 7
v_cvt_pk_bf16_f32 v64, v8, v9
v_cvt_pk_bf16_f32 v65, v10, v11
v_cvt_pk_bf16_f32 v66, v12, v13
v_cvt_pk_bf16_f32 v67, v14, v15
s_nop 1
v_permlane32_swap_b32 v64, v66
v_permlane32_swap_b32 v65, v67
s_nop 1
v_permlane16_swap_b32 v64, v66
v_permlane16_swap_b32 v65, v67
s_nop 1
s_mov_b32 s25, s55
s_lshl_b32 s52, s99, 2
s_add_u32 s52, s52, s3
s_add_u32 s52, s52, 0
s_mul_hi_u32 s55, s52, 214748365
s_min_u32 s55, s55, 3
s_mul_i32 s56, s55, 20
s_sub_u32 s56, s52, s56
s_cmp_eq_u32 s55, 3
s_cselect_b32 s57, 0, 20
s_add_u32 s56, s56, s57
s_mul_i32 s53, s55, 40
s_add_u32 s53, s53, s56
s_lshl_b32 s53, s53, 10
s_cmp_lt_u32 s52, 80
s_cselect_b32 s59, 0, 0x40000000
s_lshr_b32 s57, s56, 1
s_and_b32 s58, s56, 1
s_cmp_eq_u32 s55, 3
s_cselect_b32 s57, s56, s57
s_cselect_b32 s58, 0, s58
s_lshl_b32 s55, s55, 1
s_add_u32 s55, s55, s58
s_mul_i32 s55, s55, 40960
s_lshl_b32 s57, s57, 6
s_add_u32 s55, s55, s57
s_add_u32 s55, s55, s54
s_add_u32 s55, s55, s59
s_waitcnt vmcnt(23)
v_mfma_f32_16x16x32_bf16 v[8:11], v[244:247], v[112:115], 0
v_mfma_f32_16x16x32_bf16 v[12:15], v[248:251], v[112:115], 0
s_waitcnt vmcnt(22)
v_mfma_f32_16x16x32_bf16 v[8:11], v[244:247], v[116:119], v[8:11]
v_mfma_f32_16x16x32_bf16 v[12:15], v[248:251], v[116:119], v[12:15]
s_waitcnt vmcnt(21)
v_mfma_f32_16x16x32_bf16 v[8:11], v[244:247], v[120:123], v[8:11]
v_mfma_f32_16x16x32_bf16 v[12:15], v[248:251], v[120:123], v[12:15]
s_waitcnt vmcnt(20)
v_mfma_f32_16x16x32_bf16 v[8:11], v[244:247], v[124:127], v[8:11]
v_mfma_f32_16x16x32_bf16 v[12:15], v[248:251], v[124:127], v[12:15]
s_waitcnt vmcnt(19)
v_mfma_f32_16x16x32_bf16 v[8:11], v[244:247], v[128:131], v[8:11]
v_mfma_f32_16x16x32_bf16 v[12:15], v[248:251], v[128:131], v[12:15]
s_waitcnt vmcnt(18)
v_mfma_f32_16x16x32_bf16 v[8:11], v[244:247], v[132:135], v[8:11]
v_mfma_f32_16x16x32_bf16 v[12:15], v[248:251], v[132:135], v[12:15]
s_waitcnt vmcnt(17)
v_mfma_f32_16x16x32_bf16 v[8:11], v[244:247], v[136:139], v[8:11]
v_mfma_f32_16x16x32_bf16 v[12:15], v[248:251], v[136:139], v[12:15]
s_waitcnt vmcnt(16)
v_mfma_f32_16x16x32_bf16 v[8:11], v[244:247], v[140:143], v[8:11]
v_mfma_f32_16x16x32_bf16 v[12:15], v[248:251], v[140:143], v[12:15]
s_nop 7
v_cvt_pk_bf16_f32 v112, v8, v9
v_cvt_pk_bf16_f32 v113, v10, v11
v_cvt_pk_bf16_f32 v114, v12, v13
v_cvt_pk_bf16_f32 v115, v14, v15
s_nop 1
v_permlane32_swap_b32 v112, v114
v_permlane32_swap_b32 v113, v115
s_nop 1
v_permlane16_swap_b32 v112, v114
v_permlane16_swap_b32 v113, v115
s_nop 1
s_mov_b32 s20, s55
s_lshl_b32 s52, s99, 2
s_add_u32 s52, s52, s3
s_add_u32 s52, s52, 32
s_mul_hi_u32 s55, s52, 214748365
s_min_u32 s55, s55, 3
s_mul_i32 s56, s55, 20
s_sub_u32 s56, s52, s56
s_cmp_eq_u32 s55, 3
s_cselect_b32 s57, 0, 20
s_add_u32 s56, s56, s57
s_mul_i32 s53, s55, 40
s_add_u32 s53, s53, s56
s_lshl_b32 s53, s53, 10
s_cmp_lt_u32 s52, 80
s_cselect_b32 s59, 0, 0x40000000
s_lshr_b32 s57, s56, 1
s_and_b32 s58, s56, 1
s_cmp_eq_u32 s55, 3
s_cselect_b32 s57, s56, s57
s_cselect_b32 s58, 0, s58
s_lshl_b32 s55, s55, 1
s_add_u32 s55, s55, s58
s_mul_i32 s55, s55, 40960
s_lshl_b32 s57, s57, 6
s_add_u32 s55, s55, s57
s_add_u32 s55, s55, s54
s_add_u32 s55, s55, s59
s_waitcnt vmcnt(15)
v_mfma_f32_16x16x32_bf16 v[8:11], v[244:247], v[144:147], 0
v_mfma_f32_16x16x32_bf16 v[12:15], v[248:251], v[144:147], 0
s_waitcnt vmcnt(14)
v_mfma_f32_16x16x32_bf16 v[8:11], v[244:247], v[148:151], v[8:11]
v_mfma_f32_16x16x32_bf16 v[12:15], v[248:251], v[148:151], v[12:15]
s_waitcnt vmcnt(13)
v_mfma_f32_16x16x32_bf16 v[8:11], v[244:247], v[152:155], v[8:11]
v_mfma_f32_16x16x32_bf16 v[12:15], v[248:251], v[152:155], v[12:15]
s_waitcnt vmcnt(12)
v_mfma_f32_16x16x32_bf16 v[8:11], v[244:247], v[156:159], v[8:11]
v_mfma_f32_16x16x32_bf16 v[12:15], v[248:251], v[156:159], v[12:15]
s_waitcnt vmcnt(11)
v_mfma_f32_16x16x32_bf16 v[8:11], v[244:247], v[160:163], v[8:11]
v_mfma_f32_16x16x32_bf16 v[12:15], v[248:251], v[160:163], v[12:15]
s_waitcnt vmcnt(10)
v_mfma_f32_16x16x32_bf16 v[8:11], v[244:247], v[164:167], v[8:11]
v_mfma_f32_16x16x32_bf16 v[12:15], v[248:251], v[164:167], v[12:15]
s_waitcnt vmcnt(9)
v_mfma_f32_16x16x32_bf16 v[8:11], v[244:247], v[168:171], v[8:11]
v_mfma_f32_16x16x32_bf16 v[12:15], v[248:251], v[168:171], v[12:15]
s_waitcnt vmcnt(8)
v_mfma_f32_16x16x32_bf16 v[8:11], v[244:247], v[172:175], v[8:11]
v_mfma_f32_16x16x32_bf16 v[12:15], v[248:251], v[172:175], v[12:15]
s_nop 7
v_cvt_pk_bf16_f32 v144, v8, v9
v_cvt_pk_bf16_f32 v145, v10, v11
v_cvt_pk_bf16_f32 v146, v12, v13
v_cvt_pk_bf16_f32 v147, v14, v15
s_nop 1
v_permlane32_swap_b32 v144, v146
v_permlane32_swap_b32 v145, v147
s_nop 1
v_permlane16_swap_b32 v144, v146
v_permlane16_swap_b32 v145, v147
s_nop 1
s_mov_b32 s21, s55
s_lshl_b32 s52, s99, 2
s_add_u32 s52, s52, s3
s_add_u32 s52, s52, 64
s_mul_hi_u32 s55, s52, 214748365
s_min_u32 s55, s55, 3
s_mul_i32 s56, s55, 20
s_sub_u32 s56, s52, s56
s_cmp_eq_u32 s55, 3
s_cselect_b32 s57, 0, 20
s_add_u32 s56, s56, s57
s_mul_i32 s53, s55, 40
s_add_u32 s53, s53, s56
s_lshl_b32 s53, s53, 10
s_cmp_lt_u32 s52, 80
s_cselect_b32 s59, 0, 0x40000000
s_lshr_b32 s57, s56, 1
s_and_b32 s58, s56, 1
s_cmp_eq_u32 s55, 3
s_cselect_b32 s57, s56, s57
s_cselect_b32 s58, 0, s58
s_lshl_b32 s55, s55, 1
s_add_u32 s55, s55, s58
s_mul_i32 s55, s55, 40960
s_lshl_b32 s57, s57, 6
s_add_u32 s55, s55, s57
s_add_u32 s55, s55, s54
s_add_u32 s55, s55, s59
s_waitcnt vmcnt(7)
v_mfma_f32_16x16x32_bf16 v[8:11], v[244:247], v[176:179], 0
v_mfma_f32_16x16x32_bf16 v[12:15], v[248:251], v[176:179], 0
s_waitcnt vmcnt(6)
v_mfma_f32_16x16x32_bf16 v[8:11], v[244:247], v[180:183], v[8:11]
v_mfma_f32_16x16x32_bf16 v[12:15], v[248:251], v[180:183], v[12:15]
s_waitcnt vmcnt(5)
v_mfma_f32_16x16x32_bf16 v[8:11], v[244:247], v[184:187], v[8:11]
v_mfma_f32_16x16x32_bf16 v[12:15], v[248:251], v[184:187], v[12:15]
s_waitcnt vmcnt(4)
v_mfma_f32_16x16x32_bf16 v[8:11], v[244:247], v[188:191], v[8:11]
v_mfma_f32_16x16x32_bf16 v[12:15], v[248:251], v[188:191], v[12:15]
s_waitcnt vmcnt(3)
v_mfma_f32_16x16x32_bf16 v[8:11], v[244:247], v[192:195], v[8:11]
v_mfma_f32_16x16x32_bf16 v[12:15], v[248:251], v[192:195], v[12:15]
s_waitcnt vmcnt(2)
v_mfma_f32_16x16x32_bf16 v[8:11], v[244:247], v[196:199], v[8:11]
v_mfma_f32_16x16x32_bf16 v[12:15], v[248:251], v[196:199], v[12:15]
s_waitcnt vmcnt(1)
v_mfma_f32_16x16x32_bf16 v[8:11], v[244:247], v[200:203], v[8:11]
v_mfma_f32_16x16x32_bf16 v[12:15], v[248:251], v[200:203], v[12:15]
s_waitcnt vmcnt(0)
v_mfma_f32_16x16x32_bf16 v[8:11], v[244:247], v[204:207], v[8:11]
v_mfma_f32_16x16x32_bf16 v[12:15], v[248:251], v[204:207], v[12:15]
s_nop 7
v_cvt_pk_bf16_f32 v176, v8, v9
v_cvt_pk_bf16_f32 v177, v10, v11
v_cvt_pk_bf16_f32 v178, v12, v13
v_cvt_pk_bf16_f32 v179, v14, v15
s_nop 1
v_permlane32_swap_b32 v176, v178
v_permlane32_swap_b32 v177, v179
s_nop 1
v_permlane16_swap_b32 v176, v178
v_permlane16_swap_b32 v177, v179
s_nop 1
s_mov_b32 s22, s55
buffer_store_dwordx4 v[32:35], v6, s[4:7], s24 offen
buffer_store_dwordx4 v[64:67], v6, s[4:7], s25 offen
buffer_store_dwordx4 v[112:115], v6, s[4:7], s20 offen
buffer_store_dwordx4 v[144:147], v6, s[4:7], s21 offen
buffer_store_dwordx4 v[176:179], v6, s[4:7], s22 offen
s_endpgm
L_AF:
s_waitcnt lgkmcnt(6)
v_mfma_f32_16x16x32_bf16 v[144:147], a[208:211], v[192:195], v[136:139]
ds_read_b128 a[244:247], v7 offset:6272
ds_read_b128 a[248:251], v6 offset:6400
v_exp_f32_e32 v154, v154
v_exp_f32_e32 v155, v155
v_add_f32_e32 v128, v128, v152
v_add_f32_e32 v129, v129, v153
v_add_f32_e32 v130, v130, v154
v_mfma_f32_16x16x32_bf16 v[144:147], a[212:215], v[200:203], v[144:147]
ds_read_b128 a[252:255], v7 offset:6400
v_add_f32_e32 v131, v131, v155
v_cvt_pk_bf16_f32 v171, v154, v155
v_mfma_f32_16x16x32_bf16 v[144:147], a[216:219], v[208:211], v[144:147]
s_waitcnt lgkmcnt(6)
v_mfma_f32_16x16x32_bf16 v[144:147], a[220:223], v[216:219], v[144:147]
s_waitcnt vmcnt(63)
s_barrier
s_movk_i32 m0, 12352
s_addk_i32 s33, 4096
buffer_load_dwordx4 v46, s[12:15], s33 offen nt lds
ds_read_b64_tr_b16 a[208:209], v8 offset:37056
ds_read_b64_tr_b16 a[210:211], v8 offset:43200
ds_read_b64_tr_b16 a[212:213], v9 offset:37056
v_mfma_f32_16x16x32_bf16 v[144:147], a[224:227], v[224:227], v[144:147]
ds_read_b64_tr_b16 a[214:215], v9 offset:43200
ds_read_b64_tr_b16 a[216:217], v10 offset:37056
ds_read_b64_tr_b16 a[218:219], v10 offset:43200
buffer_load_dwordx4 v47, s[12:15], s33 offen offset:1024 nt lds
v_mfma_f32_16x16x32_bf16 v[144:147], a[228:231], v[232:235], v[144:147]
s_waitcnt lgkmcnt(9)
ds_read_b64_tr_b16 a[220:221], v11 offset:37056
ds_read_b64_tr_b16 a[222:223], v11 offset:43200
buffer_load_dwordx4 v52, s[12:15], s33 offen offset:2048 nt lds
v_mfma_f32_16x16x32_bf16 v[152:155], a[232:235], v[192:195], v[136:139]
ds_read_b64_tr_b16 a[224:225], v8 offset:37184
ds_read_b64_tr_b16 a[226:227], v8 offset:43328
v_mfma_f32_16x16x32_bf16 v[152:155], a[236:239], v[200:203], v[152:155]
ds_read_b64_tr_b16 a[228:229], v9 offset:37184
v_exp_f32_e32 v144, v144
v_exp_f32_e32 v145, v145
v_exp_f32_e32 v146, v146
v_exp_f32_e32 v147, v147
v_mfma_f32_16x16x32_bf16 v[152:155], a[240:243], v[208:211], v[152:155]
s_waitcnt lgkmcnt(11)
ds_read_b64_tr_b16 a[230:231], v9 offset:43328
ds_read_b64_tr_b16 a[232:233], v10 offset:37184
ds_read_b64_tr_b16 a[234:235], v10 offset:43328
buffer_load_dwordx4 v46, s[12:15], s33 offen offset:3072 nt lds
v_add_f32_e32 v128, v128, v144
v_add_f32_e32 v129, v129, v145
v_add_f32_e32 v130, v130, v146
v_mfma_f32_16x16x32_bf16 v[152:155], a[244:247], v[216:219], v[152:155]
ds_read_b64_tr_b16 a[236:237], v11 offset:37184
ds_read_b64_tr_b16 a[238:239], v11 offset:43328
v_add_f32_e32 v131, v131, v147
v_cvt_pk_bf16_f32 v160, v144, v145
v_cvt_pk_bf16_f32 v161, v146, v147
v_mfma_f32_16x16x32_bf16 v[152:155], a[248:251], v[224:227], v[152:155]
ds_read_b64_tr_b16 a[240:241], v8 offset:37312
ds_read_b64_tr_b16 a[242:243], v8 offset:43456
v_mfma_f32_16x16x32_bf16 v[152:155], a[252:255], v[232:235], v[152:155]
s_waitcnt lgkmcnt(12)
ds_read_b64_tr_b16 a[244:245], v9 offset:37312
ds_read_b64_tr_b16 a[246:247], v9 offset:43456
v_mfma_f32_16x16x32_bf16 v[32:35], a[208:211], v[168:171], v[32:35]
ds_read_b64_tr_b16 a[248:249], v10 offset:37312
ds_read_b64_tr_b16 a[250:251], v10 offset:43456
v_mfma_f32_16x16x32_bf16 v[40:43], a[212:215], v[168:171], v[40:43]
ds_read_b64_tr_b16 a[252:253], v11 offset:37312
ds_read_b64_tr_b16 a[254:255], v11 offset:43456
v_exp_f32_e32 v152, v152
v_exp_f32_e32 v153, v153
v_mfma_f32_16x16x32_bf16 v[48:51], a[216:219], v[168:171], v[48:51]
s_waitcnt lgkmcnt(12)
v_cvt_pk_bf16_f32 v162, v152, v153
v_mfma_f32_16x16x32_bf16 v[56:59], a[220:223], v[168:171], v[56:59]
s_waitcnt vmcnt(36)
s_barrier
s_movk_i32 m0, 16448
s_addk_i32 s33, 4096
buffer_load_dwordx4 v47, s[12:15], s33 offen nt lds
ds_read_b128 a[208:211], v6 offset:24704
ds_read_b128 a[212:215], v7 offset:24704
v_mfma_f32_16x16x32_bf16 v[64:67], a[224:227], v[168:171], v[64:67]
ds_read_b128 a[216:219], v6 offset:24832
buffer_load_dwordx4 v52, s[12:15], s33 offen offset:1024 nt lds
v_mfma_f32_16x16x32_bf16 v[72:75], a[228:231], v[168:171], v[72:75]
s_waitcnt lgkmcnt(9)
ds_read_b128 a[220:223], v7 offset:24832
buffer_load_dwordx4 v46, s[12:15], s33 offen offset:2048 nt lds
v_mfma_f32_16x16x32_bf16 v[80:83], a[232:235], v[168:171], v[80:83]
ds_read_b128 a[224:227], v6 offset:24960
v_mfma_f32_16x16x32_bf16 v[88:91], a[236:239], v[168:171], v[88:91]
ds_read_b128 a[228:231], v7 offset:24960
buffer_load_dwordx4 v47, s[12:15], s33 offen offset:3072 nt lds
v_mfma_f32_16x16x32_bf16 v[96:99], a[240:243], v[168:171], v[96:99]
s_waitcnt lgkmcnt(6)
s_movk_i32 m0, 20544
s_addk_i32 s33, 4096
buffer_load_dwordx4 v52, s[12:15], s33 offen nt lds
ds_read_b128 a[232:235], v6 offset:30848
v_mfma_f32_16x16x32_bf16 v[104:107], a[244:247], v[168:171], v[104:107]
ds_read_b128 a[236:239], v7 offset:30848
buffer_load_dwordx4 v46, s[12:15], s33 offen offset:1024 nt lds
v_mfma_f32_16x16x32_bf16 v[112:115], a[248:251], v[168:171], v[112:115]
ds_read_b128 a[240:243], v6 offset:30976
v_mfma_f32_16x16x32_bf16 v[120:123], a[252:255], v[168:171], v[120:123]
s_waitcnt lgkmcnt(6)
ds_read_b128 a[244:247], v7 offset:30976
buffer_load_dwordx4 v47, s[12:15], s33 offen offset:2048 nt lds
v_mfma_f32_16x16x32_bf16 v[144:147], a[208:211], v[192:195], v[136:139]
ds_read_b128 a[248:251], v6 offset:31104
buffer_load_dwordx4 v52, s[12:15], s33 offen offset:3072 nt lds
v_exp_f32_e32 v154, v154
v_exp_f32_e32 v155, v155
v_add_f32_e32 v128, v128, v152
v_mfma_f32_16x16x32_bf16 v[144:147], a[212:215], v[200:203], v[144:147]
ds_read_b128 a[252:255], v7 offset:31104
v_add_f32_e32 v129, v129, v153
v_add_f32_e32 v130, v130, v154
v_add_f32_e32 v131, v131, v155
v_cvt_pk_bf16_f32 v163, v154, v155
v_mfma_f32_16x16x32_bf16 v[144:147], a[216:219], v[208:211], v[144:147]
s_waitcnt lgkmcnt(6)
v_mfma_f32_16x16x32_bf16 v[144:147], a[220:223], v[216:219], v[144:147]
s_waitcnt vmcnt(63)
s_barrier
s_addk_i32 m0, 28864
s_addk_i32 s32, 4096
buffer_load_dwordx4 v36, s[8:11], s32 offen nt lds
ds_read_b64_tr_b16 a[208:209], v12 offset:12352
ds_read_b64_tr_b16 a[210:211], v12 offset:18496
ds_read_b64_tr_b16 a[212:213], v13 offset:12352
v_mfma_f32_16x16x32_bf16 v[144:147], a[224:227], v[224:227], v[144:147]
ds_read_b64_tr_b16 a[214:215], v13 offset:18496
ds_read_b64_tr_b16 a[216:217], v14 offset:12352
ds_read_b64_tr_b16 a[218:219], v14 offset:18496
buffer_load_dwordx4 v37, s[8:11], s32 offen offset:1024 nt lds
buffer_load_dwordx4 v38, s[8:11], s32 offen offset:2048 nt lds
v_mfma_f32_16x16x32_bf16 v[144:147], a[228:231], v[232:235], v[144:147]
s_waitcnt lgkmcnt(9)
ds_read_b64_tr_b16 a[220:221], v15 offset:12352
ds_read_b64_tr_b16 a[222:223], v15 offset:18496
buffer_load_dwordx4 v39, s[8:11], s32 offen offset:3072 nt lds
v_mfma_f32_16x16x32_bf16 v[152:155], a[232:235], v[192:195], v[136:139]
s_addk_i32 m0, 4096
s_addk_i32 s32, 4096
buffer_load_dwordx4 v44, s[8:11], s32 offen nt lds
ds_read_b64_tr_b16 a[224:225], v12 offset:12480
v_exp_f32_e32 v144, v144
v_exp_f32_e32 v145, v145
v_mfma_f32_16x16x32_bf16 v[152:155], a[236:239], v[200:203], v[152:155]
ds_read_b64_tr_b16 a[226:227], v12 offset:18624
ds_read_b64_tr_b16 a[228:229], v13 offset:12480
ds_read_b64_tr_b16 a[230:231], v13 offset:18624
v_exp_f32_e32 v146, v146
v_exp_f32_e32 v147, v147
v_add_f32_e32 v128, v128, v144
v_add_f32_e32 v129, v129, v145
v_mfma_f32_16x16x32_bf16 v[152:155], a[240:243], v[208:211], v[152:155]
s_waitcnt lgkmcnt(12)
ds_read_b64_tr_b16 a[232:233], v14 offset:12480
ds_read_b64_tr_b16 a[234:235], v14 offset:18624
buffer_load_dwordx4 v45, s[8:11], s32 offen offset:1024 nt lds
buffer_load_dwordx4 v36, s[8:11], s32 offen offset:2048 nt lds
v_add_f32_e32 v130, v130, v146
v_add_f32_e32 v131, v131, v147
v_mfma_f32_16x16x32_bf16 v[152:155], a[244:247], v[216:219], v[152:155]
ds_read_b64_tr_b16 a[236:237], v15 offset:12480
ds_read_b64_tr_b16 a[238:239], v15 offset:18624
buffer_load_dwordx4 v37, s[8:11], s32 offen offset:3072 nt lds
v_cvt_pk_bf16_f32 v168, v144, v145
v_cvt_pk_bf16_f32 v169, v146, v147
v_mfma_f32_16x16x32_bf16 v[152:155], a[248:251], v[224:227], v[152:155]
s_addk_i32 m0, 4096
s_addk_i32 s32, 4096
buffer_load_dwordx4 v38, s[8:11], s32 offen nt lds
ds_read_b64_tr_b16 a[240:241], v12 offset:12608
ds_read_b64_tr_b16 a[242:243], v12 offset:18752
buffer_load_dwordx4 v39, s[8:11], s32 offen offset:1024 nt lds
v_mfma_f32_16x16x32_bf16 v[152:155], a[252:255], v[232:235], v[152:155]
s_waitcnt lgkmcnt(12)
ds_read_b64_tr_b16 a[244:245], v13 offset:12608
ds_read_b64_tr_b16 a[246:247], v13 offset:18752
buffer_load_dwordx4 v44, s[8:11], s32 offen offset:2048 nt lds
buffer_load_dwordx4 v45, s[8:11], s32 offen offset:3072 nt lds
v_mfma_f32_16x16x32_bf16 v[32:35], a[208:211], v[160:163], v[32:35]
s_addk_i32 m0, -20544
s_addk_i32 s33, 4096
buffer_load_dwordx4 v46, s[12:15], s33 offen nt lds
ds_read_b64_tr_b16 a[248:249], v14 offset:12608
v_exp_f32_e32 v152, v152
v_exp_f32_e32 v153, v153
v_mfma_f32_16x16x32_bf16 v[40:43], a[212:215], v[160:163], v[40:43]
ds_read_b64_tr_b16 a[250:251], v14 offset:18752
ds_read_b64_tr_b16 a[252:253], v15 offset:12608
ds_read_b64_tr_b16 a[254:255], v15 offset:18752
buffer_load_dwordx4 v47, s[12:15], s33 offen offset:1024 nt lds
buffer_load_dwordx4 v52, s[12:15], s33 offen offset:2048 nt lds
v_cvt_pk_bf16_f32 v170, v152, v153
v_mfma_f32_16x16x32_bf16 v[48:51], a[216:219], v[160:163], v[48:51]
s_waitcnt lgkmcnt(12)
buffer_load_dwordx4 v46, s[12:15], s33 offen offset:3072 nt lds
s_addk_i32 m0, 4096
s_addk_i32 s33, 4096
buffer_load_dwordx4 v47, s[12:15], s33 offen nt lds
buffer_load_dwordx4 v52, s[12:15], s33 offen offset:1024 nt lds
buffer_load_dwordx4 v46, s[12:15], s33 offen offset:2048 nt lds
buffer_load_dwordx4 v47, s[12:15], s33 offen offset:3072 nt lds
s_addk_i32 m0, 4096
s_addk_i32 s33, 4096
buffer_load_dwordx4 v52, s[12:15], s33 offen nt lds
buffer_load_dwordx4 v46, s[12:15], s33 offen offset:1024 nt lds
buffer_load_dwordx4 v47, s[12:15], s33 offen offset:2048 nt lds
buffer_load_dwordx4 v52, s[12:15], s33 offen offset:3072 nt lds
v_mfma_f32_16x16x32_bf16 v[56:59], a[220:223], v[160:163], v[56:59]
s_waitcnt vmcnt(56)
s_barrier
s_addk_i32 m0, 28864
s_addk_i32 s32, 4096
buffer_load_dwordx4 v36, s[8:11], s32 offen nt lds
ds_read_b128 a[208:211], v4 offset:0
ds_read_b128 a[212:215], v5 offset:0
v_mfma_f32_16x16x32_bf16 v[64:67], a[224:227], v[160:163], v[64:67]
ds_read_b128 a[216:219], v4 offset:128
buffer_load_dwordx4 v37, s[8:11], s32 offen offset:1024 nt lds
v_mfma_f32_16x16x32_bf16 v[72:75], a[228:231], v[160:163], v[72:75]
s_waitcnt lgkmcnt(9)
ds_read_b128 a[220:223], v5 offset:128
buffer_load_dwordx4 v38, s[8:11], s32 offen offset:2048 nt lds
v_mfma_f32_16x16x32_bf16 v[80:83], a[232:235], v[160:163], v[80:83]
ds_read_b128 a[224:227], v4 offset:256
v_mfma_f32_16x16x32_bf16 v[88:91], a[236:239], v[160:163], v[88:91]
ds_read_b128 a[228:231], v5 offset:256
buffer_load_dwordx4 v39, s[8:11], s32 offen offset:3072 nt lds
v_mfma_f32_16x16x32_bf16 v[96:99], a[240:243], v[160:163], v[96:99]
s_waitcnt lgkmcnt(6)
ds_read_b128 a[232:235], v4 offset:6144
v_mfma_f32_16x16x32_bf16 v[104:107], a[244:247], v[160:163], v[104:107]
ds_read_b128 a[236:239], v5 offset:6144
v_mfma_f32_16x16x32_bf16 v[112:115], a[248:251], v[160:163], v[112:115]
ds_read_b128 a[240:243], v4 offset:6272
v_mfma_f32_16x16x32_bf16 v[120:123], a[252:255], v[160:163], v[120:123]
s_waitcnt lgkmcnt(6)
ds_read_b128 a[244:247], v5 offset:6272
v_mfma_f32_16x16x32_bf16 v[144:147], a[208:211], v[192:195], v[136:139]
ds_read_b128 a[248:251], v4 offset:6400
v_exp_f32_e32 v154, v154
v_exp_f32_e32 v155, v155
v_add_f32_e32 v128, v128, v152
v_add_f32_e32 v129, v129, v153
v_add_f32_e32 v130, v130, v154
v_add_f32_e32 v131, v131, v155
v_mfma_f32_16x16x32_bf16 v[144:147], a[212:215], v[200:203], v[144:147]
ds_read_b128 a[252:255], v5 offset:6400
v_cvt_pk_bf16_f32 v171, v154, v155
v_mfma_f32_16x16x32_bf16 v[144:147], a[216:219], v[208:211], v[144:147]
s_waitcnt lgkmcnt(6)
v_mfma_f32_16x16x32_bf16 v[144:147], a[220:223], v[216:219], v[144:147]
s_waitcnt vmcnt(52)
s_barrier
s_addk_i32 m0, 4096
s_addk_i32 s32, 4096
buffer_load_dwordx4 v44, s[8:11], s32 offen nt lds
ds_read_b64_tr_b16 a[208:209], v12 offset:37056
ds_read_b64_tr_b16 a[210:211], v12 offset:43200
ds_read_b64_tr_b16 a[212:213], v13 offset:37056
v_mfma_f32_16x16x32_bf16 v[144:147], a[224:227], v[224:227], v[144:147]
ds_read_b64_tr_b16 a[214:215], v13 offset:43200
ds_read_b64_tr_b16 a[216:217], v14 offset:37056
ds_read_b64_tr_b16 a[218:219], v14 offset:43200
buffer_load_dwordx4 v45, s[8:11], s32 offen offset:1024 nt lds
v_mfma_f32_16x16x32_bf16 v[144:147], a[228:231], v[232:235], v[144:147]
s_waitcnt lgkmcnt(9)
ds_read_b64_tr_b16 a[220:221], v15 offset:37056
ds_read_b64_tr_b16 a[222:223], v15 offset:43200
buffer_load_dwordx4 v36, s[8:11], s32 offen offset:2048 nt lds
v_mfma_f32_16x16x32_bf16 v[152:155], a[232:235], v[192:195], v[136:139]
ds_read_b64_tr_b16 a[224:225], v12 offset:37184
ds_read_b64_tr_b16 a[226:227], v12 offset:43328
v_mfma_f32_16x16x32_bf16 v[152:155], a[236:239], v[200:203], v[152:155]
ds_read_b64_tr_b16 a[228:229], v13 offset:37184
v_exp_f32_e32 v144, v144
v_exp_f32_e32 v145, v145
v_exp_f32_e32 v146, v146
v_exp_f32_e32 v147, v147
v_mfma_f32_16x16x32_bf16 v[152:155], a[240:243], v[208:211], v[152:155]
s_waitcnt lgkmcnt(11)
ds_read_b64_tr_b16 a[230:231], v13 offset:43328
ds_read_b64_tr_b16 a[232:233], v14 offset:37184
ds_read_b64_tr_b16 a[234:235], v14 offset:43328
buffer_load_dwordx4 v37, s[8:11], s32 offen offset:3072 nt lds
v_add_f32_e32 v128, v128, v144
v_add_f32_e32 v129, v129, v145
v_add_f32_e32 v130, v130, v146
v_mfma_f32_16x16x32_bf16 v[152:155], a[244:247], v[216:219], v[152:155]
s_addk_i32 m0, -16448
s_addk_i32 s33, 4096
buffer_load_dwordx4 v46, s[12:15], s33 offen nt lds
ds_read_b64_tr_b16 a[236:237], v15 offset:37184
ds_read_b64_tr_b16 a[238:239], v15 offset:43328
buffer_load_dwordx4 v47, s[12:15], s33 offen offset:1024 nt lds
v_add_f32_e32 v131, v131, v147
v_mfma_f32_16x16x32_bf16 v[152:155], a[248:251], v[224:227], v[152:155]
ds_read_b64_tr_b16 a[240:241], v12 offset:37312
ds_read_b64_tr_b16 a[242:243], v12 offset:43456
v_cvt_pk_bf16_f32 v160, v144, v145
v_cvt_pk_bf16_f32 v161, v146, v147
v_mfma_f32_16x16x32_bf16 v[152:155], a[252:255], v[232:235], v[152:155]
s_waitcnt lgkmcnt(12)
ds_read_b64_tr_b16 a[244:245], v13 offset:37312
ds_read_b64_tr_b16 a[246:247], v13 offset:43456
buffer_load_dwordx4 v52, s[12:15], s33 offen offset:2048 nt lds
v_mfma_f32_16x16x32_bf16 v[32:35], a[208:211], v[168:171], v[32:35]
ds_read_b64_tr_b16 a[248:249], v14 offset:37312
ds_read_b64_tr_b16 a[250:251], v14 offset:43456
buffer_load_dwordx4 v46, s[12:15], s33 offen offset:3072 nt lds
v_exp_f32_e32 v152, v152
v_exp_f32_e32 v153, v153
v_mfma_f32_16x16x32_bf16 v[40:43], a[212:215], v[168:171], v[40:43]
ds_read_b64_tr_b16 a[252:253], v15 offset:37312
ds_read_b64_tr_b16 a[254:255], v15 offset:43456
v_cvt_pk_bf16_f32 v162, v152, v153
v_mfma_f32_16x16x32_bf16 v[48:51], a[216:219], v[168:171], v[48:51]
s_waitcnt lgkmcnt(12)
v_mfma_f32_16x16x32_bf16 v[56:59], a[220:223], v[168:171], v[56:59]
s_waitcnt vmcnt(48)
s_barrier
s_addk_i32 m0, 20544
s_addk_i32 s32, 4096
buffer_load_dwordx4 v38, s[8:11], s32 offen nt lds
ds_read_b128 a[208:211], v4 offset:24704
ds_read_b128 a[212:215], v5 offset:24704
v_mfma_f32_16x16x32_bf16 v[64:67], a[224:227], v[168:171], v[64:67]
ds_read_b128 a[216:219], v4 offset:24832
buffer_load_dwordx4 v39, s[8:11], s32 offen offset:1024 nt lds
v_mfma_f32_16x16x32_bf16 v[72:75], a[228:231], v[168:171], v[72:75]
s_waitcnt lgkmcnt(9)
ds_read_b128 a[220:223], v5 offset:24832
buffer_load_dwordx4 v44, s[8:11], s32 offen offset:2048 nt lds
v_mfma_f32_16x16x32_bf16 v[80:83], a[232:235], v[168:171], v[80:83]
ds_read_b128 a[224:227], v4 offset:24960
buffer_load_dwordx4 v45, s[8:11], s32 offen offset:3072 nt lds
v_mfma_f32_16x16x32_bf16 v[88:91], a[236:239], v[168:171], v[88:91]
s_movk_i32 m0, 0
s_addk_i32 s32, 4096
buffer_load_dwordx4 v36, s[8:11], s32 offen nt lds
ds_read_b128 a[228:231], v5 offset:24960
v_mfma_f32_16x16x32_bf16 v[96:99], a[240:243], v[168:171], v[96:99]
s_waitcnt lgkmcnt(6)
ds_read_b128 a[232:235], v4 offset:30848
buffer_load_dwordx4 v37, s[8:11], s32 offen offset:1024 nt lds
v_mfma_f32_16x16x32_bf16 v[104:107], a[244:247], v[168:171], v[104:107]
ds_read_b128 a[236:239], v5 offset:30848
buffer_load_dwordx4 v38, s[8:11], s32 offen offset:2048 nt lds
v_mfma_f32_16x16x32_bf16 v[112:115], a[248:251], v[168:171], v[112:115]
ds_read_b128 a[240:243], v4 offset:30976
buffer_load_dwordx4 v39, s[8:11], s32 offen offset:3072 nt lds
v_mfma_f32_16x16x32_bf16 v[120:123], a[252:255], v[168:171], v[120:123]
s_waitcnt lgkmcnt(6)
s_movk_i32 m0, 4096
s_addk_i32 s32, 4096
buffer_load_dwordx4 v44, s[8:11], s32 offen nt lds
ds_read_b128 a[244:247], v5 offset:30976
v_mfma_f32_16x16x32_bf16 v[144:147], a[208:211], v[192:195], v[136:139]
ds_read_b128 a[248:251], v4 offset:31104
buffer_load_dwordx4 v45, s[8:11], s32 offen offset:1024 nt lds
v_exp_f32_e32 v154, v154
v_exp_f32_e32 v155, v155
v_add_f32_e32 v128, v128, v152
v_mfma_f32_16x16x32_bf16 v[144:147], a[212:215], v[200:203], v[144:147]
ds_read_b128 a[252:255], v5 offset:31104
buffer_load_dwordx4 v36, s[8:11], s32 offen offset:2048 nt lds
v_add_f32_e32 v129, v129, v153
v_add_f32_e32 v130, v130, v154
v_add_f32_e32 v131, v131, v155
v_cvt_pk_bf16_f32 v163, v154, v155
v_mfma_f32_16x16x32_bf16 v[144:147], a[216:219], v[208:211], v[144:147]
s_waitcnt lgkmcnt(6)
buffer_load_dwordx4 v37, s[8:11], s32 offen offset:3072 nt lds
v_mfma_f32_16x16x32_bf16 v[144:147], a[220:223], v[216:219], v[144:147]
s_waitcnt vmcnt(48)
s_barrier
s_movk_i32 m0, 8192
s_addk_i32 s32, 4096
buffer_load_dwordx4 v38, s[8:11], s32 offen nt lds
ds_read_b64_tr_b16 a[208:209], v8 offset:12352
ds_read_b64_tr_b16 a[210:211], v8 offset:18496
ds_read_b64_tr_b16 a[212:213], v9 offset:12352
v_mfma_f32_16x16x32_bf16 v[144:147], a[224:227], v[224:227], v[144:147]
ds_read_b64_tr_b16 a[214:215], v9 offset:18496
ds_read_b64_tr_b16 a[216:217], v10 offset:12352
ds_read_b64_tr_b16 a[218:219], v10 offset:18496
buffer_load_dwordx4 v39, s[8:11], s32 offen offset:1024 nt lds
v_mfma_f32_16x16x32_bf16 v[144:147], a[228:231], v[232:235], v[144:147]
s_waitcnt lgkmcnt(9)
ds_read_b64_tr_b16 a[220:221], v11 offset:12352
ds_read_b64_tr_b16 a[222:223], v11 offset:18496
buffer_load_dwordx4 v44, s[8:11], s32 offen offset:2048 nt lds
v_mfma_f32_16x16x32_bf16 v[152:155], a[232:235], v[192:195], v[136:139]
ds_read_b64_tr_b16 a[224:225], v8 offset:12480
ds_read_b64_tr_b16 a[226:227], v8 offset:18624
v_mfma_f32_16x16x32_bf16 v[152:155], a[236:239], v[200:203], v[152:155]
ds_read_b64_tr_b16 a[228:229], v9 offset:12480
v_exp_f32_e32 v144, v144
v_exp_f32_e32 v145, v145
v_exp_f32_e32 v146, v146
v_exp_f32_e32 v147, v147
v_mfma_f32_16x16x32_bf16 v[152:155], a[240:243], v[208:211], v[152:155]
s_waitcnt lgkmcnt(11)
ds_read_b64_tr_b16 a[230:231], v9 offset:18624
ds_read_b64_tr_b16 a[232:233], v10 offset:12480
ds_read_b64_tr_b16 a[234:235], v10 offset:18624
buffer_load_dwordx4 v45, s[8:11], s32 offen offset:3072 nt lds
v_add_f32_e32 v128, v128, v144
v_add_f32_e32 v129, v129, v145
v_add_f32_e32 v130, v130, v146
v_mfma_f32_16x16x32_bf16 v[152:155], a[244:247], v[216:219], v[152:155]
ds_read_b64_tr_b16 a[236:237], v11 offset:12480
ds_read_b64_tr_b16 a[238:239], v11 offset:18624
v_add_f32_e32 v131, v131, v147
v_cvt_pk_bf16_f32 v168, v144, v145
v_cvt_pk_bf16_f32 v169, v146, v147
v_mfma_f32_16x16x32_bf16 v[152:155], a[248:251], v[224:227], v[152:155]
ds_read_b64_tr_b16 a[240:241], v8 offset:12608
ds_read_b64_tr_b16 a[242:243], v8 offset:18752
v_mfma_f32_16x16x32_bf16 v[152:155], a[252:255], v[232:235], v[152:155]
s_waitcnt lgkmcnt(12)
ds_read_b64_tr_b16 a[244:245], v9 offset:12608
ds_read_b64_tr_b16 a[246:247], v9 offset:18752
v_mfma_f32_16x16x32_bf16 v[32:35], a[208:211], v[160:163], v[32:35]
ds_read_b64_tr_b16 a[248:249], v10 offset:12608
ds_read_b64_tr_b16 a[250:251], v10 offset:18752
v_mfma_f32_16x16x32_bf16 v[40:43], a[212:215], v[160:163], v[40:43]
ds_read_b64_tr_b16 a[252:253], v11 offset:12608
ds_read_b64_tr_b16 a[254:255], v11 offset:18752
v_exp_f32_e32 v152, v152
v_exp_f32_e32 v153, v153
v_mfma_f32_16x16x32_bf16 v[48:51], a[216:219], v[160:163], v[48:51]
s_waitcnt lgkmcnt(12)
v_cvt_pk_bf16_f32 v170, v152, v153
v_mfma_f32_16x16x32_bf16 v[56:59], a[220:223], v[160:163], v[56:59]
s_waitcnt vmcnt(40)
s_barrier
s_mov_b32 m0, 65856
s_addk_i32 s33, 4096
buffer_load_dwordx4 v47, s[12:15], s33 offen nt lds
ds_read_b128 a[208:211], v6 offset:0
ds_read_b128 a[212:215], v7 offset:0
v_mfma_f32_16x16x32_bf16 v[64:67], a[224:227], v[160:163], v[64:67]
ds_read_b128 a[216:219], v6 offset:128
buffer_load_dwordx4 v52, s[12:15], s33 offen offset:1024 nt lds
buffer_load_dwordx4 v46, s[12:15], s33 offen offset:2048 nt lds
v_mfma_f32_16x16x32_bf16 v[72:75], a[228:231], v[160:163], v[72:75]
s_waitcnt lgkmcnt(9)
ds_read_b128 a[220:223], v7 offset:128
buffer_load_dwordx4 v47, s[12:15], s33 offen offset:3072 nt lds
v_mfma_f32_16x16x32_bf16 v[80:83], a[232:235], v[160:163], v[80:83]
s_addk_i32 m0, 4096
s_addk_i32 s33, 4096
buffer_load_dwordx4 v52, s[12:15], s33 offen nt lds
ds_read_b128 a[224:227], v6 offset:256
buffer_load_dwordx4 v46, s[12:15], s33 offen offset:1024 nt lds
v_mfma_f32_16x16x32_bf16 v[88:91], a[236:239], v[160:163], v[88:91]
ds_read_b128 a[228:231], v7 offset:256
buffer_load_dwordx4 v47, s[12:15], s33 offen offset:2048 nt lds
v_mfma_f32_16x16x32_bf16 v[96:99], a[240:243], v[160:163], v[96:99]
s_waitcnt lgkmcnt(6)
ds_read_b128 a[232:235], v6 offset:6144
buffer_load_dwordx4 v52, s[12:15], s33 offen offset:3072 nt lds
v_mfma_f32_16x16x32_bf16 v[104:107], a[244:247], v[160:163], v[104:107]
s_addk_i32 m0, 16512
s_addk_i32 s33, 4096
buffer_load_dwordx4 v46, s[12:15], s33 offen nt lds
ds_read_b128 a[236:239], v7 offset:6144
buffer_load_dwordx4 v47, s[12:15], s33 offen offset:1024 nt lds
v_mfma_f32_16x16x32_bf16 v[112:115], a[248:251], v[160:163], v[112:115]
ds_read_b128 a[240:243], v6 offset:6272
buffer_load_dwordx4 v52, s[12:15], s33 offen offset:2048 nt lds
v_mfma_f32_16x16x32_bf16 v[120:123], a[252:255], v[160:163], v[120:123]
s_waitcnt lgkmcnt(6)
ds_read_b128 a[244:247], v7 offset:6272
buffer_load_dwordx4 v46, s[12:15], s33 offen offset:3072 nt lds
v_mfma_f32_16x16x32_bf16 v[144:147], a[208:211], v[192:195], v[136:139]
s_addk_i32 m0, 4096
s_addk_i32 s33, 4096
buffer_load_dwordx4 v47, s[12:15], s33 offen nt lds
ds_read_b128 a[248:251], v6 offset:6400
v_exp_f32_e32 v154, v154
v_exp_f32_e32 v155, v155
v_mfma_f32_16x16x32_bf16 v[144:147], a[212:215], v[200:203], v[144:147]
ds_read_b128 a[252:255], v7 offset:6400
buffer_load_dwordx4 v52, s[12:15], s33 offen offset:1024 nt lds
buffer_load_dwordx4 v46, s[12:15], s33 offen offset:2048 nt lds
v_add_f32_e32 v128, v128, v152
v_add_f32_e32 v129, v129, v153
v_add_f32_e32 v130, v130, v154
v_mfma_f32_16x16x32_bf16 v[144:147], a[216:219], v[208:211], v[144:147]
s_waitcnt lgkmcnt(6)
buffer_load_dwordx4 v47, s[12:15], s33 offen offset:3072 nt lds
v_add_f32_e32 v131, v131, v155
v_cvt_pk_bf16_f32 v171, v154, v155
v_mfma_f32_16x16x32_bf16 v[144:147], a[220:223], v[216:219], v[144:147]
s_waitcnt vmcnt(44)
s_barrier
s_movk_i32 m0, 24704
s_addk_i32 s32, 4096
buffer_load_dwordx4 v36, s[8:11], s32 offen nt lds
ds_read_b64_tr_b16 a[208:209], v8 offset:37056
ds_read_b64_tr_b16 a[210:211], v8 offset:43200
ds_read_b64_tr_b16 a[212:213], v9 offset:37056
v_mfma_f32_16x16x32_bf16 v[144:147], a[224:227], v[224:227], v[144:147]
ds_read_b64_tr_b16 a[214:215], v9 offset:43200
ds_read_b64_tr_b16 a[216:217], v10 offset:37056
ds_read_b64_tr_b16 a[218:219], v10 offset:43200
buffer_load_dwordx4 v37, s[8:11], s32 offen offset:1024 nt lds
v_mfma_f32_16x16x32_bf16 v[144:147], a[228:231], v[232:235], v[144:147]
s_waitcnt lgkmcnt(9)
ds_read_b64_tr_b16 a[220:221], v11 offset:37056
ds_read_b64_tr_b16 a[222:223], v11 offset:43200
buffer_load_dwordx4 v38, s[8:11], s32 offen offset:2048 nt lds
v_mfma_f32_16x16x32_bf16 v[152:155], a[232:235], v[192:195], v[136:139]
ds_read_b64_tr_b16 a[224:225], v8 offset:37184
ds_read_b64_tr_b16 a[226:227], v8 offset:43328
buffer_load_dwordx4 v39, s[8:11], s32 offen offset:3072 nt lds
v_exp_f32_e32 v144, v144
v_exp_f32_e32 v145, v145
v_mfma_f32_16x16x32_bf16 v[152:155], a[236:239], v[200:203], v[152:155]
s_movk_i32 m0, 28800
s_addk_i32 s32, 4096
buffer_load_dwordx4 v44, s[8:11], s32 offen nt lds
ds_read_b64_tr_b16 a[228:229], v9 offset:37184
v_exp_f32_e32 v146, v146
v_exp_f32_e32 v147, v147
v_mfma_f32_16x16x32_bf16 v[152:155], a[240:243], v[208:211], v[152:155]
s_waitcnt lgkmcnt(11)
ds_read_b64_tr_b16 a[230:231], v9 offset:43328
ds_read_b64_tr_b16 a[232:233], v10 offset:37184
ds_read_b64_tr_b16 a[234:235], v10 offset:43328
buffer_load_dwordx4 v45, s[8:11], s32 offen offset:1024 nt lds
v_add_f32_e32 v128, v128, v144
v_add_f32_e32 v129, v129, v145
v_add_f32_e32 v130, v130, v146
v_mfma_f32_16x16x32_bf16 v[152:155], a[244:247], v[216:219], v[152:155]
ds_read_b64_tr_b16 a[236:237], v11 offset:37184
ds_read_b64_tr_b16 a[238:239], v11 offset:43328
buffer_load_dwordx4 v36, s[8:11], s32 offen offset:2048 nt lds
v_add_f32_e32 v131, v131, v147
v_cvt_pk_bf16_f32 v160, v144, v145
v_cvt_pk_bf16_f32 v161, v146, v147
v_mfma_f32_16x16x32_bf16 v[152:155], a[248:251], v[224:227], v[152:155]
ds_read_b64_tr_b16 a[240:241], v8 offset:37312
ds_read_b64_tr_b16 a[242:243], v8 offset:43456
buffer_load_dwordx4 v37, s[8:11], s32 offen offset:3072 nt lds
v_mfma_f32_16x16x32_bf16 v[152:155], a[252:255], v[232:235], v[152:155]
s_waitcnt lgkmcnt(12)
s_mov_b32 m0, 94656
s_addk_i32 s33, 4096
buffer_load_dwordx4 v52, s[12:15], s33 offen nt lds
ds_read_b64_tr_b16 a[244:245], v9 offset:37312
ds_read_b64_tr_b16 a[246:247], v9 offset:43456
v_mfma_f32_16x16x32_bf16 v[32:35], a[208:211], v[168:171], v[32:35]
ds_read_b64_tr_b16 a[248:249], v10 offset:37312
ds_read_b64_tr_b16 a[250:251], v10 offset:43456
buffer_load_dwordx4 v46, s[12:15], s33 offen offset:1024 nt lds
v_exp_f32_e32 v152, v152
v_exp_f32_e32 v153, v153
v_mfma_f32_16x16x32_bf16 v[40:43], a[212:215], v[168:171], v[40:43]
ds_read_b64_tr_b16 a[252:253], v11 offset:37312
ds_read_b64_tr_b16 a[254:255], v11 offset:43456
buffer_load_dwordx4 v47, s[12:15], s33 offen offset:2048 nt lds
v_cvt_pk_bf16_f32 v162, v152, v153
v_mfma_f32_16x16x32_bf16 v[48:51], a[216:219], v[168:171], v[48:51]
s_waitcnt lgkmcnt(12)
buffer_load_dwordx4 v52, s[12:15], s33 offen offset:3072 nt lds
v_mfma_f32_16x16x32_bf16 v[56:59], a[220:223], v[168:171], v[56:59]
s_waitcnt vmcnt(40)
s_barrier
s_mov_b32 m0, 32896
s_addk_i32 s32, 4096
buffer_load_dwordx4 v38, s[8:11], s32 offen nt lds
ds_read_b128 a[208:211], v6 offset:24704
ds_read_b128 a[212:215], v7 offset:24704
v_mfma_f32_16x16x32_bf16 v[64:67], a[224:227], v[168:171], v[64:67]
ds_read_b128 a[216:219], v6 offset:24832
buffer_load_dwordx4 v39, s[8:11], s32 offen offset:1024 nt lds
buffer_load_dwordx4 v44, s[8:11], s32 offen offset:2048 nt lds
buffer_load_dwordx4 v45, s[8:11], s32 offen offset:3072 nt lds
v_mfma_f32_16x16x32_bf16 v[72:75], a[228:231], v[168:171], v[72:75]
s_waitcnt lgkmcnt(9)
s_addk_i32 m0, 16512
s_addk_i32 s32, 4096
buffer_load_dwordx4 v36, s[8:11], s32 offen nt lds
ds_read_b128 a[220:223], v7 offset:24832
v_mfma_f32_16x16x32_bf16 v[80:83], a[232:235], v[168:171], v[80:83]
ds_read_b128 a[224:227], v6 offset:24960
buffer_load_dwordx4 v37, s[8:11], s32 offen offset:1024 nt lds
buffer_load_dwordx4 v38, s[8:11], s32 offen offset:2048 nt lds
v_mfma_f32_16x16x32_bf16 v[88:91], a[236:239], v[168:171], v[88:91]
ds_read_b128 a[228:231], v7 offset:24960
buffer_load_dwordx4 v39, s[8:11], s32 offen offset:3072 nt lds
v_mfma_f32_16x16x32_bf16 v[96:99], a[240:243], v[168:171], v[96:99]
s_waitcnt lgkmcnt(6)
s_movk_i32 m0, 12352
s_addk_i32 s33, 4096
buffer_load_dwordx4 v46, s[12:15], s33 offen nt lds
ds_read_b128 a[232:235], v6 offset:30848
buffer_load_dwordx4 v47, s[12:15], s33 offen offset:1024 nt lds
v_mfma_f32_16x16x32_bf16 v[104:107], a[244:247], v[168:171], v[104:107]
ds_read_b128 a[236:239], v7 offset:30848
buffer_load_dwordx4 v52, s[12:15], s33 offen offset:2048 nt lds
buffer_load_dwordx4 v46, s[12:15], s33 offen offset:3072 nt lds
v_mfma_f32_16x16x32_bf16 v[112:115], a[248:251], v[168:171], v[112:115]
s_movk_i32 m0, 16448
s_addk_i32 s33, 4096
buffer_load_dwordx4 v47, s[12:15], s33 offen nt lds
ds_read_b128 a[240:243], v6 offset:30976
buffer_load_dwordx4 v52, s[12:15], s33 offen offset:1024 nt lds
v_mfma_f32_16x16x32_bf16 v[120:123], a[252:255], v[168:171], v[120:123]
s_waitcnt lgkmcnt(6)
ds_read_b128 a[244:247], v7 offset:30976
buffer_load_dwordx4 v46, s[12:15], s33 offen offset:2048 nt lds
v_mfma_f32_16x16x32_bf16 v[144:147], a[208:211], v[192:195], v[136:139]
ds_read_b128 a[248:251], v6 offset:31104
buffer_load_dwordx4 v47, s[12:15], s33 offen offset:3072 nt lds
v_exp_f32_e32 v154, v154
v_exp_f32_e32 v155, v155
v_add_f32_e32 v128, v128, v152
v_mfma_f32_16x16x32_bf16 v[144:147], a[212:215], v[200:203], v[144:147]
s_movk_i32 m0, 20544
s_addk_i32 s33, 4096
buffer_load_dwordx4 v52, s[12:15], s33 offen nt lds
ds_read_b128 a[252:255], v7 offset:31104
buffer_load_dwordx4 v46, s[12:15], s33 offen offset:1024 nt lds
v_add_f32_e32 v129, v129, v153
v_add_f32_e32 v130, v130, v154
v_mfma_f32_16x16x32_bf16 v[144:147], a[216:219], v[208:211], v[144:147]
s_waitcnt lgkmcnt(6)
buffer_load_dwordx4 v47, s[12:15], s33 offen offset:2048 nt lds
buffer_load_dwordx4 v52, s[12:15], s33 offen offset:3072 nt lds
v_add_f32_e32 v131, v131, v155
v_cvt_pk_bf16_f32 v163, v154, v155
v_mfma_f32_16x16x32_bf16 v[144:147], a[220:223], v[216:219], v[144:147]
s_waitcnt vmcnt(40)
s_barrier
s_mov_b32 m0, 53504
s_addk_i32 s32, 4096
buffer_load_dwordx4 v44, s[8:11], s32 offen nt lds
ds_read_b64_tr_b16 a[208:209], v12 offset:12352
ds_read_b64_tr_b16 a[210:211], v12 offset:18496
ds_read_b64_tr_b16 a[212:213], v13 offset:12352
v_mfma_f32_16x16x32_bf16 v[144:147], a[224:227], v[224:227], v[144:147]
ds_read_b64_tr_b16 a[214:215], v13 offset:18496
ds_read_b64_tr_b16 a[216:217], v14 offset:12352
ds_read_b64_tr_b16 a[218:219], v14 offset:18496
buffer_load_dwordx4 v45, s[8:11], s32 offen offset:1024 nt lds
v_mfma_f32_16x16x32_bf16 v[144:147], a[228:231], v[232:235], v[144:147]
s_waitcnt lgkmcnt(9)
ds_read_b64_tr_b16 a[220:221], v15 offset:12352
ds_read_b64_tr_b16 a[222:223], v15 offset:18496
buffer_load_dwordx4 v36, s[8:11], s32 offen offset:2048 nt lds
v_mfma_f32_16x16x32_bf16 v[152:155], a[232:235], v[192:195], v[136:139]
ds_read_b64_tr_b16 a[224:225], v12 offset:12480
ds_read_b64_tr_b16 a[226:227], v12 offset:18624
buffer_load_dwordx4 v37, s[8:11], s32 offen offset:3072 nt lds
v_exp_f32_e32 v144, v144
v_exp_f32_e32 v145, v145
v_mfma_f32_16x16x32_bf16 v[152:155], a[236:239], v[200:203], v[152:155]
s_addk_i32 m0, 4096
s_addk_i32 s32, 4096
buffer_load_dwordx4 v38, s[8:11], s32 offen nt lds
ds_read_b64_tr_b16 a[228:229], v13 offset:12480
v_exp_f32_e32 v146, v146
v_exp_f32_e32 v147, v147
v_mfma_f32_16x16x32_bf16 v[152:155], a[240:243], v[208:211], v[152:155]
s_waitcnt lgkmcnt(11)
ds_read_b64_tr_b16 a[230:231], v13 offset:18624
ds_read_b64_tr_b16 a[232:233], v14 offset:12480
ds_read_b64_tr_b16 a[234:235], v14 offset:18624
buffer_load_dwordx4 v39, s[8:11], s32 offen offset:1024 nt lds
v_add_f32_e32 v128, v128, v144
v_add_f32_e32 v129, v129, v145
v_add_f32_e32 v130, v130, v146
v_mfma_f32_16x16x32_bf16 v[152:155], a[244:247], v[216:219], v[152:155]
ds_read_b64_tr_b16 a[236:237], v15 offset:12480
ds_read_b64_tr_b16 a[238:239], v15 offset:18624
buffer_load_dwordx4 v44, s[8:11], s32 offen offset:2048 nt lds
v_add_f32_e32 v131, v131, v147
v_cvt_pk_bf16_f32 v168, v144, v145
v_cvt_pk_bf16_f32 v169, v146, v147
v_mfma_f32_16x16x32_bf16 v[152:155], a[248:251], v[224:227], v[152:155]
ds_read_b64_tr_b16 a[240:241], v12 offset:12608
ds_read_b64_tr_b16 a[242:243], v12 offset:18752
buffer_load_dwordx4 v45, s[8:11], s32 offen offset:3072 nt lds
v_mfma_f32_16x16x32_bf16 v[152:155], a[252:255], v[232:235], v[152:155]
s_waitcnt lgkmcnt(12)
s_addk_i32 m0, -20544
s_addk_i32 s33, 4096
buffer_load_dwordx4 v46, s[12:15], s33 offen nt lds
ds_read_b64_tr_b16 a[244:245], v13 offset:12608
ds_read_b64_tr_b16 a[246:247], v13 offset:18752
v_mfma_f32_16x16x32_bf16 v[32:35], a[208:211], v[160:163], v[32:35]
ds_read_b64_tr_b16 a[248:249], v14 offset:12608
ds_read_b64_tr_b16 a[250:251], v14 offset:18752
buffer_load_dwordx4 v47, s[12:15], s33 offen offset:1024 nt lds
v_exp_f32_e32 v152, v152
v_exp_f32_e32 v153, v153
v_mfma_f32_16x16x32_bf16 v[40:43], a[212:215], v[160:163], v[40:43]
ds_read_b64_tr_b16 a[252:253], v15 offset:12608
ds_read_b64_tr_b16 a[254:255], v15 offset:18752
buffer_load_dwordx4 v52, s[12:15], s33 offen offset:2048 nt lds
v_cvt_pk_bf16_f32 v170, v152, v153
v_mfma_f32_16x16x32_bf16 v[48:51], a[216:219], v[160:163], v[48:51]
s_waitcnt lgkmcnt(12)
buffer_load_dwordx4 v46, s[12:15], s33 offen offset:3072 nt lds
v_mfma_f32_16x16x32_bf16 v[56:59], a[220:223], v[160:163], v[56:59]
s_waitcnt vmcnt(60)
s_barrier
s_addk_i32 m0, 4096
s_addk_i32 s33, 4096
buffer_load_dwordx4 v47, s[12:15], s33 offen nt lds
ds_read_b128 a[208:211], v4 offset:0
ds_read_b128 a[212:215], v5 offset:0
v_mfma_f32_16x16x32_bf16 v[64:67], a[224:227], v[160:163], v[64:67]
ds_read_b128 a[216:219], v4 offset:128
buffer_load_dwordx4 v52, s[12:15], s33 offen offset:1024 nt lds
v_mfma_f32_16x16x32_bf16 v[72:75], a[228:231], v[160:163], v[72:75]
s_waitcnt lgkmcnt(9)
ds_read_b128 a[220:223], v5 offset:128
buffer_load_dwordx4 v46, s[12:15], s33 offen offset:2048 nt lds
v_mfma_f32_16x16x32_bf16 v[80:83], a[232:235], v[160:163], v[80:83]
ds_read_b128 a[224:227], v4 offset:256
v_mfma_f32_16x16x32_bf16 v[88:91], a[236:239], v[160:163], v[88:91]
ds_read_b128 a[228:231], v5 offset:256
buffer_load_dwordx4 v47, s[12:15], s33 offen offset:3072 nt lds
v_mfma_f32_16x16x32_bf16 v[96:99], a[240:243], v[160:163], v[96:99]
s_waitcnt lgkmcnt(6)
s_addk_i32 m0, 4096
s_addk_i32 s33, 4096
buffer_load_dwordx4 v52, s[12:15], s33 offen nt lds
ds_read_b128 a[232:235], v4 offset:6144
v_mfma_f32_16x16x32_bf16 v[104:107], a[244:247], v[160:163], v[104:107]
ds_read_b128 a[236:239], v5 offset:6144
buffer_load_dwordx4 v46, s[12:15], s33 offen offset:1024 nt lds
v_mfma_f32_16x16x32_bf16 v[112:115], a[248:251], v[160:163], v[112:115]
ds_read_b128 a[240:243], v4 offset:6272
v_mfma_f32_16x16x32_bf16 v[120:123], a[252:255], v[160:163], v[120:123]
s_waitcnt lgkmcnt(6)
ds_read_b128 a[244:247], v5 offset:6272
buffer_load_dwordx4 v47, s[12:15], s33 offen offset:2048 nt lds
v_mfma_f32_16x16x32_bf16 v[144:147], a[208:211], v[192:195], v[136:139]
ds_read_b128 a[248:251], v4 offset:6400
buffer_load_dwordx4 v52, s[12:15], s33 offen offset:3072 nt lds
v_exp_f32_e32 v154, v154
v_exp_f32_e32 v155, v155
v_add_f32_e32 v128, v128, v152
v_mfma_f32_16x16x32_bf16 v[144:147], a[212:215], v[200:203], v[144:147]
ds_read_b128 a[252:255], v5 offset:6400
v_add_f32_e32 v129, v129, v153
v_add_f32_e32 v130, v130, v154
v_add_f32_e32 v131, v131, v155
v_cvt_pk_bf16_f32 v171, v154, v155
v_mfma_f32_16x16x32_bf16 v[144:147], a[216:219], v[208:211], v[144:147]
s_waitcnt lgkmcnt(6)
v_mfma_f32_16x16x32_bf16 v[144:147], a[220:223], v[216:219], v[144:147]
s_waitcnt vmcnt(40)
s_barrier
s_addk_i32 m0, 28864
s_addk_i32 s32, 4096
buffer_load_dwordx4 v36, s[8:11], s32 offen nt lds
ds_read_b64_tr_b16 a[208:209], v12 offset:37056
ds_read_b64_tr_b16 a[210:211], v12 offset:43200
ds_read_b64_tr_b16 a[212:213], v13 offset:37056
v_mfma_f32_16x16x32_bf16 v[144:147], a[224:227], v[224:227], v[144:147]
ds_read_b64_tr_b16 a[214:215], v13 offset:43200
ds_read_b64_tr_b16 a[216:217], v14 offset:37056
ds_read_b64_tr_b16 a[218:219], v14 offset:43200
buffer_load_dwordx4 v37, s[8:11], s32 offen offset:1024 nt lds
buffer_load_dwordx4 v38, s[8:11], s32 offen offset:2048 nt lds
v_mfma_f32_16x16x32_bf16 v[144:147], a[228:231], v[232:235], v[144:147]
s_waitcnt lgkmcnt(9)
ds_read_b64_tr_b16 a[220:221], v15 offset:37056
ds_read_b64_tr_b16 a[222:223], v15 offset:43200
buffer_load_dwordx4 v39, s[8:11], s32 offen offset:3072 nt lds
v_mfma_f32_16x16x32_bf16 v[152:155], a[232:235], v[192:195], v[136:139]
s_addk_i32 m0, 4096
s_addk_i32 s32, 4096
buffer_load_dwordx4 v44, s[8:11], s32 offen nt lds
ds_read_b64_tr_b16 a[224:225], v12 offset:37184
v_exp_f32_e32 v144, v144
v_exp_f32_e32 v145, v145
v_mfma_f32_16x16x32_bf16 v[152:155], a[236:239], v[200:203], v[152:155]
ds_read_b64_tr_b16 a[226:227], v12 offset:43328
ds_read_b64_tr_b16 a[228:229], v13 offset:37184
ds_read_b64_tr_b16 a[230:231], v13 offset:43328
v_exp_f32_e32 v146, v146
v_exp_f32_e32 v147, v147
v_add_f32_e32 v128, v128, v144
v_add_f32_e32 v129, v129, v145
v_mfma_f32_16x16x32_bf16 v[152:155], a[240:243], v[208:211], v[152:155]
s_waitcnt lgkmcnt(12)
ds_read_b64_tr_b16 a[232:233], v14 offset:37184
ds_read_b64_tr_b16 a[234:235], v14 offset:43328
buffer_load_dwordx4 v45, s[8:11], s32 offen offset:1024 nt lds
buffer_load_dwordx4 v36, s[8:11], s32 offen offset:2048 nt lds
v_add_f32_e32 v130, v130, v146
v_add_f32_e32 v131, v131, v147
v_mfma_f32_16x16x32_bf16 v[152:155], a[244:247], v[216:219], v[152:155]
ds_read_b64_tr_b16 a[236:237], v15 offset:37184
ds_read_b64_tr_b16 a[238:239], v15 offset:43328
buffer_load_dwordx4 v37, s[8:11], s32 offen offset:3072 nt lds
v_cvt_pk_bf16_f32 v160, v144, v145
v_cvt_pk_bf16_f32 v161, v146, v147
v_mfma_f32_16x16x32_bf16 v[152:155], a[248:251], v[224:227], v[152:155]
s_addk_i32 m0, 4096
s_addk_i32 s32, 4096
buffer_load_dwordx4 v38, s[8:11], s32 offen nt lds
ds_read_b64_tr_b16 a[240:241], v12 offset:37312
ds_read_b64_tr_b16 a[242:243], v12 offset:43456
buffer_load_dwordx4 v39, s[8:11], s32 offen offset:1024 nt lds
v_mfma_f32_16x16x32_bf16 v[152:155], a[252:255], v[232:235], v[152:155]
s_waitcnt lgkmcnt(12)
ds_read_b64_tr_b16 a[244:245], v13 offset:37312
ds_read_b64_tr_b16 a[246:247], v13 offset:43456
buffer_load_dwordx4 v44, s[8:11], s32 offen offset:2048 nt lds
buffer_load_dwordx4 v45, s[8:11], s32 offen offset:3072 nt lds
v_mfma_f32_16x16x32_bf16 v[32:35], a[208:211], v[168:171], v[32:35]
s_addk_i32 m0, -20544
s_addk_i32 s33, 4096
buffer_load_dwordx4 v46, s[12:15], s33 offen nt lds
ds_read_b64_tr_b16 a[248:249], v14 offset:37312
v_exp_f32_e32 v152, v152
v_exp_f32_e32 v153, v153
v_mfma_f32_16x16x32_bf16 v[40:43], a[212:215], v[168:171], v[40:43]
ds_read_b64_tr_b16 a[250:251], v14 offset:43456
ds_read_b64_tr_b16 a[252:253], v15 offset:37312
ds_read_b64_tr_b16 a[254:255], v15 offset:43456
buffer_load_dwordx4 v47, s[12:15], s33 offen offset:1024 nt lds
buffer_load_dwordx4 v52, s[12:15], s33 offen offset:2048 nt lds
v_cvt_pk_bf16_f32 v162, v152, v153
v_mfma_f32_16x16x32_bf16 v[48:51], a[216:219], v[168:171], v[48:51]
s_waitcnt lgkmcnt(12)
buffer_load_dwordx4 v46, s[12:15], s33 offen offset:3072 nt lds
v_mfma_f32_16x16x32_bf16 v[56:59], a[220:223], v[168:171], v[56:59]
s_waitcnt vmcnt(52)
s_barrier
ds_read_b128 a[208:211], v4 offset:24704
ds_read_b128 a[212:215], v5 offset:24704
v_mfma_f32_16x16x32_bf16 v[64:67], a[224:227], v[168:171], v[64:67]
ds_read_b128 a[216:219], v4 offset:24832
v_mfma_f32_16x16x32_bf16 v[72:75], a[228:231], v[168:171], v[72:75]
s_waitcnt lgkmcnt(9)
ds_read_b128 a[220:223], v5 offset:24832
v_mfma_f32_16x16x32_bf16 v[80:83], a[232:235], v[168:171], v[80:83]
ds_read_b128 a[224:227], v4 offset:24960
v_mfma_f32_16x16x32_bf16 v[88:91], a[236:239], v[168:171], v[88:91]
ds_read_b128 a[228:231], v5 offset:24960
v_mfma_f32_16x16x32_bf16 v[96:99], a[240:243], v[168:171], v[96:99]
s_waitcnt lgkmcnt(6)
ds_read_b128 a[232:235], v4 offset:30848
v_mfma_f32_16x16x32_bf16 v[104:107], a[244:247], v[168:171], v[104:107]
ds_read_b128 a[236:239], v5 offset:30848
v_mfma_f32_16x16x32_bf16 v[112:115], a[248:251], v[168:171], v[112:115]
ds_read_b128 a[240:243], v4 offset:30976
v_mfma_f32_16x16x32_bf16 v[120:123], a[252:255], v[168:171], v[120:123]
s_waitcnt lgkmcnt(6)
ds_read_b128 a[244:247], v5 offset:30976
v_mfma_f32_16x16x32_bf16 v[144:147], a[208:211], v[192:195], v[136:139]
ds_read_b128 a[248:251], v4 offset:31104
v_exp_f32_e32 v154, v154
v_exp_f32_e32 v155, v155
v_add_f32_e32 v128, v128, v152
v_add_f32_e32 v129, v129, v153
v_add_f32_e32 v130, v130, v154
v_add_f32_e32 v131, v131, v155
v_mfma_f32_16x16x32_bf16 v[144:147], a[212:215], v[200:203], v[144:147]
ds_read_b128 a[252:255], v5 offset:31104
v_cvt_pk_bf16_f32 v163, v154, v155
v_mfma_f32_16x16x32_bf16 v[144:147], a[216:219], v[208:211], v[144:147]
s_waitcnt lgkmcnt(6)
v_mfma_f32_16x16x32_bf16 v[144:147], a[220:223], v[216:219], v[144:147]
s_waitcnt vmcnt(36)
s_barrier
s_movk_i32 m0, 0
s_addk_i32 s32, 4096
buffer_load_dwordx4 v36, s[8:11], s32 offen nt lds
ds_read_b64_tr_b16 a[208:209], v8 offset:12352
ds_read_b64_tr_b16 a[210:211], v8 offset:18496
ds_read_b64_tr_b16 a[212:213], v9 offset:12352
v_mfma_f32_16x16x32_bf16 v[144:147], a[224:227], v[224:227], v[144:147]
ds_read_b64_tr_b16 a[214:215], v9 offset:18496
ds_read_b64_tr_b16 a[216:217], v10 offset:12352
ds_read_b64_tr_b16 a[218:219], v10 offset:18496
buffer_load_dwordx4 v37, s[8:11], s32 offen offset:1024 nt lds
v_mfma_f32_16x16x32_bf16 v[144:147], a[228:231], v[232:235], v[144:147]
s_waitcnt lgkmcnt(9)
ds_read_b64_tr_b16 a[220:221], v11 offset:12352
ds_read_b64_tr_b16 a[222:223], v11 offset:18496
buffer_load_dwordx4 v38, s[8:11], s32 offen offset:2048 nt lds
v_mfma_f32_16x16x32_bf16 v[152:155], a[232:235], v[192:195], v[136:139]
ds_read_b64_tr_b16 a[224:225], v8 offset:12480
ds_read_b64_tr_b16 a[226:227], v8 offset:18624
buffer_load_dwordx4 v39, s[8:11], s32 offen offset:3072 nt lds
v_exp_f32_e32 v144, v144
v_exp_f32_e32 v145, v145
v_mfma_f32_16x16x32_bf16 v[152:155], a[236:239], v[200:203], v[152:155]
s_movk_i32 m0, 4096
s_addk_i32 s32, 4096
buffer_load_dwordx4 v44, s[8:11], s32 offen nt lds
ds_read_b64_tr_b16 a[228:229], v9 offset:12480
v_exp_f32_e32 v146, v146
v_exp_f32_e32 v147, v147
v_mfma_f32_16x16x32_bf16 v[152:155], a[240:243], v[208:211], v[152:155]
s_waitcnt lgkmcnt(11)
ds_read_b64_tr_b16 a[230:231], v9 offset:18624
ds_read_b64_tr_b16 a[232:233], v10 offset:12480
ds_read_b64_tr_b16 a[234:235], v10 offset:18624
buffer_load_dwordx4 v45, s[8:11], s32 offen offset:1024 nt lds
v_add_f32_e32 v128, v128, v144
v_add_f32_e32 v129, v129, v145
v_add_f32_e32 v130, v130, v146
v_mfma_f32_16x16x32_bf16 v[152:155], a[244:247], v[216:219], v[152:155]
ds_read_b64_tr_b16 a[236:237], v11 offset:12480
ds_read_b64_tr_b16 a[238:239], v11 offset:18624
buffer_load_dwordx4 v36, s[8:11], s32 offen offset:2048 nt lds
v_add_f32_e32 v131, v131, v147
v_cvt_pk_bf16_f32 v168, v144, v145
v_cvt_pk_bf16_f32 v169, v146, v147
v_mfma_f32_16x16x32_bf16 v[152:155], a[248:251], v[224:227], v[152:155]
ds_read_b64_tr_b16 a[240:241], v8 offset:12608
ds_read_b64_tr_b16 a[242:243], v8 offset:18752
buffer_load_dwordx4 v37, s[8:11], s32 offen offset:3072 nt lds
v_mfma_f32_16x16x32_bf16 v[152:155], a[252:255], v[232:235], v[152:155]
s_waitcnt lgkmcnt(12)
s_movk_i32 m0, 8192
s_addk_i32 s32, 4096
buffer_load_dwordx4 v38, s[8:11], s32 offen nt lds
ds_read_b64_tr_b16 a[244:245], v9 offset:12608
ds_read_b64_tr_b16 a[246:247], v9 offset:18752
v_mfma_f32_16x16x32_bf16 v[32:35], a[208:211], v[160:163], v[32:35]
ds_read_b64_tr_b16 a[248:249], v10 offset:12608
ds_read_b64_tr_b16 a[250:251], v10 offset:18752
buffer_load_dwordx4 v39, s[8:11], s32 offen offset:1024 nt lds
v_exp_f32_e32 v152, v152
v_exp_f32_e32 v153, v153
v_mfma_f32_16x16x32_bf16 v[40:43], a[212:215], v[160:163], v[40:43]
ds_read_b64_tr_b16 a[252:253], v11 offset:12608
ds_read_b64_tr_b16 a[254:255], v11 offset:18752
buffer_load_dwordx4 v44, s[8:11], s32 offen offset:2048 nt lds
v_cvt_pk_bf16_f32 v170, v152, v153
v_mfma_f32_16x16x32_bf16 v[48:51], a[216:219], v[160:163], v[48:51]
s_waitcnt lgkmcnt(12)
buffer_load_dwordx4 v45, s[8:11], s32 offen offset:3072 nt lds
v_mfma_f32_16x16x32_bf16 v[56:59], a[220:223], v[160:163], v[56:59]
s_waitcnt vmcnt(40)
s_barrier
s_mov_b32 m0, 65856
s_addk_i32 s33, 4096
buffer_load_dwordx4 v47, s[12:15], s33 offen nt lds
ds_read_b128 a[208:211], v6 offset:0
ds_read_b128 a[212:215], v7 offset:0
v_mfma_f32_16x16x32_bf16 v[64:67], a[224:227], v[160:163], v[64:67]
ds_read_b128 a[216:219], v6 offset:128
buffer_load_dwordx4 v52, s[12:15], s33 offen offset:1024 nt lds
v_mfma_f32_16x16x32_bf16 v[72:75], a[228:231], v[160:163], v[72:75]
s_waitcnt lgkmcnt(9)
ds_read_b128 a[220:223], v7 offset:128
buffer_load_dwordx4 v46, s[12:15], s33 offen offset:2048 nt lds
v_mfma_f32_16x16x32_bf16 v[80:83], a[232:235], v[160:163], v[80:83]
ds_read_b128 a[224:227], v6 offset:256
v_mfma_f32_16x16x32_bf16 v[88:91], a[236:239], v[160:163], v[88:91]
ds_read_b128 a[228:231], v7 offset:256
buffer_load_dwordx4 v47, s[12:15], s33 offen offset:3072 nt lds
v_mfma_f32_16x16x32_bf16 v[96:99], a[240:243], v[160:163], v[96:99]
s_waitcnt lgkmcnt(6)
ds_read_b128 a[232:235], v6 offset:6144
v_mfma_f32_16x16x32_bf16 v[104:107], a[244:247], v[160:163], v[104:107]
ds_read_b128 a[236:239], v7 offset:6144
v_mfma_f32_16x16x32_bf16 v[112:115], a[248:251], v[160:163], v[112:115]
ds_read_b128 a[240:243], v6 offset:6272
v_mfma_f32_16x16x32_bf16 v[120:123], a[252:255], v[160:163], v[120:123]
s_waitcnt lgkmcnt(6)
ds_read_b128 a[244:247], v7 offset:6272
v_mfma_f32_16x16x32_bf16 v[144:147], a[208:211], v[192:195], v[136:139]
ds_read_b128 a[248:251], v6 offset:6400
v_exp_f32_e32 v154, v154
v_exp_f32_e32 v155, v155
v_add_f32_e32 v128, v128, v152
v_add_f32_e32 v129, v129, v153
v_add_f32_e32 v130, v130, v154
v_add_f32_e32 v131, v131, v155
v_mfma_f32_16x16x32_bf16 v[144:147], a[212:215], v[200:203], v[144:147]
ds_read_b128 a[252:255], v7 offset:6400
v_cvt_pk_bf16_f32 v171, v154, v155
v_mfma_f32_16x16x32_bf16 v[144:147], a[216:219], v[208:211], v[144:147]
s_waitcnt lgkmcnt(6)
v_mfma_f32_16x16x32_bf16 v[144:147], a[220:223], v[216:219], v[144:147]
s_waitcnt vmcnt(32)
s_barrier
s_addk_i32 m0, 4096
s_addk_i32 s33, 4096
buffer_load_dwordx4 v52, s[12:15], s33 offen nt lds
ds_read_b64_tr_b16 a[208:209], v8 offset:37056
ds_read_b64_tr_b16 a[210:211], v8 offset:43200
ds_read_b64_tr_b16 a[212:213], v9 offset:37056
v_mfma_f32_16x16x32_bf16 v[144:147], a[224:227], v[224:227], v[144:147]
ds_read_b64_tr_b16 a[214:215], v9 offset:43200
ds_read_b64_tr_b16 a[216:217], v10 offset:37056
ds_read_b64_tr_b16 a[218:219], v10 offset:43200
buffer_load_dwordx4 v46, s[12:15], s33 offen offset:1024 nt lds
buffer_load_dwordx4 v47, s[12:15], s33 offen offset:2048 nt lds
v_mfma_f32_16x16x32_bf16 v[144:147], a[228:231], v[232:235], v[144:147]
s_waitcnt lgkmcnt(9)
ds_read_b64_tr_b16 a[220:221], v11 offset:37056
ds_read_b64_tr_b16 a[222:223], v11 offset:43200
buffer_load_dwordx4 v52, s[12:15], s33 offen offset:3072 nt lds
v_mfma_f32_16x16x32_bf16 v[152:155], a[232:235], v[192:195], v[136:139]
s_addk_i32 m0, 16512
s_addk_i32 s33, 4096
buffer_load_dwordx4 v46, s[12:15], s33 offen nt lds
ds_read_b64_tr_b16 a[224:225], v8 offset:37184
v_exp_f32_e32 v144, v144
v_exp_f32_e32 v145, v145
v_mfma_f32_16x16x32_bf16 v[152:155], a[236:239], v[200:203], v[152:155]
ds_read_b64_tr_b16 a[226:227], v8 offset:43328
ds_read_b64_tr_b16 a[228:229], v9 offset:37184
ds_read_b64_tr_b16 a[230:231], v9 offset:43328
v_exp_f32_e32 v146, v146
v_exp_f32_e32 v147, v147
v_add_f32_e32 v128, v128, v144
v_add_f32_e32 v129, v129, v145
v_mfma_f32_16x16x32_bf16 v[152:155], a[240:243], v[208:211], v[152:155]
s_waitcnt lgkmcnt(12)
ds_read_b64_tr_b16 a[232:233], v10 offset:37184
ds_read_b64_tr_b16 a[234:235], v10 offset:43328
buffer_load_dwordx4 v47, s[12:15], s33 offen offset:1024 nt lds
buffer_load_dwordx4 v52, s[12:15], s33 offen offset:2048 nt lds
v_add_f32_e32 v130, v130, v146
v_add_f32_e32 v131, v131, v147
v_mfma_f32_16x16x32_bf16 v[152:155], a[244:247], v[216:219], v[152:155]
ds_read_b64_tr_b16 a[236:237], v11 offset:37184
ds_read_b64_tr_b16 a[238:239], v11 offset:43328
buffer_load_dwordx4 v46, s[12:15], s33 offen offset:3072 nt lds
v_cvt_pk_bf16_f32 v160, v144, v145
v_cvt_pk_bf16_f32 v161, v146, v147
v_mfma_f32_16x16x32_bf16 v[152:155], a[248:251], v[224:227], v[152:155]
s_addk_i32 m0, 4096
s_addk_i32 s33, 4096
buffer_load_dwordx4 v47, s[12:15], s33 offen nt lds
ds_read_b64_tr_b16 a[240:241], v8 offset:37312
ds_read_b64_tr_b16 a[242:243], v8 offset:43456
buffer_load_dwordx4 v52, s[12:15], s33 offen offset:1024 nt lds
v_mfma_f32_16x16x32_bf16 v[152:155], a[252:255], v[232:235], v[152:155]
s_waitcnt lgkmcnt(12)
ds_read_b64_tr_b16 a[244:245], v9 offset:37312
ds_read_b64_tr_b16 a[246:247], v9 offset:43456
buffer_load_dwordx4 v46, s[12:15], s33 offen offset:2048 nt lds
buffer_load_dwordx4 v47, s[12:15], s33 offen offset:3072 nt lds
v_mfma_f32_16x16x32_bf16 v[32:35], a[208:211], v[168:171], v[32:35]
s_addk_i32 m0, 4096
s_addk_i32 s33, 4096
buffer_load_dwordx4 v52, s[12:15], s33 offen nt lds
ds_read_b64_tr_b16 a[248:249], v10 offset:37312
v_exp_f32_e32 v152, v152
v_exp_f32_e32 v153, v153
v_mfma_f32_16x16x32_bf16 v[40:43], a[212:215], v[168:171], v[40:43]
ds_read_b64_tr_b16 a[250:251], v10 offset:43456
ds_read_b64_tr_b16 a[252:253], v11 offset:37312
ds_read_b64_tr_b16 a[254:255], v11 offset:43456
buffer_load_dwordx4 v46, s[12:15], s33 offen offset:1024 nt lds
buffer_load_dwordx4 v47, s[12:15], s33 offen offset:2048 nt lds
v_cvt_pk_bf16_f32 v162, v152, v153
v_mfma_f32_16x16x32_bf16 v[48:51], a[216:219], v[168:171], v[48:51]
s_waitcnt lgkmcnt(12)
buffer_load_dwordx4 v52, s[12:15], s33 offen offset:3072 nt lds
s_movk_i32 m0, 12352
s_addk_i32 s33, 4096
buffer_load_dwordx4 v46, s[12:15], s33 offen nt lds
buffer_load_dwordx4 v47, s[12:15], s33 offen offset:1024 nt lds
buffer_load_dwordx4 v52, s[12:15], s33 offen offset:2048 nt lds
buffer_load_dwordx4 v46, s[12:15], s33 offen offset:3072 nt lds
s_movk_i32 m0, 16448
s_addk_i32 s33, 4096
buffer_load_dwordx4 v47, s[12:15], s33 offen nt lds
buffer_load_dwordx4 v52, s[12:15], s33 offen offset:1024 nt lds
buffer_load_dwordx4 v46, s[12:15], s33 offen offset:2048 nt lds
buffer_load_dwordx4 v47, s[12:15], s33 offen offset:3072 nt lds
v_mfma_f32_16x16x32_bf16 v[56:59], a[220:223], v[168:171], v[56:59]
s_waitcnt vmcnt(44)
s_barrier
s_movk_i32 m0, 24704
s_addk_i32 s32, 4096
buffer_load_dwordx4 v36, s[8:11], s32 offen nt lds
ds_read_b128 a[208:211], v6 offset:24704
ds_read_b128 a[212:215], v7 offset:24704
v_mfma_f32_16x16x32_bf16 v[64:67], a[224:227], v[168:171], v[64:67]
ds_read_b128 a[216:219], v6 offset:24832
buffer_load_dwordx4 v37, s[8:11], s32 offen offset:1024 nt lds
v_mfma_f32_16x16x32_bf16 v[72:75], a[228:231], v[168:171], v[72:75]
s_waitcnt lgkmcnt(9)
ds_read_b128 a[220:223], v7 offset:24832
buffer_load_dwordx4 v38, s[8:11], s32 offen offset:2048 nt lds
v_mfma_f32_16x16x32_bf16 v[80:83], a[232:235], v[168:171], v[80:83]
ds_read_b128 a[224:227], v6 offset:24960
v_mfma_f32_16x16x32_bf16 v[88:91], a[236:239], v[168:171], v[88:91]
ds_read_b128 a[228:231], v7 offset:24960
buffer_load_dwordx4 v39, s[8:11], s32 offen offset:3072 nt lds
v_mfma_f32_16x16x32_bf16 v[96:99], a[240:243], v[168:171], v[96:99]
s_waitcnt lgkmcnt(6)
s_movk_i32 m0, 28800
s_addk_i32 s32, 4096
buffer_load_dwordx4 v44, s[8:11], s32 offen nt lds
ds_read_b128 a[232:235], v6 offset:30848
v_mfma_f32_16x16x32_bf16 v[104:107], a[244:247], v[168:171], v[104:107]
ds_read_b128 a[236:239], v7 offset:30848
buffer_load_dwordx4 v45, s[8:11], s32 offen offset:1024 nt lds
v_mfma_f32_16x16x32_bf16 v[112:115], a[248:251], v[168:171], v[112:115]
ds_read_b128 a[240:243], v6 offset:30976
v_mfma_f32_16x16x32_bf16 v[120:123], a[252:255], v[168:171], v[120:123]
s_waitcnt lgkmcnt(6)
ds_read_b128 a[244:247], v7 offset:30976
buffer_load_dwordx4 v36, s[8:11], s32 offen offset:2048 nt lds
v_mfma_f32_16x16x32_bf16 v[144:147], a[208:211], v[192:195], v[136:139]
ds_read_b128 a[248:251], v6 offset:31104
buffer_load_dwordx4 v37, s[8:11], s32 offen offset:3072 nt lds
v_exp_f32_e32 v154, v154
v_exp_f32_e32 v155, v155
v_add_f32_e32 v128, v128, v152
v_mfma_f32_16x16x32_bf16 v[144:147], a[212:215], v[200:203], v[144:147]
ds_read_b128 a[252:255], v7 offset:31104
v_add_f32_e32 v129, v129, v153
v_add_f32_e32 v130, v130, v154
v_add_f32_e32 v131, v131, v155
v_cvt_pk_bf16_f32 v163, v154, v155
v_mfma_f32_16x16x32_bf16 v[144:147], a[216:219], v[208:211], v[144:147]
s_waitcnt lgkmcnt(6)
v_mfma_f32_16x16x32_bf16 v[144:147], a[220:223], v[216:219], v[144:147]
s_waitcnt vmcnt(28)
s_barrier
s_addk_i32 m0, 4096
s_addk_i32 s32, 4096
buffer_load_dwordx4 v38, s[8:11], s32 offen nt lds
ds_read_b64_tr_b16 a[208:209], v12 offset:12352
ds_read_b64_tr_b16 a[210:211], v12 offset:18496
ds_read_b64_tr_b16 a[212:213], v13 offset:12352
v_mfma_f32_16x16x32_bf16 v[144:147], a[224:227], v[224:227], v[144:147]
ds_read_b64_tr_b16 a[214:215], v13 offset:18496
ds_read_b64_tr_b16 a[216:217], v14 offset:12352
ds_read_b64_tr_b16 a[218:219], v14 offset:18496
buffer_load_dwordx4 v39, s[8:11], s32 offen offset:1024 nt lds
v_mfma_f32_16x16x32_bf16 v[144:147], a[228:231], v[232:235], v[144:147]
s_waitcnt lgkmcnt(9)
ds_read_b64_tr_b16 a[220:221], v15 offset:12352
ds_read_b64_tr_b16 a[222:223], v15 offset:18496
buffer_load_dwordx4 v44, s[8:11], s32 offen offset:2048 nt lds
v_mfma_f32_16x16x32_bf16 v[152:155], a[232:235], v[192:195], v[136:139]
ds_read_b64_tr_b16 a[224:225], v12 offset:12480
ds_read_b64_tr_b16 a[226:227], v12 offset:18624
buffer_load_dwordx4 v45, s[8:11], s32 offen offset:3072 nt lds
v_exp_f32_e32 v144, v144
v_exp_f32_e32 v145, v145
v_mfma_f32_16x16x32_bf16 v[152:155], a[236:239], v[200:203], v[152:155]
s_addk_i32 m0, 16512
s_addk_i32 s32, 4096
buffer_load_dwordx4 v36, s[8:11], s32 offen nt lds
ds_read_b64_tr_b16 a[228:229], v13 offset:12480
v_exp_f32_e32 v146, v146
v_exp_f32_e32 v147, v147
v_mfma_f32_16x16x32_bf16 v[152:155], a[240:243], v[208:211], v[152:155]
s_waitcnt lgkmcnt(11)
ds_read_b64_tr_b16 a[230:231], v13 offset:18624
ds_read_b64_tr_b16 a[232:233], v14 offset:12480
ds_read_b64_tr_b16 a[234:235], v14 offset:18624
buffer_load_dwordx4 v37, s[8:11], s32 offen offset:1024 nt lds
v_add_f32_e32 v128, v128, v144
v_add_f32_e32 v129, v129, v145
v_add_f32_e32 v130, v130, v146
v_mfma_f32_16x16x32_bf16 v[152:155], a[244:247], v[216:219], v[152:155]
ds_read_b64_tr_b16 a[236:237], v15 offset:12480
ds_read_b64_tr_b16 a[238:239], v15 offset:18624
buffer_load_dwordx4 v38, s[8:11], s32 offen offset:2048 nt lds
v_add_f32_e32 v131, v131, v147
v_cvt_pk_bf16_f32 v168, v144, v145
v_cvt_pk_bf16_f32 v169, v146, v147
v_mfma_f32_16x16x32_bf16 v[152:155], a[248:251], v[224:227], v[152:155]
ds_read_b64_tr_b16 a[240:241], v12 offset:12608
ds_read_b64_tr_b16 a[242:243], v12 offset:18752
buffer_load_dwordx4 v39, s[8:11], s32 offen offset:3072 nt lds
v_mfma_f32_16x16x32_bf16 v[152:155], a[252:255], v[232:235], v[152:155]
s_waitcnt lgkmcnt(12)
s_addk_i32 m0, 4096
s_addk_i32 s32, 4096
buffer_load_dwordx4 v44, s[8:11], s32 offen nt lds
ds_read_b64_tr_b16 a[244:245], v13 offset:12608
ds_read_b64_tr_b16 a[246:247], v13 offset:18752
v_mfma_f32_16x16x32_bf16 v[32:35], a[208:211], v[160:163], v[32:35]
ds_read_b64_tr_b16 a[248:249], v14 offset:12608
ds_read_b64_tr_b16 a[250:251], v14 offset:18752
buffer_load_dwordx4 v45, s[8:11], s32 offen offset:1024 nt lds
v_exp_f32_e32 v152, v152
v_exp_f32_e32 v153, v153
v_mfma_f32_16x16x32_bf16 v[40:43], a[212:215], v[160:163], v[40:43]
ds_read_b64_tr_b16 a[252:253], v15 offset:12608
ds_read_b64_tr_b16 a[254:255], v15 offset:18752
buffer_load_dwordx4 v36, s[8:11], s32 offen offset:2048 nt lds
v_cvt_pk_bf16_f32 v170, v152, v153
v_mfma_f32_16x16x32_bf16 v[48:51], a[216:219], v[160:163], v[48:51]
s_waitcnt lgkmcnt(12)
buffer_load_dwordx4 v37, s[8:11], s32 offen offset:3072 nt lds
v_mfma_f32_16x16x32_bf16 v[56:59], a[220:223], v[160:163], v[56:59]
s_waitcnt vmcnt(48)
s_barrier
s_movk_i32 m0, 20544
s_addk_i32 s33, 4096
buffer_load_dwordx4 v52, s[12:15], s33 offen nt lds
ds_read_b128 a[208:211], v4 offset:0
ds_read_b128 a[212:215], v5 offset:0
v_mfma_f32_16x16x32_bf16 v[64:67], a[224:227], v[160:163], v[64:67]
ds_read_b128 a[216:219], v4 offset:128
buffer_load_dwordx4 v46, s[12:15], s33 offen offset:1024 nt lds
v_mfma_f32_16x16x32_bf16 v[72:75], a[228:231], v[160:163], v[72:75]
s_waitcnt lgkmcnt(9)
ds_read_b128 a[220:223], v5 offset:128
buffer_load_dwordx4 v47, s[12:15], s33 offen offset:2048 nt lds
v_mfma_f32_16x16x32_bf16 v[80:83], a[232:235], v[160:163], v[80:83]
ds_read_b128 a[224:227], v4 offset:256
v_mfma_f32_16x16x32_bf16 v[88:91], a[236:239], v[160:163], v[88:91]
ds_read_b128 a[228:231], v5 offset:256
buffer_load_dwordx4 v52, s[12:15], s33 offen offset:3072 nt lds
v_mfma_f32_16x16x32_bf16 v[96:99], a[240:243], v[160:163], v[96:99]
s_waitcnt lgkmcnt(6)
s_addk_i32 m0, 16512
s_addk_i32 s33, 4096
buffer_load_dwordx4 v46, s[12:15], s33 offen nt lds
ds_read_b128 a[232:235], v4 offset:6144
v_mfma_f32_16x16x32_bf16 v[104:107], a[244:247], v[160:163], v[104:107]
ds_read_b128 a[236:239], v5 offset:6144
buffer_load_dwordx4 v47, s[12:15], s33 offen offset:1024 nt lds
v_mfma_f32_16x16x32_bf16 v[112:115], a[248:251], v[160:163], v[112:115]
ds_read_b128 a[240:243], v4 offset:6272
v_mfma_f32_16x16x32_bf16 v[120:123], a[252:255], v[160:163], v[120:123]
s_waitcnt lgkmcnt(6)
ds_read_b128 a[244:247], v5 offset:6272
buffer_load_dwordx4 v52, s[12:15], s33 offen offset:2048 nt lds
v_mfma_f32_16x16x32_bf16 v[144:147], a[208:211], v[192:195], v[136:139]
ds_read_b128 a[248:251], v4 offset:6400
buffer_load_dwordx4 v46, s[12:15], s33 offen offset:3072 nt lds
v_exp_f32_e32 v154, v154
v_exp_f32_e32 v155, v155
v_add_f32_e32 v128, v128, v152
v_mfma_f32_16x16x32_bf16 v[144:147], a[212:215], v[200:203], v[144:147]
s_mul_i32 s36, s28, 384
s_add_u32 s36, s36, s101
buffer_load_dword v254, v79, s[16:19], s36 offen offset:0
buffer_load_dword v254, v84, s[16:19], s36 offen offset:0
ds_read_b128 a[252:255], v5 offset:6400
v_add_f32_e32 v129, v129, v153
v_add_f32_e32 v130, v130, v154
v_mfma_f32_16x16x32_bf16 v[144:147], a[216:219], v[208:211], v[144:147]
s_waitcnt lgkmcnt(6)
v_add_f32_e32 v131, v131, v155
v_cvt_pk_bf16_f32 v171, v154, v155
v_mfma_f32_16x16x32_bf16 v[144:147], a[220:223], v[216:219], v[144:147]
s_waitcnt vmcnt(38)
s_barrier
s_addk_i32 m0, 20544
s_addk_i32 s32, 4096
buffer_load_dwordx4 v38, s[8:11], s32 offen nt lds
ds_read_b64_tr_b16 a[208:209], v12 offset:37056
ds_read_b64_tr_b16 a[210:211], v12 offset:43200
ds_read_b64_tr_b16 a[212:213], v13 offset:37056
v_mfma_f32_16x16x32_bf16 v[144:147], a[224:227], v[224:227], v[144:147]
ds_read_b64_tr_b16 a[214:215], v13 offset:43200
ds_read_b64_tr_b16 a[216:217], v14 offset:37056
ds_read_b64_tr_b16 a[218:219], v14 offset:43200
buffer_load_dwordx4 v39, s[8:11], s32 offen offset:1024 nt lds
buffer_load_dwordx4 v44, s[8:11], s32 offen offset:2048 nt lds
v_mfma_f32_16x16x32_bf16 v[144:147], a[228:231], v[232:235], v[144:147]
s_waitcnt lgkmcnt(9)
ds_read_b64_tr_b16 a[220:221], v15 offset:37056
ds_read_b64_tr_b16 a[222:223], v15 offset:43200
buffer_load_dwordx4 v45, s[8:11], s32 offen offset:3072 nt lds
v_mfma_f32_16x16x32_bf16 v[152:155], a[232:235], v[192:195], v[136:139]
s_addk_i32 m0, 16512
s_addk_i32 s32, 4096
buffer_load_dwordx4 v36, s[8:11], s32 offen nt lds
ds_read_b64_tr_b16 a[224:225], v12 offset:37184
v_exp_f32_e32 v144, v144
v_exp_f32_e32 v145, v145
v_mfma_f32_16x16x32_bf16 v[152:155], a[236:239], v[200:203], v[152:155]
ds_read_b64_tr_b16 a[226:227], v12 offset:43328
ds_read_b64_tr_b16 a[228:229], v13 offset:37184
ds_read_b64_tr_b16 a[230:231], v13 offset:43328
v_exp_f32_e32 v146, v146
v_exp_f32_e32 v147, v147
v_add_f32_e32 v128, v128, v144
v_add_f32_e32 v129, v129, v145
v_mfma_f32_16x16x32_bf16 v[152:155], a[240:243], v[208:211], v[152:155]
s_waitcnt lgkmcnt(12)
ds_read_b64_tr_b16 a[232:233], v14 offset:37184
ds_read_b64_tr_b16 a[234:235], v14 offset:43328
buffer_load_dwordx4 v37, s[8:11], s32 offen offset:1024 nt lds
buffer_load_dwordx4 v38, s[8:11], s32 offen offset:2048 nt lds
v_add_f32_e32 v130, v130, v146
v_add_f32_e32 v131, v131, v147
v_mfma_f32_16x16x32_bf16 v[152:155], a[244:247], v[216:219], v[152:155]
ds_read_b64_tr_b16 a[236:237], v15 offset:37184
ds_read_b64_tr_b16 a[238:239], v15 offset:43328
buffer_load_dwordx4 v39, s[8:11], s32 offen offset:3072 nt lds
v_cvt_pk_bf16_f32 v160, v144, v145
v_cvt_pk_bf16_f32 v161, v146, v147
v_mfma_f32_16x16x32_bf16 v[152:155], a[248:251], v[224:227], v[152:155]
s_mov_b32 m0, 41152
s_addk_i32 s33, 4096
buffer_load_dwordx4 v47, s[12:15], s33 offen nt lds
ds_read_b64_tr_b16 a[240:241], v12 offset:37312
ds_read_b64_tr_b16 a[242:243], v12 offset:43456
buffer_load_dwordx4 v52, s[12:15], s33 offen offset:1024 nt lds
v_mfma_f32_16x16x32_bf16 v[152:155], a[252:255], v[232:235], v[152:155]
s_waitcnt lgkmcnt(12)
ds_read_b64_tr_b16 a[244:245], v13 offset:37312
ds_read_b64_tr_b16 a[246:247], v13 offset:43456
buffer_load_dwordx4 v46, s[12:15], s33 offen offset:2048 nt lds
buffer_load_dwordx4 v47, s[12:15], s33 offen offset:3072 nt lds
v_mfma_f32_16x16x32_bf16 v[32:35], a[208:211], v[168:171], v[32:35]
s_addk_i32 m0, 4096
s_addk_i32 s33, 4096
buffer_load_dwordx4 v52, s[12:15], s33 offen nt lds
ds_read_b64_tr_b16 a[248:249], v14 offset:37312
v_exp_f32_e32 v152, v152
v_exp_f32_e32 v153, v153
v_mfma_f32_16x16x32_bf16 v[40:43], a[212:215], v[168:171], v[40:43]
ds_read_b64_tr_b16 a[250:251], v14 offset:43456
ds_read_b64_tr_b16 a[252:253], v15 offset:37312
ds_read_b64_tr_b16 a[254:255], v15 offset:43456
buffer_load_dwordx4 v46, s[12:15], s33 offen offset:1024 nt lds
buffer_load_dwordx4 v47, s[12:15], s33 offen offset:2048 nt lds
v_cvt_pk_bf16_f32 v162, v152, v153
v_mfma_f32_16x16x32_bf16 v[48:51], a[216:219], v[168:171], v[48:51]
s_waitcnt lgkmcnt(12)
buffer_load_dwordx4 v52, s[12:15], s33 offen offset:3072 nt lds
v_mfma_f32_16x16x32_bf16 v[56:59], a[220:223], v[168:171], v[56:59]
s_waitcnt vmcnt(34)
s_barrier
s_mov_b32 m0, 78208
s_addk_i32 s32, 4096
buffer_load_dwordx4 v44, s[8:11], s32 offen nt lds
ds_read_b128 a[208:211], v4 offset:24704
ds_read_b128 a[212:215], v5 offset:24704
v_mfma_f32_16x16x32_bf16 v[64:67], a[224:227], v[168:171], v[64:67]
ds_read_b128 a[216:219], v4 offset:24832
buffer_load_dwordx4 v45, s[8:11], s32 offen offset:1024 nt lds
buffer_load_dwordx4 v36, s[8:11], s32 offen offset:2048 nt lds
v_mfma_f32_16x16x32_bf16 v[72:75], a[228:231], v[168:171], v[72:75]
s_waitcnt lgkmcnt(9)
ds_read_b128 a[220:223], v5 offset:24832
buffer_load_dwordx4 v37, s[8:11], s32 offen offset:3072 nt lds
v_mfma_f32_16x16x32_bf16 v[80:83], a[232:235], v[168:171], v[80:83]
s_addk_i32 m0, 4096
s_addk_i32 s32, 4096
buffer_load_dwordx4 v38, s[8:11], s32 offen nt lds
ds_read_b128 a[224:227], v4 offset:24960
buffer_load_dwordx4 v39, s[8:11], s32 offen offset:1024 nt lds
v_mfma_f32_16x16x32_bf16 v[88:91], a[236:239], v[168:171], v[88:91]
ds_read_b128 a[228:231], v5 offset:24960
buffer_load_dwordx4 v44, s[8:11], s32 offen offset:2048 nt lds
v_mfma_f32_16x16x32_bf16 v[96:99], a[240:243], v[168:171], v[96:99]
s_waitcnt lgkmcnt(6)
ds_read_b128 a[232:235], v4 offset:30848
buffer_load_dwordx4 v45, s[8:11], s32 offen offset:3072 nt lds
v_mfma_f32_16x16x32_bf16 v[104:107], a[244:247], v[168:171], v[104:107]
s_addk_i32 m0, -20544
s_addk_i32 s33, 4096
buffer_load_dwordx4 v46, s[12:15], s33 offen nt lds
ds_read_b128 a[236:239], v5 offset:30848
buffer_load_dwordx4 v47, s[12:15], s33 offen offset:1024 nt lds
v_mfma_f32_16x16x32_bf16 v[112:115], a[248:251], v[168:171], v[112:115]
ds_read_b128 a[240:243], v4 offset:30976
buffer_load_dwordx4 v52, s[12:15], s33 offen offset:2048 nt lds
v_mfma_f32_16x16x32_bf16 v[120:123], a[252:255], v[168:171], v[120:123]
s_waitcnt lgkmcnt(6)
ds_read_b128 a[244:247], v5 offset:30976
buffer_load_dwordx4 v46, s[12:15], s33 offen offset:3072 nt lds
v_mfma_f32_16x16x32_bf16 v[144:147], a[208:211], v[192:195], v[136:139]
s_addk_i32 m0, 4096
s_addk_i32 s33, 4096
buffer_load_dwordx4 v47, s[12:15], s33 offen nt lds
ds_read_b128 a[248:251], v4 offset:31104
v_exp_f32_e32 v154, v154
v_exp_f32_e32 v155, v155
v_mfma_f32_16x16x32_bf16 v[144:147], a[212:215], v[200:203], v[144:147]
ds_read_b128 a[252:255], v5 offset:31104
buffer_load_dwordx4 v52, s[12:15], s33 offen offset:1024 nt lds
buffer_load_dwordx4 v46, s[12:15], s33 offen offset:2048 nt lds
v_add_f32_e32 v128, v128, v152
v_add_f32_e32 v129, v129, v153
v_add_f32_e32 v130, v130, v154
v_mfma_f32_16x16x32_bf16 v[144:147], a[216:219], v[208:211], v[144:147]
s_waitcnt lgkmcnt(6)
buffer_load_dwordx4 v47, s[12:15], s33 offen offset:3072 nt lds
v_add_f32_e32 v131, v131, v155
v_cvt_pk_bf16_f32 v163, v154, v155
v_mfma_f32_16x16x32_bf16 v[144:147], a[220:223], v[216:219], v[144:147]
s_waitcnt vmcnt(38)
s_barrier
s_addk_i32 m0, 4096
s_addk_i32 s33, 4096
buffer_load_dwordx4 v52, s[12:15], s33 offen nt lds
ds_read_b64_tr_b16 a[208:209], v8 offset:12352
ds_read_b64_tr_b16 a[210:211], v8 offset:18496
ds_read_b64_tr_b16 a[212:213], v9 offset:12352
v_mfma_f32_16x16x32_bf16 v[144:147], a[224:227], v[224:227], v[144:147]
ds_read_b64_tr_b16 a[214:215], v9 offset:18496
ds_read_b64_tr_b16 a[216:217], v10 offset:12352
ds_read_b64_tr_b16 a[218:219], v10 offset:18496
buffer_load_dwordx4 v46, s[12:15], s33 offen offset:1024 nt lds
v_mfma_f32_16x16x32_bf16 v[144:147], a[228:231], v[232:235], v[144:147]
s_waitcnt lgkmcnt(9)
ds_read_b64_tr_b16 a[220:221], v11 offset:12352
ds_read_b64_tr_b16 a[222:223], v11 offset:18496
buffer_load_dwordx4 v47, s[12:15], s33 offen offset:2048 nt lds
v_mfma_f32_16x16x32_bf16 v[152:155], a[232:235], v[192:195], v[136:139]
ds_read_b64_tr_b16 a[224:225], v8 offset:12480
ds_read_b64_tr_b16 a[226:227], v8 offset:18624
v_mfma_f32_16x16x32_bf16 v[152:155], a[236:239], v[200:203], v[152:155]
ds_read_b64_tr_b16 a[228:229], v9 offset:12480
v_exp_f32_e32 v144, v144
v_exp_f32_e32 v145, v145
v_exp_f32_e32 v146, v146
v_exp_f32_e32 v147, v147
v_mfma_f32_16x16x32_bf16 v[152:155], a[240:243], v[208:211], v[152:155]
s_waitcnt lgkmcnt(11)
ds_read_b64_tr_b16 a[230:231], v9 offset:18624
ds_read_b64_tr_b16 a[232:233], v10 offset:12480
ds_read_b64_tr_b16 a[234:235], v10 offset:18624
buffer_load_dwordx4 v52, s[12:15], s33 offen offset:3072 nt lds
v_add_f32_e32 v128, v128, v144
v_add_f32_e32 v129, v129, v145
v_add_f32_e32 v130, v130, v146
v_mfma_f32_16x16x32_bf16 v[152:155], a[244:247], v[216:219], v[152:155]
s_addk_i32 m0, 16512
s_addk_i32 s33, 4096
buffer_load_dwordx4 v46, s[12:15], s33 offen nt lds
ds_read_b64_tr_b16 a[236:237], v11 offset:12480
ds_read_b64_tr_b16 a[238:239], v11 offset:18624
buffer_load_dwordx4 v47, s[12:15], s33 offen offset:1024 nt lds
v_add_f32_e32 v131, v131, v147
v_mfma_f32_16x16x32_bf16 v[152:155], a[248:251], v[224:227], v[152:155]
ds_read_b64_tr_b16 a[240:241], v8 offset:12608
ds_read_b64_tr_b16 a[242:243], v8 offset:18752
v_cvt_pk_bf16_f32 v168, v144, v145
v_cvt_pk_bf16_f32 v169, v146, v147
v_mfma_f32_16x16x32_bf16 v[152:155], a[252:255], v[232:235], v[152:155]
s_waitcnt lgkmcnt(12)
ds_read_b64_tr_b16 a[244:245], v9 offset:12608
ds_read_b64_tr_b16 a[246:247], v9 offset:18752
buffer_load_dwordx4 v52, s[12:15], s33 offen offset:2048 nt lds
v_mfma_f32_16x16x32_bf16 v[32:35], a[208:211], v[160:163], v[32:35]
ds_read_b64_tr_b16 a[248:249], v10 offset:12608
ds_read_b64_tr_b16 a[250:251], v10 offset:18752
buffer_load_dwordx4 v46, s[12:15], s33 offen offset:3072 nt lds
v_exp_f32_e32 v152, v152
v_exp_f32_e32 v153, v153
v_mfma_f32_16x16x32_bf16 v[40:43], a[212:215], v[160:163], v[40:43]
ds_read_b64_tr_b16 a[252:253], v11 offset:12608
ds_read_b64_tr_b16 a[254:255], v11 offset:18752
v_cvt_pk_bf16_f32 v170, v152, v153
v_mfma_f32_16x16x32_bf16 v[48:51], a[216:219], v[160:163], v[48:51]
s_waitcnt lgkmcnt(12)
v_mfma_f32_16x16x32_bf16 v[56:59], a[220:223], v[160:163], v[56:59]
s_waitcnt vmcnt(36)
s_barrier
s_addk_i32 m0, 4096
s_addk_i32 s33, 4096
buffer_load_dwordx4 v47, s[12:15], s33 offen nt lds
ds_read_b128 a[208:211], v6 offset:0
ds_read_b128 a[212:215], v7 offset:0
v_mfma_f32_16x16x32_bf16 v[64:67], a[224:227], v[160:163], v[64:67]
ds_read_b128 a[216:219], v6 offset:128
buffer_load_dwordx4 v52, s[12:15], s33 offen offset:1024 nt lds
v_mfma_f32_16x16x32_bf16 v[72:75], a[228:231], v[160:163], v[72:75]
s_waitcnt lgkmcnt(9)
ds_read_b128 a[220:223], v7 offset:128
buffer_load_dwordx4 v46, s[12:15], s33 offen offset:2048 nt lds
v_mfma_f32_16x16x32_bf16 v[80:83], a[232:235], v[160:163], v[80:83]
ds_read_b128 a[224:227], v6 offset:256
buffer_load_dwordx4 v47, s[12:15], s33 offen offset:3072 nt lds
v_mfma_f32_16x16x32_bf16 v[88:91], a[236:239], v[160:163], v[88:91]
s_addk_i32 m0, 4096
s_addk_i32 s33, 4096
buffer_load_dwordx4 v52, s[12:15], s33 offen nt lds
ds_read_b128 a[228:231], v7 offset:256
v_mfma_f32_16x16x32_bf16 v[96:99], a[240:243], v[160:163], v[96:99]
s_waitcnt lgkmcnt(6)
ds_read_b128 a[232:235], v6 offset:6144
v_mfma_f32_16x16x32_bf16 v[104:107], a[244:247], v[160:163], v[104:107]
ds_read_b128 a[236:239], v7 offset:6144
buffer_load_dwordx4 v46, s[12:15], s33 offen offset:1024 nt lds
v_mfma_f32_16x16x32_bf16 v[112:115], a[248:251], v[160:163], v[112:115]
ds_read_b128 a[240:243], v6 offset:6272
buffer_load_dwordx4 v47, s[12:15], s33 offen offset:2048 nt lds
v_mfma_f32_16x16x32_bf16 v[120:123], a[252:255], v[160:163], v[120:123]
s_waitcnt lgkmcnt(6)
ds_read_b128 a[244:247], v7 offset:6272
buffer_load_dwordx4 v52, s[12:15], s33 offen offset:3072 nt lds
v_mfma_f32_16x16x32_bf16 v[144:147], a[208:211], v[192:195], v[136:139]
s_add_u32 s36, s28, 1
s_mul_i32 s34, s36, 384
s_mul_i32 s35, s28, 245760
s_addk_i32 m0, 4160
s_add_u32 s36, s34, 0
buffer_load_dwordx4 v53, s[16:19], s36 offen lds
buffer_load_dwordx4 v54, s[16:19], s36 offen offset:1024 lds
buffer_load_dwordx4 v55, s[16:19], s36 offen offset:2048 lds
s_addk_i32 m0, 3096
s_add_u32 s36, s34, 98304
buffer_load_dwordx4 v53, s[16:19], s36 offen lds
buffer_load_dwordx4 v54, s[16:19], s36 offen offset:1024 lds
buffer_load_dwordx4 v55, s[16:19], s36 offen offset:2048 lds
s_addk_i32 m0, 3080
s_add_u32 s36, s34, 196608
buffer_load_dwordx4 v53, s[16:19], s36 offen lds
buffer_load_dwordx4 v54, s[16:19], s36 offen offset:1024 lds
buffer_load_dwordx4 v55, s[16:19], s36 offen offset:2048 lds
s_addk_i32 m0, 3096
s_add_u32 s36, s34, 294912
buffer_load_dwordx4 v53, s[16:19], s36 offen lds
buffer_load_dwordx4 v54, s[16:19], s36 offen offset:1024 lds
buffer_load_dwordx4 v55, s[16:19], s36 offen offset:2048 lds
v_mfma_f32_16x16x32_bf16 v[144:147], a[212:215], v[200:203], v[144:147]
s_addk_i32 m0, 3080
s_add_u32 s36, s34, 393216
buffer_load_dwordx4 v53, s[16:19], s36 offen lds
buffer_load_dwordx4 v54, s[16:19], s36 offen offset:1024 lds
buffer_load_dwordx4 v55, s[16:19], s36 offen offset:2048 lds
s_addk_i32 m0, 3096
s_add_u32 s36, s34, 491520
buffer_load_dwordx4 v53, s[16:19], s36 offen lds
buffer_load_dwordx4 v54, s[16:19], s36 offen offset:1024 lds
buffer_load_dwordx4 v55, s[16:19], s36 offen offset:2048 lds
s_addk_i32 m0, 3080
s_add_u32 s36, s34, 589824
buffer_load_dwordx4 v53, s[16:19], s36 offen lds
buffer_load_dwordx4 v54, s[16:19], s36 offen offset:1024 lds
buffer_load_dwordx4 v55, s[16:19], s36 offen offset:2048 lds
s_addk_i32 m0, 3096
s_add_u32 s36, s34, 688128
buffer_load_dwordx4 v53, s[16:19], s36 offen lds
buffer_load_dwordx4 v54, s[16:19], s36 offen offset:1024 lds
buffer_load_dwordx4 v55, s[16:19], s36 offen offset:2048 lds
ds_read_b128 a[248:251], v6 offset:6400
v_mfma_f32_16x16x32_bf16 v[144:147], a[216:219], v[208:211], v[144:147]
s_waitcnt lgkmcnt(5)
ds_read_b128 a[252:255], v7 offset:6400
v_exp_f32_e32 v154, v154
v_exp_f32_e32 v155, v155
v_add_f32_e32 v128, v128, v152
v_add_f32_e32 v129, v129, v153
v_add_f32_e32 v130, v130, v154
v_add_f32_e32 v131, v131, v155
v_mfma_f32_16x16x32_bf16 v[144:147], a[220:223], v[216:219], v[144:147]
s_waitcnt vmcnt(56)
s_barrier
ds_read_b64_tr_b16 a[208:209], v8 offset:37056
ds_read_b64_tr_b16 a[210:211], v8 offset:43200
ds_read_b64_tr_b16 a[212:213], v9 offset:37056
ds_read_b64_tr_b16 a[214:215], v9 offset:43200
v_cvt_pk_bf16_f32 v171, v154, v155
v_mfma_f32_16x16x32_bf16 v[144:147], a[224:227], v[224:227], v[144:147]
ds_read_b64_tr_b16 a[216:217], v10 offset:37056
ds_read_b64_tr_b16 a[218:219], v10 offset:43200
v_mfma_f32_16x16x32_bf16 v[144:147], a[228:231], v[232:235], v[144:147]
s_waitcnt lgkmcnt(9)
ds_read_b64_tr_b16 a[220:221], v11 offset:37056
ds_read_b64_tr_b16 a[222:223], v11 offset:43200
v_mfma_f32_16x16x32_bf16 v[152:155], a[232:235], v[192:195], v[136:139]
ds_read_b64_tr_b16 a[224:225], v8 offset:37184
ds_read_b64_tr_b16 a[226:227], v8 offset:43328
v_mfma_f32_16x16x32_bf16 v[152:155], a[236:239], v[200:203], v[152:155]
ds_read_b64_tr_b16 a[228:229], v9 offset:37184
v_exp_f32_e32 v144, v144
v_exp_f32_e32 v145, v145
v_exp_f32_e32 v146, v146
v_exp_f32_e32 v147, v147
v_mfma_f32_16x16x32_bf16 v[152:155], a[240:243], v[208:211], v[152:155]
s_waitcnt lgkmcnt(11)
ds_read_b64_tr_b16 a[230:231], v9 offset:43328
ds_read_b64_tr_b16 a[232:233], v10 offset:37184
ds_read_b64_tr_b16 a[234:235], v10 offset:43328
v_add_f32_e32 v128, v128, v144
v_add_f32_e32 v129, v129, v145
v_add_f32_e32 v130, v130, v146
v_add_f32_e32 v131, v131, v147
v_cvt_pk_bf16_f32 v160, v144, v145
v_cvt_pk_bf16_f32 v161, v146, v147
v_mfma_f32_16x16x32_bf16 v[152:155], a[244:247], v[216:219], v[152:155]
ds_read_b64_tr_b16 a[236:237], v11 offset:37184
ds_read_b64_tr_b16 a[238:239], v11 offset:43328
v_mfma_f32_16x16x32_bf16 v[152:155], a[248:251], v[224:227], v[152:155]
ds_read_b64_tr_b16 a[240:241], v8 offset:37312
ds_read_b64_tr_b16 a[242:243], v8 offset:43456
v_mfma_f32_16x16x32_bf16 v[152:155], a[252:255], v[232:235], v[152:155]
s_waitcnt lgkmcnt(12)
ds_read_b64_tr_b16 a[244:245], v9 offset:37312
ds_read_b64_tr_b16 a[246:247], v9 offset:43456
v_mfma_f32_16x16x32_bf16 v[32:35], a[208:211], v[168:171], v[32:35]
ds_read_b64_tr_b16 a[248:249], v10 offset:37312
ds_read_b64_tr_b16 a[250:251], v10 offset:43456
v_mfma_f32_16x16x32_bf16 v[40:43], a[212:215], v[168:171], v[40:43]
ds_read_b64_tr_b16 a[252:253], v11 offset:37312
ds_read_b64_tr_b16 a[254:255], v11 offset:43456
v_exp_f32_e32 v152, v152
v_exp_f32_e32 v153, v153
v_mfma_f32_16x16x32_bf16 v[48:51], a[216:219], v[168:171], v[48:51]
s_waitcnt lgkmcnt(12)
v_cvt_pk_bf16_f32 v162, v152, v153
v_mfma_f32_16x16x32_bf16 v[56:59], a[220:223], v[168:171], v[56:59]
s_waitcnt vmcnt(48)
s_barrier
s_addk_i32 m0, 3080
s_add_u32 s36, s34, 786432
buffer_load_dwordx4 v53, s[16:19], s36 offen lds
buffer_load_dwordx4 v54, s[16:19], s36 offen offset:1024 lds
buffer_load_dwordx4 v55, s[16:19], s36 offen offset:2048 lds
s_addk_i32 m0, 3096
s_add_u32 s36, s34, 884736
buffer_load_dwordx4 v53, s[16:19], s36 offen lds
buffer_load_dwordx4 v54, s[16:19], s36 offen offset:1024 lds
buffer_load_dwordx4 v55, s[16:19], s36 offen offset:2048 lds
s_addk_i32 m0, 3080
s_add_u32 s36, s34, 983040
buffer_load_dwordx4 v53, s[16:19], s36 offen lds
buffer_load_dwordx4 v54, s[16:19], s36 offen offset:1024 lds
buffer_load_dwordx4 v55, s[16:19], s36 offen offset:2048 lds
s_addk_i32 m0, 3096
s_add_u32 s36, s34, 1081344
buffer_load_dwordx4 v53, s[16:19], s36 offen lds
buffer_load_dwordx4 v54, s[16:19], s36 offen offset:1024 lds
buffer_load_dwordx4 v55, s[16:19], s36 offen offset:2048 lds
ds_read_b128 a[208:211], v6 offset:24704
v_mfma_f32_16x16x32_bf16 v[64:67], a[224:227], v[168:171], v[64:67]
ds_read_b128 a[212:215], v7 offset:24704
ds_read_b128 a[216:219], v6 offset:24832
v_mfma_f32_16x16x32_bf16 v[72:75], a[228:231], v[168:171], v[72:75]
s_waitcnt lgkmcnt(9)
ds_read_b128 a[220:223], v7 offset:24832
v_mfma_f32_16x16x32_bf16 v[80:83], a[232:235], v[168:171], v[80:83]
ds_read_b128 a[224:227], v6 offset:24960
v_mfma_f32_16x16x32_bf16 v[88:91], a[236:239], v[168:171], v[88:91]
ds_read_b128 a[228:231], v7 offset:24960
v_mfma_f32_16x16x32_bf16 v[96:99], a[240:243], v[168:171], v[96:99]
s_waitcnt lgkmcnt(6)
ds_read_b128 a[232:235], v6 offset:30848
v_mfma_f32_16x16x32_bf16 v[104:107], a[244:247], v[168:171], v[104:107]
ds_read_b128 a[236:239], v7 offset:30848
v_mfma_f32_16x16x32_bf16 v[112:115], a[248:251], v[168:171], v[112:115]
ds_read_b128 a[240:243], v6 offset:30976
v_mfma_f32_16x16x32_bf16 v[120:123], a[252:255], v[168:171], v[120:123]
s_waitcnt lgkmcnt(6)
ds_read_b128 a[244:247], v7 offset:30976
v_mfma_f32_16x16x32_bf16 v[144:147], a[208:211], v[192:195], v[136:139]
ds_read_b128 a[248:251], v6 offset:31104
v_exp_f32_e32 v154, v154
v_exp_f32_e32 v155, v155
v_add_f32_e32 v128, v128, v152
v_add_f32_e32 v129, v129, v153
v_add_f32_e32 v130, v130, v154
v_add_f32_e32 v131, v131, v155
v_mfma_f32_16x16x32_bf16 v[144:147], a[212:215], v[200:203], v[144:147]
ds_read_b128 a[252:255], v7 offset:31104
v_cvt_pk_bf16_f32 v163, v154, v155
v_mfma_f32_16x16x32_bf16 v[144:147], a[216:219], v[208:211], v[144:147]
s_waitcnt lgkmcnt(6)
v_mfma_f32_16x16x32_bf16 v[144:147], a[220:223], v[216:219], v[144:147]
s_waitcnt vmcnt(48)
s_barrier
s_addk_i32 m0, 3080
s_add_u32 s36, s34, 1179648
buffer_load_dwordx4 v53, s[16:19], s36 offen lds
buffer_load_dwordx4 v54, s[16:19], s36 offen offset:1024 lds
buffer_load_dwordx4 v55, s[16:19], s36 offen offset:2048 lds
s_addk_i32 m0, 3096
s_add_u32 s36, s34, 1277952
buffer_load_dwordx4 v53, s[16:19], s36 offen lds
buffer_load_dwordx4 v54, s[16:19], s36 offen offset:1024 lds
buffer_load_dwordx4 v55, s[16:19], s36 offen offset:2048 lds
s_addk_i32 m0, 3080
s_add_u32 s36, s34, 1376256
buffer_load_dwordx4 v53, s[16:19], s36 offen lds
buffer_load_dwordx4 v54, s[16:19], s36 offen offset:1024 lds
buffer_load_dwordx4 v55, s[16:19], s36 offen offset:2048 lds
s_addk_i32 m0, 3096
s_add_u32 s36, s34, 1474560
buffer_load_dwordx4 v53, s[16:19], s36 offen lds
buffer_load_dwordx4 v54, s[16:19], s36 offen offset:1024 lds
buffer_load_dwordx4 v55, s[16:19], s36 offen offset:2048 lds
ds_read_b64_tr_b16 a[208:209], v12 offset:12352
ds_read_b64_tr_b16 a[210:211], v12 offset:18496
v_mfma_f32_16x16x32_bf16 v[144:147], a[224:227], v[224:227], v[144:147]
s_movk_i32 m0, 0
s_addk_i32 s32, 4096
buffer_load_dwordx4 v36, s[8:11], s32 offen nt lds
ds_read_b64_tr_b16 a[212:213], v13 offset:12352
ds_read_b64_tr_b16 a[214:215], v13 offset:18496
ds_read_b64_tr_b16 a[216:217], v14 offset:12352
ds_read_b64_tr_b16 a[218:219], v14 offset:18496
v_mfma_f32_16x16x32_bf16 v[144:147], a[228:231], v[232:235], v[144:147]
s_waitcnt lgkmcnt(9)
ds_read_b64_tr_b16 a[220:221], v15 offset:12352
ds_read_b64_tr_b16 a[222:223], v15 offset:18496
buffer_load_dwordx4 v37, s[8:11], s32 offen offset:1024 nt lds
buffer_load_dwordx4 v38, s[8:11], s32 offen offset:2048 nt lds
v_mfma_f32_16x16x32_bf16 v[152:155], a[232:235], v[192:195], v[136:139]
ds_read_b64_tr_b16 a[224:225], v12 offset:12480
ds_read_b64_tr_b16 a[226:227], v12 offset:18624
v_exp_f32_e32 v144, v144
v_exp_f32_e32 v145, v145
v_exp_f32_e32 v146, v146
v_cvt_pk_bf16_f32 v168, v144, v145
v_mfma_f32_16x16x32_bf16 v[152:155], a[236:239], v[200:203], v[152:155]
ds_read_b64_tr_b16 a[228:229], v13 offset:12480
ds_read_b64_tr_b16 a[230:231], v13 offset:18624
buffer_load_dwordx4 v39, s[8:11], s32 offen offset:3072 nt lds
v_exp_f32_e32 v147, v147
v_add_f32_e32 v128, v128, v144
v_cvt_pk_bf16_f32 v169, v146, v147
v_mfma_f32_16x16x32_bf16 v[152:155], a[240:243], v[208:211], v[152:155]
s_waitcnt lgkmcnt(12)
s_movk_i32 m0, 4096
s_addk_i32 s32, 4096
buffer_load_dwordx4 v44, s[8:11], s32 offen nt lds
ds_read_b64_tr_b16 a[232:233], v14 offset:12480
ds_read_b64_tr_b16 a[234:235], v14 offset:18624
buffer_load_dwordx4 v45, s[8:11], s32 offen offset:1024 nt lds
v_mfma_f32_16x16x32_bf16 v[152:155], a[244:247], v[216:219], v[152:155]
ds_read_b64_tr_b16 a[236:237], v15 offset:12480
ds_read_b64_tr_b16 a[238:239], v15 offset:18624
buffer_load_dwordx4 v36, s[8:11], s32 offen offset:2048 nt lds
buffer_load_dwordx4 v37, s[8:11], s32 offen offset:3072 nt lds
v_add_f32_e32 v129, v129, v145
v_add_f32_e32 v130, v130, v146
v_mfma_f32_16x16x32_bf16 v[152:155], a[248:251], v[224:227], v[152:155]
s_movk_i32 m0, 8192
s_addk_i32 s32, 4096
buffer_load_dwordx4 v38, s[8:11], s32 offen nt lds
ds_read_b64_tr_b16 a[240:241], v12 offset:12608
ds_read_b64_tr_b16 a[242:243], v12 offset:18752
buffer_load_dwordx4 v39, s[8:11], s32 offen offset:1024 nt lds
v_add_f32_e32 v131, v131, v147
v_mfma_f32_16x16x32_bf16 v[152:155], a[252:255], v[232:235], v[152:155]
s_waitcnt lgkmcnt(12)
ds_read_b64_tr_b16 a[244:245], v13 offset:12608
ds_read_b64_tr_b16 a[246:247], v13 offset:18752
buffer_load_dwordx4 v44, s[8:11], s32 offen offset:2048 nt lds
buffer_load_dwordx4 v45, s[8:11], s32 offen offset:3072 nt lds
v_mfma_f32_16x16x32_bf16 v[32:35], a[208:211], v[160:163], v[32:35]
s_movk_i32 m0, 24704
s_addk_i32 s32, 4096
buffer_load_dwordx4 v36, s[8:11], s32 offen nt lds
ds_read_b64_tr_b16 a[248:249], v14 offset:12608
v_exp_f32_e32 v152, v152
v_exp_f32_e32 v153, v153
v_mfma_f32_16x16x32_bf16 v[40:43], a[212:215], v[160:163], v[40:43]
ds_read_b64_tr_b16 a[250:251], v14 offset:18752
ds_read_b64_tr_b16 a[252:253], v15 offset:12608
ds_read_b64_tr_b16 a[254:255], v15 offset:18752
v_exp_f32_e32 v154, v154
v_exp_f32_e32 v155, v155
v_cvt_pk_bf16_f32 v170, v152, v153
v_cvt_pk_bf16_f32 v171, v154, v155
v_mfma_f32_16x16x32_bf16 v[48:51], a[216:219], v[160:163], v[48:51]
s_waitcnt lgkmcnt(12)
buffer_load_dwordx4 v37, s[8:11], s32 offen offset:1024 nt lds
buffer_load_dwordx4 v38, s[8:11], s32 offen offset:2048 nt lds
buffer_load_dwordx4 v39, s[8:11], s32 offen offset:3072 nt lds
s_movk_i32 m0, 28800
s_addk_i32 s32, 4096
buffer_load_dwordx4 v44, s[8:11], s32 offen nt lds
buffer_load_dwordx4 v45, s[8:11], s32 offen offset:1024 nt lds
buffer_load_dwordx4 v36, s[8:11], s32 offen offset:2048 nt lds
buffer_load_dwordx4 v37, s[8:11], s32 offen offset:3072 nt lds
s_addk_i32 m0, 4096
s_addk_i32 s32, 4096
buffer_load_dwordx4 v38, s[8:11], s32 offen nt lds
buffer_load_dwordx4 v39, s[8:11], s32 offen offset:1024 nt lds
buffer_load_dwordx4 v44, s[8:11], s32 offen offset:2048 nt lds
buffer_load_dwordx4 v45, s[8:11], s32 offen offset:3072 nt lds
s_addk_i32 m0, 16512
s_addk_i32 s32, 4096
buffer_load_dwordx4 v36, s[8:11], s32 offen nt lds
buffer_load_dwordx4 v37, s[8:11], s32 offen offset:1024 nt lds
buffer_load_dwordx4 v38, s[8:11], s32 offen offset:2048 nt lds
buffer_load_dwordx4 v39, s[8:11], s32 offen offset:3072 nt lds
s_movk_i32 m0, 12352
s_addk_i32 s33, 4096
buffer_load_dwordx4 v46, s[12:15], s33 offen nt lds
buffer_load_dwordx4 v47, s[12:15], s33 offen offset:1024 nt lds
buffer_load_dwordx4 v52, s[12:15], s33 offen offset:2048 nt lds
buffer_load_dwordx4 v46, s[12:15], s33 offen offset:3072 nt lds
s_movk_i32 m0, 16448
s_addk_i32 s33, 4096
buffer_load_dwordx4 v47, s[12:15], s33 offen nt lds
buffer_load_dwordx4 v52, s[12:15], s33 offen offset:1024 nt lds
buffer_load_dwordx4 v46, s[12:15], s33 offen offset:2048 nt lds
buffer_load_dwordx4 v47, s[12:15], s33 offen offset:3072 nt lds
s_add_u32 m0, s93, 148224
s_mov_b32 s37, 0
buffer_load_dwordx4 v1, s[4:7], s37 offen lds
buffer_load_dwordx4 v2, s[4:7], s37 offen offset:1024 lds
v_mfma_f32_16x16x32_bf16 v[56:59], a[220:223], v[160:163], v[56:59]
s_waitcnt vmcnt(63)
s_barrier
s_mov_b32 m0, 53504
s_addk_i32 s32, 4096
buffer_load_dwordx4 v44, s[8:11], s32 offen nt lds
ds_read_b64_tr_b16 a[208:209], v12 offset:37056
ds_read_b64_tr_b16 a[210:211], v12 offset:43200
ds_read_b64_tr_b16 a[212:213], v13 offset:37056
v_mfma_f32_16x16x32_bf16 v[64:67], a[224:227], v[160:163], v[64:67]
ds_read_b64_tr_b16 a[214:215], v13 offset:43200
ds_read_b64_tr_b16 a[216:217], v14 offset:37056
ds_read_b64_tr_b16 a[218:219], v14 offset:43200
v_add_f32_e32 v128, v128, v152
v_add_f32_e32 v129, v129, v153
v_add_f32_e32 v130, v130, v154
v_add_f32_e32 v131, v131, v155
v_mfma_f32_16x16x32_bf16 v[72:75], a[228:231], v[160:163], v[72:75]
s_waitcnt lgkmcnt(12)
ds_read_b64_tr_b16 a[220:221], v15 offset:37056
ds_read_b64_tr_b16 a[222:223], v15 offset:43200
buffer_load_dwordx4 v45, s[8:11], s32 offen offset:1024 nt lds
buffer_load_dwordx4 v36, s[8:11], s32 offen offset:2048 nt lds
v_mfma_f32_16x16x32_bf16 v[80:83], a[232:235], v[160:163], v[80:83]
ds_read_b64_tr_b16 a[224:225], v12 offset:37184
ds_read_b64_tr_b16 a[226:227], v12 offset:43328
buffer_load_dwordx4 v37, s[8:11], s32 offen offset:3072 nt lds
v_mfma_f32_16x16x32_bf16 v[88:91], a[236:239], v[160:163], v[88:91]
s_addk_i32 m0, 4096
s_addk_i32 s32, 4096
buffer_load_dwordx4 v38, s[8:11], s32 offen nt lds
ds_read_b64_tr_b16 a[228:229], v13 offset:37184
ds_read_b64_tr_b16 a[230:231], v13 offset:43328
v_mfma_f32_16x16x32_bf16 v[96:99], a[240:243], v[160:163], v[96:99]
s_waitcnt lgkmcnt(12)
ds_read_b64_tr_b16 a[232:233], v14 offset:37184
ds_read_b64_tr_b16 a[234:235], v14 offset:43328
buffer_load_dwordx4 v39, s[8:11], s32 offen offset:1024 nt lds
v_mfma_f32_16x16x32_bf16 v[104:107], a[244:247], v[160:163], v[104:107]
ds_read_b64_tr_b16 a[236:237], v15 offset:37184
ds_read_b64_tr_b16 a[238:239], v15 offset:43328
buffer_load_dwordx4 v44, s[8:11], s32 offen offset:2048 nt lds
v_mfma_f32_16x16x32_bf16 v[112:115], a[248:251], v[160:163], v[112:115]
ds_read_b64_tr_b16 a[240:241], v12 offset:37312
ds_read_b64_tr_b16 a[242:243], v12 offset:43456
buffer_load_dwordx4 v45, s[8:11], s32 offen offset:3072 nt lds
v_mfma_f32_16x16x32_bf16 v[120:123], a[252:255], v[160:163], v[120:123]
s_waitcnt lgkmcnt(12)
s_movk_i32 m0, 20544
s_addk_i32 s33, 4096
buffer_load_dwordx4 v52, s[12:15], s33 offen nt lds
ds_read_b64_tr_b16 a[244:245], v13 offset:37312
ds_read_b64_tr_b16 a[246:247], v13 offset:43456
v_mfma_f32_16x16x32_bf16 v[32:35], a[208:211], v[168:171], v[32:35]
ds_read_b64_tr_b16 a[248:249], v14 offset:37312
ds_read_b64_tr_b16 a[250:251], v14 offset:43456
buffer_load_dwordx4 v46, s[12:15], s33 offen offset:1024 nt lds
v_add_f32_e32 v128, v128, v129
v_add_f32_e32 v130, v130, v131
v_add_f32_e32 v128, v128, v130
v_mov_b32_e32 v27, v128
v_mfma_f32_16x16x32_bf16 v[40:43], a[212:215], v[168:171], v[40:43]
ds_read_b64_tr_b16 a[252:253], v15 offset:37312
ds_read_b64_tr_b16 a[254:255], v15 offset:43456
buffer_load_dwordx4 v47, s[12:15], s33 offen offset:2048 nt lds
v_permlane32_swap_b32 v128, v27
v_add_f32_e32 v128, v128, v27
v_mov_b32_e32 v27, v128
v_mfma_f32_16x16x32_bf16 v[48:51], a[216:219], v[168:171], v[48:51]
s_waitcnt lgkmcnt(12)
buffer_load_dwordx4 v52, s[12:15], s33 offen offset:3072 nt lds
v_permlane16_swap_b32 v128, v27
v_add_f32_e32 v128, v128, v27
v_rcp_f32_e32 v28, v128
v_cmp_nge_f32_e64 vcc, s42, v128
v_mfma_f32_16x16x32_bf16 v[56:59], a[220:223], v[168:171], v[56:59]
s_addk_i32 m0, 16512
s_addk_i32 s33, 4096
buffer_load_dwordx4 v46, s[12:15], s33 offen nt lds
v_mul_f32_e32 v32, v28, v32
v_mul_f32_e32 v33, v28, v33
v_mul_f32_e32 v34, v28, v34
v_mul_f32_e32 v35, v28, v35
v_mul_f32_e32 v40, v28, v40
v_mfma_f32_16x16x32_bf16 v[64:67], a[224:227], v[168:171], v[64:67]
buffer_load_dwordx4 v47, s[12:15], s33 offen offset:1024 nt lds
v_mul_f32_e32 v41, v28, v41
v_mul_f32_e32 v42, v28, v42
v_mul_f32_e32 v43, v28, v43
v_mul_f32_e32 v48, v28, v48
v_mul_f32_e32 v49, v28, v49
v_mul_f32_e32 v50, v28, v50
v_mfma_f32_16x16x32_bf16 v[72:75], a[228:231], v[168:171], v[72:75]
s_waitcnt lgkmcnt(6)
buffer_load_dwordx4 v52, s[12:15], s33 offen offset:2048 nt lds
v_mul_f32_e32 v51, v28, v51
v_mfma_f32_16x16x32_bf16 v[80:83], a[232:235], v[168:171], v[80:83]
buffer_load_dwordx4 v46, s[12:15], s33 offen offset:3072 nt lds
v_mfma_f32_16x16x32_bf16 v[88:91], a[236:239], v[168:171], v[88:91]
s_addk_i32 m0, 4096
s_addk_i32 s33, 4096
buffer_load_dwordx4 v47, s[12:15], s33 offen nt lds
v_mfma_f32_16x16x32_bf16 v[96:99], a[240:243], v[168:171], v[96:99]
s_waitcnt lgkmcnt(0)
buffer_load_dwordx4 v52, s[12:15], s33 offen offset:1024 nt lds
v_mfma_f32_16x16x32_bf16 v[104:107], a[244:247], v[168:171], v[104:107]
buffer_load_dwordx4 v46, s[12:15], s33 offen offset:2048 nt lds
v_mfma_f32_16x16x32_bf16 v[112:115], a[248:251], v[168:171], v[112:115]
buffer_load_dwordx4 v47, s[12:15], s33 offen offset:3072 nt lds
v_mfma_f32_16x16x32_bf16 v[120:123], a[252:255], v[168:171], v[120:123]
s_branch L_T2
L_slow1:
s_nop 7
s_waitcnt vmcnt(0) lgkmcnt(0)
v_mbcnt_lo_u32_b32 v185, -1, 0
v_mbcnt_hi_u32_b32 v185, -1, v185
v_and_b32_e32 v186, 15, v185
v_lshrrev_b32_e32 v187, 4, v185
v_mul_u32_u24_e32 v27, 384, v186
v_lshl_add_u32 v27, v187, 4, v27
v_lshrrev_b32_e32 v29, 1, v185
v_mul_u32_u24_e32 v29, 384, v29
v_and_b32_e32 v184, 1, v185
v_lshl_add_u32 v29, v184, 4, v29
s_lshl_b32 s44, s3, 10
s_add_u32 s44, s44, 74112
v_lshlrev_b32_e32 v184, 4, v185
v_add_u32_e32 v184, s44, v184
v_lshrrev_b32_e32 v31, 2, v186
v_lshl_add_u32 v31, v187, 2, v31
v_lshlrev_b32_e32 v31, 5, v31
v_and_b32_e32 v186, 3, v186
v_lshl_add_u32 v31, v186, 3, v31
v_add_u32_e32 v31, s44, v31
v_mov_b32_e32 v240, 0x3f803f80
v_mov_b32_e32 v241, 0x3f803f80
v_mov_b32_e32 v242, 0x3f803f80
v_mov_b32_e32 v243, 0x3f803f80
s_mul_i32 s45, s28, 196608
v_mov_b32_e32 v28, 0xff800000
s_mov_b32 s46, s45
s_mov_b32 s48, 0
L_sl1_1:
s_add_u32 s47, s46, 0
buffer_load_dwordx4 v[176:179], v27, s[8:11], s47 offen offset:0
s_waitcnt vmcnt(0)
v_mfma_f32_16x16x32_bf16 v[144:147], v[176:179], v[192:195], 0
s_nop 7
s_add_u32 s47, s46, 0
buffer_load_dwordx4 v[176:179], v27, s[8:11], s47 offen offset:64
s_waitcnt vmcnt(0)
v_mfma_f32_16x16x32_bf16 v[144:147], v[176:179], v[200:203], v[144:147]
s_nop 7
s_add_u32 s47, s46, 0
buffer_load_dwordx4 v[176:179], v27, s[8:11], s47 offen offset:128
s_waitcnt vmcnt(0)
v_mfma_f32_16x16x32_bf16 v[144:147], v[176:179], v[208:211], v[144:147]
s_nop 7
s_add_u32 s47, s46, 0
buffer_load_dwordx4 v[176:179], v27, s[8:11], s47 offen offset:192
s_waitcnt vmcnt(0)
v_mfma_f32_16x16x32_bf16 v[144:147], v[176:179], v[216:219], v[144:147]
s_nop 7
s_add_u32 s47, s46, 0
buffer_load_dwordx4 v[176:179], v27, s[8:11], s47 offen offset:256
s_waitcnt vmcnt(0)
v_mfma_f32_16x16x32_bf16 v[144:147], v[176:179], v[224:227], v[144:147]
s_nop 7
s_add_u32 s47, s46, 0
buffer_load_dwordx4 v[176:179], v27, s[8:11], s47 offen offset:320
s_waitcnt vmcnt(0)
v_mfma_f32_16x16x32_bf16 v[144:147], v[176:179], v[232:235], v[144:147]
s_nop 7
s_add_u32 s47, s46, 6144
buffer_load_dwordx4 v[176:179], v27, s[8:11], s47 offen offset:0
s_waitcnt vmcnt(0)
v_mfma_f32_16x16x32_bf16 v[152:155], v[176:179], v[192:195], 0
s_nop 7
s_add_u32 s47, s46, 6144
buffer_load_dwordx4 v[176:179], v27, s[8:11], s47 offen offset:64
s_waitcnt vmcnt(0)
v_mfma_f32_16x16x32_bf16 v[152:155], v[176:179], v[200:203], v[152:155]
s_nop 7
s_add_u32 s47, s46, 6144
buffer_load_dwordx4 v[176:179], v27, s[8:11], s47 offen offset:128
s_waitcnt vmcnt(0)
v_mfma_f32_16x16x32_bf16 v[152:155], v[176:179], v[208:211], v[152:155]
s_nop 7
s_add_u32 s47, s46, 6144
buffer_load_dwordx4 v[176:179], v27, s[8:11], s47 offen offset:192
s_waitcnt vmcnt(0)
v_mfma_f32_16x16x32_bf16 v[152:155], v[176:179], v[216:219], v[152:155]
s_nop 7
s_add_u32 s47, s46, 6144
buffer_load_dwordx4 v[176:179], v27, s[8:11], s47 offen offset:256
s_waitcnt vmcnt(0)
v_mfma_f32_16x16x32_bf16 v[152:155], v[176:179], v[224:227], v[152:155]
s_nop 7
s_add_u32 s47, s46, 6144
buffer_load_dwordx4 v[176:179], v27, s[8:11], s47 offen offset:320
s_waitcnt vmcnt(0)
v_mfma_f32_16x16x32_bf16 v[152:155], v[176:179], v[232:235], v[152:155]
s_nop 7
s_nop 7
v_max3_f32 v28, v28, v144, v145
v_max3_f32 v28, v28, v146, v147
v_max3_f32 v28, v28, v152, v153
v_max3_f32 v28, v28, v154, v155
s_add_u32 s46, s46, 12288
s_add_u32 s48, s48, 1
s_cmp_lt_u32 s48, 16
s_cbranch_scc1 L_sl1_1
v_mov_b32_e32 v186, v28
s_nop 1
v_permlane32_swap_b32 v28, v186
s_nop 1
v_max_f32_e32 v28, v28, v186
v_mov_b32_e32 v186, v28
s_nop 1
v_permlane16_swap_b32 v28, v186
s_nop 1
v_max_f32_e32 v28, v28, v186
v_sub_f32_e32 v136, 0, v28
v_mov_b32_e32 v128, 0
v_sub_f32_e32 v137, 0, v28
v_mov_b32_e32 v129, 0
v_sub_f32_e32 v138, 0, v28
v_mov_b32_e32 v130, 0
v_sub_f32_e32 v139, 0, v28
v_mov_b32_e32 v131, 0
v_mov_b32_e32 v32, 0
v_mov_b32_e32 v33, 0
v_mov_b32_e32 v34, 0
v_mov_b32_e32 v35, 0
v_mov_b32_e32 v40, 0
v_mov_b32_e32 v41, 0
v_mov_b32_e32 v42, 0
v_mov_b32_e32 v43, 0
v_mov_b32_e32 v48, 0
v_mov_b32_e32 v49, 0
v_mov_b32_e32 v50, 0
v_mov_b32_e32 v51, 0
v_mov_b32_e32 v56, 0
v_mov_b32_e32 v57, 0
v_mov_b32_e32 v58, 0
v_mov_b32_e32 v59, 0
v_mov_b32_e32 v64, 0
v_mov_b32_e32 v65, 0
v_mov_b32_e32 v66, 0
v_mov_b32_e32 v67, 0
v_mov_b32_e32 v72, 0
v_mov_b32_e32 v73, 0
v_mov_b32_e32 v74, 0
v_mov_b32_e32 v75, 0
v_mov_b32_e32 v80, 0
v_mov_b32_e32 v81, 0
v_mov_b32_e32 v82, 0
v_mov_b32_e32 v83, 0
v_mov_b32_e32 v88, 0
v_mov_b32_e32 v89, 0
v_mov_b32_e32 v90, 0
v_mov_b32_e32 v91, 0
v_mov_b32_e32 v96, 0
v_mov_b32_e32 v97, 0
v_mov_b32_e32 v98, 0
v_mov_b32_e32 v99, 0
v_mov_b32_e32 v104, 0
v_mov_b32_e32 v105, 0
v_mov_b32_e32 v106, 0
v_mov_b32_e32 v107, 0
v_mov_b32_e32 v112, 0
v_mov_b32_e32 v113, 0
v_mov_b32_e32 v114, 0
v_mov_b32_e32 v115, 0
v_mov_b32_e32 v120, 0
v_mov_b32_e32 v121, 0
v_mov_b32_e32 v122, 0
v_mov_b32_e32 v123, 0
s_nop 1
s_mov_b32 s46, s45
s_mov_b32 s48, 0
L_sl2_1:
s_add_u32 s47, s46, 0
buffer_load_dwordx4 v[176:179], v27, s[8:11], s47 offen offset:0
s_waitcnt vmcnt(0)
v_mfma_f32_16x16x32_bf16 v[144:147], v[176:179], v[192:195], v[136:139]
s_nop 7
s_add_u32 s47, s46, 0
buffer_load_dwordx4 v[176:179], v27, s[8:11], s47 offen offset:64
s_waitcnt vmcnt(0)
v_mfma_f32_16x16x32_bf16 v[144:147], v[176:179], v[200:203], v[144:147]
s_nop 7
s_add_u32 s47, s46, 0
buffer_load_dwordx4 v[176:179], v27, s[8:11], s47 offen offset:128
s_waitcnt vmcnt(0)
v_mfma_f32_16x16x32_bf16 v[144:147], v[176:179], v[208:211], v[144:147]
s_nop 7
s_add_u32 s47, s46, 0
buffer_load_dwordx4 v[176:179], v27, s[8:11], s47 offen offset:192
s_waitcnt vmcnt(0)
v_mfma_f32_16x16x32_bf16 v[144:147], v[176:179], v[216:219], v[144:147]
s_nop 7
s_add_u32 s47, s46, 0
buffer_load_dwordx4 v[176:179], v27, s[8:11], s47 offen offset:256
s_waitcnt vmcnt(0)
v_mfma_f32_16x16x32_bf16 v[144:147], v[176:179], v[224:227], v[144:147]
s_nop 7
s_add_u32 s47, s46, 0
buffer_load_dwordx4 v[176:179], v27, s[8:11], s47 offen offset:320
s_waitcnt vmcnt(0)
v_mfma_f32_16x16x32_bf16 v[144:147], v[176:179], v[232:235], v[144:147]
s_nop 7
s_add_u32 s47, s46, 6144
buffer_load_dwordx4 v[176:179], v27, s[8:11], s47 offen offset:0
s_waitcnt vmcnt(0)
v_mfma_f32_16x16x32_bf16 v[152:155], v[176:179], v[192:195], v[136:139]
s_nop 7
s_add_u32 s47, s46, 6144
buffer_load_dwordx4 v[176:179], v27, s[8:11], s47 offen offset:64
s_waitcnt vmcnt(0)
v_mfma_f32_16x16x32_bf16 v[152:155], v[176:179], v[200:203], v[152:155]
s_nop 7
s_add_u32 s47, s46, 6144
buffer_load_dwordx4 v[176:179], v27, s[8:11], s47 offen offset:128
s_waitcnt vmcnt(0)
v_mfma_f32_16x16x32_bf16 v[152:155], v[176:179], v[208:211], v[152:155]
s_nop 7
s_add_u32 s47, s46, 6144
buffer_load_dwordx4 v[176:179], v27, s[8:11], s47 offen offset:192
s_waitcnt vmcnt(0)
v_mfma_f32_16x16x32_bf16 v[152:155], v[176:179], v[216:219], v[152:155]
s_nop 7
s_add_u32 s47, s46, 6144
buffer_load_dwordx4 v[176:179], v27, s[8:11], s47 offen offset:256
s_waitcnt vmcnt(0)
v_mfma_f32_16x16x32_bf16 v[152:155], v[176:179], v[224:227], v[152:155]
s_nop 7
s_add_u32 s47, s46, 6144
buffer_load_dwordx4 v[176:179], v27, s[8:11], s47 offen offset:320
s_waitcnt vmcnt(0)
v_mfma_f32_16x16x32_bf16 v[152:155], v[176:179], v[232:235], v[152:155]
s_nop 7
s_nop 7
v_exp_f32_e32 v144, v144
v_exp_f32_e32 v145, v145
v_exp_f32_e32 v146, v146
v_exp_f32_e32 v147, v147
v_exp_f32_e32 v152, v152
v_exp_f32_e32 v153, v153
v_exp_f32_e32 v154, v154
v_exp_f32_e32 v155, v155
s_nop 1
v_cvt_pk_bf16_f32 v160, v144, v145
v_cvt_pk_bf16_f32 v161, v146, v147
v_cvt_pk_bf16_f32 v162, v152, v153
v_cvt_pk_bf16_f32 v163, v154, v155
s_nop 1
v_mfma_f32_16x16x32_bf16 v[128:131], v[240:243], v[160:163], v[128:131]
buffer_load_dwordx4 v[180:183], v29, s[12:15], s46 offen offset:0
s_waitcnt vmcnt(0)
ds_write_b128 v184, v[180:183]
s_waitcnt lgkmcnt(0)
ds_read_b64_tr_b16 v[176:177], v31
ds_read_b64_tr_b16 v[178:179], v31 offset:512
s_waitcnt lgkmcnt(0)
v_mfma_f32_16x16x32_bf16 v[32:35], v[176:179], v[160:163], v[32:35]
s_nop 7
buffer_load_dwordx4 v[180:183], v29, s[12:15], s46 offen offset:32
s_waitcnt vmcnt(0)
ds_write_b128 v184, v[180:183]
s_waitcnt lgkmcnt(0)
ds_read_b64_tr_b16 v[176:177], v31
ds_read_b64_tr_b16 v[178:179], v31 offset:512
s_waitcnt lgkmcnt(0)
v_mfma_f32_16x16x32_bf16 v[40:43], v[176:179], v[160:163], v[40:43]
s_nop 7
buffer_load_dwordx4 v[180:183], v29, s[12:15], s46 offen offset:64
s_waitcnt vmcnt(0)
ds_write_b128 v184, v[180:183]
s_waitcnt lgkmcnt(0)
ds_read_b64_tr_b16 v[176:177], v31
ds_read_b64_tr_b16 v[178:179], v31 offset:512
s_waitcnt lgkmcnt(0)
v_mfma_f32_16x16x32_bf16 v[48:51], v[176:179], v[160:163], v[48:51]
s_nop 7
buffer_load_dwordx4 v[180:183], v29, s[12:15], s46 offen offset:96
s_waitcnt vmcnt(0)
ds_write_b128 v184, v[180:183]
s_waitcnt lgkmcnt(0)
ds_read_b64_tr_b16 v[176:177], v31
ds_read_b64_tr_b16 v[178:179], v31 offset:512
s_waitcnt lgkmcnt(0)
v_mfma_f32_16x16x32_bf16 v[56:59], v[176:179], v[160:163], v[56:59]
s_nop 7
buffer_load_dwordx4 v[180:183], v29, s[12:15], s46 offen offset:128
s_waitcnt vmcnt(0)
ds_write_b128 v184, v[180:183]
s_waitcnt lgkmcnt(0)
ds_read_b64_tr_b16 v[176:177], v31
ds_read_b64_tr_b16 v[178:179], v31 offset:512
s_waitcnt lgkmcnt(0)
v_mfma_f32_16x16x32_bf16 v[64:67], v[176:179], v[160:163], v[64:67]
s_nop 7
buffer_load_dwordx4 v[180:183], v29, s[12:15], s46 offen offset:160
s_waitcnt vmcnt(0)
ds_write_b128 v184, v[180:183]
s_waitcnt lgkmcnt(0)
ds_read_b64_tr_b16 v[176:177], v31
ds_read_b64_tr_b16 v[178:179], v31 offset:512
s_waitcnt lgkmcnt(0)
v_mfma_f32_16x16x32_bf16 v[72:75], v[176:179], v[160:163], v[72:75]
s_nop 7
buffer_load_dwordx4 v[180:183], v29, s[12:15], s46 offen offset:192
s_waitcnt vmcnt(0)
ds_write_b128 v184, v[180:183]
s_waitcnt lgkmcnt(0)
ds_read_b64_tr_b16 v[176:177], v31
ds_read_b64_tr_b16 v[178:179], v31 offset:512
s_waitcnt lgkmcnt(0)
v_mfma_f32_16x16x32_bf16 v[80:83], v[176:179], v[160:163], v[80:83]
s_nop 7
buffer_load_dwordx4 v[180:183], v29, s[12:15], s46 offen offset:224
s_waitcnt vmcnt(0)
ds_write_b128 v184, v[180:183]
s_waitcnt lgkmcnt(0)
ds_read_b64_tr_b16 v[176:177], v31
ds_read_b64_tr_b16 v[178:179], v31 offset:512
s_waitcnt lgkmcnt(0)
v_mfma_f32_16x16x32_bf16 v[88:91], v[176:179], v[160:163], v[88:91]
s_nop 7
buffer_load_dwordx4 v[180:183], v29, s[12:15], s46 offen offset:256
s_waitcnt vmcnt(0)
ds_write_b128 v184, v[180:183]
s_waitcnt lgkmcnt(0)
ds_read_b64_tr_b16 v[176:177], v31
ds_read_b64_tr_b16 v[178:179], v31 offset:512
s_waitcnt lgkmcnt(0)
v_mfma_f32_16x16x32_bf16 v[96:99], v[176:179], v[160:163], v[96:99]
s_nop 7
buffer_load_dwordx4 v[180:183], v29, s[12:15], s46 offen offset:288
s_waitcnt vmcnt(0)
ds_write_b128 v184, v[180:183]
s_waitcnt lgkmcnt(0)
ds_read_b64_tr_b16 v[176:177], v31
ds_read_b64_tr_b16 v[178:179], v31 offset:512
s_waitcnt lgkmcnt(0)
v_mfma_f32_16x16x32_bf16 v[104:107], v[176:179], v[160:163], v[104:107]
s_nop 7
buffer_load_dwordx4 v[180:183], v29, s[12:15], s46 offen offset:320
s_waitcnt vmcnt(0)
ds_write_b128 v184, v[180:183]
s_waitcnt lgkmcnt(0)
ds_read_b64_tr_b16 v[176:177], v31
ds_read_b64_tr_b16 v[178:179], v31 offset:512
s_waitcnt lgkmcnt(0)
v_mfma_f32_16x16x32_bf16 v[112:115], v[176:179], v[160:163], v[112:115]
s_nop 7
buffer_load_dwordx4 v[180:183], v29, s[12:15], s46 offen offset:352
s_waitcnt vmcnt(0)
ds_write_b128 v184, v[180:183]
s_waitcnt lgkmcnt(0)
ds_read_b64_tr_b16 v[176:177], v31
ds_read_b64_tr_b16 v[178:179], v31 offset:512
s_waitcnt lgkmcnt(0)
v_mfma_f32_16x16x32_bf16 v[120:123], v[176:179], v[160:163], v[120:123]
s_nop 7
s_add_u32 s46, s46, 12288
s_add_u32 s48, s48, 1
s_cmp_lt_u32 s48, 16
s_cbranch_scc1 L_sl2_1
s_nop 7
v_rcp_f32_e32 v28, v128
s_nop 0
v_mul_f32_e32 v32, v28, v32
v_mul_f32_e32 v33, v28, v33
v_mul_f32_e32 v34, v28, v34
v_mul_f32_e32 v35, v28, v35
v_mul_f32_e32 v40, v28, v40
v_mul_f32_e32 v41, v28, v41
v_mul_f32_e32 v42, v28, v42
v_mul_f32_e32 v43, v28, v43
v_mul_f32_e32 v48, v28, v48
v_mul_f32_e32 v49, v28, v49
v_mul_f32_e32 v50, v28, v50
v_mul_f32_e32 v51, v28, v51
s_branch L_back1
L_fb0:
s_nop 0
s_barrier
v_pk_mul_f32 v[56:57], v[56:57], v[28:29] op_sel_hi:[1,0]
v_pk_mul_f32 v[58:59], v[58:59], v[28:29] op_sel_hi:[1,0]
v_pk_mul_f32 v[60:61], v[60:61], v[30:31] op_sel_hi:[1,0]
v_pk_mul_f32 v[62:63], v[62:63], v[30:31] op_sel_hi:[1,0]
v_pk_mul_f32 v[64:65], v[64:65], v[28:29] op_sel_hi:[1,0]
v_pk_mul_f32 v[66:67], v[66:67], v[28:29] op_sel_hi:[1,0]
v_pk_mul_f32 v[68:69], v[68:69], v[30:31] op_sel_hi:[1,0]
v_pk_mul_f32 v[70:71], v[70:71], v[30:31] op_sel_hi:[1,0]
v_pk_mul_f32 v[72:73], v[72:73], v[28:29] op_sel_hi:[1,0]
v_pk_mul_f32 v[74:75], v[74:75], v[28:29] op_sel_hi:[1,0]
v_pk_mul_f32 v[76:77], v[76:77], v[30:31] op_sel_hi:[1,0]
v_pk_mul_f32 v[78:79], v[78:79], v[30:31] op_sel_hi:[1,0]
v_pk_mul_f32 v[80:81], v[80:81], v[28:29] op_sel_hi:[1,0]
v_pk_mul_f32 v[82:83], v[82:83], v[28:29] op_sel_hi:[1,0]
v_pk_mul_f32 v[84:85], v[84:85], v[30:31] op_sel_hi:[1,0]
v_pk_mul_f32 v[86:87], v[86:87], v[30:31] op_sel_hi:[1,0]
v_pk_mul_f32 v[88:89], v[88:89], v[28:29] op_sel_hi:[1,0]
v_pk_mul_f32 v[90:91], v[90:91], v[28:29] op_sel_hi:[1,0]
v_pk_mul_f32 v[92:93], v[92:93], v[30:31] op_sel_hi:[1,0]
v_pk_mul_f32 v[94:95], v[94:95], v[30:31] op_sel_hi:[1,0]
v_pk_mul_f32 v[96:97], v[96:97], v[28:29] op_sel_hi:[1,0]
v_pk_mul_f32 v[98:99], v[98:99], v[28:29] op_sel_hi:[1,0]
v_pk_mul_f32 v[100:101], v[100:101], v[30:31] op_sel_hi:[1,0]
v_pk_mul_f32 v[102:103], v[102:103], v[30:31] op_sel_hi:[1,0]
v_pk_mul_f32 v[104:105], v[104:105], v[28:29] op_sel_hi:[1,0]
v_pk_mul_f32 v[106:107], v[106:107], v[28:29] op_sel_hi:[1,0]
v_pk_mul_f32 v[108:109], v[108:109], v[30:31] op_sel_hi:[1,0]
v_pk_mul_f32 v[110:111], v[110:111], v[30:31] op_sel_hi:[1,0]
v_pk_mul_f32 v[112:113], v[112:113], v[28:29] op_sel_hi:[1,0]
v_pk_mul_f32 v[114:115], v[114:115], v[28:29] op_sel_hi:[1,0]
v_pk_mul_f32 v[116:117], v[116:117], v[30:31] op_sel_hi:[1,0]
v_pk_mul_f32 v[118:119], v[118:119], v[30:31] op_sel_hi:[1,0]
v_pk_mul_f32 v[120:121], v[120:121], v[28:29] op_sel_hi:[1,0]
v_pk_mul_f32 v[122:123], v[122:123], v[28:29] op_sel_hi:[1,0]
v_pk_mul_f32 v[124:125], v[124:125], v[30:31] op_sel_hi:[1,0]
v_pk_mul_f32 v[126:127], v[126:127], v[30:31] op_sel_hi:[1,0]
v_mfma_f32_16x16x32_bf16 v[144:147], v[244:247], a[0:3], 0
ds_read_b64_tr_b16 a[208:209], v20 offset:0
ds_read_b64_tr_b16 a[210:211], v20 offset:2048
v_mfma_f32_16x16x32_bf16 v[148:151], v[244:247], a[4:7], 0
ds_read_b64_tr_b16 a[212:213], v20 offset:4096
ds_read_b64_tr_b16 a[214:215], v20 offset:6144
v_mfma_f32_16x16x32_bf16 v[160:163], v[248:251], a[0:3], 0
ds_read_b64_tr_b16 a[216:217], v20 offset:8192
ds_read_b64_tr_b16 a[218:219], v20 offset:10240
v_mfma_f32_16x16x32_bf16 v[164:167], v[248:251], a[4:7], 0
ds_read_b64_tr_b16 a[220:221], v21 offset:0
ds_read_b64_tr_b16 a[222:223], v21 offset:2048
v_mfma_f32_16x16x32_bf16 v[176:179], v[244:247], a[8:11], 0
ds_read_b64_tr_b16 a[224:225], v21 offset:4096
ds_read_b64_tr_b16 a[226:227], v21 offset:6144
v_mfma_f32_16x16x32_bf16 v[180:183], v[244:247], a[12:15], 0
ds_read_b64_tr_b16 a[228:229], v21 offset:8192
ds_read_b64_tr_b16 a[230:231], v21 offset:10240
v_mfma_f32_16x16x32_bf16 v[184:187], v[248:251], a[8:11], 0
ds_read_b64_tr_b16 a[232:233], v22 offset:0
ds_read_b64_tr_b16 a[234:235], v22 offset:2048
v_cvt_pk_bf16_f32 v32, v32, v33
v_accvgpr_write_b32 a160, v32
v_cvt_pk_bf16_f32 v34, v34, v35
v_accvgpr_write_b32 a161, v34
v_cvt_pk_bf16_f32 v40, v40, v41
v_accvgpr_write_b32 a162, v40
v_cvt_pk_bf16_f32 v42, v42, v43
v_accvgpr_write_b32 a163, v42
v_mfma_f32_16x16x32_bf16 v[188:191], v[248:251], a[12:15], 0
s_waitcnt lgkmcnt(8)
ds_read_b64_tr_b16 a[236:237], v22 offset:4096
ds_read_b64_tr_b16 a[238:239], v22 offset:6144
v_cvt_pk_bf16_f32 v36, v36, v37
v_accvgpr_write_b32 a164, v36
v_cvt_pk_bf16_f32 v38, v38, v39
v_accvgpr_write_b32 a165, v38
v_cvt_pk_bf16_f32 v44, v44, v45
v_accvgpr_write_b32 a166, v44
v_cvt_pk_bf16_f32 v46, v46, v47
v_accvgpr_write_b32 a167, v46
v_mfma_f32_16x16x32_bf16 v[144:147], a[208:211], a[160:163], v[144:147]
ds_read_b64_tr_b16 a[240:241], v22 offset:8192
ds_read_b64_tr_b16 a[242:243], v22 offset:10240
v_cvt_pk_bf16_f32 v48, v48, v49
v_accvgpr_write_b32 a168, v48
v_cvt_pk_bf16_f32 v50, v50, v51
v_accvgpr_write_b32 a169, v50
v_cvt_pk_bf16_f32 v56, v56, v57
v_accvgpr_write_b32 a170, v56
v_cvt_pk_bf16_f32 v58, v58, v59
v_accvgpr_write_b32 a171, v58
v_mfma_f32_16x16x32_bf16 v[148:151], a[208:211], a[164:167], v[148:151]
ds_read_b64_tr_b16 a[244:245], v23 offset:0
ds_read_b64_tr_b16 a[246:247], v23 offset:2048
v_cvt_pk_bf16_f32 v52, v52, v53
v_accvgpr_write_b32 a172, v52
v_cvt_pk_bf16_f32 v54, v54, v55
v_accvgpr_write_b32 a173, v54
v_cvt_pk_bf16_f32 v60, v60, v61
v_accvgpr_write_b32 a174, v60
v_cvt_pk_bf16_f32 v62, v62, v63
v_accvgpr_write_b32 a175, v62
v_mfma_f32_16x16x32_bf16 v[144:147], a[212:215], a[168:171], v[144:147]
v_cvt_pk_bf16_f32 v64, v64, v65
v_accvgpr_write_b32 a176, v64
v_cvt_pk_bf16_f32 v66, v66, v67
v_accvgpr_write_b32 a177, v66
v_cvt_pk_bf16_f32 v72, v72, v73
v_accvgpr_write_b32 a178, v72
v_cvt_pk_bf16_f32 v74, v74, v75
v_accvgpr_write_b32 a179, v74
v_mfma_f32_16x16x32_bf16 v[148:151], a[212:215], a[172:175], v[148:151]
ds_read_b64_tr_b16 a[248:249], v23 offset:4096
ds_read_b64_tr_b16 a[250:251], v23 offset:6144
v_cvt_pk_bf16_f32 v68, v68, v69
v_accvgpr_write_b32 a180, v68
v_cvt_pk_bf16_f32 v70, v70, v71
v_accvgpr_write_b32 a181, v70
v_cvt_pk_bf16_f32 v76, v76, v77
v_accvgpr_write_b32 a182, v76
v_cvt_pk_bf16_f32 v78, v78, v79
v_accvgpr_write_b32 a183, v78
v_mfma_f32_16x16x32_bf16 v[144:147], a[216:219], a[176:179], v[144:147]
ds_read_b64_tr_b16 a[252:253], v23 offset:8192
v_cvt_pk_bf16_f32 v80, v80, v81
v_mfma_f32_16x16x32_bf16 v[148:151], a[216:219], a[180:183], v[148:151]
s_waitcnt lgkmcnt(11)
ds_read_b64_tr_b16 a[254:255], v23 offset:10240
v_accvgpr_write_b32 a184, v80
v_mfma_f32_16x16x32_bf16 v[160:163], a[220:223], a[160:163], v[160:163]
s_barrier
v_cvt_pk_bf16_f32 v82, v82, v83
v_accvgpr_write_b32 a185, v82
v_mfma_f32_16x16x32_bf16 v[164:167], a[220:223], a[164:167], v[164:167]
ds_read_b64_tr_b16 a[208:209], v20 offset:12352
ds_read_b64_tr_b16 a[210:211], v20 offset:14400
v_mfma_f32_16x16x32_bf16 v[160:163], a[224:227], a[168:171], v[160:163]
ds_read_b64_tr_b16 a[212:213], v20 offset:16448
v_cvt_pk_bf16_f32 v88, v88, v89
v_mfma_f32_16x16x32_bf16 v[164:167], a[224:227], a[172:175], v[164:167]
ds_read_b64_tr_b16 a[214:215], v20 offset:18496
v_accvgpr_write_b32 a186, v88
v_mfma_f32_16x16x32_bf16 v[160:163], a[228:231], a[176:179], v[160:163]
ds_read_b64_tr_b16 a[216:217], v20 offset:20544
v_cvt_pk_bf16_f32 v90, v90, v91
v_mfma_f32_16x16x32_bf16 v[164:167], a[228:231], a[180:183], v[164:167]
s_waitcnt lgkmcnt(11)
ds_read_b64_tr_b16 a[218:219], v20 offset:22592
v_accvgpr_write_b32 a187, v90
v_mfma_f32_16x16x32_bf16 v[176:179], a[232:235], a[160:163], v[176:179]
ds_read_b64_tr_b16 a[220:221], v21 offset:12352
v_cvt_pk_bf16_f32 v84, v84, v85
v_mfma_f32_16x16x32_bf16 v[180:183], a[232:235], a[164:167], v[180:183]
ds_read_b64_tr_b16 a[222:223], v21 offset:14400
v_accvgpr_write_b32 a188, v84
v_mfma_f32_16x16x32_bf16 v[176:179], a[236:239], a[168:171], v[176:179]
ds_read_b64_tr_b16 a[224:225], v21 offset:16448
v_cvt_pk_bf16_f32 v86, v86, v87
v_mfma_f32_16x16x32_bf16 v[180:183], a[236:239], a[172:175], v[180:183]
ds_read_b64_tr_b16 a[226:227], v21 offset:18496
v_accvgpr_write_b32 a189, v86
v_mfma_f32_16x16x32_bf16 v[176:179], a[240:243], a[176:179], v[176:179]
ds_read_b64_tr_b16 a[228:229], v21 offset:20544
v_cvt_pk_bf16_f32 v92, v92, v93
v_mfma_f32_16x16x32_bf16 v[180:183], a[240:243], a[180:183], v[180:183]
s_waitcnt lgkmcnt(11)
ds_read_b64_tr_b16 a[230:231], v21 offset:22592
v_accvgpr_write_b32 a190, v92
v_mfma_f32_16x16x32_bf16 v[184:187], a[244:247], a[160:163], v[184:187]
ds_read_b64_tr_b16 a[232:233], v22 offset:12352
v_cvt_pk_bf16_f32 v94, v94, v95
v_mfma_f32_16x16x32_bf16 v[188:191], a[244:247], a[164:167], v[188:191]
ds_read_b64_tr_b16 a[234:235], v22 offset:14400
v_accvgpr_write_b32 a191, v94
v_mfma_f32_16x16x32_bf16 v[184:187], a[248:251], a[168:171], v[184:187]
ds_read_b64_tr_b16 a[236:237], v22 offset:16448
v_cvt_pk_bf16_f32 v96, v96, v97
v_mfma_f32_16x16x32_bf16 v[188:191], a[248:251], a[172:175], v[188:191]
ds_read_b64_tr_b16 a[238:239], v22 offset:18496
v_accvgpr_write_b32 a192, v96
v_mfma_f32_16x16x32_bf16 v[184:187], a[252:255], a[176:179], v[184:187]
ds_read_b64_tr_b16 a[240:241], v22 offset:20544
v_cvt_pk_bf16_f32 v98, v98, v99
v_mfma_f32_16x16x32_bf16 v[188:191], a[252:255], a[180:183], v[188:191]
s_waitcnt lgkmcnt(11)
ds_read_b64_tr_b16 a[242:243], v22 offset:22592
v_accvgpr_write_b32 a193, v98
v_mfma_f32_16x16x32_bf16 v[144:147], a[208:211], a[184:187], v[144:147]
v_cvt_pk_bf16_f32 v104, v104, v105
v_accvgpr_write_b32 a194, v104
v_cvt_pk_bf16_f32 v106, v106, v107
v_accvgpr_write_b32 a195, v106
v_mfma_f32_16x16x32_bf16 v[148:151], a[208:211], a[188:191], v[148:151]
ds_read_b64_tr_b16 a[244:245], v23 offset:12352
ds_read_b64_tr_b16 a[246:247], v23 offset:14400
v_cvt_pk_bf16_f32 v100, v100, v101
v_accvgpr_write_b32 a196, v100
v_cvt_pk_bf16_f32 v102, v102, v103
v_accvgpr_write_b32 a197, v102
v_cvt_pk_bf16_f32 v108, v108, v109
v_accvgpr_write_b32 a198, v108
v_cvt_pk_bf16_f32 v110, v110, v111
v_accvgpr_write_b32 a199, v110
v_mfma_f32_16x16x32_bf16 v[144:147], a[212:215], a[192:195], v[144:147]
v_cvt_pk_bf16_f32 v112, v112, v113
v_accvgpr_write_b32 a200, v112
v_cvt_pk_bf16_f32 v114, v114, v115
v_accvgpr_write_b32 a201, v114
v_cvt_pk_bf16_f32 v120, v120, v121
v_accvgpr_write_b32 a202, v120
v_cvt_pk_bf16_f32 v122, v122, v123
v_accvgpr_write_b32 a203, v122
v_mfma_f32_16x16x32_bf16 v[148:151], a[212:215], a[196:199], v[148:151]
ds_read_b64_tr_b16 a[248:249], v23 offset:16448
ds_read_b64_tr_b16 a[250:251], v23 offset:18496
v_cvt_pk_bf16_f32 v116, v116, v117
v_accvgpr_write_b32 a204, v116
v_cvt_pk_bf16_f32 v118, v118, v119
v_accvgpr_write_b32 a205, v118
v_cvt_pk_bf16_f32 v124, v124, v125
v_accvgpr_write_b32 a206, v124
v_cvt_pk_bf16_f32 v126, v126, v127
v_accvgpr_write_b32 a207, v126
v_mfma_f32_16x16x32_bf16 v[144:147], a[216:219], a[200:203], v[144:147]
ds_read_b64_tr_b16 a[252:253], v23 offset:20544
v_mfma_f32_16x16x32_bf16 v[148:151], a[216:219], a[204:207], v[148:151]
s_waitcnt lgkmcnt(11)
ds_read_b64_tr_b16 a[254:255], v23 offset:22592
v_mfma_f32_16x16x32_bf16 v[160:163], a[220:223], a[184:187], v[160:163]
s_barrier
v_mfma_f32_16x16x32_bf16 v[164:167], a[220:223], a[188:191], v[164:167]
ds_read_b64_tr_b16 a[208:209], v20 offset:24704
ds_read_b64_tr_b16 a[210:211], v20 offset:26752
v_mfma_f32_16x16x32_bf16 v[160:163], a[224:227], a[192:195], v[160:163]
ds_read_b64_tr_b16 a[212:213], v20 offset:28800
v_cvt_pk_bf16_f32 v192, v144, v145
v_mfma_f32_16x16x32_bf16 v[164:167], a[224:227], a[196:199], v[164:167]
ds_read_b64_tr_b16 a[214:215], v20 offset:30848
v_cvt_pk_bf16_f32 v193, v146, v147
v_mfma_f32_16x16x32_bf16 v[160:163], a[228:231], a[200:203], v[160:163]
ds_read_b64_tr_b16 a[216:217], v20 offset:32896
v_cvt_pk_bf16_f32 v196, v148, v149
v_mfma_f32_16x16x32_bf16 v[164:167], a[228:231], a[204:207], v[164:167]
s_waitcnt lgkmcnt(11)
ds_read_b64_tr_b16 a[218:219], v20 offset:34944
v_cvt_pk_bf16_f32 v197, v150, v151
v_mfma_f32_16x16x32_bf16 v[176:179], a[232:235], a[184:187], v[176:179]
ds_read_b64_tr_b16 a[220:221], v21 offset:24704
v_cvt_pk_bf16_f32 v194, v160, v161
v_mfma_f32_16x16x32_bf16 v[180:183], a[232:235], a[188:191], v[180:183]
ds_read_b64_tr_b16 a[222:223], v21 offset:26752
v_cvt_pk_bf16_f32 v195, v162, v163
v_mfma_f32_16x16x32_bf16 v[176:179], a[236:239], a[192:195], v[176:179]
ds_read_b64_tr_b16 a[224:225], v21 offset:28800
v_cvt_pk_bf16_f32 v198, v164, v165
v_mfma_f32_16x16x32_bf16 v[180:183], a[236:239], a[196:199], v[180:183]
ds_read_b64_tr_b16 a[226:227], v21 offset:30848
v_cvt_pk_bf16_f32 v199, v166, v167
v_mfma_f32_16x16x32_bf16 v[176:179], a[240:243], a[200:203], v[176:179]
ds_read_b64_tr_b16 a[228:229], v21 offset:32896
v_mfma_f32_16x16x32_bf16 v[180:183], a[240:243], a[204:207], v[180:183]
s_waitcnt lgkmcnt(11)
ds_read_b64_tr_b16 a[230:231], v21 offset:34944
v_mfma_f32_16x16x32_bf16 v[184:187], a[244:247], a[184:187], v[184:187]
ds_read_b64_tr_b16 a[232:233], v22 offset:24704
v_mfma_f32_16x16x32_bf16 v[188:191], a[244:247], a[188:191], v[188:191]
ds_read_b64_tr_b16 a[234:235], v22 offset:26752
v_cvt_pk_bf16_f32 v200, v176, v177
v_mfma_f32_16x16x32_bf16 v[184:187], a[248:251], a[192:195], v[184:187]
ds_read_b64_tr_b16 a[236:237], v22 offset:28800
v_cvt_pk_bf16_f32 v201, v178, v179
v_mfma_f32_16x16x32_bf16 v[188:191], a[248:251], a[196:199], v[188:191]
ds_read_b64_tr_b16 a[238:239], v22 offset:30848
v_cvt_pk_bf16_f32 v204, v180, v181
v_mfma_f32_16x16x32_bf16 v[184:187], a[252:255], a[200:203], v[184:187]
ds_read_b64_tr_b16 a[240:241], v22 offset:32896
v_cvt_pk_bf16_f32 v205, v182, v183
v_mfma_f32_16x16x32_bf16 v[188:191], a[252:255], a[204:207], v[188:191]
ds_read_b64_tr_b16 a[242:243], v22 offset:34944
v_mfma_f32_16x16x32_bf16 v[144:147], v[244:247], a[16:19], 0
ds_read_b64_tr_b16 a[244:245], v23 offset:24704
v_mfma_f32_16x16x32_bf16 v[148:151], v[244:247], a[20:23], 0
s_waitcnt lgkmcnt(13)
ds_read_b64_tr_b16 a[246:247], v23 offset:26752
v_cvt_pk_bf16_f32 v202, v184, v185
v_mfma_f32_16x16x32_bf16 v[144:147], a[208:211], a[160:163], v[144:147]
ds_read_b64_tr_b16 a[248:249], v23 offset:28800
v_cvt_pk_bf16_f32 v203, v186, v187
v_mfma_f32_16x16x32_bf16 v[148:151], a[208:211], a[164:167], v[148:151]
ds_read_b64_tr_b16 a[250:251], v23 offset:30848
v_cvt_pk_bf16_f32 v206, v188, v189
v_mfma_f32_16x16x32_bf16 v[144:147], a[212:215], a[168:171], v[144:147]
ds_read_b64_tr_b16 a[252:253], v23 offset:32896
v_cvt_pk_bf16_f32 v207, v190, v191
v_mfma_f32_16x16x32_bf16 v[148:151], a[212:215], a[172:175], v[148:151]
ds_read_b64_tr_b16 a[254:255], v23 offset:34944
v_mfma_f32_16x16x32_bf16 v[144:147], a[216:219], a[176:179], v[144:147]
s_barrier
v_mfma_f32_16x16x32_bf16 v[148:151], a[216:219], a[180:183], v[148:151]
ds_read_b64_tr_b16 a[208:209], v20 offset:37056
v_mfma_f32_16x16x32_bf16 v[160:163], v[248:251], a[16:19], 0
ds_read_b64_tr_b16 a[210:211], v20 offset:39104
v_mfma_f32_16x16x32_bf16 v[164:167], v[248:251], a[20:23], 0
s_waitcnt lgkmcnt(14)
v_mfma_f32_16x16x32_bf16 v[160:163], a[220:223], a[160:163], v[160:163]
ds_read_b64_tr_b16 a[212:213], v20 offset:41152
v_mfma_f32_16x16x32_bf16 v[164:167], a[220:223], a[164:167], v[164:167]
ds_read_b64_tr_b16 a[214:215], v20 offset:43200
v_mfma_f32_16x16x32_bf16 v[160:163], a[224:227], a[168:171], v[160:163]
ds_read_b64_tr_b16 a[216:217], v20 offset:45248
v_mfma_f32_16x16x32_bf16 v[164:167], a[224:227], a[172:175], v[164:167]
ds_read_b64_tr_b16 a[218:219], v20 offset:47296
v_mfma_f32_16x16x32_bf16 v[160:163], a[228:231], a[176:179], v[160:163]
ds_read_b64_tr_b16 a[220:221], v21 offset:37056
v_mfma_f32_16x16x32_bf16 v[164:167], a[228:231], a[180:183], v[164:167]
ds_read_b64_tr_b16 a[222:223], v21 offset:39104
v_mfma_f32_16x16x32_bf16 v[176:179], v[244:247], a[24:27], 0
v_mfma_f32_16x16x32_bf16 v[180:183], v[244:247], a[28:31], 0
s_waitcnt lgkmcnt(14)
v_mfma_f32_16x16x32_bf16 v[176:179], a[232:235], a[160:163], v[176:179]
ds_read_b64_tr_b16 a[224:225], v21 offset:41152
v_mfma_f32_16x16x32_bf16 v[180:183], a[232:235], a[164:167], v[180:183]
ds_read_b64_tr_b16 a[226:227], v21 offset:43200
v_mfma_f32_16x16x32_bf16 v[176:179], a[236:239], a[168:171], v[176:179]
ds_read_b64_tr_b16 a[228:229], v21 offset:45248
v_mfma_f32_16x16x32_bf16 v[180:183], a[236:239], a[172:175], v[180:183]
ds_read_b64_tr_b16 a[230:231], v21 offset:47296
v_mfma_f32_16x16x32_bf16 v[176:179], a[240:243], a[176:179], v[176:179]
ds_read_b64_tr_b16 a[232:233], v22 offset:37056
v_mfma_f32_16x16x32_bf16 v[180:183], a[240:243], a[180:183], v[180:183]
ds_read_b64_tr_b16 a[234:235], v22 offset:39104
v_mfma_f32_16x16x32_bf16 v[184:187], v[248:251], a[24:27], 0
s_cmp_lg_u32 s3, 0
s_cbranch_scc1 L_st0_0_0
s_mov_b32 s36, 0
buffer_store_dwordx4 v[192:195], v26, s[24:27], s36 offen offset:0 sc1
buffer_store_dwordx4 v[196:199], v26, s[24:27], s36 offen offset:1024 sc1
buffer_store_dwordx4 v[200:203], v26, s[24:27], s36 offen offset:2048 sc1
buffer_store_dwordx4 v[204:207], v26, s[24:27], s36 offen offset:3072 sc1
L_st0_0_0:
v_mfma_f32_16x16x32_bf16 v[188:191], v[248:251], a[28:31], 0
s_waitcnt lgkmcnt(14)
v_mfma_f32_16x16x32_bf16 v[184:187], a[244:247], a[160:163], v[184:187]
ds_read_b64_tr_b16 a[236:237], v22 offset:41152
v_mfma_f32_16x16x32_bf16 v[188:191], a[244:247], a[164:167], v[188:191]
ds_read_b64_tr_b16 a[238:239], v22 offset:43200
v_mfma_f32_16x16x32_bf16 v[184:187], a[248:251], a[168:171], v[184:187]
ds_read_b64_tr_b16 a[240:241], v22 offset:45248
v_mfma_f32_16x16x32_bf16 v[188:191], a[248:251], a[172:175], v[188:191]
ds_read_b64_tr_b16 a[242:243], v22 offset:47296
v_mfma_f32_16x16x32_bf16 v[184:187], a[252:255], a[176:179], v[184:187]
ds_read_b64_tr_b16 a[244:245], v23 offset:37056
v_mfma_f32_16x16x32_bf16 v[188:191], a[252:255], a[180:183], v[188:191]
s_waitcnt lgkmcnt(13)
ds_read_b64_tr_b16 a[246:247], v23 offset:39104
v_mfma_f32_16x16x32_bf16 v[144:147], a[208:211], a[184:187], v[144:147]
ds_read_b64_tr_b16 a[248:249], v23 offset:41152
v_mfma_f32_16x16x32_bf16 v[148:151], a[208:211], a[188:191], v[148:151]
ds_read_b64_tr_b16 a[250:251], v23 offset:43200
v_mfma_f32_16x16x32_bf16 v[144:147], a[212:215], a[192:195], v[144:147]
ds_read_b64_tr_b16 a[252:253], v23 offset:45248
v_mfma_f32_16x16x32_bf16 v[148:151], a[212:215], a[196:199], v[148:151]
ds_read_b64_tr_b16 a[254:255], v23 offset:47296
v_mfma_f32_16x16x32_bf16 v[144:147], a[216:219], a[200:203], v[144:147]
s_barrier
v_mfma_f32_16x16x32_bf16 v[148:151], a[216:219], a[204:207], v[148:151]
s_waitcnt lgkmcnt(12)
ds_read_b64_tr_b16 a[208:209], v20 offset:49408
v_mfma_f32_16x16x32_bf16 v[160:163], a[220:223], a[184:187], v[160:163]
ds_read_b64_tr_b16 a[210:211], v20 offset:51456
v_mfma_f32_16x16x32_bf16 v[164:167], a[220:223], a[188:191], v[164:167]
ds_read_b64_tr_b16 a[212:213], v20 offset:53504
v_cvt_pk_bf16_f32 v208, v144, v145
v_mfma_f32_16x16x32_bf16 v[160:163], a[224:227], a[192:195], v[160:163]
ds_read_b64_tr_b16 a[214:215], v20 offset:55552
v_cvt_pk_bf16_f32 v209, v146, v147
v_mfma_f32_16x16x32_bf16 v[164:167], a[224:227], a[196:199], v[164:167]
ds_read_b64_tr_b16 a[216:217], v20 offset:57600
v_cvt_pk_bf16_f32 v212, v148, v149
v_mfma_f32_16x16x32_bf16 v[160:163], a[228:231], a[200:203], v[160:163]
s_cmp_lg_u32 s3, 1
s_cbranch_scc1 L_st0_0_1
s_mov_b32 s36, 0
buffer_store_dwordx4 v[192:195], v26, s[24:27], s36 offen offset:0 sc1
buffer_store_dwordx4 v[196:199], v26, s[24:27], s36 offen offset:1024 sc1
buffer_store_dwordx4 v[200:203], v26, s[24:27], s36 offen offset:2048 sc1
buffer_store_dwordx4 v[204:207], v26, s[24:27], s36 offen offset:3072 sc1
L_st0_0_1:
v_mfma_f32_16x16x32_bf16 v[164:167], a[228:231], a[204:207], v[164:167]
s_waitcnt lgkmcnt(11)
ds_read_b64_tr_b16 a[218:219], v20 offset:59648
v_cvt_pk_bf16_f32 v213, v150, v151
v_mfma_f32_16x16x32_bf16 v[176:179], a[232:235], a[184:187], v[176:179]
ds_read_b64_tr_b16 a[220:221], v21 offset:49408
v_cvt_pk_bf16_f32 v210, v160, v161
v_mfma_f32_16x16x32_bf16 v[180:183], a[232:235], a[188:191], v[180:183]
ds_read_b64_tr_b16 a[222:223], v21 offset:51456
v_cvt_pk_bf16_f32 v211, v162, v163
v_mfma_f32_16x16x32_bf16 v[176:179], a[236:239], a[192:195], v[176:179]
ds_read_b64_tr_b16 a[224:225], v21 offset:53504
v_cvt_pk_bf16_f32 v214, v164, v165
v_mfma_f32_16x16x32_bf16 v[180:183], a[236:239], a[196:199], v[180:183]
ds_read_b64_tr_b16 a[226:227], v21 offset:55552
v_cvt_pk_bf16_f32 v215, v166, v167
v_mfma_f32_16x16x32_bf16 v[176:179], a[240:243], a[200:203], v[176:179]
ds_read_b64_tr_b16 a[228:229], v21 offset:57600
v_mfma_f32_16x16x32_bf16 v[180:183], a[240:243], a[204:207], v[180:183]
s_waitcnt lgkmcnt(11)
ds_read_b64_tr_b16 a[230:231], v21 offset:59648
v_mfma_f32_16x16x32_bf16 v[184:187], a[244:247], a[184:187], v[184:187]
ds_read_b64_tr_b16 a[232:233], v22 offset:49408
v_mfma_f32_16x16x32_bf16 v[188:191], a[244:247], a[188:191], v[188:191]
ds_read_b64_tr_b16 a[234:235], v22 offset:51456
v_cvt_pk_bf16_f32 v216, v176, v177
v_mfma_f32_16x16x32_bf16 v[184:187], a[248:251], a[192:195], v[184:187]
ds_read_b64_tr_b16 a[236:237], v22 offset:53504
v_cvt_pk_bf16_f32 v217, v178, v179
v_mfma_f32_16x16x32_bf16 v[188:191], a[248:251], a[196:199], v[188:191]
ds_read_b64_tr_b16 a[238:239], v22 offset:55552
v_cvt_pk_bf16_f32 v220, v180, v181
v_mfma_f32_16x16x32_bf16 v[184:187], a[252:255], a[200:203], v[184:187]
ds_read_b64_tr_b16 a[240:241], v22 offset:57600
v_cvt_pk_bf16_f32 v221, v182, v183
v_mfma_f32_16x16x32_bf16 v[188:191], a[252:255], a[204:207], v[188:191]
ds_read_b64_tr_b16 a[242:243], v22 offset:59648
v_mfma_f32_16x16x32_bf16 v[144:147], v[244:247], a[32:35], 0
ds_read_b64_tr_b16 a[244:245], v23 offset:49408
v_mfma_f32_16x16x32_bf16 v[148:151], v[244:247], a[36:39], 0
s_waitcnt lgkmcnt(13)
ds_read_b64_tr_b16 a[246:247], v23 offset:51456
v_cvt_pk_bf16_f32 v218, v184, v185
v_mfma_f32_16x16x32_bf16 v[144:147], a[208:211], a[160:163], v[144:147]
ds_read_b64_tr_b16 a[248:249], v23 offset:53504
v_cvt_pk_bf16_f32 v219, v186, v187
v_mfma_f32_16x16x32_bf16 v[148:151], a[208:211], a[164:167], v[148:151]
ds_read_b64_tr_b16 a[250:251], v23 offset:55552
v_cvt_pk_bf16_f32 v222, v188, v189
v_mfma_f32_16x16x32_bf16 v[144:147], a[212:215], a[168:171], v[144:147]
s_cmp_lg_u32 s3, 2
s_cbranch_scc1 L_st0_0_2
s_mov_b32 s36, 0
buffer_store_dwordx4 v[192:195], v26, s[24:27], s36 offen offset:0 sc1
buffer_store_dwordx4 v[196:199], v26, s[24:27], s36 offen offset:1024 sc1
buffer_store_dwordx4 v[200:203], v26, s[24:27], s36 offen offset:2048 sc1
buffer_store_dwordx4 v[204:207], v26, s[24:27], s36 offen offset:3072 sc1
L_st0_0_2:
v_mfma_f32_16x16x32_bf16 v[148:151], a[212:215], a[172:175], v[148:151]
ds_read_b64_tr_b16 a[252:253], v23 offset:57600
v_cvt_pk_bf16_f32 v223, v190, v191
v_mfma_f32_16x16x32_bf16 v[144:147], a[216:219], a[176:179], v[144:147]
ds_read_b64_tr_b16 a[254:255], v23 offset:59648
v_mfma_f32_16x16x32_bf16 v[148:151], a[216:219], a[180:183], v[148:151]
s_barrier
v_mfma_f32_16x16x32_bf16 v[160:163], v[248:251], a[32:35], 0
ds_read_b64_tr_b16 a[208:209], v20 offset:0
v_mfma_f32_16x16x32_bf16 v[164:167], v[248:251], a[36:39], 0
s_waitcnt lgkmcnt(13)
ds_read_b64_tr_b16 a[210:211], v20 offset:2048
v_mfma_f32_16x16x32_bf16 v[160:163], a[220:223], a[160:163], v[160:163]
ds_read_b64_tr_b16 a[212:213], v20 offset:4096
v_mfma_f32_16x16x32_bf16 v[164:167], a[220:223], a[164:167], v[164:167]
ds_read_b64_tr_b16 a[214:215], v20 offset:6144
v_mfma_f32_16x16x32_bf16 v[160:163], a[224:227], a[168:171], v[160:163]
ds_read_b64_tr_b16 a[216:217], v20 offset:8192
v_mfma_f32_16x16x32_bf16 v[164:167], a[224:227], a[172:175], v[164:167]
ds_read_b64_tr_b16 a[218:219], v20 offset:10240
v_mfma_f32_16x16x32_bf16 v[160:163], a[228:231], a[176:179], v[160:163]
ds_read_b64_tr_b16 a[220:221], v21 offset:0
v_mfma_f32_16x16x32_bf16 v[164:167], a[228:231], a[180:183], v[164:167]
ds_read_b64_tr_b16 a[222:223], v21 offset:2048
v_mfma_f32_16x16x32_bf16 v[176:179], v[244:247], a[40:43], 0
v_mfma_f32_16x16x32_bf16 v[180:183], v[244:247], a[44:47], 0
s_waitcnt lgkmcnt(14)
v_mfma_f32_16x16x32_bf16 v[176:179], a[232:235], a[160:163], v[176:179]
ds_read_b64_tr_b16 a[224:225], v21 offset:4096
v_mfma_f32_16x16x32_bf16 v[180:183], a[232:235], a[164:167], v[180:183]
ds_read_b64_tr_b16 a[226:227], v21 offset:6144
v_mfma_f32_16x16x32_bf16 v[176:179], a[236:239], a[168:171], v[176:179]
ds_read_b64_tr_b16 a[228:229], v21 offset:8192
v_mfma_f32_16x16x32_bf16 v[180:183], a[236:239], a[172:175], v[180:183]
ds_read_b64_tr_b16 a[230:231], v21 offset:10240
v_mfma_f32_16x16x32_bf16 v[176:179], a[240:243], a[176:179], v[176:179]
ds_read_b64_tr_b16 a[232:233], v22 offset:0
v_mfma_f32_16x16x32_bf16 v[180:183], a[240:243], a[180:183], v[180:183]
ds_read_b64_tr_b16 a[234:235], v22 offset:2048
v_mfma_f32_16x16x32_bf16 v[184:187], v[248:251], a[40:43], 0
s_cmp_lg_u32 s3, 0
s_cbranch_scc1 L_st0_1_0
s_mov_b32 s36, 4096
buffer_store_dwordx4 v[208:211], v26, s[24:27], s36 offen offset:0 sc1
buffer_store_dwordx4 v[212:215], v26, s[24:27], s36 offen offset:1024 sc1
buffer_store_dwordx4 v[216:219], v26, s[24:27], s36 offen offset:2048 sc1
buffer_store_dwordx4 v[220:223], v26, s[24:27], s36 offen offset:3072 sc1
L_st0_1_0:
v_mfma_f32_16x16x32_bf16 v[188:191], v[248:251], a[44:47], 0
s_waitcnt lgkmcnt(14)
v_mfma_f32_16x16x32_bf16 v[184:187], a[244:247], a[160:163], v[184:187]
ds_read_b64_tr_b16 a[236:237], v22 offset:4096
v_mfma_f32_16x16x32_bf16 v[188:191], a[244:247], a[164:167], v[188:191]
ds_read_b64_tr_b16 a[238:239], v22 offset:6144
v_mfma_f32_16x16x32_bf16 v[184:187], a[248:251], a[168:171], v[184:187]
ds_read_b64_tr_b16 a[240:241], v22 offset:8192
v_mfma_f32_16x16x32_bf16 v[188:191], a[248:251], a[172:175], v[188:191]
ds_read_b64_tr_b16 a[242:243], v22 offset:10240
v_mfma_f32_16x16x32_bf16 v[184:187], a[252:255], a[176:179], v[184:187]
ds_read_b64_tr_b16 a[244:245], v23 offset:0
v_mfma_f32_16x16x32_bf16 v[188:191], a[252:255], a[180:183], v[188:191]
s_waitcnt lgkmcnt(13)
ds_read_b64_tr_b16 a[246:247], v23 offset:2048
v_mfma_f32_16x16x32_bf16 v[144:147], a[208:211], a[184:187], v[144:147]
ds_read_b64_tr_b16 a[248:249], v23 offset:4096
v_mfma_f32_16x16x32_bf16 v[148:151], a[208:211], a[188:191], v[148:151]
ds_read_b64_tr_b16 a[250:251], v23 offset:6144
v_mfma_f32_16x16x32_bf16 v[144:147], a[212:215], a[192:195], v[144:147]
ds_read_b64_tr_b16 a[252:253], v23 offset:8192
v_mfma_f32_16x16x32_bf16 v[148:151], a[212:215], a[196:199], v[148:151]
ds_read_b64_tr_b16 a[254:255], v23 offset:10240
v_mfma_f32_16x16x32_bf16 v[144:147], a[216:219], a[200:203], v[144:147]
s_barrier
v_mfma_f32_16x16x32_bf16 v[148:151], a[216:219], a[204:207], v[148:151]
s_waitcnt lgkmcnt(12)
ds_read_b64_tr_b16 a[208:209], v20 offset:12352
v_mfma_f32_16x16x32_bf16 v[160:163], a[220:223], a[184:187], v[160:163]
ds_read_b64_tr_b16 a[210:211], v20 offset:14400
v_mfma_f32_16x16x32_bf16 v[164:167], a[220:223], a[188:191], v[164:167]
ds_read_b64_tr_b16 a[212:213], v20 offset:16448
v_cvt_pk_bf16_f32 v224, v144, v145
v_mfma_f32_16x16x32_bf16 v[160:163], a[224:227], a[192:195], v[160:163]
ds_read_b64_tr_b16 a[214:215], v20 offset:18496
v_cvt_pk_bf16_f32 v225, v146, v147
v_mfma_f32_16x16x32_bf16 v[164:167], a[224:227], a[196:199], v[164:167]
ds_read_b64_tr_b16 a[216:217], v20 offset:20544
v_cvt_pk_bf16_f32 v228, v148, v149
v_mfma_f32_16x16x32_bf16 v[160:163], a[228:231], a[200:203], v[160:163]
s_cmp_lg_u32 s3, 1
s_cbranch_scc1 L_st0_1_1
s_mov_b32 s36, 4096
buffer_store_dwordx4 v[208:211], v26, s[24:27], s36 offen offset:0 sc1
buffer_store_dwordx4 v[212:215], v26, s[24:27], s36 offen offset:1024 sc1
buffer_store_dwordx4 v[216:219], v26, s[24:27], s36 offen offset:2048 sc1
buffer_store_dwordx4 v[220:223], v26, s[24:27], s36 offen offset:3072 sc1
L_st0_1_1:
v_mfma_f32_16x16x32_bf16 v[164:167], a[228:231], a[204:207], v[164:167]
s_waitcnt lgkmcnt(11)
ds_read_b64_tr_b16 a[218:219], v20 offset:22592
v_cvt_pk_bf16_f32 v229, v150, v151
v_mfma_f32_16x16x32_bf16 v[176:179], a[232:235], a[184:187], v[176:179]
ds_read_b64_tr_b16 a[220:221], v21 offset:12352
v_cvt_pk_bf16_f32 v226, v160, v161
v_mfma_f32_16x16x32_bf16 v[180:183], a[232:235], a[188:191], v[180:183]
ds_read_b64_tr_b16 a[222:223], v21 offset:14400
v_cvt_pk_bf16_f32 v227, v162, v163
v_mfma_f32_16x16x32_bf16 v[176:179], a[236:239], a[192:195], v[176:179]
ds_read_b64_tr_b16 a[224:225], v21 offset:16448
v_cvt_pk_bf16_f32 v230, v164, v165
v_mfma_f32_16x16x32_bf16 v[180:183], a[236:239], a[196:199], v[180:183]
ds_read_b64_tr_b16 a[226:227], v21 offset:18496
v_cvt_pk_bf16_f32 v231, v166, v167
v_mfma_f32_16x16x32_bf16 v[176:179], a[240:243], a[200:203], v[176:179]
ds_read_b64_tr_b16 a[228:229], v21 offset:20544
v_mfma_f32_16x16x32_bf16 v[180:183], a[240:243], a[204:207], v[180:183]
s_waitcnt lgkmcnt(11)
ds_read_b64_tr_b16 a[230:231], v21 offset:22592
v_mfma_f32_16x16x32_bf16 v[184:187], a[244:247], a[184:187], v[184:187]
ds_read_b64_tr_b16 a[232:233], v22 offset:12352
v_mfma_f32_16x16x32_bf16 v[188:191], a[244:247], a[188:191], v[188:191]
ds_read_b64_tr_b16 a[234:235], v22 offset:14400
v_cvt_pk_bf16_f32 v232, v176, v177
v_mfma_f32_16x16x32_bf16 v[184:187], a[248:251], a[192:195], v[184:187]
ds_read_b64_tr_b16 a[236:237], v22 offset:16448
v_cvt_pk_bf16_f32 v233, v178, v179
v_mfma_f32_16x16x32_bf16 v[188:191], a[248:251], a[196:199], v[188:191]
ds_read_b64_tr_b16 a[238:239], v22 offset:18496
v_cvt_pk_bf16_f32 v236, v180, v181
v_mfma_f32_16x16x32_bf16 v[184:187], a[252:255], a[200:203], v[184:187]
ds_read_b64_tr_b16 a[240:241], v22 offset:20544
v_cvt_pk_bf16_f32 v237, v182, v183
v_mfma_f32_16x16x32_bf16 v[188:191], a[252:255], a[204:207], v[188:191]
ds_read_b64_tr_b16 a[242:243], v22 offset:22592
v_mfma_f32_16x16x32_bf16 v[144:147], v[244:247], a[48:51], 0
ds_read_b64_tr_b16 a[244:245], v23 offset:12352
v_mfma_f32_16x16x32_bf16 v[148:151], v[244:247], a[52:55], 0
s_waitcnt lgkmcnt(13)
ds_read_b64_tr_b16 a[246:247], v23 offset:14400
v_cvt_pk_bf16_f32 v234, v184, v185
v_mfma_f32_16x16x32_bf16 v[144:147], a[208:211], a[160:163], v[144:147]
ds_read_b64_tr_b16 a[248:249], v23 offset:16448
v_cvt_pk_bf16_f32 v235, v186, v187
v_mfma_f32_16x16x32_bf16 v[148:151], a[208:211], a[164:167], v[148:151]
ds_read_b64_tr_b16 a[250:251], v23 offset:18496
v_cvt_pk_bf16_f32 v238, v188, v189
v_mfma_f32_16x16x32_bf16 v[144:147], a[212:215], a[168:171], v[144:147]
s_cmp_lg_u32 s3, 2
s_cbranch_scc1 L_st0_1_2
s_mov_b32 s36, 4096
buffer_store_dwordx4 v[208:211], v26, s[24:27], s36 offen offset:0 sc1
buffer_store_dwordx4 v[212:215], v26, s[24:27], s36 offen offset:1024 sc1
buffer_store_dwordx4 v[216:219], v26, s[24:27], s36 offen offset:2048 sc1
buffer_store_dwordx4 v[220:223], v26, s[24:27], s36 offen offset:3072 sc1
L_st0_1_2:
v_mfma_f32_16x16x32_bf16 v[148:151], a[212:215], a[172:175], v[148:151]
ds_read_b64_tr_b16 a[252:253], v23 offset:20544
v_cvt_pk_bf16_f32 v239, v190, v191
v_mfma_f32_16x16x32_bf16 v[144:147], a[216:219], a[176:179], v[144:147]
ds_read_b64_tr_b16 a[254:255], v23 offset:22592
v_mfma_f32_16x16x32_bf16 v[148:151], a[216:219], a[180:183], v[148:151]
s_barrier
v_mfma_f32_16x16x32_bf16 v[160:163], v[248:251], a[48:51], 0
ds_read_b64_tr_b16 a[208:209], v20 offset:24704
v_mfma_f32_16x16x32_bf16 v[164:167], v[248:251], a[52:55], 0
s_waitcnt lgkmcnt(13)
ds_read_b64_tr_b16 a[210:211], v20 offset:26752
v_mfma_f32_16x16x32_bf16 v[160:163], a[220:223], a[160:163], v[160:163]
ds_read_b64_tr_b16 a[212:213], v20 offset:28800
v_mfma_f32_16x16x32_bf16 v[164:167], a[220:223], a[164:167], v[164:167]
ds_read_b64_tr_b16 a[214:215], v20 offset:30848
v_mfma_f32_16x16x32_bf16 v[160:163], a[224:227], a[168:171], v[160:163]
ds_read_b64_tr_b16 a[216:217], v20 offset:32896
v_mfma_f32_16x16x32_bf16 v[164:167], a[224:227], a[172:175], v[164:167]
ds_read_b64_tr_b16 a[218:219], v20 offset:34944
v_mfma_f32_16x16x32_bf16 v[160:163], a[228:231], a[176:179], v[160:163]
ds_read_b64_tr_b16 a[220:221], v21 offset:24704
v_mfma_f32_16x16x32_bf16 v[164:167], a[228:231], a[180:183], v[164:167]
ds_read_b64_tr_b16 a[222:223], v21 offset:26752
v_mfma_f32_16x16x32_bf16 v[176:179], v[244:247], a[56:59], 0
v_mfma_f32_16x16x32_bf16 v[180:183], v[244:247], a[60:63], 0
s_waitcnt lgkmcnt(14)
v_mfma_f32_16x16x32_bf16 v[176:179], a[232:235], a[160:163], v[176:179]
ds_read_b64_tr_b16 a[224:225], v21 offset:28800
v_mfma_f32_16x16x32_bf16 v[180:183], a[232:235], a[164:167], v[180:183]
ds_read_b64_tr_b16 a[226:227], v21 offset:30848
v_mfma_f32_16x16x32_bf16 v[176:179], a[236:239], a[168:171], v[176:179]
ds_read_b64_tr_b16 a[228:229], v21 offset:32896
v_mfma_f32_16x16x32_bf16 v[180:183], a[236:239], a[172:175], v[180:183]
ds_read_b64_tr_b16 a[230:231], v21 offset:34944
v_mfma_f32_16x16x32_bf16 v[176:179], a[240:243], a[176:179], v[176:179]
ds_read_b64_tr_b16 a[232:233], v22 offset:24704
v_mfma_f32_16x16x32_bf16 v[180:183], a[240:243], a[180:183], v[180:183]
ds_read_b64_tr_b16 a[234:235], v22 offset:26752
v_mfma_f32_16x16x32_bf16 v[184:187], v[248:251], a[56:59], 0
s_cmp_lg_u32 s3, 0
s_cbranch_scc1 L_st0_2_0
s_mov_b32 s36, 8192
buffer_store_dwordx4 v[224:227], v26, s[24:27], s36 offen offset:0 sc1
buffer_store_dwordx4 v[228:231], v26, s[24:27], s36 offen offset:1024 sc1
buffer_store_dwordx4 v[232:235], v26, s[24:27], s36 offen offset:2048 sc1
buffer_store_dwordx4 v[236:239], v26, s[24:27], s36 offen offset:3072 sc1
L_st0_2_0:
v_mfma_f32_16x16x32_bf16 v[188:191], v[248:251], a[60:63], 0
s_waitcnt lgkmcnt(14)
v_mfma_f32_16x16x32_bf16 v[184:187], a[244:247], a[160:163], v[184:187]
ds_read_b64_tr_b16 a[236:237], v22 offset:28800
v_mfma_f32_16x16x32_bf16 v[188:191], a[244:247], a[164:167], v[188:191]
ds_read_b64_tr_b16 a[238:239], v22 offset:30848
v_mfma_f32_16x16x32_bf16 v[184:187], a[248:251], a[168:171], v[184:187]
ds_read_b64_tr_b16 a[240:241], v22 offset:32896
v_mfma_f32_16x16x32_bf16 v[188:191], a[248:251], a[172:175], v[188:191]
ds_read_b64_tr_b16 a[242:243], v22 offset:34944
v_mfma_f32_16x16x32_bf16 v[184:187], a[252:255], a[176:179], v[184:187]
ds_read_b64_tr_b16 a[244:245], v23 offset:24704
v_mfma_f32_16x16x32_bf16 v[188:191], a[252:255], a[180:183], v[188:191]
s_waitcnt lgkmcnt(13)
ds_read_b64_tr_b16 a[246:247], v23 offset:26752
v_mfma_f32_16x16x32_bf16 v[144:147], a[208:211], a[184:187], v[144:147]
ds_read_b64_tr_b16 a[248:249], v23 offset:28800
v_mfma_f32_16x16x32_bf16 v[148:151], a[208:211], a[188:191], v[148:151]
ds_read_b64_tr_b16 a[250:251], v23 offset:30848
v_mfma_f32_16x16x32_bf16 v[144:147], a[212:215], a[192:195], v[144:147]
ds_read_b64_tr_b16 a[252:253], v23 offset:32896
v_mfma_f32_16x16x32_bf16 v[148:151], a[212:215], a[196:199], v[148:151]
ds_read_b64_tr_b16 a[254:255], v23 offset:34944
v_mfma_f32_16x16x32_bf16 v[144:147], a[216:219], a[200:203], v[144:147]
s_barrier
v_mfma_f32_16x16x32_bf16 v[148:151], a[216:219], a[204:207], v[148:151]
s_waitcnt lgkmcnt(12)
ds_read_b64_tr_b16 a[208:209], v20 offset:37056
v_mfma_f32_16x16x32_bf16 v[160:163], a[220:223], a[184:187], v[160:163]
ds_read_b64_tr_b16 a[210:211], v20 offset:39104
v_mfma_f32_16x16x32_bf16 v[164:167], a[220:223], a[188:191], v[164:167]
ds_read_b64_tr_b16 a[212:213], v20 offset:41152
v_cvt_pk_bf16_f32 v192, v144, v145
v_mfma_f32_16x16x32_bf16 v[160:163], a[224:227], a[192:195], v[160:163]
ds_read_b64_tr_b16 a[214:215], v20 offset:43200
v_cvt_pk_bf16_f32 v193, v146, v147
v_mfma_f32_16x16x32_bf16 v[164:167], a[224:227], a[196:199], v[164:167]
ds_read_b64_tr_b16 a[216:217], v20 offset:45248
v_cvt_pk_bf16_f32 v196, v148, v149
v_mfma_f32_16x16x32_bf16 v[160:163], a[228:231], a[200:203], v[160:163]
s_cmp_lg_u32 s3, 1
s_cbranch_scc1 L_st0_2_1
s_mov_b32 s36, 8192
buffer_store_dwordx4 v[224:227], v26, s[24:27], s36 offen offset:0 sc1
buffer_store_dwordx4 v[228:231], v26, s[24:27], s36 offen offset:1024 sc1
buffer_store_dwordx4 v[232:235], v26, s[24:27], s36 offen offset:2048 sc1
buffer_store_dwordx4 v[236:239], v26, s[24:27], s36 offen offset:3072 sc1
L_st0_2_1:
v_mfma_f32_16x16x32_bf16 v[164:167], a[228:231], a[204:207], v[164:167]
s_waitcnt lgkmcnt(11)
ds_read_b64_tr_b16 a[218:219], v20 offset:47296
v_cvt_pk_bf16_f32 v197, v150, v151
v_mfma_f32_16x16x32_bf16 v[176:179], a[232:235], a[184:187], v[176:179]
ds_read_b64_tr_b16 a[220:221], v21 offset:37056
v_cvt_pk_bf16_f32 v194, v160, v161
v_mfma_f32_16x16x32_bf16 v[180:183], a[232:235], a[188:191], v[180:183]
ds_read_b64_tr_b16 a[222:223], v21 offset:39104
v_cvt_pk_bf16_f32 v195, v162, v163
v_mfma_f32_16x16x32_bf16 v[176:179], a[236:239], a[192:195], v[176:179]
ds_read_b64_tr_b16 a[224:225], v21 offset:41152
v_cvt_pk_bf16_f32 v198, v164, v165
v_mfma_f32_16x16x32_bf16 v[180:183], a[236:239], a[196:199], v[180:183]
ds_read_b64_tr_b16 a[226:227], v21 offset:43200
v_cvt_pk_bf16_f32 v199, v166, v167
v_mfma_f32_16x16x32_bf16 v[176:179], a[240:243], a[200:203], v[176:179]
ds_read_b64_tr_b16 a[228:229], v21 offset:45248
v_mfma_f32_16x16x32_bf16 v[180:183], a[240:243], a[204:207], v[180:183]
s_waitcnt lgkmcnt(11)
ds_read_b64_tr_b16 a[230:231], v21 offset:47296
v_mfma_f32_16x16x32_bf16 v[184:187], a[244:247], a[184:187], v[184:187]
ds_read_b64_tr_b16 a[232:233], v22 offset:37056
v_mfma_f32_16x16x32_bf16 v[188:191], a[244:247], a[188:191], v[188:191]
ds_read_b64_tr_b16 a[234:235], v22 offset:39104
v_cvt_pk_bf16_f32 v200, v176, v177
v_mfma_f32_16x16x32_bf16 v[184:187], a[248:251], a[192:195], v[184:187]
ds_read_b64_tr_b16 a[236:237], v22 offset:41152
v_cvt_pk_bf16_f32 v201, v178, v179
v_mfma_f32_16x16x32_bf16 v[188:191], a[248:251], a[196:199], v[188:191]
ds_read_b64_tr_b16 a[238:239], v22 offset:43200
v_cvt_pk_bf16_f32 v204, v180, v181
v_mfma_f32_16x16x32_bf16 v[184:187], a[252:255], a[200:203], v[184:187]
ds_read_b64_tr_b16 a[240:241], v22 offset:45248
v_cvt_pk_bf16_f32 v205, v182, v183
v_mfma_f32_16x16x32_bf16 v[188:191], a[252:255], a[204:207], v[188:191]
ds_read_b64_tr_b16 a[242:243], v22 offset:47296
v_mfma_f32_16x16x32_bf16 v[144:147], v[244:247], a[64:67], 0
ds_read_b64_tr_b16 a[244:245], v23 offset:37056
v_mfma_f32_16x16x32_bf16 v[148:151], v[244:247], a[68:71], 0
s_waitcnt lgkmcnt(13)
ds_read_b64_tr_b16 a[246:247], v23 offset:39104
v_cvt_pk_bf16_f32 v202, v184, v185
v_mfma_f32_16x16x32_bf16 v[144:147], a[208:211], a[160:163], v[144:147]
ds_read_b64_tr_b16 a[248:249], v23 offset:41152
v_cvt_pk_bf16_f32 v203, v186, v187
v_mfma_f32_16x16x32_bf16 v[148:151], a[208:211], a[164:167], v[148:151]
ds_read_b64_tr_b16 a[250:251], v23 offset:43200
v_cvt_pk_bf16_f32 v206, v188, v189
v_mfma_f32_16x16x32_bf16 v[144:147], a[212:215], a[168:171], v[144:147]
s_cmp_lg_u32 s3, 2
s_cbranch_scc1 L_st0_2_2
s_mov_b32 s36, 8192
buffer_store_dwordx4 v[224:227], v26, s[24:27], s36 offen offset:0 sc1
buffer_store_dwordx4 v[228:231], v26, s[24:27], s36 offen offset:1024 sc1
buffer_store_dwordx4 v[232:235], v26, s[24:27], s36 offen offset:2048 sc1
buffer_store_dwordx4 v[236:239], v26, s[24:27], s36 offen offset:3072 sc1
L_st0_2_2:
v_mfma_f32_16x16x32_bf16 v[148:151], a[212:215], a[172:175], v[148:151]
ds_read_b64_tr_b16 a[252:253], v23 offset:45248
v_cvt_pk_bf16_f32 v207, v190, v191
v_mfma_f32_16x16x32_bf16 v[144:147], a[216:219], a[176:179], v[144:147]
ds_read_b64_tr_b16 a[254:255], v23 offset:47296
v_mfma_f32_16x16x32_bf16 v[148:151], a[216:219], a[180:183], v[148:151]
s_barrier
v_mfma_f32_16x16x32_bf16 v[160:163], v[248:251], a[64:67], 0
ds_read_b64_tr_b16 a[208:209], v20 offset:49408
v_mfma_f32_16x16x32_bf16 v[164:167], v[248:251], a[68:71], 0
s_waitcnt lgkmcnt(13)
ds_read_b64_tr_b16 a[210:211], v20 offset:51456
v_mfma_f32_16x16x32_bf16 v[160:163], a[220:223], a[160:163], v[160:163]
ds_read_b64_tr_b16 a[212:213], v20 offset:53504
v_mfma_f32_16x16x32_bf16 v[164:167], a[220:223], a[164:167], v[164:167]
ds_read_b64_tr_b16 a[214:215], v20 offset:55552
v_mfma_f32_16x16x32_bf16 v[160:163], a[224:227], a[168:171], v[160:163]
ds_read_b64_tr_b16 a[216:217], v20 offset:57600
v_mfma_f32_16x16x32_bf16 v[164:167], a[224:227], a[172:175], v[164:167]
ds_read_b64_tr_b16 a[218:219], v20 offset:59648
v_mfma_f32_16x16x32_bf16 v[160:163], a[228:231], a[176:179], v[160:163]
ds_read_b64_tr_b16 a[220:221], v21 offset:49408
v_mfma_f32_16x16x32_bf16 v[164:167], a[228:231], a[180:183], v[164:167]
ds_read_b64_tr_b16 a[222:223], v21 offset:51456
v_mfma_f32_16x16x32_bf16 v[176:179], v[244:247], a[72:75], 0
v_mfma_f32_16x16x32_bf16 v[180:183], v[244:247], a[76:79], 0
s_waitcnt lgkmcnt(14)
v_mfma_f32_16x16x32_bf16 v[176:179], a[232:235], a[160:163], v[176:179]
ds_read_b64_tr_b16 a[224:225], v21 offset:53504
v_mfma_f32_16x16x32_bf16 v[180:183], a[232:235], a[164:167], v[180:183]
ds_read_b64_tr_b16 a[226:227], v21 offset:55552
v_mfma_f32_16x16x32_bf16 v[176:179], a[236:239], a[168:171], v[176:179]
ds_read_b64_tr_b16 a[228:229], v21 offset:57600
v_mfma_f32_16x16x32_bf16 v[180:183], a[236:239], a[172:175], v[180:183]
ds_read_b64_tr_b16 a[230:231], v21 offset:59648
v_mfma_f32_16x16x32_bf16 v[176:179], a[240:243], a[176:179], v[176:179]
ds_read_b64_tr_b16 a[232:233], v22 offset:49408
v_mfma_f32_16x16x32_bf16 v[180:183], a[240:243], a[180:183], v[180:183]
ds_read_b64_tr_b16 a[234:235], v22 offset:51456
v_mfma_f32_16x16x32_bf16 v[184:187], v[248:251], a[72:75], 0
s_cmp_lg_u32 s3, 0
s_cbranch_scc1 L_st0_3_0
s_mov_b32 s36, 12288
buffer_store_dwordx4 v[192:195], v26, s[24:27], s36 offen offset:0 sc1
buffer_store_dwordx4 v[196:199], v26, s[24:27], s36 offen offset:1024 sc1
buffer_store_dwordx4 v[200:203], v26, s[24:27], s36 offen offset:2048 sc1
buffer_store_dwordx4 v[204:207], v26, s[24:27], s36 offen offset:3072 sc1
L_st0_3_0:
v_mfma_f32_16x16x32_bf16 v[188:191], v[248:251], a[76:79], 0
s_waitcnt lgkmcnt(14)
v_mfma_f32_16x16x32_bf16 v[184:187], a[244:247], a[160:163], v[184:187]
ds_read_b64_tr_b16 a[236:237], v22 offset:53504
v_mfma_f32_16x16x32_bf16 v[188:191], a[244:247], a[164:167], v[188:191]
ds_read_b64_tr_b16 a[238:239], v22 offset:55552
v_mfma_f32_16x16x32_bf16 v[184:187], a[248:251], a[168:171], v[184:187]
ds_read_b64_tr_b16 a[240:241], v22 offset:57600
v_mfma_f32_16x16x32_bf16 v[188:191], a[248:251], a[172:175], v[188:191]
ds_read_b64_tr_b16 a[242:243], v22 offset:59648
v_mfma_f32_16x16x32_bf16 v[184:187], a[252:255], a[176:179], v[184:187]
ds_read_b64_tr_b16 a[244:245], v23 offset:49408
v_mfma_f32_16x16x32_bf16 v[188:191], a[252:255], a[180:183], v[188:191]
s_waitcnt lgkmcnt(13)
ds_read_b64_tr_b16 a[246:247], v23 offset:51456
v_mfma_f32_16x16x32_bf16 v[144:147], a[208:211], a[184:187], v[144:147]
ds_read_b64_tr_b16 a[248:249], v23 offset:53504
v_mfma_f32_16x16x32_bf16 v[148:151], a[208:211], a[188:191], v[148:151]
ds_read_b64_tr_b16 a[250:251], v23 offset:55552
v_mfma_f32_16x16x32_bf16 v[144:147], a[212:215], a[192:195], v[144:147]
ds_read_b64_tr_b16 a[252:253], v23 offset:57600
v_mfma_f32_16x16x32_bf16 v[148:151], a[212:215], a[196:199], v[148:151]
ds_read_b64_tr_b16 a[254:255], v23 offset:59648
v_mfma_f32_16x16x32_bf16 v[144:147], a[216:219], a[200:203], v[144:147]
s_barrier
v_mfma_f32_16x16x32_bf16 v[148:151], a[216:219], a[204:207], v[148:151]
s_waitcnt lgkmcnt(12)
ds_read_b64_tr_b16 a[208:209], v20 offset:0
v_mfma_f32_16x16x32_bf16 v[160:163], a[220:223], a[184:187], v[160:163]
ds_read_b64_tr_b16 a[210:211], v20 offset:2048
v_mfma_f32_16x16x32_bf16 v[164:167], a[220:223], a[188:191], v[164:167]
ds_read_b64_tr_b16 a[212:213], v20 offset:4096
v_cvt_pk_bf16_f32 v208, v144, v145
v_mfma_f32_16x16x32_bf16 v[160:163], a[224:227], a[192:195], v[160:163]
ds_read_b64_tr_b16 a[214:215], v20 offset:6144
v_cvt_pk_bf16_f32 v209, v146, v147
v_mfma_f32_16x16x32_bf16 v[164:167], a[224:227], a[196:199], v[164:167]
ds_read_b64_tr_b16 a[216:217], v20 offset:8192
v_cvt_pk_bf16_f32 v212, v148, v149
v_mfma_f32_16x16x32_bf16 v[160:163], a[228:231], a[200:203], v[160:163]
s_cmp_lg_u32 s3, 1
s_cbranch_scc1 L_st0_3_1
s_mov_b32 s36, 12288
buffer_store_dwordx4 v[192:195], v26, s[24:27], s36 offen offset:0 sc1
buffer_store_dwordx4 v[196:199], v26, s[24:27], s36 offen offset:1024 sc1
buffer_store_dwordx4 v[200:203], v26, s[24:27], s36 offen offset:2048 sc1
buffer_store_dwordx4 v[204:207], v26, s[24:27], s36 offen offset:3072 sc1
L_st0_3_1:
v_mfma_f32_16x16x32_bf16 v[164:167], a[228:231], a[204:207], v[164:167]
s_waitcnt lgkmcnt(11)
ds_read_b64_tr_b16 a[218:219], v20 offset:10240
v_cvt_pk_bf16_f32 v213, v150, v151
v_mfma_f32_16x16x32_bf16 v[176:179], a[232:235], a[184:187], v[176:179]
ds_read_b64_tr_b16 a[220:221], v21 offset:0
v_cvt_pk_bf16_f32 v210, v160, v161
v_mfma_f32_16x16x32_bf16 v[180:183], a[232:235], a[188:191], v[180:183]
ds_read_b64_tr_b16 a[222:223], v21 offset:2048
v_cvt_pk_bf16_f32 v211, v162, v163
v_mfma_f32_16x16x32_bf16 v[176:179], a[236:239], a[192:195], v[176:179]
ds_read_b64_tr_b16 a[224:225], v21 offset:4096
v_cvt_pk_bf16_f32 v214, v164, v165
v_mfma_f32_16x16x32_bf16 v[180:183], a[236:239], a[196:199], v[180:183]
ds_read_b64_tr_b16 a[226:227], v21 offset:6144
v_cvt_pk_bf16_f32 v215, v166, v167
v_mfma_f32_16x16x32_bf16 v[176:179], a[240:243], a[200:203], v[176:179]
ds_read_b64_tr_b16 a[228:229], v21 offset:8192
v_mfma_f32_16x16x32_bf16 v[180:183], a[240:243], a[204:207], v[180:183]
s_waitcnt lgkmcnt(11)
ds_read_b64_tr_b16 a[230:231], v21 offset:10240
v_mfma_f32_16x16x32_bf16 v[184:187], a[244:247], a[184:187], v[184:187]
ds_read_b64_tr_b16 a[232:233], v22 offset:0
v_mfma_f32_16x16x32_bf16 v[188:191], a[244:247], a[188:191], v[188:191]
ds_read_b64_tr_b16 a[234:235], v22 offset:2048
v_cvt_pk_bf16_f32 v216, v176, v177
v_mfma_f32_16x16x32_bf16 v[184:187], a[248:251], a[192:195], v[184:187]
ds_read_b64_tr_b16 a[236:237], v22 offset:4096
v_cvt_pk_bf16_f32 v217, v178, v179
v_mfma_f32_16x16x32_bf16 v[188:191], a[248:251], a[196:199], v[188:191]
ds_read_b64_tr_b16 a[238:239], v22 offset:6144
v_cvt_pk_bf16_f32 v220, v180, v181
v_mfma_f32_16x16x32_bf16 v[184:187], a[252:255], a[200:203], v[184:187]
ds_read_b64_tr_b16 a[240:241], v22 offset:8192
v_cvt_pk_bf16_f32 v221, v182, v183
v_mfma_f32_16x16x32_bf16 v[188:191], a[252:255], a[204:207], v[188:191]
ds_read_b64_tr_b16 a[242:243], v22 offset:10240
v_mfma_f32_16x16x32_bf16 v[144:147], v[244:247], a[80:83], 0
ds_read_b64_tr_b16 a[244:245], v23 offset:0
v_mfma_f32_16x16x32_bf16 v[148:151], v[244:247], a[84:87], 0
s_waitcnt lgkmcnt(13)
ds_read_b64_tr_b16 a[246:247], v23 offset:2048
v_cvt_pk_bf16_f32 v218, v184, v185
v_mfma_f32_16x16x32_bf16 v[144:147], a[208:211], a[160:163], v[144:147]
ds_read_b64_tr_b16 a[248:249], v23 offset:4096
v_cvt_pk_bf16_f32 v219, v186, v187
v_mfma_f32_16x16x32_bf16 v[148:151], a[208:211], a[164:167], v[148:151]
ds_read_b64_tr_b16 a[250:251], v23 offset:6144
v_cvt_pk_bf16_f32 v222, v188, v189
v_mfma_f32_16x16x32_bf16 v[144:147], a[212:215], a[168:171], v[144:147]
s_cmp_lg_u32 s3, 2
s_cbranch_scc1 L_st0_3_2
s_mov_b32 s36, 12288
buffer_store_dwordx4 v[192:195], v26, s[24:27], s36 offen offset:0 sc1
buffer_store_dwordx4 v[196:199], v26, s[24:27], s36 offen offset:1024 sc1
buffer_store_dwordx4 v[200:203], v26, s[24:27], s36 offen offset:2048 sc1
buffer_store_dwordx4 v[204:207], v26, s[24:27], s36 offen offset:3072 sc1
L_st0_3_2:
v_mfma_f32_16x16x32_bf16 v[148:151], a[212:215], a[172:175], v[148:151]
ds_read_b64_tr_b16 a[252:253], v23 offset:8192
v_cvt_pk_bf16_f32 v223, v190, v191
v_mfma_f32_16x16x32_bf16 v[144:147], a[216:219], a[176:179], v[144:147]
ds_read_b64_tr_b16 a[254:255], v23 offset:10240
v_mfma_f32_16x16x32_bf16 v[148:151], a[216:219], a[180:183], v[148:151]
s_barrier
v_mfma_f32_16x16x32_bf16 v[160:163], v[248:251], a[80:83], 0
ds_read_b64_tr_b16 a[208:209], v20 offset:12352
v_mfma_f32_16x16x32_bf16 v[164:167], v[248:251], a[84:87], 0
s_waitcnt lgkmcnt(13)
ds_read_b64_tr_b16 a[210:211], v20 offset:14400
v_mfma_f32_16x16x32_bf16 v[160:163], a[220:223], a[160:163], v[160:163]
ds_read_b64_tr_b16 a[212:213], v20 offset:16448
v_mfma_f32_16x16x32_bf16 v[164:167], a[220:223], a[164:167], v[164:167]
ds_read_b64_tr_b16 a[214:215], v20 offset:18496
v_mfma_f32_16x16x32_bf16 v[160:163], a[224:227], a[168:171], v[160:163]
ds_read_b64_tr_b16 a[216:217], v20 offset:20544
v_mfma_f32_16x16x32_bf16 v[164:167], a[224:227], a[172:175], v[164:167]
ds_read_b64_tr_b16 a[218:219], v20 offset:22592
v_mfma_f32_16x16x32_bf16 v[160:163], a[228:231], a[176:179], v[160:163]
ds_read_b64_tr_b16 a[220:221], v21 offset:12352
v_mfma_f32_16x16x32_bf16 v[164:167], a[228:231], a[180:183], v[164:167]
ds_read_b64_tr_b16 a[222:223], v21 offset:14400
v_mfma_f32_16x16x32_bf16 v[176:179], v[244:247], a[88:91], 0
v_mfma_f32_16x16x32_bf16 v[180:183], v[244:247], a[92:95], 0
s_waitcnt lgkmcnt(14)
v_mfma_f32_16x16x32_bf16 v[176:179], a[232:235], a[160:163], v[176:179]
ds_read_b64_tr_b16 a[224:225], v21 offset:16448
v_mfma_f32_16x16x32_bf16 v[180:183], a[232:235], a[164:167], v[180:183]
ds_read_b64_tr_b16 a[226:227], v21 offset:18496
v_mfma_f32_16x16x32_bf16 v[176:179], a[236:239], a[168:171], v[176:179]
ds_read_b64_tr_b16 a[228:229], v21 offset:20544
v_mfma_f32_16x16x32_bf16 v[180:183], a[236:239], a[172:175], v[180:183]
ds_read_b64_tr_b16 a[230:231], v21 offset:22592
v_mfma_f32_16x16x32_bf16 v[176:179], a[240:243], a[176:179], v[176:179]
ds_read_b64_tr_b16 a[232:233], v22 offset:12352
v_mfma_f32_16x16x32_bf16 v[180:183], a[240:243], a[180:183], v[180:183]
ds_read_b64_tr_b16 a[234:235], v22 offset:14400
v_mfma_f32_16x16x32_bf16 v[184:187], v[248:251], a[88:91], 0
s_cmp_lg_u32 s3, 0
s_cbranch_scc1 L_st0_4_0
s_mov_b32 s36, 16384
buffer_store_dwordx4 v[208:211], v26, s[24:27], s36 offen offset:0 sc1
buffer_store_dwordx4 v[212:215], v26, s[24:27], s36 offen offset:1024 sc1
buffer_store_dwordx4 v[216:219], v26, s[24:27], s36 offen offset:2048 sc1
buffer_store_dwordx4 v[220:223], v26, s[24:27], s36 offen offset:3072 sc1
L_st0_4_0:
v_mfma_f32_16x16x32_bf16 v[188:191], v[248:251], a[92:95], 0
s_waitcnt lgkmcnt(14)
v_mfma_f32_16x16x32_bf16 v[184:187], a[244:247], a[160:163], v[184:187]
ds_read_b64_tr_b16 a[236:237], v22 offset:16448
v_mfma_f32_16x16x32_bf16 v[188:191], a[244:247], a[164:167], v[188:191]
ds_read_b64_tr_b16 a[238:239], v22 offset:18496
v_mfma_f32_16x16x32_bf16 v[184:187], a[248:251], a[168:171], v[184:187]
ds_read_b64_tr_b16 a[240:241], v22 offset:20544
v_mfma_f32_16x16x32_bf16 v[188:191], a[248:251], a[172:175], v[188:191]
ds_read_b64_tr_b16 a[242:243], v22 offset:22592
v_mfma_f32_16x16x32_bf16 v[184:187], a[252:255], a[176:179], v[184:187]
ds_read_b64_tr_b16 a[244:245], v23 offset:12352
v_mfma_f32_16x16x32_bf16 v[188:191], a[252:255], a[180:183], v[188:191]
s_waitcnt lgkmcnt(13)
ds_read_b64_tr_b16 a[246:247], v23 offset:14400
v_mfma_f32_16x16x32_bf16 v[144:147], a[208:211], a[184:187], v[144:147]
ds_read_b64_tr_b16 a[248:249], v23 offset:16448
v_mfma_f32_16x16x32_bf16 v[148:151], a[208:211], a[188:191], v[148:151]
ds_read_b64_tr_b16 a[250:251], v23 offset:18496
v_mfma_f32_16x16x32_bf16 v[144:147], a[212:215], a[192:195], v[144:147]
ds_read_b64_tr_b16 a[252:253], v23 offset:20544
v_mfma_f32_16x16x32_bf16 v[148:151], a[212:215], a[196:199], v[148:151]
ds_read_b64_tr_b16 a[254:255], v23 offset:22592
v_mfma_f32_16x16x32_bf16 v[144:147], a[216:219], a[200:203], v[144:147]
s_barrier
v_mfma_f32_16x16x32_bf16 v[148:151], a[216:219], a[204:207], v[148:151]
s_waitcnt lgkmcnt(12)
ds_read_b64_tr_b16 a[208:209], v20 offset:24704
v_mfma_f32_16x16x32_bf16 v[160:163], a[220:223], a[184:187], v[160:163]
ds_read_b64_tr_b16 a[210:211], v20 offset:26752
v_mfma_f32_16x16x32_bf16 v[164:167], a[220:223], a[188:191], v[164:167]
ds_read_b64_tr_b16 a[212:213], v20 offset:28800
v_cvt_pk_bf16_f32 v224, v144, v145
v_mfma_f32_16x16x32_bf16 v[160:163], a[224:227], a[192:195], v[160:163]
ds_read_b64_tr_b16 a[214:215], v20 offset:30848
v_cvt_pk_bf16_f32 v225, v146, v147
v_mfma_f32_16x16x32_bf16 v[164:167], a[224:227], a[196:199], v[164:167]
ds_read_b64_tr_b16 a[216:217], v20 offset:32896
v_cvt_pk_bf16_f32 v228, v148, v149
v_mfma_f32_16x16x32_bf16 v[160:163], a[228:231], a[200:203], v[160:163]
s_cmp_lg_u32 s3, 1
s_cbranch_scc1 L_st0_4_1
s_mov_b32 s36, 16384
buffer_store_dwordx4 v[208:211], v26, s[24:27], s36 offen offset:0 sc1
buffer_store_dwordx4 v[212:215], v26, s[24:27], s36 offen offset:1024 sc1
buffer_store_dwordx4 v[216:219], v26, s[24:27], s36 offen offset:2048 sc1
buffer_store_dwordx4 v[220:223], v26, s[24:27], s36 offen offset:3072 sc1
L_st0_4_1:
v_mfma_f32_16x16x32_bf16 v[164:167], a[228:231], a[204:207], v[164:167]
s_waitcnt lgkmcnt(11)
ds_read_b64_tr_b16 a[218:219], v20 offset:34944
v_cvt_pk_bf16_f32 v229, v150, v151
v_mfma_f32_16x16x32_bf16 v[176:179], a[232:235], a[184:187], v[176:179]
ds_read_b64_tr_b16 a[220:221], v21 offset:24704
v_cvt_pk_bf16_f32 v226, v160, v161
v_mfma_f32_16x16x32_bf16 v[180:183], a[232:235], a[188:191], v[180:183]
ds_read_b64_tr_b16 a[222:223], v21 offset:26752
v_cvt_pk_bf16_f32 v227, v162, v163
v_mfma_f32_16x16x32_bf16 v[176:179], a[236:239], a[192:195], v[176:179]
ds_read_b64_tr_b16 a[224:225], v21 offset:28800
v_cvt_pk_bf16_f32 v230, v164, v165
v_mfma_f32_16x16x32_bf16 v[180:183], a[236:239], a[196:199], v[180:183]
ds_read_b64_tr_b16 a[226:227], v21 offset:30848
v_cvt_pk_bf16_f32 v231, v166, v167
v_mfma_f32_16x16x32_bf16 v[176:179], a[240:243], a[200:203], v[176:179]
ds_read_b64_tr_b16 a[228:229], v21 offset:32896
v_mfma_f32_16x16x32_bf16 v[180:183], a[240:243], a[204:207], v[180:183]
s_waitcnt lgkmcnt(11)
ds_read_b64_tr_b16 a[230:231], v21 offset:34944
v_mfma_f32_16x16x32_bf16 v[184:187], a[244:247], a[184:187], v[184:187]
ds_read_b64_tr_b16 a[232:233], v22 offset:24704
v_mfma_f32_16x16x32_bf16 v[188:191], a[244:247], a[188:191], v[188:191]
ds_read_b64_tr_b16 a[234:235], v22 offset:26752
v_cvt_pk_bf16_f32 v232, v176, v177
v_mfma_f32_16x16x32_bf16 v[184:187], a[248:251], a[192:195], v[184:187]
ds_read_b64_tr_b16 a[236:237], v22 offset:28800
v_cvt_pk_bf16_f32 v233, v178, v179
v_mfma_f32_16x16x32_bf16 v[188:191], a[248:251], a[196:199], v[188:191]
ds_read_b64_tr_b16 a[238:239], v22 offset:30848
v_cvt_pk_bf16_f32 v236, v180, v181
v_mfma_f32_16x16x32_bf16 v[184:187], a[252:255], a[200:203], v[184:187]
ds_read_b64_tr_b16 a[240:241], v22 offset:32896
v_cvt_pk_bf16_f32 v237, v182, v183
v_mfma_f32_16x16x32_bf16 v[188:191], a[252:255], a[204:207], v[188:191]
ds_read_b64_tr_b16 a[242:243], v22 offset:34944
v_mfma_f32_16x16x32_bf16 v[144:147], v[244:247], a[96:99], 0
ds_read_b64_tr_b16 a[244:245], v23 offset:24704
v_mfma_f32_16x16x32_bf16 v[148:151], v[244:247], a[100:103], 0
s_waitcnt lgkmcnt(13)
ds_read_b64_tr_b16 a[246:247], v23 offset:26752
v_cvt_pk_bf16_f32 v234, v184, v185
v_mfma_f32_16x16x32_bf16 v[144:147], a[208:211], a[160:163], v[144:147]
ds_read_b64_tr_b16 a[248:249], v23 offset:28800
v_cvt_pk_bf16_f32 v235, v186, v187
v_mfma_f32_16x16x32_bf16 v[148:151], a[208:211], a[164:167], v[148:151]
ds_read_b64_tr_b16 a[250:251], v23 offset:30848
v_cvt_pk_bf16_f32 v238, v188, v189
v_mfma_f32_16x16x32_bf16 v[144:147], a[212:215], a[168:171], v[144:147]
s_cmp_lg_u32 s3, 2
s_cbranch_scc1 L_st0_4_2
s_mov_b32 s36, 16384
buffer_store_dwordx4 v[208:211], v26, s[24:27], s36 offen offset:0 sc1
buffer_store_dwordx4 v[212:215], v26, s[24:27], s36 offen offset:1024 sc1
buffer_store_dwordx4 v[216:219], v26, s[24:27], s36 offen offset:2048 sc1
buffer_store_dwordx4 v[220:223], v26, s[24:27], s36 offen offset:3072 sc1
L_st0_4_2:
v_mfma_f32_16x16x32_bf16 v[148:151], a[212:215], a[172:175], v[148:151]
ds_read_b64_tr_b16 a[252:253], v23 offset:32896
v_cvt_pk_bf16_f32 v239, v190, v191
v_mfma_f32_16x16x32_bf16 v[144:147], a[216:219], a[176:179], v[144:147]
ds_read_b64_tr_b16 a[254:255], v23 offset:34944
v_mfma_f32_16x16x32_bf16 v[148:151], a[216:219], a[180:183], v[148:151]
s_barrier
v_mfma_f32_16x16x32_bf16 v[160:163], v[248:251], a[96:99], 0
ds_read_b64_tr_b16 a[208:209], v20 offset:37056
v_mfma_f32_16x16x32_bf16 v[164:167], v[248:251], a[100:103], 0
s_waitcnt lgkmcnt(13)
ds_read_b64_tr_b16 a[210:211], v20 offset:39104
v_mfma_f32_16x16x32_bf16 v[160:163], a[220:223], a[160:163], v[160:163]
ds_read_b64_tr_b16 a[212:213], v20 offset:41152
v_mfma_f32_16x16x32_bf16 v[164:167], a[220:223], a[164:167], v[164:167]
ds_read_b64_tr_b16 a[214:215], v20 offset:43200
v_mfma_f32_16x16x32_bf16 v[160:163], a[224:227], a[168:171], v[160:163]
ds_read_b64_tr_b16 a[216:217], v20 offset:45248
v_mfma_f32_16x16x32_bf16 v[164:167], a[224:227], a[172:175], v[164:167]
ds_read_b64_tr_b16 a[218:219], v20 offset:47296
v_mfma_f32_16x16x32_bf16 v[160:163], a[228:231], a[176:179], v[160:163]
ds_read_b64_tr_b16 a[220:221], v21 offset:37056
v_mfma_f32_16x16x32_bf16 v[164:167], a[228:231], a[180:183], v[164:167]
ds_read_b64_tr_b16 a[222:223], v21 offset:39104
v_mfma_f32_16x16x32_bf16 v[176:179], v[244:247], a[104:107], 0
v_mfma_f32_16x16x32_bf16 v[180:183], v[244:247], a[108:111], 0
s_waitcnt lgkmcnt(14)
v_mfma_f32_16x16x32_bf16 v[176:179], a[232:235], a[160:163], v[176:179]
ds_read_b64_tr_b16 a[224:225], v21 offset:41152
v_mfma_f32_16x16x32_bf16 v[180:183], a[232:235], a[164:167], v[180:183]
ds_read_b64_tr_b16 a[226:227], v21 offset:43200
v_mfma_f32_16x16x32_bf16 v[176:179], a[236:239], a[168:171], v[176:179]
ds_read_b64_tr_b16 a[228:229], v21 offset:45248
v_mfma_f32_16x16x32_bf16 v[180:183], a[236:239], a[172:175], v[180:183]
ds_read_b64_tr_b16 a[230:231], v21 offset:47296
v_mfma_f32_16x16x32_bf16 v[176:179], a[240:243], a[176:179], v[176:179]
ds_read_b64_tr_b16 a[232:233], v22 offset:37056
v_mfma_f32_16x16x32_bf16 v[180:183], a[240:243], a[180:183], v[180:183]
ds_read_b64_tr_b16 a[234:235], v22 offset:39104
v_mfma_f32_16x16x32_bf16 v[184:187], v[248:251], a[104:107], 0
s_cmp_lg_u32 s3, 0
s_cbranch_scc1 L_st0_5_0
s_mov_b32 s36, 20480
buffer_store_dwordx4 v[224:227], v26, s[24:27], s36 offen offset:0 sc1
buffer_store_dwordx4 v[228:231], v26, s[24:27], s36 offen offset:1024 sc1
buffer_store_dwordx4 v[232:235], v26, s[24:27], s36 offen offset:2048 sc1
buffer_store_dwordx4 v[236:239], v26, s[24:27], s36 offen offset:3072 sc1
L_st0_5_0:
v_mfma_f32_16x16x32_bf16 v[188:191], v[248:251], a[108:111], 0
s_waitcnt lgkmcnt(14)
v_mfma_f32_16x16x32_bf16 v[184:187], a[244:247], a[160:163], v[184:187]
ds_read_b64_tr_b16 a[236:237], v22 offset:41152
v_mfma_f32_16x16x32_bf16 v[188:191], a[244:247], a[164:167], v[188:191]
ds_read_b64_tr_b16 a[238:239], v22 offset:43200
v_mfma_f32_16x16x32_bf16 v[184:187], a[248:251], a[168:171], v[184:187]
ds_read_b64_tr_b16 a[240:241], v22 offset:45248
v_mfma_f32_16x16x32_bf16 v[188:191], a[248:251], a[172:175], v[188:191]
ds_read_b64_tr_b16 a[242:243], v22 offset:47296
v_mfma_f32_16x16x32_bf16 v[184:187], a[252:255], a[176:179], v[184:187]
ds_read_b64_tr_b16 a[244:245], v23 offset:37056
v_mfma_f32_16x16x32_bf16 v[188:191], a[252:255], a[180:183], v[188:191]
s_waitcnt lgkmcnt(13)
ds_read_b64_tr_b16 a[246:247], v23 offset:39104
v_mfma_f32_16x16x32_bf16 v[144:147], a[208:211], a[184:187], v[144:147]
ds_read_b64_tr_b16 a[248:249], v23 offset:41152
v_mfma_f32_16x16x32_bf16 v[148:151], a[208:211], a[188:191], v[148:151]
ds_read_b64_tr_b16 a[250:251], v23 offset:43200
v_mfma_f32_16x16x32_bf16 v[144:147], a[212:215], a[192:195], v[144:147]
ds_read_b64_tr_b16 a[252:253], v23 offset:45248
v_mfma_f32_16x16x32_bf16 v[148:151], a[212:215], a[196:199], v[148:151]
ds_read_b64_tr_b16 a[254:255], v23 offset:47296
v_mfma_f32_16x16x32_bf16 v[144:147], a[216:219], a[200:203], v[144:147]
s_barrier
v_mfma_f32_16x16x32_bf16 v[148:151], a[216:219], a[204:207], v[148:151]
s_waitcnt lgkmcnt(12)
ds_read_b64_tr_b16 a[208:209], v20 offset:49408
v_mfma_f32_16x16x32_bf16 v[160:163], a[220:223], a[184:187], v[160:163]
ds_read_b64_tr_b16 a[210:211], v20 offset:51456
v_mfma_f32_16x16x32_bf16 v[164:167], a[220:223], a[188:191], v[164:167]
ds_read_b64_tr_b16 a[212:213], v20 offset:53504
v_cvt_pk_bf16_f32 v192, v144, v145
v_mfma_f32_16x16x32_bf16 v[160:163], a[224:227], a[192:195], v[160:163]
ds_read_b64_tr_b16 a[214:215], v20 offset:55552
v_cvt_pk_bf16_f32 v193, v146, v147
v_mfma_f32_16x16x32_bf16 v[164:167], a[224:227], a[196:199], v[164:167]
ds_read_b64_tr_b16 a[216:217], v20 offset:57600
v_cvt_pk_bf16_f32 v196, v148, v149
v_mfma_f32_16x16x32_bf16 v[160:163], a[228:231], a[200:203], v[160:163]
s_cmp_lg_u32 s3, 1
s_cbranch_scc1 L_st0_5_1
s_mov_b32 s36, 20480
buffer_store_dwordx4 v[224:227], v26, s[24:27], s36 offen offset:0 sc1
buffer_store_dwordx4 v[228:231], v26, s[24:27], s36 offen offset:1024 sc1
buffer_store_dwordx4 v[232:235], v26, s[24:27], s36 offen offset:2048 sc1
buffer_store_dwordx4 v[236:239], v26, s[24:27], s36 offen offset:3072 sc1
L_st0_5_1:
v_mfma_f32_16x16x32_bf16 v[164:167], a[228:231], a[204:207], v[164:167]
s_waitcnt lgkmcnt(11)
ds_read_b64_tr_b16 a[218:219], v20 offset:59648
v_cvt_pk_bf16_f32 v197, v150, v151
v_mfma_f32_16x16x32_bf16 v[176:179], a[232:235], a[184:187], v[176:179]
ds_read_b64_tr_b16 a[220:221], v21 offset:49408
v_cvt_pk_bf16_f32 v194, v160, v161
v_mfma_f32_16x16x32_bf16 v[180:183], a[232:235], a[188:191], v[180:183]
ds_read_b64_tr_b16 a[222:223], v21 offset:51456
v_cvt_pk_bf16_f32 v195, v162, v163
v_mfma_f32_16x16x32_bf16 v[176:179], a[236:239], a[192:195], v[176:179]
ds_read_b64_tr_b16 a[224:225], v21 offset:53504
v_cvt_pk_bf16_f32 v198, v164, v165
v_mfma_f32_16x16x32_bf16 v[180:183], a[236:239], a[196:199], v[180:183]
ds_read_b64_tr_b16 a[226:227], v21 offset:55552
v_cvt_pk_bf16_f32 v199, v166, v167
v_mfma_f32_16x16x32_bf16 v[176:179], a[240:243], a[200:203], v[176:179]
ds_read_b64_tr_b16 a[228:229], v21 offset:57600
v_mfma_f32_16x16x32_bf16 v[180:183], a[240:243], a[204:207], v[180:183]
s_waitcnt lgkmcnt(11)
ds_read_b64_tr_b16 a[230:231], v21 offset:59648
v_mfma_f32_16x16x32_bf16 v[184:187], a[244:247], a[184:187], v[184:187]
ds_read_b64_tr_b16 a[232:233], v22 offset:49408
v_mfma_f32_16x16x32_bf16 v[188:191], a[244:247], a[188:191], v[188:191]
ds_read_b64_tr_b16 a[234:235], v22 offset:51456
v_cvt_pk_bf16_f32 v200, v176, v177
v_mfma_f32_16x16x32_bf16 v[184:187], a[248:251], a[192:195], v[184:187]
ds_read_b64_tr_b16 a[236:237], v22 offset:53504
v_cvt_pk_bf16_f32 v201, v178, v179
v_mfma_f32_16x16x32_bf16 v[188:191], a[248:251], a[196:199], v[188:191]
ds_read_b64_tr_b16 a[238:239], v22 offset:55552
v_cvt_pk_bf16_f32 v204, v180, v181
v_mfma_f32_16x16x32_bf16 v[184:187], a[252:255], a[200:203], v[184:187]
ds_read_b64_tr_b16 a[240:241], v22 offset:57600
v_cvt_pk_bf16_f32 v205, v182, v183
v_mfma_f32_16x16x32_bf16 v[188:191], a[252:255], a[204:207], v[188:191]
ds_read_b64_tr_b16 a[242:243], v22 offset:59648
v_mfma_f32_16x16x32_bf16 v[144:147], v[244:247], a[112:115], 0
ds_read_b64_tr_b16 a[244:245], v23 offset:49408
v_mfma_f32_16x16x32_bf16 v[148:151], v[244:247], a[116:119], 0
s_waitcnt lgkmcnt(13)
ds_read_b64_tr_b16 a[246:247], v23 offset:51456
v_cvt_pk_bf16_f32 v202, v184, v185
v_mfma_f32_16x16x32_bf16 v[144:147], a[208:211], a[160:163], v[144:147]
ds_read_b64_tr_b16 a[248:249], v23 offset:53504
v_cvt_pk_bf16_f32 v203, v186, v187
v_mfma_f32_16x16x32_bf16 v[148:151], a[208:211], a[164:167], v[148:151]
ds_read_b64_tr_b16 a[250:251], v23 offset:55552
v_cvt_pk_bf16_f32 v206, v188, v189
v_mfma_f32_16x16x32_bf16 v[144:147], a[212:215], a[168:171], v[144:147]
s_cmp_lg_u32 s3, 2
s_cbranch_scc1 L_st0_5_2
s_mov_b32 s36, 20480
buffer_store_dwordx4 v[224:227], v26, s[24:27], s36 offen offset:0 sc1
buffer_store_dwordx4 v[228:231], v26, s[24:27], s36 offen offset:1024 sc1
buffer_store_dwordx4 v[232:235], v26, s[24:27], s36 offen offset:2048 sc1
buffer_store_dwordx4 v[236:239], v26, s[24:27], s36 offen offset:3072 sc1
L_st0_5_2:
v_mfma_f32_16x16x32_bf16 v[148:151], a[212:215], a[172:175], v[148:151]
ds_read_b64_tr_b16 a[252:253], v23 offset:57600
v_cvt_pk_bf16_f32 v207, v190, v191
v_mfma_f32_16x16x32_bf16 v[144:147], a[216:219], a[176:179], v[144:147]
ds_read_b64_tr_b16 a[254:255], v23 offset:59648
v_mfma_f32_16x16x32_bf16 v[148:151], a[216:219], a[180:183], v[148:151]
s_waitcnt vmcnt(4)
v_mfma_f32_16x16x32_bf16 v[160:163], v[248:251], a[112:115], 0
s_barrier
v_mfma_f32_16x16x32_bf16 v[164:167], v[248:251], a[116:119], 0
s_waitcnt lgkmcnt(12)
ds_read_b64_tr_b16 a[208:209], v20 offset:0
v_mfma_f32_16x16x32_bf16 v[160:163], a[220:223], a[160:163], v[160:163]
ds_read_b64_tr_b16 a[210:211], v20 offset:2048
v_mfma_f32_16x16x32_bf16 v[164:167], a[220:223], a[164:167], v[164:167]
ds_read_b64_tr_b16 a[212:213], v20 offset:4096
v_mfma_f32_16x16x32_bf16 v[160:163], a[224:227], a[168:171], v[160:163]
ds_read_b64_tr_b16 a[214:215], v20 offset:6144
v_mfma_f32_16x16x32_bf16 v[164:167], a[224:227], a[172:175], v[164:167]
ds_read_b64_tr_b16 a[216:217], v20 offset:8192
v_mfma_f32_16x16x32_bf16 v[160:163], a[228:231], a[176:179], v[160:163]
ds_read_b64_tr_b16 a[218:219], v20 offset:10240
v_mfma_f32_16x16x32_bf16 v[164:167], a[228:231], a[180:183], v[164:167]
ds_read_b64_tr_b16 a[220:221], v21 offset:0
v_mfma_f32_16x16x32_bf16 v[176:179], v[244:247], a[120:123], 0
ds_read_b64_tr_b16 a[222:223], v21 offset:2048
v_mfma_f32_16x16x32_bf16 v[180:183], v[244:247], a[124:127], 0
s_waitcnt lgkmcnt(14)
v_mfma_f32_16x16x32_bf16 v[176:179], a[232:235], a[160:163], v[176:179]
ds_read_b64_tr_b16 a[224:225], v21 offset:4096
v_mfma_f32_16x16x32_bf16 v[180:183], a[232:235], a[164:167], v[180:183]
ds_read_b64_tr_b16 a[226:227], v21 offset:6144
v_mfma_f32_16x16x32_bf16 v[176:179], a[236:239], a[168:171], v[176:179]
ds_read_b64_tr_b16 a[228:229], v21 offset:8192
v_mfma_f32_16x16x32_bf16 v[180:183], a[236:239], a[172:175], v[180:183]
ds_read_b64_tr_b16 a[230:231], v21 offset:10240
v_mfma_f32_16x16x32_bf16 v[176:179], a[240:243], a[176:179], v[176:179]
ds_read_b64_tr_b16 a[232:233], v22 offset:0
v_mfma_f32_16x16x32_bf16 v[180:183], a[240:243], a[180:183], v[180:183]
ds_read_b64_tr_b16 a[234:235], v22 offset:2048
v_mfma_f32_16x16x32_bf16 v[184:187], v[248:251], a[120:123], 0
s_cmp_lg_u32 s3, 0
s_cbranch_scc1 L_st0_6_0
s_mov_b32 s36, 24576
buffer_store_dwordx4 v[192:195], v26, s[24:27], s36 offen offset:0 sc1
buffer_store_dwordx4 v[196:199], v26, s[24:27], s36 offen offset:1024 sc1
buffer_store_dwordx4 v[200:203], v26, s[24:27], s36 offen offset:2048 sc1
buffer_store_dwordx4 v[204:207], v26, s[24:27], s36 offen offset:3072 sc1
L_st0_6_0:
v_mfma_f32_16x16x32_bf16 v[188:191], v[248:251], a[124:127], 0
s_waitcnt lgkmcnt(14)
v_mfma_f32_16x16x32_bf16 v[184:187], a[244:247], a[160:163], v[184:187]
ds_read_b64_tr_b16 a[236:237], v22 offset:4096
v_mfma_f32_16x16x32_bf16 v[188:191], a[244:247], a[164:167], v[188:191]
ds_read_b64_tr_b16 a[238:239], v22 offset:6144
v_mfma_f32_16x16x32_bf16 v[184:187], a[248:251], a[168:171], v[184:187]
ds_read_b64_tr_b16 a[240:241], v22 offset:8192
v_mfma_f32_16x16x32_bf16 v[188:191], a[248:251], a[172:175], v[188:191]
ds_read_b64_tr_b16 a[242:243], v22 offset:10240
v_mfma_f32_16x16x32_bf16 v[184:187], a[252:255], a[176:179], v[184:187]
ds_read_b64_tr_b16 a[244:245], v23 offset:0
v_mfma_f32_16x16x32_bf16 v[188:191], a[252:255], a[180:183], v[188:191]
s_waitcnt lgkmcnt(13)
ds_read_b64_tr_b16 a[246:247], v23 offset:2048
v_mfma_f32_16x16x32_bf16 v[144:147], a[208:211], a[184:187], v[144:147]
ds_read_b64_tr_b16 a[248:249], v23 offset:4096
v_mfma_f32_16x16x32_bf16 v[148:151], a[208:211], a[188:191], v[148:151]
ds_read_b64_tr_b16 a[250:251], v23 offset:6144
v_mfma_f32_16x16x32_bf16 v[144:147], a[212:215], a[192:195], v[144:147]
ds_read_b64_tr_b16 a[252:253], v23 offset:8192
v_mfma_f32_16x16x32_bf16 v[148:151], a[212:215], a[196:199], v[148:151]
ds_read_b64_tr_b16 a[254:255], v23 offset:10240
v_mfma_f32_16x16x32_bf16 v[144:147], a[216:219], a[200:203], v[144:147]
s_barrier
v_mfma_f32_16x16x32_bf16 v[148:151], a[216:219], a[204:207], v[148:151]
s_waitcnt lgkmcnt(12)
ds_read_b64_tr_b16 a[208:209], v20 offset:12352
v_mfma_f32_16x16x32_bf16 v[160:163], a[220:223], a[184:187], v[160:163]
ds_read_b64_tr_b16 a[210:211], v20 offset:14400
v_mfma_f32_16x16x32_bf16 v[164:167], a[220:223], a[188:191], v[164:167]
ds_read_b64_tr_b16 a[212:213], v20 offset:16448
v_cvt_pk_bf16_f32 v208, v144, v145
v_mfma_f32_16x16x32_bf16 v[160:163], a[224:227], a[192:195], v[160:163]
ds_read_b64_tr_b16 a[214:215], v20 offset:18496
v_cvt_pk_bf16_f32 v209, v146, v147
v_mfma_f32_16x16x32_bf16 v[164:167], a[224:227], a[196:199], v[164:167]
ds_read_b64_tr_b16 a[216:217], v20 offset:20544
v_cvt_pk_bf16_f32 v212, v148, v149
v_mfma_f32_16x16x32_bf16 v[160:163], a[228:231], a[200:203], v[160:163]
s_cmp_lg_u32 s3, 1
s_cbranch_scc1 L_st0_6_1
s_mov_b32 s36, 24576
buffer_store_dwordx4 v[192:195], v26, s[24:27], s36 offen offset:0 sc1
buffer_store_dwordx4 v[196:199], v26, s[24:27], s36 offen offset:1024 sc1
buffer_store_dwordx4 v[200:203], v26, s[24:27], s36 offen offset:2048 sc1
buffer_store_dwordx4 v[204:207], v26, s[24:27], s36 offen offset:3072 sc1
L_st0_6_1:
v_mfma_f32_16x16x32_bf16 v[164:167], a[228:231], a[204:207], v[164:167]
s_waitcnt lgkmcnt(11)
ds_read_b64_tr_b16 a[218:219], v20 offset:22592
v_cvt_pk_bf16_f32 v213, v150, v151
v_mfma_f32_16x16x32_bf16 v[176:179], a[232:235], a[184:187], v[176:179]
ds_read_b64_tr_b16 a[220:221], v21 offset:12352
v_cvt_pk_bf16_f32 v210, v160, v161
v_mfma_f32_16x16x32_bf16 v[180:183], a[232:235], a[188:191], v[180:183]
ds_read_b64_tr_b16 a[222:223], v21 offset:14400
v_cvt_pk_bf16_f32 v211, v162, v163
v_mfma_f32_16x16x32_bf16 v[176:179], a[236:239], a[192:195], v[176:179]
ds_read_b64_tr_b16 a[224:225], v21 offset:16448
v_cvt_pk_bf16_f32 v214, v164, v165
v_mfma_f32_16x16x32_bf16 v[180:183], a[236:239], a[196:199], v[180:183]
ds_read_b64_tr_b16 a[226:227], v21 offset:18496
v_cvt_pk_bf16_f32 v215, v166, v167
v_mfma_f32_16x16x32_bf16 v[176:179], a[240:243], a[200:203], v[176:179]
ds_read_b64_tr_b16 a[228:229], v21 offset:20544
v_mfma_f32_16x16x32_bf16 v[180:183], a[240:243], a[204:207], v[180:183]
s_waitcnt lgkmcnt(11)
ds_read_b64_tr_b16 a[230:231], v21 offset:22592
v_mfma_f32_16x16x32_bf16 v[184:187], a[244:247], a[184:187], v[184:187]
ds_read_b64_tr_b16 a[232:233], v22 offset:12352
v_mfma_f32_16x16x32_bf16 v[188:191], a[244:247], a[188:191], v[188:191]
ds_read_b64_tr_b16 a[234:235], v22 offset:14400
v_cvt_pk_bf16_f32 v216, v176, v177
v_mfma_f32_16x16x32_bf16 v[184:187], a[248:251], a[192:195], v[184:187]
ds_read_b64_tr_b16 a[236:237], v22 offset:16448
v_cvt_pk_bf16_f32 v217, v178, v179
v_mfma_f32_16x16x32_bf16 v[188:191], a[248:251], a[196:199], v[188:191]
ds_read_b64_tr_b16 a[238:239], v22 offset:18496
v_cvt_pk_bf16_f32 v220, v180, v181
v_mfma_f32_16x16x32_bf16 v[184:187], a[252:255], a[200:203], v[184:187]
ds_read_b64_tr_b16 a[240:241], v22 offset:20544
v_cvt_pk_bf16_f32 v221, v182, v183
v_mfma_f32_16x16x32_bf16 v[188:191], a[252:255], a[204:207], v[188:191]
ds_read_b64_tr_b16 a[242:243], v22 offset:22592
v_mfma_f32_16x16x32_bf16 v[144:147], v[244:247], a[128:131], 0
ds_read_b64_tr_b16 a[244:245], v23 offset:12352
v_mfma_f32_16x16x32_bf16 v[148:151], v[244:247], a[132:135], 0
s_waitcnt lgkmcnt(13)
ds_read_b64_tr_b16 a[246:247], v23 offset:14400
v_cvt_pk_bf16_f32 v218, v184, v185
v_mfma_f32_16x16x32_bf16 v[144:147], a[208:211], a[160:163], v[144:147]
ds_read_b64_tr_b16 a[248:249], v23 offset:16448
v_cvt_pk_bf16_f32 v219, v186, v187
v_mfma_f32_16x16x32_bf16 v[148:151], a[208:211], a[164:167], v[148:151]
ds_read_b64_tr_b16 a[250:251], v23 offset:18496
v_cvt_pk_bf16_f32 v222, v188, v189
v_mfma_f32_16x16x32_bf16 v[144:147], a[212:215], a[168:171], v[144:147]
s_cmp_lg_u32 s3, 2
s_cbranch_scc1 L_st0_6_2
s_mov_b32 s36, 24576
buffer_store_dwordx4 v[192:195], v26, s[24:27], s36 offen offset:0 sc1
buffer_store_dwordx4 v[196:199], v26, s[24:27], s36 offen offset:1024 sc1
buffer_store_dwordx4 v[200:203], v26, s[24:27], s36 offen offset:2048 sc1
buffer_store_dwordx4 v[204:207], v26, s[24:27], s36 offen offset:3072 sc1
L_st0_6_2:
v_mfma_f32_16x16x32_bf16 v[148:151], a[212:215], a[172:175], v[148:151]
ds_read_b64_tr_b16 a[252:253], v23 offset:20544
v_cvt_pk_bf16_f32 v223, v190, v191
v_mfma_f32_16x16x32_bf16 v[144:147], a[216:219], a[176:179], v[144:147]
ds_read_b64_tr_b16 a[254:255], v23 offset:22592
v_mfma_f32_16x16x32_bf16 v[148:151], a[216:219], a[180:183], v[148:151]
s_barrier
v_mfma_f32_16x16x32_bf16 v[160:163], v[248:251], a[128:131], 0
ds_read_b64_tr_b16 a[208:209], v20 offset:24704
v_mfma_f32_16x16x32_bf16 v[164:167], v[248:251], a[132:135], 0
s_waitcnt lgkmcnt(13)
ds_read_b64_tr_b16 a[210:211], v20 offset:26752
v_mfma_f32_16x16x32_bf16 v[160:163], a[220:223], a[160:163], v[160:163]
ds_read_b64_tr_b16 a[212:213], v20 offset:28800
v_mfma_f32_16x16x32_bf16 v[164:167], a[220:223], a[164:167], v[164:167]
ds_read_b64_tr_b16 a[214:215], v20 offset:30848
v_mfma_f32_16x16x32_bf16 v[160:163], a[224:227], a[168:171], v[160:163]
ds_read_b64_tr_b16 a[216:217], v20 offset:32896
v_mfma_f32_16x16x32_bf16 v[164:167], a[224:227], a[172:175], v[164:167]
ds_read_b64_tr_b16 a[218:219], v20 offset:34944
v_mfma_f32_16x16x32_bf16 v[160:163], a[228:231], a[176:179], v[160:163]
ds_read_b64_tr_b16 a[220:221], v21 offset:24704
v_mfma_f32_16x16x32_bf16 v[164:167], a[228:231], a[180:183], v[164:167]
ds_read_b64_tr_b16 a[222:223], v21 offset:26752
v_mfma_f32_16x16x32_bf16 v[176:179], v[244:247], a[136:139], 0
v_mfma_f32_16x16x32_bf16 v[180:183], v[244:247], a[140:143], 0
s_waitcnt lgkmcnt(14)
v_mfma_f32_16x16x32_bf16 v[176:179], a[232:235], a[160:163], v[176:179]
ds_read_b64_tr_b16 a[224:225], v21 offset:28800
v_mfma_f32_16x16x32_bf16 v[180:183], a[232:235], a[164:167], v[180:183]
ds_read_b64_tr_b16 a[226:227], v21 offset:30848
v_mfma_f32_16x16x32_bf16 v[176:179], a[236:239], a[168:171], v[176:179]
ds_read_b64_tr_b16 a[228:229], v21 offset:32896
v_mfma_f32_16x16x32_bf16 v[180:183], a[236:239], a[172:175], v[180:183]
ds_read_b64_tr_b16 a[230:231], v21 offset:34944
v_mfma_f32_16x16x32_bf16 v[176:179], a[240:243], a[176:179], v[176:179]
ds_read_b64_tr_b16 a[232:233], v22 offset:24704
v_mfma_f32_16x16x32_bf16 v[180:183], a[240:243], a[180:183], v[180:183]
ds_read_b64_tr_b16 a[234:235], v22 offset:26752
v_mfma_f32_16x16x32_bf16 v[184:187], v[248:251], a[136:139], 0
s_cmp_lg_u32 s3, 0
s_cbranch_scc1 L_st0_7_0
s_mov_b32 s36, 28672
buffer_store_dwordx4 v[208:211], v26, s[24:27], s36 offen offset:0 sc1
buffer_store_dwordx4 v[212:215], v26, s[24:27], s36 offen offset:1024 sc1
buffer_store_dwordx4 v[216:219], v26, s[24:27], s36 offen offset:2048 sc1
buffer_store_dwordx4 v[220:223], v26, s[24:27], s36 offen offset:3072 sc1
L_st0_7_0:
v_mfma_f32_16x16x32_bf16 v[188:191], v[248:251], a[140:143], 0
s_waitcnt lgkmcnt(14)
v_mfma_f32_16x16x32_bf16 v[184:187], a[244:247], a[160:163], v[184:187]
ds_read_b64_tr_b16 a[236:237], v22 offset:28800
v_mfma_f32_16x16x32_bf16 v[188:191], a[244:247], a[164:167], v[188:191]
ds_read_b64_tr_b16 a[238:239], v22 offset:30848
v_mfma_f32_16x16x32_bf16 v[184:187], a[248:251], a[168:171], v[184:187]
ds_read_b64_tr_b16 a[240:241], v22 offset:32896
v_mfma_f32_16x16x32_bf16 v[188:191], a[248:251], a[172:175], v[188:191]
ds_read_b64_tr_b16 a[242:243], v22 offset:34944
v_mfma_f32_16x16x32_bf16 v[184:187], a[252:255], a[176:179], v[184:187]
ds_read_b64_tr_b16 a[244:245], v23 offset:24704
v_mfma_f32_16x16x32_bf16 v[188:191], a[252:255], a[180:183], v[188:191]
s_waitcnt lgkmcnt(13)
ds_read_b64_tr_b16 a[246:247], v23 offset:26752
v_mfma_f32_16x16x32_bf16 v[144:147], a[208:211], a[184:187], v[144:147]
ds_read_b64_tr_b16 a[248:249], v23 offset:28800
v_mfma_f32_16x16x32_bf16 v[148:151], a[208:211], a[188:191], v[148:151]
ds_read_b64_tr_b16 a[250:251], v23 offset:30848
v_mfma_f32_16x16x32_bf16 v[144:147], a[212:215], a[192:195], v[144:147]
ds_read_b64_tr_b16 a[252:253], v23 offset:32896
v_mfma_f32_16x16x32_bf16 v[148:151], a[212:215], a[196:199], v[148:151]
ds_read_b64_tr_b16 a[254:255], v23 offset:34944
v_mfma_f32_16x16x32_bf16 v[144:147], a[216:219], a[200:203], v[144:147]
s_barrier
v_mfma_f32_16x16x32_bf16 v[148:151], a[216:219], a[204:207], v[148:151]
s_waitcnt lgkmcnt(12)
ds_read_b64_tr_b16 a[208:209], v20 offset:37056
v_mfma_f32_16x16x32_bf16 v[160:163], a[220:223], a[184:187], v[160:163]
ds_read_b64_tr_b16 a[210:211], v20 offset:39104
v_mfma_f32_16x16x32_bf16 v[164:167], a[220:223], a[188:191], v[164:167]
ds_read_b64_tr_b16 a[212:213], v20 offset:41152
v_cvt_pk_bf16_f32 v224, v144, v145
v_mfma_f32_16x16x32_bf16 v[160:163], a[224:227], a[192:195], v[160:163]
ds_read_b64_tr_b16 a[214:215], v20 offset:43200
v_cvt_pk_bf16_f32 v225, v146, v147
v_mfma_f32_16x16x32_bf16 v[164:167], a[224:227], a[196:199], v[164:167]
ds_read_b64_tr_b16 a[216:217], v20 offset:45248
v_cvt_pk_bf16_f32 v228, v148, v149
v_mfma_f32_16x16x32_bf16 v[160:163], a[228:231], a[200:203], v[160:163]
s_cmp_lg_u32 s3, 1
s_cbranch_scc1 L_st0_7_1
s_mov_b32 s36, 28672
buffer_store_dwordx4 v[208:211], v26, s[24:27], s36 offen offset:0 sc1
buffer_store_dwordx4 v[212:215], v26, s[24:27], s36 offen offset:1024 sc1
buffer_store_dwordx4 v[216:219], v26, s[24:27], s36 offen offset:2048 sc1
buffer_store_dwordx4 v[220:223], v26, s[24:27], s36 offen offset:3072 sc1
L_st0_7_1:
v_mfma_f32_16x16x32_bf16 v[164:167], a[228:231], a[204:207], v[164:167]
s_waitcnt lgkmcnt(11)
ds_read_b64_tr_b16 a[218:219], v20 offset:47296
v_cvt_pk_bf16_f32 v229, v150, v151
v_mfma_f32_16x16x32_bf16 v[176:179], a[232:235], a[184:187], v[176:179]
ds_read_b64_tr_b16 a[220:221], v21 offset:37056
v_cvt_pk_bf16_f32 v226, v160, v161
v_mfma_f32_16x16x32_bf16 v[180:183], a[232:235], a[188:191], v[180:183]
ds_read_b64_tr_b16 a[222:223], v21 offset:39104
v_cvt_pk_bf16_f32 v227, v162, v163
v_mfma_f32_16x16x32_bf16 v[176:179], a[236:239], a[192:195], v[176:179]
ds_read_b64_tr_b16 a[224:225], v21 offset:41152
v_cvt_pk_bf16_f32 v230, v164, v165
v_mfma_f32_16x16x32_bf16 v[180:183], a[236:239], a[196:199], v[180:183]
ds_read_b64_tr_b16 a[226:227], v21 offset:43200
v_cvt_pk_bf16_f32 v231, v166, v167
v_mfma_f32_16x16x32_bf16 v[176:179], a[240:243], a[200:203], v[176:179]
ds_read_b64_tr_b16 a[228:229], v21 offset:45248
v_mfma_f32_16x16x32_bf16 v[180:183], a[240:243], a[204:207], v[180:183]
s_waitcnt lgkmcnt(11)
ds_read_b64_tr_b16 a[230:231], v21 offset:47296
v_mfma_f32_16x16x32_bf16 v[184:187], a[244:247], a[184:187], v[184:187]
ds_read_b64_tr_b16 a[232:233], v22 offset:37056
v_mfma_f32_16x16x32_bf16 v[188:191], a[244:247], a[188:191], v[188:191]
ds_read_b64_tr_b16 a[234:235], v22 offset:39104
v_cvt_pk_bf16_f32 v232, v176, v177
v_mfma_f32_16x16x32_bf16 v[184:187], a[248:251], a[192:195], v[184:187]
ds_read_b64_tr_b16 a[236:237], v22 offset:41152
v_cvt_pk_bf16_f32 v233, v178, v179
v_mfma_f32_16x16x32_bf16 v[188:191], a[248:251], a[196:199], v[188:191]
ds_read_b64_tr_b16 a[238:239], v22 offset:43200
v_cvt_pk_bf16_f32 v236, v180, v181
v_mfma_f32_16x16x32_bf16 v[184:187], a[252:255], a[200:203], v[184:187]
ds_read_b64_tr_b16 a[240:241], v22 offset:45248
v_cvt_pk_bf16_f32 v237, v182, v183
v_mfma_f32_16x16x32_bf16 v[188:191], a[252:255], a[204:207], v[188:191]
ds_read_b64_tr_b16 a[242:243], v22 offset:47296
v_mfma_f32_16x16x32_bf16 v[144:147], v[244:247], a[144:147], 0
ds_read_b64_tr_b16 a[244:245], v23 offset:37056
v_mfma_f32_16x16x32_bf16 v[148:151], v[244:247], a[148:151], 0
s_waitcnt lgkmcnt(13)
ds_read_b64_tr_b16 a[246:247], v23 offset:39104
v_cvt_pk_bf16_f32 v234, v184, v185
v_mfma_f32_16x16x32_bf16 v[144:147], a[208:211], a[160:163], v[144:147]
ds_read_b64_tr_b16 a[248:249], v23 offset:41152
v_cvt_pk_bf16_f32 v235, v186, v187
v_mfma_f32_16x16x32_bf16 v[148:151], a[208:211], a[164:167], v[148:151]
ds_read_b64_tr_b16 a[250:251], v23 offset:43200
v_cvt_pk_bf16_f32 v238, v188, v189
v_mfma_f32_16x16x32_bf16 v[144:147], a[212:215], a[168:171], v[144:147]
s_cmp_lg_u32 s3, 2
s_cbranch_scc1 L_st0_7_2
s_mov_b32 s36, 28672
buffer_store_dwordx4 v[208:211], v26, s[24:27], s36 offen offset:0 sc1
buffer_store_dwordx4 v[212:215], v26, s[24:27], s36 offen offset:1024 sc1
buffer_store_dwordx4 v[216:219], v26, s[24:27], s36 offen offset:2048 sc1
buffer_store_dwordx4 v[220:223], v26, s[24:27], s36 offen offset:3072 sc1
L_st0_7_2:
v_mfma_f32_16x16x32_bf16 v[148:151], a[212:215], a[172:175], v[148:151]
ds_read_b64_tr_b16 a[252:253], v23 offset:45248
v_cvt_pk_bf16_f32 v239, v190, v191
v_mfma_f32_16x16x32_bf16 v[144:147], a[216:219], a[176:179], v[144:147]
ds_read_b64_tr_b16 a[254:255], v23 offset:47296
v_mfma_f32_16x16x32_bf16 v[148:151], a[216:219], a[180:183], v[148:151]
s_barrier
v_mfma_f32_16x16x32_bf16 v[160:163], v[248:251], a[144:147], 0
ds_read_b64_tr_b16 a[208:209], v20 offset:49408
v_mfma_f32_16x16x32_bf16 v[164:167], v[248:251], a[148:151], 0
s_waitcnt lgkmcnt(13)
ds_read_b64_tr_b16 a[210:211], v20 offset:51456
v_mfma_f32_16x16x32_bf16 v[160:163], a[220:223], a[160:163], v[160:163]
ds_read_b64_tr_b16 a[212:213], v20 offset:53504
v_mfma_f32_16x16x32_bf16 v[164:167], a[220:223], a[164:167], v[164:167]
ds_read_b64_tr_b16 a[214:215], v20 offset:55552
v_mfma_f32_16x16x32_bf16 v[160:163], a[224:227], a[168:171], v[160:163]
ds_read_b64_tr_b16 a[216:217], v20 offset:57600
v_mfma_f32_16x16x32_bf16 v[164:167], a[224:227], a[172:175], v[164:167]
ds_read_b64_tr_b16 a[218:219], v20 offset:59648
v_mfma_f32_16x16x32_bf16 v[160:163], a[228:231], a[176:179], v[160:163]
ds_read_b64_tr_b16 a[220:221], v21 offset:49408
v_mfma_f32_16x16x32_bf16 v[164:167], a[228:231], a[180:183], v[164:167]
ds_read_b64_tr_b16 a[222:223], v21 offset:51456
v_mfma_f32_16x16x32_bf16 v[176:179], v[244:247], a[152:155], 0
v_mfma_f32_16x16x32_bf16 v[180:183], v[244:247], a[156:159], 0
s_waitcnt lgkmcnt(14)
v_mfma_f32_16x16x32_bf16 v[176:179], a[232:235], a[160:163], v[176:179]
ds_read_b64_tr_b16 a[224:225], v21 offset:53504
v_mfma_f32_16x16x32_bf16 v[180:183], a[232:235], a[164:167], v[180:183]
ds_read_b64_tr_b16 a[226:227], v21 offset:55552
v_mfma_f32_16x16x32_bf16 v[176:179], a[236:239], a[168:171], v[176:179]
ds_read_b64_tr_b16 a[228:229], v21 offset:57600
v_mfma_f32_16x16x32_bf16 v[180:183], a[236:239], a[172:175], v[180:183]
ds_read_b64_tr_b16 a[230:231], v21 offset:59648
v_mfma_f32_16x16x32_bf16 v[176:179], a[240:243], a[176:179], v[176:179]
ds_read_b64_tr_b16 a[232:233], v22 offset:49408
v_mfma_f32_16x16x32_bf16 v[180:183], a[240:243], a[180:183], v[180:183]
ds_read_b64_tr_b16 a[234:235], v22 offset:51456
v_mfma_f32_16x16x32_bf16 v[184:187], v[248:251], a[152:155], 0
s_cmp_lg_u32 s3, 0
s_cbranch_scc1 L_st0_8_0
s_mov_b32 s36, 32768
buffer_store_dwordx4 v[224:227], v26, s[24:27], s36 offen offset:0 sc1
buffer_store_dwordx4 v[228:231], v26, s[24:27], s36 offen offset:1024 sc1
buffer_store_dwordx4 v[232:235], v26, s[24:27], s36 offen offset:2048 sc1
buffer_store_dwordx4 v[236:239], v26, s[24:27], s36 offen offset:3072 sc1
L_st0_8_0:
v_mfma_f32_16x16x32_bf16 v[188:191], v[248:251], a[156:159], 0
s_waitcnt lgkmcnt(14)
v_mfma_f32_16x16x32_bf16 v[184:187], a[244:247], a[160:163], v[184:187]
ds_read_b64_tr_b16 a[236:237], v22 offset:53504
v_mfma_f32_16x16x32_bf16 v[188:191], a[244:247], a[164:167], v[188:191]
ds_read_b64_tr_b16 a[238:239], v22 offset:55552
v_mfma_f32_16x16x32_bf16 v[184:187], a[248:251], a[168:171], v[184:187]
ds_read_b64_tr_b16 a[240:241], v22 offset:57600
v_mfma_f32_16x16x32_bf16 v[188:191], a[248:251], a[172:175], v[188:191]
ds_read_b64_tr_b16 a[242:243], v22 offset:59648
v_mfma_f32_16x16x32_bf16 v[184:187], a[252:255], a[176:179], v[184:187]
ds_read_b64_tr_b16 a[244:245], v23 offset:49408
v_mfma_f32_16x16x32_bf16 v[188:191], a[252:255], a[180:183], v[188:191]
s_waitcnt lgkmcnt(13)
ds_read_b64_tr_b16 a[246:247], v23 offset:51456
v_mfma_f32_16x16x32_bf16 v[144:147], a[208:211], a[184:187], v[144:147]
ds_read_b64_tr_b16 a[248:249], v23 offset:53504
v_mfma_f32_16x16x32_bf16 v[148:151], a[208:211], a[188:191], v[148:151]
ds_read_b64_tr_b16 a[250:251], v23 offset:55552
v_mfma_f32_16x16x32_bf16 v[144:147], a[212:215], a[192:195], v[144:147]
ds_read_b64_tr_b16 a[252:253], v23 offset:57600
v_mfma_f32_16x16x32_bf16 v[148:151], a[212:215], a[196:199], v[148:151]
ds_read_b64_tr_b16 a[254:255], v23 offset:59648
v_mfma_f32_16x16x32_bf16 v[144:147], a[216:219], a[200:203], v[144:147]
v_mfma_f32_16x16x32_bf16 v[148:151], a[216:219], a[204:207], v[148:151]
s_waitcnt lgkmcnt(12)
v_mfma_f32_16x16x32_bf16 v[160:163], a[220:223], a[184:187], v[160:163]
v_mfma_f32_16x16x32_bf16 v[164:167], a[220:223], a[188:191], v[164:167]
v_mfma_f32_16x16x32_bf16 v[160:163], a[224:227], a[192:195], v[160:163]
v_mfma_f32_16x16x32_bf16 v[164:167], a[224:227], a[196:199], v[164:167]
v_mfma_f32_16x16x32_bf16 v[160:163], a[228:231], a[200:203], v[160:163]
s_cmp_lg_u32 s3, 1
s_cbranch_scc1 L_st0_8_1
s_mov_b32 s36, 32768
buffer_store_dwordx4 v[224:227], v26, s[24:27], s36 offen offset:0 sc1
buffer_store_dwordx4 v[228:231], v26, s[24:27], s36 offen offset:1024 sc1
buffer_store_dwordx4 v[232:235], v26, s[24:27], s36 offen offset:2048 sc1
buffer_store_dwordx4 v[236:239], v26, s[24:27], s36 offen offset:3072 sc1
L_st0_8_1:
v_mfma_f32_16x16x32_bf16 v[164:167], a[228:231], a[204:207], v[164:167]
s_waitcnt lgkmcnt(6)
v_cvt_pk_bf16_f32 v192, v144, v145
v_cvt_pk_bf16_f32 v193, v146, v147
v_mfma_f32_16x16x32_bf16 v[176:179], a[232:235], a[184:187], v[176:179]
v_cvt_pk_bf16_f32 v196, v148, v149
v_cvt_pk_bf16_f32 v197, v150, v151
v_mfma_f32_16x16x32_bf16 v[180:183], a[232:235], a[188:191], v[180:183]
v_cvt_pk_bf16_f32 v194, v160, v161
v_cvt_pk_bf16_f32 v195, v162, v163
v_mfma_f32_16x16x32_bf16 v[176:179], a[236:239], a[192:195], v[176:179]
v_cvt_pk_bf16_f32 v198, v164, v165
v_cvt_pk_bf16_f32 v199, v166, v167
v_mfma_f32_16x16x32_bf16 v[180:183], a[236:239], a[196:199], v[180:183]
v_mfma_f32_16x16x32_bf16 v[176:179], a[240:243], a[200:203], v[176:179]
v_mfma_f32_16x16x32_bf16 v[180:183], a[240:243], a[204:207], v[180:183]
s_waitcnt lgkmcnt(0)
v_mfma_f32_16x16x32_bf16 v[184:187], a[244:247], a[184:187], v[184:187]
s_cmp_lg_u32 s3, 2
s_cbranch_scc1 L_st0_8_2
s_mov_b32 s36, 32768
buffer_store_dwordx4 v[224:227], v26, s[24:27], s36 offen offset:0 sc1
buffer_store_dwordx4 v[228:231], v26, s[24:27], s36 offen offset:1024 sc1
buffer_store_dwordx4 v[232:235], v26, s[24:27], s36 offen offset:2048 sc1
buffer_store_dwordx4 v[236:239], v26, s[24:27], s36 offen offset:3072 sc1
L_st0_8_2:
v_mfma_f32_16x16x32_bf16 v[188:191], a[244:247], a[188:191], v[188:191]
v_mfma_f32_16x16x32_bf16 v[184:187], a[248:251], a[192:195], v[184:187]
v_mfma_f32_16x16x32_bf16 v[188:191], a[248:251], a[196:199], v[188:191]
v_cvt_pk_bf16_f32 v200, v176, v177
v_cvt_pk_bf16_f32 v201, v178, v179
v_mfma_f32_16x16x32_bf16 v[184:187], a[252:255], a[200:203], v[184:187]
v_cvt_pk_bf16_f32 v204, v180, v181
v_cvt_pk_bf16_f32 v205, v182, v183
v_mfma_f32_16x16x32_bf16 v[188:191], a[252:255], a[204:207], v[188:191]
s_nop 4
v_cvt_pk_bf16_f32 v202, v184, v185
v_cvt_pk_bf16_f32 v203, v186, v187
s_nop 0
v_cvt_pk_bf16_f32 v206, v188, v189
v_cvt_pk_bf16_f32 v207, v190, v191
s_mov_b32 s36, 36864
buffer_store_dwordx4 v[192:195], v26, s[24:27], s36 offen offset:0 sc1
buffer_store_dwordx4 v[196:199], v26, s[24:27], s36 offen offset:1024 sc1
buffer_store_dwordx4 v[200:203], v26, s[24:27], s36 offen offset:2048 sc1
buffer_store_dwordx4 v[204:207], v26, s[24:27], s36 offen offset:3072 sc1
L_end0:
s_branch L_fin
L_slow0:
s_nop 7
s_waitcnt vmcnt(0) lgkmcnt(0)
v_mbcnt_lo_u32_b32 v185, -1, 0
v_mbcnt_hi_u32_b32 v185, -1, v185
v_and_b32_e32 v186, 15, v185
v_lshrrev_b32_e32 v187, 4, v185
v_mul_u32_u24_e32 v27, 384, v186
v_lshl_add_u32 v27, v187, 4, v27
v_lshrrev_b32_e32 v29, 1, v185
v_mul_u32_u24_e32 v29, 384, v29
v_and_b32_e32 v184, 1, v185
v_lshl_add_u32 v29, v184, 4, v29
s_lshl_b32 s44, s3, 10
s_add_u32 s44, s44, 74112
v_lshlrev_b32_e32 v184, 4, v185
v_add_u32_e32 v184, s44, v184
v_lshrrev_b32_e32 v31, 2, v186
v_lshl_add_u32 v31, v187, 2, v31
v_lshlrev_b32_e32 v31, 5, v31
v_and_b32_e32 v186, 3, v186
v_lshl_add_u32 v31, v186, 3, v31
v_add_u32_e32 v31, s44, v31
v_mov_b32_e32 v240, 0x3f803f80
v_mov_b32_e32 v241, 0x3f803f80
v_mov_b32_e32 v242, 0x3f803f80
v_mov_b32_e32 v243, 0x3f803f80
s_mul_i32 s45, s28, 196608
v_mov_b32_e32 v28, 0xff800000
v_mov_b32_e32 v30, 0xff800000
s_mov_b32 s46, s45
s_mov_b32 s48, 0
L_sl1_0:
s_add_u32 s47, s46, 0
buffer_load_dwordx4 v[176:179], v27, s[8:11], s47 offen offset:0
s_waitcnt vmcnt(0)
v_mfma_f32_16x16x32_bf16 v[144:147], v[176:179], v[192:195], 0
v_mfma_f32_16x16x32_bf16 v[148:151], v[176:179], v[196:199], 0
s_nop 7
s_add_u32 s47, s46, 0
buffer_load_dwordx4 v[176:179], v27, s[8:11], s47 offen offset:64
s_waitcnt vmcnt(0)
v_mfma_f32_16x16x32_bf16 v[144:147], v[176:179], v[200:203], v[144:147]
v_mfma_f32_16x16x32_bf16 v[148:151], v[176:179], v[204:207], v[148:151]
s_nop 7
s_add_u32 s47, s46, 0
buffer_load_dwordx4 v[176:179], v27, s[8:11], s47 offen offset:128
s_waitcnt vmcnt(0)
v_mfma_f32_16x16x32_bf16 v[144:147], v[176:179], v[208:211], v[144:147]
v_mfma_f32_16x16x32_bf16 v[148:151], v[176:179], v[212:215], v[148:151]
s_nop 7
s_add_u32 s47, s46, 0
buffer_load_dwordx4 v[176:179], v27, s[8:11], s47 offen offset:192
s_waitcnt vmcnt(0)
v_mfma_f32_16x16x32_bf16 v[144:147], v[176:179], v[216:219], v[144:147]
v_mfma_f32_16x16x32_bf16 v[148:151], v[176:179], v[220:223], v[148:151]
s_nop 7
s_add_u32 s47, s46, 0
buffer_load_dwordx4 v[176:179], v27, s[8:11], s47 offen offset:256
s_waitcnt vmcnt(0)
v_mfma_f32_16x16x32_bf16 v[144:147], v[176:179], v[224:227], v[144:147]
v_mfma_f32_16x16x32_bf16 v[148:151], v[176:179], v[228:231], v[148:151]
s_nop 7
s_add_u32 s47, s46, 0
buffer_load_dwordx4 v[176:179], v27, s[8:11], s47 offen offset:320
s_waitcnt vmcnt(0)
v_mfma_f32_16x16x32_bf16 v[144:147], v[176:179], v[232:235], v[144:147]
v_mfma_f32_16x16x32_bf16 v[148:151], v[176:179], v[236:239], v[148:151]
s_nop 7
s_add_u32 s47, s46, 6144
buffer_load_dwordx4 v[176:179], v27, s[8:11], s47 offen offset:0
s_waitcnt vmcnt(0)
v_mfma_f32_16x16x32_bf16 v[152:155], v[176:179], v[192:195], 0
v_mfma_f32_16x16x32_bf16 v[156:159], v[176:179], v[196:199], 0
s_nop 7
s_add_u32 s47, s46, 6144
buffer_load_dwordx4 v[176:179], v27, s[8:11], s47 offen offset:64
s_waitcnt vmcnt(0)
v_mfma_f32_16x16x32_bf16 v[152:155], v[176:179], v[200:203], v[152:155]
v_mfma_f32_16x16x32_bf16 v[156:159], v[176:179], v[204:207], v[156:159]
s_nop 7
s_add_u32 s47, s46, 6144
buffer_load_dwordx4 v[176:179], v27, s[8:11], s47 offen offset:128
s_waitcnt vmcnt(0)
v_mfma_f32_16x16x32_bf16 v[152:155], v[176:179], v[208:211], v[152:155]
v_mfma_f32_16x16x32_bf16 v[156:159], v[176:179], v[212:215], v[156:159]
s_nop 7
s_add_u32 s47, s46, 6144
buffer_load_dwordx4 v[176:179], v27, s[8:11], s47 offen offset:192
s_waitcnt vmcnt(0)
v_mfma_f32_16x16x32_bf16 v[152:155], v[176:179], v[216:219], v[152:155]
v_mfma_f32_16x16x32_bf16 v[156:159], v[176:179], v[220:223], v[156:159]
s_nop 7
s_add_u32 s47, s46, 6144
buffer_load_dwordx4 v[176:179], v27, s[8:11], s47 offen offset:256
s_waitcnt vmcnt(0)
v_mfma_f32_16x16x32_bf16 v[152:155], v[176:179], v[224:227], v[152:155]
v_mfma_f32_16x16x32_bf16 v[156:159], v[176:179], v[228:231], v[156:159]
s_nop 7
s_add_u32 s47, s46, 6144
buffer_load_dwordx4 v[176:179], v27, s[8:11], s47 offen offset:320
s_waitcnt vmcnt(0)
v_mfma_f32_16x16x32_bf16 v[152:155], v[176:179], v[232:235], v[152:155]
v_mfma_f32_16x16x32_bf16 v[156:159], v[176:179], v[236:239], v[156:159]
s_nop 7
s_nop 7
v_max3_f32 v28, v28, v144, v145
v_max3_f32 v28, v28, v146, v147
v_max3_f32 v28, v28, v152, v153
v_max3_f32 v28, v28, v154, v155
v_max3_f32 v30, v30, v148, v149
v_max3_f32 v30, v30, v150, v151
v_max3_f32 v30, v30, v156, v157
v_max3_f32 v30, v30, v158, v159
s_add_u32 s46, s46, 12288
s_add_u32 s48, s48, 1
s_cmp_lt_u32 s48, 16
s_cbranch_scc1 L_sl1_0
v_mov_b32_e32 v186, v28
s_nop 1
v_permlane32_swap_b32 v28, v186
s_nop 1
v_max_f32_e32 v28, v28, v186
v_mov_b32_e32 v186, v30
s_nop 1
v_permlane32_swap_b32 v30, v186
s_nop 1
v_max_f32_e32 v30, v30, v186
v_mov_b32_e32 v186, v28
s_nop 1
v_permlane16_swap_b32 v28, v186
s_nop 1
v_max_f32_e32 v28, v28, v186
v_mov_b32_e32 v186, v30
s_nop 1
v_permlane16_swap_b32 v30, v186
s_nop 1
v_max_f32_e32 v30, v30, v186
v_sub_f32_e32 v136, 0, v28
v_mov_b32_e32 v128, 0
v_sub_f32_e32 v137, 0, v28
v_mov_b32_e32 v129, 0
v_sub_f32_e32 v138, 0, v28
v_mov_b32_e32 v130, 0
v_sub_f32_e32 v139, 0, v28
v_mov_b32_e32 v131, 0
v_mov_b32_e32 v32, 0
v_mov_b32_e32 v33, 0
v_mov_b32_e32 v34, 0
v_mov_b32_e32 v35, 0
v_mov_b32_e32 v40, 0
v_mov_b32_e32 v41, 0
v_mov_b32_e32 v42, 0
v_mov_b32_e32 v43, 0
v_mov_b32_e32 v48, 0
v_mov_b32_e32 v49, 0
v_mov_b32_e32 v50, 0
v_mov_b32_e32 v51, 0
v_mov_b32_e32 v56, 0
v_mov_b32_e32 v57, 0
v_mov_b32_e32 v58, 0
v_mov_b32_e32 v59, 0
v_mov_b32_e32 v64, 0
v_mov_b32_e32 v65, 0
v_mov_b32_e32 v66, 0
v_mov_b32_e32 v67, 0
v_mov_b32_e32 v72, 0
v_mov_b32_e32 v73, 0
v_mov_b32_e32 v74, 0
v_mov_b32_e32 v75, 0
v_mov_b32_e32 v80, 0
v_mov_b32_e32 v81, 0
v_mov_b32_e32 v82, 0
v_mov_b32_e32 v83, 0
v_mov_b32_e32 v88, 0
v_mov_b32_e32 v89, 0
v_mov_b32_e32 v90, 0
v_mov_b32_e32 v91, 0
v_mov_b32_e32 v96, 0
v_mov_b32_e32 v97, 0
v_mov_b32_e32 v98, 0
v_mov_b32_e32 v99, 0
v_mov_b32_e32 v104, 0
v_mov_b32_e32 v105, 0
v_mov_b32_e32 v106, 0
v_mov_b32_e32 v107, 0
v_mov_b32_e32 v112, 0
v_mov_b32_e32 v113, 0
v_mov_b32_e32 v114, 0
v_mov_b32_e32 v115, 0
v_mov_b32_e32 v120, 0
v_mov_b32_e32 v121, 0
v_mov_b32_e32 v122, 0
v_mov_b32_e32 v123, 0
v_sub_f32_e32 v140, 0, v30
v_mov_b32_e32 v132, 0
v_sub_f32_e32 v141, 0, v30
v_mov_b32_e32 v133, 0
v_sub_f32_e32 v142, 0, v30
v_mov_b32_e32 v134, 0
v_sub_f32_e32 v143, 0, v30
v_mov_b32_e32 v135, 0
v_mov_b32_e32 v36, 0
v_mov_b32_e32 v37, 0
v_mov_b32_e32 v38, 0
v_mov_b32_e32 v39, 0
v_mov_b32_e32 v44, 0
v_mov_b32_e32 v45, 0
v_mov_b32_e32 v46, 0
v_mov_b32_e32 v47, 0
v_mov_b32_e32 v52, 0
v_mov_b32_e32 v53, 0
v_mov_b32_e32 v54, 0
v_mov_b32_e32 v55, 0
v_mov_b32_e32 v60, 0
v_mov_b32_e32 v61, 0
v_mov_b32_e32 v62, 0
v_mov_b32_e32 v63, 0
v_mov_b32_e32 v68, 0
v_mov_b32_e32 v69, 0
v_mov_b32_e32 v70, 0
v_mov_b32_e32 v71, 0
v_mov_b32_e32 v76, 0
v_mov_b32_e32 v77, 0
v_mov_b32_e32 v78, 0
v_mov_b32_e32 v79, 0
v_mov_b32_e32 v84, 0
v_mov_b32_e32 v85, 0
v_mov_b32_e32 v86, 0
v_mov_b32_e32 v87, 0
v_mov_b32_e32 v92, 0
v_mov_b32_e32 v93, 0
v_mov_b32_e32 v94, 0
v_mov_b32_e32 v95, 0
v_mov_b32_e32 v100, 0
v_mov_b32_e32 v101, 0
v_mov_b32_e32 v102, 0
v_mov_b32_e32 v103, 0
v_mov_b32_e32 v108, 0
v_mov_b32_e32 v109, 0
v_mov_b32_e32 v110, 0
v_mov_b32_e32 v111, 0
v_mov_b32_e32 v116, 0
v_mov_b32_e32 v117, 0
v_mov_b32_e32 v118, 0
v_mov_b32_e32 v119, 0
v_mov_b32_e32 v124, 0
v_mov_b32_e32 v125, 0
v_mov_b32_e32 v126, 0
v_mov_b32_e32 v127, 0
s_nop 1
s_mov_b32 s46, s45
s_mov_b32 s48, 0
L_sl2_0:
s_add_u32 s47, s46, 0
buffer_load_dwordx4 v[176:179], v27, s[8:11], s47 offen offset:0
s_waitcnt vmcnt(0)
v_mfma_f32_16x16x32_bf16 v[144:147], v[176:179], v[192:195], v[136:139]
v_mfma_f32_16x16x32_bf16 v[148:151], v[176:179], v[196:199], v[140:143]
s_nop 7
s_add_u32 s47, s46, 0
buffer_load_dwordx4 v[176:179], v27, s[8:11], s47 offen offset:64
s_waitcnt vmcnt(0)
v_mfma_f32_16x16x32_bf16 v[144:147], v[176:179], v[200:203], v[144:147]
v_mfma_f32_16x16x32_bf16 v[148:151], v[176:179], v[204:207], v[148:151]
s_nop 7
s_add_u32 s47, s46, 0
buffer_load_dwordx4 v[176:179], v27, s[8:11], s47 offen offset:128
s_waitcnt vmcnt(0)
v_mfma_f32_16x16x32_bf16 v[144:147], v[176:179], v[208:211], v[144:147]
v_mfma_f32_16x16x32_bf16 v[148:151], v[176:179], v[212:215], v[148:151]
s_nop 7
s_add_u32 s47, s46, 0
buffer_load_dwordx4 v[176:179], v27, s[8:11], s47 offen offset:192
s_waitcnt vmcnt(0)
v_mfma_f32_16x16x32_bf16 v[144:147], v[176:179], v[216:219], v[144:147]
v_mfma_f32_16x16x32_bf16 v[148:151], v[176:179], v[220:223], v[148:151]
s_nop 7
s_add_u32 s47, s46, 0
buffer_load_dwordx4 v[176:179], v27, s[8:11], s47 offen offset:256
s_waitcnt vmcnt(0)
v_mfma_f32_16x16x32_bf16 v[144:147], v[176:179], v[224:227], v[144:147]
v_mfma_f32_16x16x32_bf16 v[148:151], v[176:179], v[228:231], v[148:151]
s_nop 7
s_add_u32 s47, s46, 0
buffer_load_dwordx4 v[176:179], v27, s[8:11], s47 offen offset:320
s_waitcnt vmcnt(0)
v_mfma_f32_16x16x32_bf16 v[144:147], v[176:179], v[232:235], v[144:147]
v_mfma_f32_16x16x32_bf16 v[148:151], v[176:179], v[236:239], v[148:151]
s_nop 7
s_add_u32 s47, s46, 6144
buffer_load_dwordx4 v[176:179], v27, s[8:11], s47 offen offset:0
s_waitcnt vmcnt(0)
v_mfma_f32_16x16x32_bf16 v[152:155], v[176:179], v[192:195], v[136:139]
v_mfma_f32_16x16x32_bf16 v[156:159], v[176:179], v[196:199], v[140:143]
s_nop 7
s_add_u32 s47, s46, 6144
buffer_load_dwordx4 v[176:179], v27, s[8:11], s47 offen offset:64
s_waitcnt vmcnt(0)
v_mfma_f32_16x16x32_bf16 v[152:155], v[176:179], v[200:203], v[152:155]
v_mfma_f32_16x16x32_bf16 v[156:159], v[176:179], v[204:207], v[156:159]
s_nop 7
s_add_u32 s47, s46, 6144
buffer_load_dwordx4 v[176:179], v27, s[8:11], s47 offen offset:128
s_waitcnt vmcnt(0)
v_mfma_f32_16x16x32_bf16 v[152:155], v[176:179], v[208:211], v[152:155]
v_mfma_f32_16x16x32_bf16 v[156:159], v[176:179], v[212:215], v[156:159]
s_nop 7
s_add_u32 s47, s46, 6144
buffer_load_dwordx4 v[176:179], v27, s[8:11], s47 offen offset:192
s_waitcnt vmcnt(0)
v_mfma_f32_16x16x32_bf16 v[152:155], v[176:179], v[216:219], v[152:155]
v_mfma_f32_16x16x32_bf16 v[156:159], v[176:179], v[220:223], v[156:159]
s_nop 7
s_add_u32 s47, s46, 6144
buffer_load_dwordx4 v[176:179], v27, s[8:11], s47 offen offset:256
s_waitcnt vmcnt(0)
v_mfma_f32_16x16x32_bf16 v[152:155], v[176:179], v[224:227], v[152:155]
v_mfma_f32_16x16x32_bf16 v[156:159], v[176:179], v[228:231], v[156:159]
s_nop 7
s_add_u32 s47, s46, 6144
buffer_load_dwordx4 v[176:179], v27, s[8:11], s47 offen offset:320
s_waitcnt vmcnt(0)
v_mfma_f32_16x16x32_bf16 v[152:155], v[176:179], v[232:235], v[152:155]
v_mfma_f32_16x16x32_bf16 v[156:159], v[176:179], v[236:239], v[156:159]
s_nop 7
s_nop 7
v_exp_f32_e32 v144, v144
v_exp_f32_e32 v145, v145
v_exp_f32_e32 v146, v146
v_exp_f32_e32 v147, v147
v_exp_f32_e32 v148, v148
v_exp_f32_e32 v149, v149
v_exp_f32_e32 v150, v150
v_exp_f32_e32 v151, v151
v_exp_f32_e32 v152, v152
v_exp_f32_e32 v153, v153
v_exp_f32_e32 v154, v154
v_exp_f32_e32 v155, v155
v_exp_f32_e32 v156, v156
v_exp_f32_e32 v157, v157
v_exp_f32_e32 v158, v158
v_exp_f32_e32 v159, v159
s_nop 1
v_cvt_pk_bf16_f32 v160, v144, v145
v_cvt_pk_bf16_f32 v161, v146, v147
v_cvt_pk_bf16_f32 v164, v148, v149
v_cvt_pk_bf16_f32 v165, v150, v151
v_cvt_pk_bf16_f32 v162, v152, v153
v_cvt_pk_bf16_f32 v163, v154, v155
v_cvt_pk_bf16_f32 v166, v156, v157
v_cvt_pk_bf16_f32 v167, v158, v159
s_nop 1
v_mfma_f32_16x16x32_bf16 v[128:131], v[240:243], v[160:163], v[128:131]
v_mfma_f32_16x16x32_bf16 v[132:135], v[240:243], v[164:167], v[132:135]
buffer_load_dwordx4 v[180:183], v29, s[12:15], s46 offen offset:0
s_waitcnt vmcnt(0)
ds_write_b128 v184, v[180:183]
s_waitcnt lgkmcnt(0)
ds_read_b64_tr_b16 v[176:177], v31
ds_read_b64_tr_b16 v[178:179], v31 offset:512
s_waitcnt lgkmcnt(0)
v_mfma_f32_16x16x32_bf16 v[32:35], v[176:179], v[160:163], v[32:35]
v_mfma_f32_16x16x32_bf16 v[36:39], v[176:179], v[164:167], v[36:39]
s_nop 7
buffer_load_dwordx4 v[180:183], v29, s[12:15], s46 offen offset:32
s_waitcnt vmcnt(0)
ds_write_b128 v184, v[180:183]
s_waitcnt lgkmcnt(0)
ds_read_b64_tr_b16 v[176:177], v31
ds_read_b64_tr_b16 v[178:179], v31 offset:512
s_waitcnt lgkmcnt(0)
v_mfma_f32_16x16x32_bf16 v[40:43], v[176:179], v[160:163], v[40:43]
v_mfma_f32_16x16x32_bf16 v[44:47], v[176:179], v[164:167], v[44:47]
s_nop 7
buffer_load_dwordx4 v[180:183], v29, s[12:15], s46 offen offset:64
s_waitcnt vmcnt(0)
ds_write_b128 v184, v[180:183]
s_waitcnt lgkmcnt(0)
ds_read_b64_tr_b16 v[176:177], v31
ds_read_b64_tr_b16 v[178:179], v31 offset:512
s_waitcnt lgkmcnt(0)
v_mfma_f32_16x16x32_bf16 v[48:51], v[176:179], v[160:163], v[48:51]
v_mfma_f32_16x16x32_bf16 v[52:55], v[176:179], v[164:167], v[52:55]
s_nop 7
buffer_load_dwordx4 v[180:183], v29, s[12:15], s46 offen offset:96
s_waitcnt vmcnt(0)
ds_write_b128 v184, v[180:183]
s_waitcnt lgkmcnt(0)
ds_read_b64_tr_b16 v[176:177], v31
ds_read_b64_tr_b16 v[178:179], v31 offset:512
s_waitcnt lgkmcnt(0)
v_mfma_f32_16x16x32_bf16 v[56:59], v[176:179], v[160:163], v[56:59]
v_mfma_f32_16x16x32_bf16 v[60:63], v[176:179], v[164:167], v[60:63]
s_nop 7
buffer_load_dwordx4 v[180:183], v29, s[12:15], s46 offen offset:128
s_waitcnt vmcnt(0)
ds_write_b128 v184, v[180:183]
s_waitcnt lgkmcnt(0)
ds_read_b64_tr_b16 v[176:177], v31
ds_read_b64_tr_b16 v[178:179], v31 offset:512
s_waitcnt lgkmcnt(0)
v_mfma_f32_16x16x32_bf16 v[64:67], v[176:179], v[160:163], v[64:67]
v_mfma_f32_16x16x32_bf16 v[68:71], v[176:179], v[164:167], v[68:71]
s_nop 7
buffer_load_dwordx4 v[180:183], v29, s[12:15], s46 offen offset:160
s_waitcnt vmcnt(0)
ds_write_b128 v184, v[180:183]
s_waitcnt lgkmcnt(0)
ds_read_b64_tr_b16 v[176:177], v31
ds_read_b64_tr_b16 v[178:179], v31 offset:512
s_waitcnt lgkmcnt(0)
v_mfma_f32_16x16x32_bf16 v[72:75], v[176:179], v[160:163], v[72:75]
v_mfma_f32_16x16x32_bf16 v[76:79], v[176:179], v[164:167], v[76:79]
s_nop 7
buffer_load_dwordx4 v[180:183], v29, s[12:15], s46 offen offset:192
s_waitcnt vmcnt(0)
ds_write_b128 v184, v[180:183]
s_waitcnt lgkmcnt(0)
ds_read_b64_tr_b16 v[176:177], v31
ds_read_b64_tr_b16 v[178:179], v31 offset:512
s_waitcnt lgkmcnt(0)
v_mfma_f32_16x16x32_bf16 v[80:83], v[176:179], v[160:163], v[80:83]
v_mfma_f32_16x16x32_bf16 v[84:87], v[176:179], v[164:167], v[84:87]
s_nop 7
buffer_load_dwordx4 v[180:183], v29, s[12:15], s46 offen offset:224
s_waitcnt vmcnt(0)
ds_write_b128 v184, v[180:183]
s_waitcnt lgkmcnt(0)
ds_read_b64_tr_b16 v[176:177], v31
ds_read_b64_tr_b16 v[178:179], v31 offset:512
s_waitcnt lgkmcnt(0)
v_mfma_f32_16x16x32_bf16 v[88:91], v[176:179], v[160:163], v[88:91]
v_mfma_f32_16x16x32_bf16 v[92:95], v[176:179], v[164:167], v[92:95]
s_nop 7
buffer_load_dwordx4 v[180:183], v29, s[12:15], s46 offen offset:256
s_waitcnt vmcnt(0)
ds_write_b128 v184, v[180:183]
s_waitcnt lgkmcnt(0)
ds_read_b64_tr_b16 v[176:177], v31
ds_read_b64_tr_b16 v[178:179], v31 offset:512
s_waitcnt lgkmcnt(0)
v_mfma_f32_16x16x32_bf16 v[96:99], v[176:179], v[160:163], v[96:99]
v_mfma_f32_16x16x32_bf16 v[100:103], v[176:179], v[164:167], v[100:103]
s_nop 7
buffer_load_dwordx4 v[180:183], v29, s[12:15], s46 offen offset:288
s_waitcnt vmcnt(0)
ds_write_b128 v184, v[180:183]
s_waitcnt lgkmcnt(0)
ds_read_b64_tr_b16 v[176:177], v31
ds_read_b64_tr_b16 v[178:179], v31 offset:512
s_waitcnt lgkmcnt(0)
v_mfma_f32_16x16x32_bf16 v[104:107], v[176:179], v[160:163], v[104:107]
v_mfma_f32_16x16x32_bf16 v[108:111], v[176:179], v[164:167], v[108:111]
s_nop 7
buffer_load_dwordx4 v[180:183], v29, s[12:15], s46 offen offset:320
s_waitcnt vmcnt(0)
ds_write_b128 v184, v[180:183]
s_waitcnt lgkmcnt(0)
ds_read_b64_tr_b16 v[176:177], v31
ds_read_b64_tr_b16 v[178:179], v31 offset:512
s_waitcnt lgkmcnt(0)
v_mfma_f32_16x16x32_bf16 v[112:115], v[176:179], v[160:163], v[112:115]
v_mfma_f32_16x16x32_bf16 v[116:119], v[176:179], v[164:167], v[116:119]
s_nop 7
buffer_load_dwordx4 v[180:183], v29, s[12:15], s46 offen offset:352
s_waitcnt vmcnt(0)
ds_write_b128 v184, v[180:183]
s_waitcnt lgkmcnt(0)
ds_read_b64_tr_b16 v[176:177], v31
ds_read_b64_tr_b16 v[178:179], v31 offset:512
s_waitcnt lgkmcnt(0)
v_mfma_f32_16x16x32_bf16 v[120:123], v[176:179], v[160:163], v[120:123]
v_mfma_f32_16x16x32_bf16 v[124:127], v[176:179], v[164:167], v[124:127]
s_nop 7
s_add_u32 s46, s46, 12288
s_add_u32 s48, s48, 1
s_cmp_lt_u32 s48, 16
s_cbranch_scc1 L_sl2_0
s_nop 7
v_rcp_f32_e32 v28, v128
s_nop 0
v_mul_f32_e32 v32, v28, v32
v_mul_f32_e32 v33, v28, v33
v_mul_f32_e32 v34, v28, v34
v_mul_f32_e32 v35, v28, v35
v_mul_f32_e32 v40, v28, v40
v_mul_f32_e32 v41, v28, v41
v_mul_f32_e32 v42, v28, v42
v_mul_f32_e32 v43, v28, v43
v_mul_f32_e32 v48, v28, v48
v_mul_f32_e32 v49, v28, v49
v_mul_f32_e32 v50, v28, v50
v_mul_f32_e32 v51, v28, v51
v_rcp_f32_e32 v30, v132
s_nop 0
v_mul_f32_e32 v36, v30, v36
v_mul_f32_e32 v37, v30, v37
v_mul_f32_e32 v38, v30, v38
v_mul_f32_e32 v39, v30, v39
v_mul_f32_e32 v44, v30, v44
v_mul_f32_e32 v45, v30, v45
v_mul_f32_e32 v46, v30, v46
v_mul_f32_e32 v47, v30, v47
v_mul_f32_e32 v52, v30, v52
v_mul_f32_e32 v53, v30, v53
v_mul_f32_e32 v54, v30, v54
v_mul_f32_e32 v55, v30, v55
s_branch L_back0
L_codeend:
s_endpgm
.section .rodata,"a"
.p2align 6
.amdhsa_kernel concat_heads__mha_block_cached__gqa_block_cached__near_ridge_kernel
  .amdhsa_next_free_vgpr 512
  .amdhsa_next_free_sgpr 102
  .amdhsa_accum_offset 256
  .amdhsa_group_segment_fixed_size 0
  .amdhsa_kernarg_size 104
  .amdhsa_user_sgpr_count 2
  .amdhsa_user_sgpr_kernarg_segment_ptr 1
  .amdhsa_system_sgpr_workgroup_id_x 1
  .amdhsa_float_denorm_mode_32 3
.end_amdhsa_kernel
```
